```python
import torch

def _softmax(x, axis=-1):
    return torch.softmax(x, dim=axis)

def _gelu(x):
    return torch.nn.functional.gelu(x, approximate='tanh')

def _silu(x):
    return torch.nn.functional.silu(x)

def _sigmoid(x):
    return torch.sigmoid(x)

def _layernorm(x, axis=-1, eps=1e-05):
    m = x.mean(dim=axis, keepdim=True)
    v = x.var(dim=axis, keepdim=True, unbiased=False)
    return (x - m) / torch.sqrt(v + eps)

def _scatter_add(tgt, idx, src, axis=0):
    return tgt.clone().index_add_(axis, idx, src)

def _segment_sum(src, seg, n):
    out = torch.zeros((n,) + src.shape[1:], dtype=src.dtype)
    return out.index_add_(0, seg, src)

def _pad(x, pw):
    flat = tuple((v for pair in reversed(pw) for v in pair))
    return torch.nn.functional.pad(x, flat)
kernel_name = 'parallel_sum__compressed_kv_cla__mixer_gmlp__prompt'

def setup_inputs():

    _w = lambda a: (lambda t: t.to(torch.bfloat16) if t.is_floating_point() else t)(torch.as_tensor(a))

    def _A_setup():
        B, H, Sq, Sk, D, M = (1, 32, 2048, 2048, 128, 512)
        Dc = 4 * D
        return {'x': _w((lambda *s: torch.randn(*s, dtype=torch.bfloat16) * 0.05)(B, Sq, M)), 'c_kv': _w((lambda *s: torch.randn(*s, dtype=torch.bfloat16) * 1.6)(B, Sk, Dc)), 'w_q': _w((lambda *s: torch.randn(*s, dtype=torch.bfloat16) * 1.6)(M, H, D) * M ** (-0.5)), 'w_uk': _w((lambda *s: torch.randn(*s, dtype=torch.bfloat16) * 1.6)(Dc, H, D) * Dc ** (-0.5)), 'w_uv': _w((lambda *s: torch.randn(*s, dtype=torch.bfloat16) * 1.6)(Dc, H, D) * Dc ** (-0.5)), 'w_o': _w((lambda *s: torch.randn(*s, dtype=torch.bfloat16) * 1.6)(H, D, M) * (H * D) ** (-0.5))}
    _A_in = _A_setup()

    def _B_setup():
        B, S, D, F = (1, 2048, 512, 1792)
        Fh = F // 2
        return {'x': _w((lambda *s: torch.randn(*s, dtype=torch.bfloat16) * 0.05)(B, S, D)), 'w_in': _w((lambda *s: torch.randn(*s, dtype=torch.bfloat16) * 0.4)(D, 2 * Fh)), 'w_sp': _w(0.01 * (lambda *s: torch.randn(*s, dtype=torch.bfloat16) * 0.4)(S, S)), 'b_sp': _w(1.0 + 0.01 * (lambda *s: torch.randn(*s, dtype=torch.bfloat16) * 0.05)(S)), 'w_out': _w((lambda *s: torch.randn(*s, dtype=torch.bfloat16) * 0.05)(Fh, D))}
    _B_in = _B_setup()
    return {'A_x': _A_in['x'], 'A_c_kv': _A_in['c_kv'], 'A_w_q': _A_in['w_q'], 'A_w_uk': _A_in['w_uk'], 'A_w_uv': _A_in['w_uv'], 'A_w_o': _A_in['w_o'], 'B_x': _B_in['x'], 'B_w_in': _B_in['w_in'], 'B_w_sp': _B_in['w_sp'], 'B_b_sp': _B_in['b_sp'], 'B_w_out': _B_in['w_out']}

def reference(A_x, A_c_kv, A_w_q, A_w_uk, A_w_uv, A_w_o, B_x, B_w_in, B_w_sp, B_b_sp, B_w_out):

    def _A_ref(x, c_kv, w_q, w_uk, w_uv, w_o):
        B, Sq, M = (x.shape[0], x.shape[1], x.shape[2])
        Sk = c_kv.shape[1]
        H, D = (w_q.shape[1], w_q.shape[2])
        q = torch.einsum('bqm,mhd->bhqd', x, w_q)
        k = torch.einsum('bkc,chd->bhkd', c_kv, w_uk)
        v = torch.einsum('bkc,chd->bhkd', c_kv, w_uv)
        scores = torch.einsum('bhqd,bhkd->bhqk', q, k) * D ** (-0.5)
        off = Sk - Sq
        qi = torch.arange(Sq)[:, None]
        kj = torch.arange(Sk)[None, :]
        cmask = kj <= qi + off
        scores = torch.where(cmask[None, None], scores, -1000000000.0)
        p = _softmax(scores, axis=-1)
        ctx = torch.einsum('bhqk,bhkd->bhqd', p, v)
        return torch.einsum('bhqd,hdm->bqm', ctx, w_o)

    def _B_ref(x, w_in, w_sp, b_sp, w_out):
        B, S, D = x.shape
        F = w_in.shape[-1]
        Fh = F // 2
        z = _gelu(torch.einsum('bsd,df->bsf', x, w_in))
        z1 = z[..., :Fh].clone()
        z2 = _layernorm(z[..., Fh:], axis=-1)
        g = torch.einsum('ts,bsf->btf', w_sp, z2) + b_sp[None, :, None]
        return torch.einsum('bsf,fd->bsd', z1 * g, w_out)
    x = A_x
    xn = _layernorm(x, axis=-1)
    return x + _A_ref(xn, A_c_kv, A_w_q, A_w_uk, A_w_uv, A_w_o) + _B_ref(xn, B_w_in, B_w_sp, B_b_sp, B_w_out)
```

```asm
; @launch grid=(256,1,1) block=(512,1,1) lds=163840
.amdgcn_target "amdgcn-amd-amdhsa--gfx950"

.macro M d,a,b
v_mfma_f32_16x16x32_bf16 v[\d:\d+3],v[\a:\a+3],v[\b:\b+3],v[\d:\d+3]
.endm
.macro MZ d,a,b
v_mfma_f32_16x16x32_bf16 v[\d:\d+3],v[\a:\a+3],v[\b:\b+3],0
.endm
.macro MC d,a,b,c
v_mfma_f32_16x16x32_bf16 v[\d:\d+3],v[\a:\a+3],v[\b:\b+3],v[\c:\c+3]
.endm
.macro TR d,a,o
ds_read_b64_tr_b16 v[\d:\d+1],v\a offset:\o
.endm
.macro DR d,a,o
ds_read_b128 v[\d:\d+3],v\a offset:\o
.endm
.macro DW a,d,o
ds_write_b128 v\a,v[\d:\d+3] offset:\o
.endm
.macro PK d,a,b
v_cvt_pk_bf16_f32 v\d,v\a,v\b
.endm
.text
.globl parallel_sum__compressed_kv_cla__mixer_gmlp__prompt_kernel
.p2align 8
.type parallel_sum__compressed_kv_cla__mixer_gmlp__prompt_kernel,@function
parallel_sum__compressed_kv_cla__mixer_gmlp__prompt_kernel:
s_cmp_ge_u32 s2, 256
s_cbranch_scc1 L_k1_end
s_load_dwordx4 s[4:7], s[0:1], 0
s_load_dwordx4 s[8:11], s[0:1], 16
s_load_dwordx2 s[12:13], s[0:1], 32
s_load_dwordx2 s[14:15], s[0:1], 56
s_load_dwordx2 s[18:19], s[0:1], 96
s_load_dwordx2 s[16:17], s[0:1], 104
v_lshrrev_b32 v1, 6, v0
s_lshr_b32 s49, s2, 3
s_and_b32 s41, s2, 1
v_readfirstlane_b32 s40, v1
s_lshl_b32 s41, s41, 2
s_and_b32 s50, s49, 3
s_add_u32 s41, s41, s50
s_and_b32 s3, s2, 6
s_lshl_b32 s3, s3, 2
s_lshr_b32 s49, s49, 2
s_add_u32 s3, s3, s49
s_and_b32 s50, s2, 1
s_or_b32 s51, s49, 1
s_sub_u32 s50, s51, s50
s_bfe_u32 s51, s2, 0x30003
s_cmp_ge_u32 s49, 6
s_cselect_b32 s49, s50, s49
s_cselect_b32 s41, s51, s41
s_bitcmp1_b32 s2, 1
s_mov_b32 s44, 419561728
s_mov_b32 s45, 169477123
s_cmov_b32 s44, 453839883
s_cmov_b32 s45, 354160398
s_mov_b32 s46, 119342597
s_mov_b32 s47, 386473480
s_cmov_b32 s46, 304025872
s_cmov_b32 s47, 403968790
s_bitcmp1_b32 s2, 2
s_cselect_b64 s[44:45], s[46:47], s[44:45]
s_lshl_b32 s49, s49, 3
s_lshr_b64 s[44:45], s[44:45], s49
s_and_b32 s3, s44, 31
s_cmp_lt_u32 s3, 11
s_cbranch_scc1 L_k1_K
s_cmp_lt_u32 s3, 22
s_cbranch_scc1 L_k1_V
s_cmp_lt_u32 s3, 25
s_cbranch_scc1 L_k1_Z1
s_branch L_k1_Z2
L_k1_end:
s_endpgm
L_k1_K:
s_getpc_b64 s[36:37]
L_pc_1:
v_lshlrev_b32 v26, 7, v0
v_min_u32 v26, L_k1_K_end-L_pc_1-4, v26
v_mov_b32 v27, s37
v_add_co_u32 v26, vcc, s36, v26
s_nop 1
v_addc_co_u32 v27, vcc, 0, v27, vcc
global_load_dword v14, v[26:27], off
v_bfe_u32 v28, v0, 5, 1
v_bfe_u32 v29, v0, 2, 2
v_lshl_add_u32 v28, v28, 2, v29
v_mul_u32_u24 v28, 8192, v28
v_bfe_u32 v29, v0, 4, 1
v_lshl_add_u32 v28, v29, 6, v28
v_and_b32 v29, 3, v0
v_xor_b32 v30, 2, v29
v_lshlrev_b32 v29, 4, v29
v_lshlrev_b32 v30, 4, v30
v_add_u32 v31, 0, v28
v_add_u32 v1, v31, v29
v_add_u32 v31, 64512, v28
v_add_u32 v2, v31, v30
v_add_u32 v31, 129024, v28
v_add_u32 v3, v31, v29
v_add_u32 v31, 193536, v28
v_add_u32 v4, v31, v30
s_waitcnt lgkmcnt(0)
s_add_u32 s100, s16, 79691776
s_addc_u32 s101, s17, 0
s_or_b32 s49, s2, s40
s_cbranch_scc1 L_nonce_2
s_memrealtime s[50:51]
v_mov_b32 v24, 20
s_waitcnt lgkmcnt(0)
s_or_b32 s49, s50, 1
v_mov_b32 v25, s49
s_mov_b64 exec, 1
global_store_dword v24, v25, s[18:19] sc1
s_mov_b64 exec, -1
L_nonce_2:
s_sub_u32 s42, s3, 0
v_and_b32 v28, 63, v0
v_lshlrev_b32 v7, 4, v28
s_mov_b32 s24, s6
s_mov_b32 s25, s7
s_mov_b32 s26, 2097152
s_mov_b32 s27, 0x20000
s_mov_b32 s20, s10
s_mov_b32 s21, s11
s_mov_b32 s22, 4194304
s_mov_b32 s23, 0x20000
s_mul_i32 s58, s42, 6
s_lshl_b32 s44, s58, 7
s_cmp_lt_u32 s42, 10
s_cselect_b32 s45, 6, 4
s_mov_b32 s63, 0
s_lshl_b32 s63, s63, 1
s_cmp_ge_u32 s63, s45
s_cselect_b32 s49, s45, 0
s_sub_u32 s63, s63, s49
s_lshl_b32 s46, s40, 12
s_bfe_u32 s60, s2, 0x20005
s_bfe_u32 s49, s2, 0x20003
s_add_u32 s60, s60, s49
s_and_b32 s60, s60, 3
s_lshl_b32 s49, s60, 2
s_add_u32 s49, s49, s40
s_and_b32 s50, s49, 15
s_mul_i32 s56, s50, 262144
s_xor_b32 s50, s50, 8
s_mul_i32 s61, s50, 262144
s_and_b32 s57, s40, 3
s_mul_i32 s57, s57, 262144
s_lshr_b32 s49, s40, 2
s_lshl_b32 s49, s49, 7
s_add_u32 s57, s57, s49
s_lshl_b32 s49, s63, 7
s_add_u32 s57, s57, s49
s_add_u32 s57, s57, s44
s_add_u32 s47, s60, 0
s_and_b32 s47, s47, 3
s_mul_i32 s47, s47, 1048576
s_add_u32 s47, s47, s57
s_add_u32 m0, s46, 0
s_nop 0
buffer_load_dwordx4 v1, s[20:23], s47 offen offset:0  lds
s_add_u32 m0, s46, 0
s_nop 0
buffer_load_dwordx4 v2, s[20:23], s47 offen offset:1024  lds
s_add_u32 m0, s46, 0
s_nop 0
buffer_load_dwordx4 v3, s[20:23], s47 offen offset:2048  lds
s_add_u32 m0, s46, 0
s_nop 0
buffer_load_dwordx4 v4, s[20:23], s47 offen offset:3072  lds
v_bfe_u32 v28, v0, 3, 3
v_and_b32 v29, 7, v0
v_lshrrev_b32 v30, 1, v28
v_xor_b32 v29, v29, v30
s_lshl_b32 s49, s41, 8
s_lshl_b32 s50, s40, 5
s_add_u32 s49, s49, s50
v_add_u32 v28, s49, v28
v_lshlrev_b32 v28, 10, v28
v_xor_b32 v30, 4, v29
v_lshl_add_u32 v29, v29, 4, v28
v_lshl_add_u32 v30, v30, 4, v28
v_add_u32 v20, 0, v29
v_add_u32 v21, 7168, v30
v_add_u32 v22, 14336, v29
v_add_u32 v23, 21504, v30
s_add_u32 s43, s60, 0
s_and_b32 s43, s43, 3
s_lshl_b32 s43, s43, 8
s_add_u32 m0, s46, 98304
s_nop 0
buffer_load_dwordx4 v20, s[24:27], s43 offen offset:0 lds
s_add_u32 m0, s46, 98304
s_nop 0
buffer_load_dwordx4 v21, s[24:27], s43 offen offset:1024 lds
s_add_u32 m0, s46, 98304
s_nop 0
buffer_load_dwordx4 v22, s[24:27], s43 offen offset:2048 lds
s_add_u32 m0, s46, 98304
s_nop 0
buffer_load_dwordx4 v23, s[24:27], s43 offen offset:3072 lds
s_barrier
s_add_u32 s43, s60, 0
s_and_b32 s43, s43, 3
s_lshl_b32 s43, s43, 8
s_add_u32 s43, s43, 128
s_add_u32 m0, s46, 131072
s_nop 0
buffer_load_dwordx4 v20, s[24:27], s43 offen offset:0 lds
s_add_u32 m0, s46, 131072
s_nop 0
buffer_load_dwordx4 v21, s[24:27], s43 offen offset:1024 lds
s_add_u32 m0, s46, 131072
s_nop 0
buffer_load_dwordx4 v22, s[24:27], s43 offen offset:2048 lds
s_add_u32 m0, s46, 131072
s_nop 0
buffer_load_dwordx4 v23, s[24:27], s43 offen offset:3072 lds
s_add_u32 s47, s60, 1
s_and_b32 s47, s47, 3
s_mul_i32 s47, s47, 1048576
s_add_u32 s47, s47, s57
s_add_u32 m0, s46, 32768
s_nop 0
buffer_load_dwordx4 v1, s[20:23], s47 offen offset:0  lds
s_add_u32 m0, s46, 32768
s_nop 0
buffer_load_dwordx4 v2, s[20:23], s47 offen offset:1024  lds
s_add_u32 m0, s46, 32768
s_nop 0
buffer_load_dwordx4 v3, s[20:23], s47 offen offset:2048  lds
s_add_u32 m0, s46, 32768
s_nop 0
buffer_load_dwordx4 v4, s[20:23], s47 offen offset:3072  lds
v_and_b32 v28, 15, v0
v_bfe_u32 v29, v0, 4, 2
v_lshrrev_b32 v30, 1, v28
v_xor_b32 v29, v29, v30
v_lshlrev_b32 v29, 4, v29
v_lshl_add_u32 v29, v28, 7, v29
s_add_u32 s49, s46, 0x10000
v_add_u32 v9, s49, v29
v_xor_b32 v10, 64, v9
v_add_u32 v11, 0x10000, v9
v_add_u32 v12, 0x10000, v10
s_add_u32 s28, s16, 2097152
s_addc_u32 s29, s17, 0
s_mov_b32 s30, 16777216
s_mov_b32 s31, 0x20000
v_bfe_u32 v28, v0, 4, 2
v_lshlrev_b32 v29, 10, v28
v_bfe_u32 v30, v0, 2, 2
v_lshl_add_u32 v29, v30, 6, v29
v_and_b32 v30, 3, v0
v_lshl_add_u32 v29, v30, 3, v29
v_and_b32 v28, 1, v28
v_lshl_add_u32 v5, v28, 5, v29
v_xor_b32 v6, 32, v5
s_waitcnt vmcnt(8)
DR 128,9,32768
DR 132,9,34816
DR 136,10,32768
DR 140,10,34816
s_waitcnt vmcnt(4)
DR 144,11,0
DR 148,11,2048
DR 152,12,0
DR 156,12,2048
s_barrier
TR 32,5,0
TR 34,5,512
TR 36,5,4096
TR 38,5,4608
TR 40,5,8192
TR 42,5,8704
TR 44,5,12288
TR 46,5,12800
TR 48,6,0
TR 50,6,512
TR 52,6,4096
TR 54,6,4608
TR 56,6,8192
TR 58,6,8704
TR 60,6,12288
TR 62,6,12800
s_waitcnt lgkmcnt(15)
s_add_u32 s43, s60, 1
s_and_b32 s43, s43, 3
s_lshl_b32 s43, s43, 8
s_add_u32 m0, s46, 98304
s_nop 0
buffer_load_dwordx4 v20, s[24:27], s43 offen offset:0 lds
s_waitcnt lgkmcnt(14)
MZ 64,32,128
s_waitcnt lgkmcnt(12)
M 64,36,136
s_add_u32 m0, s46, 98304
s_nop 0
buffer_load_dwordx4 v21, s[24:27], s43 offen offset:1024 lds
s_waitcnt lgkmcnt(10)
M 64,40,144
s_waitcnt lgkmcnt(8)
M 64,44,152
s_add_u32 m0, s46, 98304
s_nop 0
buffer_load_dwordx4 v22, s[24:27], s43 offen offset:2048 lds
MZ 68,32,132
M 68,36,140
TR 32,5,256
s_add_u32 m0, s46, 98304
s_nop 0
buffer_load_dwordx4 v23, s[24:27], s43 offen offset:3072 lds
M 68,40,148
TR 34,5,768
M 68,44,156
TR 36,5,4352
s_add_u32 s43, s60, 1
s_and_b32 s43, s43, 3
s_lshl_b32 s43, s43, 8
s_add_u32 s43, s43, 128
s_add_u32 m0, s46, 131072
s_nop 0
buffer_load_dwordx4 v20, s[24:27], s43 offen offset:0 lds
s_waitcnt lgkmcnt(9)
MZ 72,48,128
TR 38,5,4864
s_waitcnt lgkmcnt(8)
M 72,52,136
TR 40,5,8448
s_add_u32 m0, s46, 131072
s_nop 0
buffer_load_dwordx4 v21, s[24:27], s43 offen offset:1024 lds
s_waitcnt lgkmcnt(7)
M 72,56,144
TR 42,5,8960
s_waitcnt lgkmcnt(6)
M 72,60,152
TR 44,5,12544
s_add_u32 m0, s46, 131072
s_nop 0
buffer_load_dwordx4 v22, s[24:27], s43 offen offset:2048 lds
MZ 76,48,132
TR 46,5,13056
M 76,52,140
TR 48,6,256
s_add_u32 m0, s46, 131072
s_nop 0
buffer_load_dwordx4 v23, s[24:27], s43 offen offset:3072 lds
M 76,56,148
TR 50,6,768
M 76,60,156
TR 52,6,4352
s_add_u32 s47, s60, 2
s_and_b32 s47, s47, 3
s_mul_i32 s47, s47, 1048576
s_add_u32 s47, s47, s57
s_add_u32 m0, s46, 65536
s_nop 0
buffer_load_dwordx4 v1, s[20:23], s47 offen offset:0  lds
s_waitcnt lgkmcnt(9)
MZ 80,32,128
TR 54,6,4864
s_waitcnt lgkmcnt(8)
M 80,36,136
TR 56,6,8448
s_add_u32 m0, s46, 65536
s_nop 0
buffer_load_dwordx4 v2, s[20:23], s47 offen offset:1024  lds
s_waitcnt lgkmcnt(7)
M 80,40,144
TR 58,6,8960
s_waitcnt lgkmcnt(6)
M 80,44,152
TR 60,6,12544
s_add_u32 m0, s46, 65536
s_nop 0
buffer_load_dwordx4 v3, s[20:23], s47 offen offset:2048  lds
MZ 84,32,132
TR 62,6,13056
M 84,36,140
TR 32,5,16384
s_add_u32 m0, s46, 65536
s_nop 0
buffer_load_dwordx4 v4, s[20:23], s47 offen offset:3072  lds
M 84,40,148
TR 34,5,16896
M 84,44,156
TR 36,5,20480
s_waitcnt lgkmcnt(9)
MZ 88,48,128
TR 38,5,20992
s_waitcnt lgkmcnt(8)
M 88,52,136
TR 40,5,24576
s_waitcnt lgkmcnt(7)
M 88,56,144
TR 42,5,25088
s_waitcnt lgkmcnt(6)
M 88,60,152
TR 44,5,28672
MZ 92,48,132
TR 46,5,29184
M 92,52,140
TR 48,6,16384
M 92,56,148
TR 50,6,16896
M 92,60,156
TR 52,6,20480
s_waitcnt lgkmcnt(9)
MZ 96,32,128
TR 54,6,20992
s_waitcnt lgkmcnt(8)
M 96,36,136
TR 56,6,24576
s_waitcnt lgkmcnt(7)
M 96,40,144
TR 58,6,25088
s_waitcnt lgkmcnt(6)
M 96,44,152
TR 60,6,28672
MZ 100,32,132
TR 62,6,29184
M 100,36,140
TR 32,5,16640
M 100,40,148
TR 34,5,17152
M 100,44,156
TR 36,5,20736
s_waitcnt vmcnt(8)
DR 160,9,32768
DR 164,9,34816
DR 168,10,32768
DR 172,10,34816
s_waitcnt lgkmcnt(13)
MZ 104,48,128
TR 38,5,21248
s_waitcnt lgkmcnt(12)
M 104,52,136
TR 40,5,24832
s_waitcnt lgkmcnt(11)
M 104,56,144
TR 42,5,25344
s_waitcnt lgkmcnt(10)
M 104,60,152
TR 44,5,28928
MZ 108,48,132
TR 46,5,29440
M 108,52,140
TR 48,6,16640
M 108,56,148
TR 50,6,17152
M 108,60,156
TR 52,6,20736
s_waitcnt lgkmcnt(8)
s_add_u32 s43, s60, 2
s_and_b32 s43, s43, 3
s_lshl_b32 s43, s43, 8
s_add_u32 m0, s46, 98304
s_nop 0
buffer_load_dwordx4 v20, s[24:27], s43 offen offset:0 lds
MZ 112,32,128
TR 54,6,21248
s_waitcnt lgkmcnt(8)
M 112,36,136
TR 56,6,24832
s_add_u32 m0, s46, 98304
s_nop 0
buffer_load_dwordx4 v21, s[24:27], s43 offen offset:1024 lds
s_waitcnt lgkmcnt(7)
M 112,40,144
TR 58,6,25344
s_waitcnt lgkmcnt(6)
M 112,44,152
TR 60,6,28928
s_add_u32 m0, s46, 98304
s_nop 0
buffer_load_dwordx4 v22, s[24:27], s43 offen offset:2048 lds
MZ 116,32,132
TR 62,6,29440
M 116,36,140
s_barrier
TR 32,5,32768
s_add_u32 m0, s46, 98304
s_nop 0
buffer_load_dwordx4 v23, s[24:27], s43 offen offset:3072 lds
M 116,40,148
TR 34,5,33280
M 116,44,156
TR 36,5,36864
s_waitcnt vmcnt(8)
DR 176,11,0
DR 180,11,2048
DR 184,12,0
DR 188,12,2048
s_waitcnt lgkmcnt(13)
MZ 120,48,128
TR 38,5,37376
s_waitcnt lgkmcnt(12)
M 120,52,136
TR 40,5,40960
s_waitcnt lgkmcnt(11)
M 120,56,144
TR 42,5,41472
s_waitcnt lgkmcnt(10)
M 120,60,152
TR 44,5,45056
MZ 124,48,132
TR 46,5,45568
M 124,52,140
TR 48,6,32768
M 124,56,148
TR 50,6,33280
M 124,60,156
TR 52,6,36864
s_waitcnt lgkmcnt(8)
s_add_u32 s43, s60, 2
s_and_b32 s43, s43, 3
s_lshl_b32 s43, s43, 8
s_add_u32 s43, s43, 128
s_add_u32 m0, s46, 131072
s_nop 0
buffer_load_dwordx4 v20, s[24:27], s43 offen offset:0 lds
M 64,32,160
TR 54,6,37376
s_waitcnt lgkmcnt(8)
M 64,36,168
TR 56,6,40960
s_add_u32 m0, s46, 131072
s_nop 0
buffer_load_dwordx4 v21, s[24:27], s43 offen offset:1024 lds
s_waitcnt lgkmcnt(7)
M 64,40,176
TR 58,6,41472
s_waitcnt lgkmcnt(6)
M 64,44,184
TR 60,6,45056
s_add_u32 m0, s46, 131072
s_nop 0
buffer_load_dwordx4 v22, s[24:27], s43 offen offset:2048 lds
M 68,32,164
TR 62,6,45568
M 68,36,172
TR 32,5,33024
s_add_u32 m0, s46, 131072
s_nop 0
buffer_load_dwordx4 v23, s[24:27], s43 offen offset:3072 lds
M 68,40,180
TR 34,5,33536
M 68,44,188
TR 36,5,37120
s_waitcnt lgkmcnt(9)
M 72,48,160
TR 38,5,37632
s_waitcnt lgkmcnt(8)
M 72,52,168
TR 40,5,41216
s_waitcnt lgkmcnt(7)
M 72,56,176
TR 42,5,41728
s_waitcnt lgkmcnt(6)
M 72,60,184
TR 44,5,45312
M 76,48,164
TR 46,5,45824
M 76,52,172
TR 48,6,33024
M 76,56,180
TR 50,6,33536
M 76,60,188
TR 52,6,37120
s_waitcnt lgkmcnt(9)
M 80,32,160
TR 54,6,37632
s_waitcnt lgkmcnt(8)
M 80,36,168
TR 56,6,41216
s_waitcnt lgkmcnt(7)
M 80,40,176
TR 58,6,41728
s_waitcnt lgkmcnt(6)
M 80,44,184
TR 60,6,45312
s_waitcnt vmcnt(4)
DR 192,9,32768
DR 196,9,34816
DR 200,10,32768
DR 204,10,34816
M 84,32,164
TR 62,6,45824
M 84,36,172
TR 32,5,49152
M 84,40,180
TR 34,5,49664
M 84,44,188
TR 36,5,53248
s_waitcnt lgkmcnt(13)
M 88,48,160
TR 38,5,53760
s_waitcnt lgkmcnt(12)
M 88,52,168
TR 40,5,57344
s_waitcnt lgkmcnt(11)
M 88,56,176
TR 42,5,57856
s_waitcnt lgkmcnt(6)
M 88,60,184
TR 44,5,61440
s_add_u32 s47, s60, 3
s_and_b32 s47, s47, 3
s_mul_i32 s47, s47, 1048576
s_add_u32 s47, s47, s57
s_add_u32 m0, s46, 98304
s_nop 0
buffer_load_dwordx4 v1, s[20:23], s47 offen offset:0  lds
M 92,48,164
TR 46,5,61952
M 92,52,172
TR 48,6,49152
s_add_u32 m0, s46, 98304
s_nop 0
buffer_load_dwordx4 v2, s[20:23], s47 offen offset:1024  lds
M 92,56,180
TR 50,6,49664
M 92,60,188
TR 52,6,53248
s_add_u32 m0, s46, 98304
s_nop 0
buffer_load_dwordx4 v3, s[20:23], s47 offen offset:2048  lds
s_waitcnt lgkmcnt(9)
M 96,32,160
TR 54,6,53760
s_waitcnt lgkmcnt(8)
M 96,36,168
TR 56,6,57344
s_add_u32 m0, s46, 98304
s_nop 0
buffer_load_dwordx4 v4, s[20:23], s47 offen offset:3072  lds
s_waitcnt lgkmcnt(7)
M 96,40,176
TR 58,6,57856
s_waitcnt lgkmcnt(6)
M 96,44,184
TR 60,6,61440
s_waitcnt vmcnt(4)
DR 208,11,0
DR 212,11,2048
DR 216,12,0
DR 220,12,2048
M 100,32,164
TR 62,6,61952
M 100,36,172
TR 32,5,49408
M 100,40,180
TR 34,5,49920
M 100,44,188
TR 36,5,53504
s_waitcnt lgkmcnt(13)
M 104,48,160
TR 38,5,54016
s_waitcnt lgkmcnt(12)
M 104,52,168
TR 40,5,57600
s_waitcnt lgkmcnt(11)
M 104,56,176
TR 42,5,58112
s_waitcnt lgkmcnt(6)
M 104,60,184
TR 44,5,61696
s_add_u32 s43, s60, 3
s_and_b32 s43, s43, 3
s_lshl_b32 s43, s43, 8
s_add_u32 m0, s46, 131072
s_nop 0
buffer_load_dwordx4 v20, s[24:27], s43 offen offset:0 lds
M 108,48,164
TR 46,5,62208
M 108,52,172
TR 48,6,49408
s_add_u32 m0, s46, 131072
s_nop 0
buffer_load_dwordx4 v21, s[24:27], s43 offen offset:1024 lds
M 108,56,180
TR 50,6,49920
M 108,60,188
TR 52,6,53504
s_add_u32 m0, s46, 131072
s_nop 0
buffer_load_dwordx4 v22, s[24:27], s43 offen offset:2048 lds
s_waitcnt lgkmcnt(9)
M 112,32,160
TR 54,6,54016
s_waitcnt lgkmcnt(8)
M 112,36,168
TR 56,6,57600
s_add_u32 m0, s46, 131072
s_nop 0
buffer_load_dwordx4 v23, s[24:27], s43 offen offset:3072 lds
s_waitcnt lgkmcnt(7)
M 112,40,176
TR 58,6,58112
s_waitcnt lgkmcnt(6)
M 112,44,184
TR 60,6,61696
M 116,32,164
TR 62,6,62208
M 116,36,172
s_barrier
v_xor_b32 v5, 0x10000, v5
v_xor_b32 v6, 0x10000, v6
TR 32,5,0
M 116,40,180
TR 34,5,512
M 116,44,188
TR 36,5,4096
s_waitcnt lgkmcnt(9)
M 120,48,160
s_add_u32 s51, s63, 2
s_cmp_ge_u32 s51, s45
s_cselect_b32 s62, s45, 0
s_sub_u32 s51, s51, s62
s_lshl_b32 s51, s51, 7
s_add_u32 s51, s51, s44
s_add_u32 s51, s51, s56
s_add_u32 m0, s46, 0
s_nop 0
buffer_load_dwordx4 v1, s[20:23], s51 offen offset:0  lds
TR 38,5,4608
s_waitcnt lgkmcnt(8)
M 120,52,168
TR 40,5,8192
s_waitcnt lgkmcnt(7)
M 120,56,176
TR 42,5,8704
s_waitcnt lgkmcnt(6)
M 120,60,184
TR 44,5,12288
M 124,48,164
TR 46,5,12800
M 124,52,172
TR 48,6,0
M 124,56,180
TR 50,6,512
M 124,60,188
TR 52,6,4096
s_waitcnt lgkmcnt(9)
M 64,32,192
TR 54,6,4608
s_waitcnt lgkmcnt(8)
M 64,36,200
TR 56,6,8192
s_waitcnt lgkmcnt(7)
M 64,40,208
TR 58,6,8704
s_waitcnt lgkmcnt(6)
M 64,44,216
TR 60,6,12288
M 68,32,196
s_add_u32 m0, s46, 0
s_nop 0
buffer_load_dwordx4 v2, s[20:23], s51 offen offset:1024  lds
TR 62,6,12800
M 68,36,204
TR 32,5,256
M 68,40,212
TR 34,5,768
M 68,44,220
TR 36,5,4352
s_waitcnt lgkmcnt(9)
M 72,48,192
TR 38,5,4864
s_waitcnt lgkmcnt(8)
M 72,52,200
TR 40,5,8448
s_waitcnt lgkmcnt(7)
M 72,56,208
TR 42,5,8960
s_waitcnt lgkmcnt(6)
M 72,60,216
TR 44,5,12544
s_waitcnt vmcnt(2)
DR 224,11,0
DR 228,11,2048
DR 232,12,0
DR 236,12,2048
M 76,48,196
TR 46,5,13056
M 76,52,204
TR 48,6,256
M 76,56,212
TR 50,6,768
M 76,60,220
TR 52,6,4352
s_waitcnt lgkmcnt(13)
M 80,32,192
s_add_u32 m0, s46, 0
s_nop 0
buffer_load_dwordx4 v3, s[20:23], s51 offen offset:2048  lds
TR 54,6,4864
s_waitcnt lgkmcnt(12)
M 80,36,200
TR 56,6,8448
s_waitcnt lgkmcnt(11)
M 80,40,208
TR 58,6,8960
s_waitcnt lgkmcnt(6)
M 80,44,216
TR 60,6,12544
s_add_u32 s43, s60, 3
s_and_b32 s43, s43, 3
s_lshl_b32 s43, s43, 8
s_add_u32 s43, s43, 128
s_add_u32 m0, s46, 131072
s_nop 0
buffer_load_dwordx4 v20, s[24:27], s43 offen offset:0 lds
M 84,32,196
TR 62,6,13056
M 84,36,204
TR 32,5,16384
s_add_u32 m0, s46, 131072
s_nop 0
buffer_load_dwordx4 v21, s[24:27], s43 offen offset:1024 lds
M 84,40,212
TR 34,5,16896
M 84,44,220
TR 36,5,20480
s_add_u32 m0, s46, 131072
s_nop 0
buffer_load_dwordx4 v22, s[24:27], s43 offen offset:2048 lds
s_waitcnt lgkmcnt(9)
M 88,48,192
TR 38,5,20992
s_waitcnt lgkmcnt(8)
M 88,52,200
TR 40,5,24576
s_add_u32 m0, s46, 131072
s_nop 0
buffer_load_dwordx4 v23, s[24:27], s43 offen offset:3072 lds
s_waitcnt lgkmcnt(7)
M 88,56,208
TR 42,5,25088
s_waitcnt lgkmcnt(6)
M 88,60,216
TR 44,5,28672
M 92,48,196
s_add_u32 m0, s46, 0
s_nop 0
buffer_load_dwordx4 v4, s[20:23], s51 offen offset:3072  lds
TR 46,5,29184
M 92,52,204
TR 48,6,16384
M 92,56,212
TR 50,6,16896
M 92,60,220
TR 52,6,20480
s_waitcnt lgkmcnt(9)
M 96,32,192
TR 54,6,20992
s_waitcnt lgkmcnt(8)
M 96,36,200
TR 56,6,24576
s_waitcnt lgkmcnt(7)
M 96,40,208
TR 58,6,25088
s_waitcnt lgkmcnt(6)
M 96,44,216
TR 60,6,28672
M 100,32,196
TR 62,6,29184
M 100,36,204
TR 32,5,16640
M 100,40,212
TR 34,5,17152
M 100,44,220
TR 36,5,20736
s_waitcnt lgkmcnt(9)
M 104,48,192
TR 38,5,21248
s_waitcnt lgkmcnt(8)
M 104,52,200
TR 40,5,24832
s_waitcnt lgkmcnt(7)
M 104,56,208
TR 42,5,25344
s_waitcnt lgkmcnt(6)
M 104,60,216
TR 44,5,28928
M 108,48,196
TR 46,5,29440
M 108,52,204
TR 48,6,16640
M 108,56,212
TR 50,6,17152
M 108,60,220
TR 52,6,20736
s_waitcnt lgkmcnt(9)
M 112,32,192
TR 54,6,21248
s_waitcnt lgkmcnt(8)
M 112,36,200
TR 56,6,24832
s_waitcnt lgkmcnt(7)
M 112,40,208
TR 58,6,25344
s_waitcnt lgkmcnt(6)
M 112,44,216
TR 60,6,28928
M 116,32,196
TR 62,6,29440
M 116,36,204
s_barrier
TR 32,5,32768
M 116,40,212
TR 34,5,33280
M 116,44,220
TR 36,5,36864
s_waitcnt vmcnt(1)
DR 240,11,0
DR 244,11,2048
DR 248,12,0
DR 252,12,2048
s_waitcnt lgkmcnt(13)
M 120,48,192
s_add_u32 s51, s63, 2
s_cmp_ge_u32 s51, s45
s_cselect_b32 s62, s45, 0
s_sub_u32 s51, s51, s62
s_lshl_b32 s51, s51, 7
s_add_u32 s51, s51, s44
s_add_u32 s51, s51, s61
s_add_u32 m0, s46, 32768
s_nop 0
buffer_load_dwordx4 v1, s[20:23], s51 offen offset:0  lds
TR 38,5,37376
s_waitcnt lgkmcnt(12)
M 120,52,200
TR 40,5,40960
s_waitcnt lgkmcnt(11)
M 120,56,208
TR 42,5,41472
s_waitcnt lgkmcnt(10)
M 120,60,216
TR 44,5,45056
M 124,48,196
TR 46,5,45568
M 124,52,204
TR 48,6,32768
M 124,56,212
TR 50,6,33280
M 124,60,220
TR 52,6,36864
s_waitcnt lgkmcnt(8)
M 64,32,224
TR 54,6,37376
s_waitcnt lgkmcnt(8)
M 64,36,232
TR 56,6,40960
s_mov_b32 s32, s8
s_mov_b32 s33, s9
s_mov_b32 s34, 4194304
s_mov_b32 s35, 0x20000
s_and_b32 s43, s2, 0xf8
s_add_u32 s43, s43, s40
s_lshl_b32 s43, s43, 14
s_and_b32 s47, s2, 6
s_lshl_b32 s47, s47, 8
s_add_u32 s47, s47, s43
v_and_b32 v14, 3, v0
v_lshlrev_b32 v14, 7, v14
v_bfe_u32 v15, v0, 2, 3
v_lshl_add_u32 v14, v15, 11, v14
v_bfe_u32 v15, v0, 5, 1
v_lshl_add_u32 v15, v15, 28, v14
buffer_load_dword v14, v15, s[32:35], s47 offen
s_cmp_lt_u32 s2, 8
s_cbranch_scc0 L_nocode_3
s_getpc_b64 s[36:37]
L_pc_4:
s_add_u32 s36, s36, L_p2-L_pc_4
s_addc_u32 s37, s37, 0
v_lshlrev_b32 v26, 7, v0
v_min_u32 v26, L_all_end-L_p2-4, v26
v_mov_b32 v27, s37
v_add_co_u32 v26, vcc, s36, v26
s_nop 1
v_addc_co_u32 v27, vcc, 0, v27, vcc
global_load_dword v14, v[26:27], off
L_nocode_3:
s_cmp_lt_u32 s2, 192
s_cbranch_scc1 L_nosp_5
s_bitcmp1_b32 s2, 0
s_cbranch_scc1 L_nosp_5
s_load_dwordx2 s[36:37], s[0:1], 64
s_and_b32 s43, s2, 56
s_add_u32 s43, s43, s40
s_lshl_b32 s43, s43, 15
s_and_b32 s47, s2, 7
s_lshl_b32 s47, s47, 20
s_add_u32 s43, s43, s47
v_bfe_u32 v13, v0, 3, 3
v_lshlrev_b32 v13, 12, v13
v_and_b32 v15, 7, v0
v_lshl_add_u32 v13, v15, 7, v13
s_waitcnt lgkmcnt(0)
s_mov_b32 s38, 8388608
s_mov_b32 s39, 0x20000
buffer_load_dword v14, v13, s[36:39], s43 offen offset:0
L_nosp_5:
s_waitcnt lgkmcnt(7)
M 64,40,240
TR 58,6,41472
s_waitcnt lgkmcnt(6)
M 64,44,248
TR 60,6,45056
M 68,32,228
s_add_u32 m0, s46, 32768
s_nop 0
buffer_load_dwordx4 v2, s[20:23], s51 offen offset:1024  lds
TR 62,6,45568
M 68,36,236
TR 32,5,33024
M 68,40,244
TR 34,5,33536
M 68,44,252
TR 36,5,37120
s_waitcnt lgkmcnt(9)
M 72,48,224
TR 38,5,37632
s_waitcnt lgkmcnt(8)
M 72,52,232
TR 40,5,41216
s_waitcnt lgkmcnt(7)
M 72,56,240
TR 42,5,41728
s_waitcnt lgkmcnt(6)
M 72,60,248
TR 44,5,45312
M 76,48,228
TR 46,5,45824
M 76,52,236
TR 48,6,33024
M 76,56,244
TR 50,6,33536
M 76,60,252
TR 52,6,37120
s_waitcnt lgkmcnt(9)
M 80,32,224
s_add_u32 m0, s46, 32768
s_nop 0
buffer_load_dwordx4 v3, s[20:23], s51 offen offset:2048  lds
TR 54,6,37632
s_waitcnt lgkmcnt(8)
M 80,36,232
TR 56,6,41216
s_waitcnt lgkmcnt(7)
M 80,40,240
TR 58,6,41728
s_waitcnt lgkmcnt(6)
M 80,44,248
TR 60,6,45312
M 84,32,228
TR 62,6,45824
M 84,36,236
TR 32,5,49152
M 84,40,244
TR 34,5,49664
M 84,44,252
TR 36,5,53248
s_waitcnt lgkmcnt(9)
M 88,48,224
TR 38,5,53760
s_waitcnt lgkmcnt(8)
M 88,52,232
TR 40,5,57344
s_waitcnt lgkmcnt(7)
M 88,56,240
TR 42,5,57856
s_waitcnt lgkmcnt(6)
M 88,60,248
TR 44,5,61440
M 92,48,228
s_add_u32 m0, s46, 32768
s_nop 0
buffer_load_dwordx4 v4, s[20:23], s51 offen offset:3072  lds
TR 46,5,61952
M 92,52,236
TR 48,6,49152
M 92,56,244
TR 50,6,49664
M 92,60,252
TR 52,6,53248
s_waitcnt lgkmcnt(9)
M 96,32,224
TR 54,6,53760
s_waitcnt lgkmcnt(8)
M 96,36,232
TR 56,6,57344
s_waitcnt lgkmcnt(7)
M 96,40,240
TR 58,6,57856
s_waitcnt lgkmcnt(6)
M 96,44,248
TR 60,6,61440
M 100,32,228
TR 62,6,61952
M 100,36,236
TR 32,5,49408
M 100,40,244
TR 34,5,49920
M 100,44,252
TR 36,5,53504
s_waitcnt lgkmcnt(9)
M 104,48,224
TR 38,5,54016
s_add_u32 s48, s63, 0
s_cmp_ge_u32 s48, s45
s_cselect_b32 s62, s45, 0
s_sub_u32 s48, s48, s62
s_waitcnt lgkmcnt(8)
M 104,52,232
TR 40,5,57600
s_add_u32 s48, s48, s58
s_lshr_b32 s49, s48, 1
s_waitcnt lgkmcnt(7)
M 104,56,240
TR 42,5,58112
s_lshl_b32 s49, s49, 19
s_waitcnt lgkmcnt(6)
M 104,60,248
TR 44,5,61696
s_and_b32 s48, s48, 1
s_lshl_b32 s48, s48, 11
M 108,48,228
TR 46,5,62208
s_add_u32 s48, s48, s49
M 108,52,236
TR 48,6,49408
s_lshl_b32 s49, s41, 16
M 108,56,244
TR 50,6,49920
s_add_u32 s48, s48, s49
M 108,60,252
TR 52,6,53504
s_lshl_b32 s49, s40, 13
s_add_u32 s48, s48, s49
s_waitcnt lgkmcnt(9)
M 112,32,224
TR 54,6,54016
s_add_u32 s50, s48, 4096
s_waitcnt lgkmcnt(8)
M 112,36,232
TR 56,6,57600
PK 16,64,65
s_waitcnt lgkmcnt(7)
M 112,40,240
TR 58,6,58112
PK 17,66,67
s_waitcnt lgkmcnt(6)
M 112,44,248
TR 60,6,61696
PK 18,72,73
PK 19,74,75
M 116,32,228
TR 62,6,62208
PK 20,80,81
M 116,36,236
s_waitcnt vmcnt(5)
s_barrier
v_xor_b32 v5, 0x10000, v5
v_xor_b32 v6, 0x10000, v6
TR 32,5,0
PK 21,82,83
M 116,40,244
TR 34,5,512
PK 22,88,89
M 116,44,252
TR 36,5,4096
PK 23,90,91
PK 24,68,69
s_waitcnt lgkmcnt(9)
M 120,48,224
s_add_u32 s51, s63, 3
s_cmp_ge_u32 s51, s45
s_cselect_b32 s62, s45, 0
s_sub_u32 s51, s51, s62
s_lshl_b32 s51, s51, 7
s_add_u32 s51, s51, s44
s_add_u32 s51, s51, s56
s_add_u32 m0, s46, 65536
s_nop 0
buffer_load_dwordx4 v1, s[20:23], s51 offen offset:0  lds
TR 38,5,4608
PK 25,70,71
s_waitcnt lgkmcnt(8)
M 120,52,232
TR 40,5,8192
PK 26,76,77
s_waitcnt lgkmcnt(7)
M 120,56,240
TR 42,5,8704
PK 27,78,79
s_waitcnt lgkmcnt(6)
M 120,60,248
TR 44,5,12288
PK 28,84,85
PK 29,86,87
M 124,48,228
TR 46,5,12800
PK 30,92,93
M 124,52,236
TR 48,6,0
PK 31,94,95
M 124,56,244
TR 50,6,512
M 124,60,252
TR 52,6,4096
buffer_store_dwordx4 v[16:19], v7, s[28:31], s48 offen offset:0 sc1
s_waitcnt lgkmcnt(9)
MZ 64,32,128
TR 54,6,4608
s_waitcnt lgkmcnt(8)
M 64,36,136
TR 56,6,8192
s_waitcnt lgkmcnt(7)
M 64,40,144
TR 58,6,8704
s_waitcnt lgkmcnt(6)
M 64,44,152
TR 60,6,12288
MZ 68,32,132
s_add_u32 m0, s46, 65536
s_nop 0
buffer_load_dwordx4 v2, s[20:23], s51 offen offset:1024  lds
TR 62,6,12800
M 68,36,140
TR 32,5,256
M 68,40,148
TR 34,5,768
M 68,44,156
TR 36,5,4352
s_waitcnt lgkmcnt(9)
MZ 72,48,128
TR 38,5,4864
s_waitcnt lgkmcnt(8)
M 72,52,136
TR 40,5,8448
s_waitcnt lgkmcnt(7)
M 72,56,144
TR 42,5,8960
s_waitcnt lgkmcnt(6)
M 72,60,152
TR 44,5,12544
MZ 76,48,132
TR 46,5,13056
M 76,52,140
TR 48,6,256
M 76,56,148
TR 50,6,768
M 76,60,156
TR 52,6,4352
s_waitcnt lgkmcnt(9)
MZ 80,32,128
s_add_u32 m0, s46, 65536
s_nop 0
buffer_load_dwordx4 v3, s[20:23], s51 offen offset:2048  lds
TR 54,6,4864
s_waitcnt lgkmcnt(8)
M 80,36,136
TR 56,6,8448
s_waitcnt lgkmcnt(7)
M 80,40,144
TR 58,6,8960
s_waitcnt lgkmcnt(6)
M 80,44,152
TR 60,6,12544
MZ 84,32,132
TR 62,6,13056
M 84,36,140
TR 32,5,16384
buffer_store_dwordx4 v[20:23], v7, s[28:31], s48 offen offset:1024 sc1
M 84,40,148
TR 34,5,16896
M 84,44,156
TR 36,5,20480
s_waitcnt lgkmcnt(9)
MZ 88,48,128
TR 38,5,20992
s_waitcnt lgkmcnt(8)
M 88,52,136
TR 40,5,24576
s_waitcnt lgkmcnt(7)
M 88,56,144
TR 42,5,25088
s_waitcnt lgkmcnt(6)
M 88,60,152
TR 44,5,28672
MZ 92,48,132
s_add_u32 m0, s46, 65536
s_nop 0
buffer_load_dwordx4 v4, s[20:23], s51 offen offset:3072  lds
TR 46,5,29184
M 92,52,140
TR 48,6,16384
M 92,56,148
TR 50,6,16896
M 92,60,156
TR 52,6,20480
s_waitcnt lgkmcnt(9)
M 64,32,160
TR 54,6,20992
s_waitcnt lgkmcnt(8)
M 64,36,168
TR 56,6,24576
s_waitcnt lgkmcnt(7)
M 64,40,176
TR 58,6,25088
s_waitcnt lgkmcnt(6)
M 64,44,184
TR 60,6,28672
M 68,32,164
TR 62,6,29184
M 68,36,172
TR 32,5,16640
M 68,40,180
TR 34,5,17152
M 68,44,188
TR 36,5,20736
s_waitcnt lgkmcnt(9)
M 72,48,160
TR 38,5,21248
s_waitcnt lgkmcnt(8)
M 72,52,168
TR 40,5,24832
s_waitcnt lgkmcnt(7)
M 72,56,176
TR 42,5,25344
s_waitcnt lgkmcnt(6)
M 72,60,184
TR 44,5,28928
buffer_store_dwordx4 v[24:27], v7, s[28:31], s50 offen offset:0 sc1
v_mov_b32 v13, 20
s_cmp_lg_u32 s40, 0
s_cbranch_scc1 L_w0_6
global_load_dword v13, v13, s[18:19] sc1
L_w0_6:
M 76,48,164
TR 46,5,29440
M 76,52,172
TR 48,6,16640
M 76,56,180
TR 50,6,17152
M 76,60,188
TR 52,6,20736
s_waitcnt lgkmcnt(9)
M 80,32,160
TR 54,6,21248
s_waitcnt lgkmcnt(8)
M 80,36,168
TR 56,6,24832
s_waitcnt lgkmcnt(7)
M 80,40,176
TR 58,6,25344
s_waitcnt lgkmcnt(6)
M 80,44,184
TR 60,6,28928
M 84,32,164
TR 62,6,29440
M 84,36,172
s_waitcnt vmcnt(7)
s_barrier
TR 32,5,32768
M 84,40,180
TR 34,5,33280
M 84,44,188
TR 36,5,36864
s_waitcnt lgkmcnt(9)
M 88,48,160
s_add_u32 s51, s63, 3
s_cmp_ge_u32 s51, s45
s_cselect_b32 s62, s45, 0
s_sub_u32 s51, s51, s62
s_lshl_b32 s51, s51, 7
s_add_u32 s51, s51, s44
s_add_u32 s51, s51, s61
s_add_u32 m0, s46, 98304
s_nop 0
buffer_load_dwordx4 v1, s[20:23], s51 offen offset:0  lds
TR 38,5,37376
s_waitcnt lgkmcnt(8)
M 88,52,168
TR 40,5,40960
s_waitcnt lgkmcnt(7)
M 88,56,176
TR 42,5,41472
s_waitcnt lgkmcnt(6)
M 88,60,184
TR 44,5,45056
M 92,48,164
TR 46,5,45568
M 92,52,172
TR 48,6,32768
M 92,56,180
TR 50,6,33280
M 92,60,188
TR 52,6,36864
s_waitcnt lgkmcnt(9)
M 64,32,192
TR 54,6,37376
s_waitcnt lgkmcnt(8)
M 64,36,200
TR 56,6,40960
buffer_store_dwordx4 v[28:31], v7, s[28:31], s50 offen offset:1024 sc1
s_waitcnt lgkmcnt(7)
M 64,40,208
TR 58,6,41472
s_waitcnt lgkmcnt(6)
M 64,44,216
TR 60,6,45056
M 68,32,196
s_add_u32 m0, s46, 98304
s_nop 0
buffer_load_dwordx4 v2, s[20:23], s51 offen offset:1024  lds
TR 62,6,45568
s_add_u32 s48, s63, 1
s_cmp_ge_u32 s48, s45
s_cselect_b32 s62, s45, 0
s_sub_u32 s48, s48, s62
s_add_u32 s48, s48, s58
M 68,36,204
TR 32,5,33024
s_lshr_b32 s49, s48, 1
s_lshl_b32 s49, s49, 19
M 68,40,212
TR 34,5,33536
s_and_b32 s48, s48, 1
s_lshl_b32 s48, s48, 11
M 68,44,220
TR 36,5,37120
s_add_u32 s48, s48, s49
s_lshl_b32 s49, s41, 16
s_waitcnt lgkmcnt(9)
M 72,48,192
TR 38,5,37632
s_add_u32 s48, s48, s49
s_lshl_b32 s49, s40, 13
s_waitcnt lgkmcnt(8)
M 72,52,200
TR 40,5,41216
s_add_u32 s48, s48, s49
s_add_u32 s50, s48, 4096
s_waitcnt lgkmcnt(7)
M 72,56,208
TR 42,5,41728
PK 96,96,97
s_waitcnt lgkmcnt(6)
M 72,60,216
TR 44,5,45312
PK 97,98,99
PK 98,104,105
M 76,48,196
TR 46,5,45824
PK 99,106,107
M 76,52,204
TR 48,6,33024
buffer_store_dwordx4 v[96:99], v7, s[28:31], s48 offen offset:0 sc1
M 76,56,212
TR 50,6,33536
M 76,60,220
TR 52,6,37120
s_waitcnt lgkmcnt(9)
M 80,32,192
s_add_u32 m0, s46, 98304
s_nop 0
buffer_load_dwordx4 v3, s[20:23], s51 offen offset:2048  lds
TR 54,6,37632
s_waitcnt lgkmcnt(8)
M 80,36,200
TR 56,6,41216
s_waitcnt lgkmcnt(7)
M 80,40,208
TR 58,6,41728
s_waitcnt lgkmcnt(6)
M 80,44,216
TR 60,6,45312
M 84,32,196
TR 62,6,45824
M 84,36,204
TR 32,5,49152
M 84,40,212
TR 34,5,49664
M 84,44,220
TR 36,5,53248
s_waitcnt lgkmcnt(9)
M 88,48,192
TR 38,5,53760
s_waitcnt lgkmcnt(8)
M 88,52,200
TR 40,5,57344
s_waitcnt lgkmcnt(7)
M 88,56,208
TR 42,5,57856
PK 112,112,113
s_waitcnt lgkmcnt(6)
M 88,60,216
TR 44,5,61440
PK 113,114,115
PK 114,120,121
M 92,48,196
s_add_u32 m0, s46, 98304
s_nop 0
buffer_load_dwordx4 v4, s[20:23], s51 offen offset:3072  lds
TR 46,5,61952
PK 115,122,123
M 92,52,204
TR 48,6,49152
buffer_store_dwordx4 v[112:115], v7, s[28:31], s48 offen offset:1024 sc1
M 92,56,212
TR 50,6,49664
M 92,60,220
TR 52,6,53248
s_waitcnt lgkmcnt(9)
M 64,32,224
TR 54,6,53760
s_waitcnt lgkmcnt(8)
M 64,36,232
TR 56,6,57344
s_waitcnt lgkmcnt(7)
M 64,40,240
TR 58,6,57856
s_waitcnt lgkmcnt(6)
M 64,44,248
TR 60,6,61440
M 68,32,228
TR 62,6,61952
M 68,36,236
TR 32,5,49408
M 68,40,244
TR 34,5,49920
M 68,44,252
TR 36,5,53504
s_waitcnt lgkmcnt(9)
M 72,48,224
TR 38,5,54016
s_waitcnt lgkmcnt(8)
M 72,52,232
TR 40,5,57600
s_waitcnt lgkmcnt(7)
M 72,56,240
TR 42,5,58112
PK 100,100,101
s_waitcnt lgkmcnt(6)
M 72,60,248
TR 44,5,61696
PK 101,102,103
PK 102,108,109
M 76,48,228
TR 46,5,62208
PK 103,110,111
M 76,52,236
TR 48,6,49408
buffer_store_dwordx4 v[100:103], v7, s[28:31], s50 offen offset:0 sc1
M 76,56,244
TR 50,6,49920
M 76,60,252
TR 52,6,53504
s_waitcnt lgkmcnt(9)
M 80,32,224
TR 54,6,54016
s_waitcnt lgkmcnt(8)
M 80,36,232
TR 56,6,57600
s_waitcnt lgkmcnt(7)
M 80,40,240
TR 58,6,58112
s_waitcnt lgkmcnt(6)
M 80,44,248
TR 60,6,61696
M 84,32,228
TR 62,6,62208
M 84,36,236
s_waitcnt vmcnt(9)
s_barrier
v_xor_b32 v5, 0x10000, v5
v_xor_b32 v6, 0x10000, v6
TR 32,5,0
M 84,40,244
TR 34,5,512
M 84,44,252
TR 36,5,4096
s_waitcnt lgkmcnt(9)
M 88,48,224
s_add_u32 s51, s60, 0
s_and_b32 s51, s51, 3
s_mul_i32 s51, s51, 1048576
s_add_u32 s51, s51, s57
s_cmp_gt_u32 s45, 4
s_cselect_b32 s62, 512, 0
s_add_u32 s51, s51, s62
s_add_u32 m0, s46, 0
s_nop 0
buffer_load_dwordx4 v1, s[20:23], s51 offen offset:0  lds
TR 38,5,4608
PK 116,116,117
s_waitcnt lgkmcnt(8)
M 88,52,232
TR 40,5,8192
PK 117,118,119
PK 118,124,125
s_waitcnt lgkmcnt(7)
M 88,56,240
TR 42,5,8704
PK 119,126,127
s_waitcnt lgkmcnt(6)
M 88,60,248
TR 44,5,12288
buffer_store_dwordx4 v[116:119], v7, s[28:31], s50 offen offset:1024 sc1
M 92,48,228
TR 46,5,12800
M 92,52,236
TR 48,6,0
M 92,56,244
TR 50,6,512
M 92,60,252
TR 52,6,4096
s_waitcnt lgkmcnt(9)
MZ 96,32,128
TR 54,6,4608
s_waitcnt lgkmcnt(8)
M 96,36,136
TR 56,6,8192
s_waitcnt lgkmcnt(7)
M 96,40,144
TR 58,6,8704
s_waitcnt lgkmcnt(6)
M 96,44,152
TR 60,6,12288
MZ 100,32,132
s_add_u32 m0, s46, 0
s_nop 0
buffer_load_dwordx4 v2, s[20:23], s51 offen offset:1024  lds
TR 62,6,12800
M 100,36,140
TR 32,5,256
M 100,40,148
TR 34,5,768
M 100,44,156
TR 36,5,4352
s_waitcnt lgkmcnt(9)
MZ 104,48,128
TR 38,5,4864
s_add_u32 s48, s63, 2
s_cmp_ge_u32 s48, s45
s_cselect_b32 s62, s45, 0
s_sub_u32 s48, s48, s62
s_add_u32 s48, s48, s58
s_waitcnt lgkmcnt(8)
M 104,52,136
TR 40,5,8448
s_lshr_b32 s49, s48, 1
s_lshl_b32 s49, s49, 19
s_waitcnt lgkmcnt(7)
M 104,56,144
TR 42,5,8960
s_and_b32 s48, s48, 1
s_lshl_b32 s48, s48, 11
s_waitcnt lgkmcnt(6)
M 104,60,152
TR 44,5,12544
s_add_u32 s48, s48, s49
s_lshl_b32 s49, s41, 16
MZ 108,48,132
TR 46,5,13056
s_add_u32 s48, s48, s49
s_lshl_b32 s49, s40, 13
M 108,52,140
TR 48,6,256
s_add_u32 s48, s48, s49
s_add_u32 s50, s48, 4096
M 108,56,148
TR 50,6,768
PK 64,64,65
M 108,60,156
TR 52,6,4352
PK 65,66,67
PK 66,72,73
s_waitcnt lgkmcnt(9)
MZ 112,32,128
s_add_u32 m0, s46, 0
s_nop 0
buffer_load_dwordx4 v3, s[20:23], s51 offen offset:2048  lds
TR 54,6,4864
PK 67,74,75
s_waitcnt lgkmcnt(8)
M 112,36,136
TR 56,6,8448
buffer_store_dwordx4 v[64:67], v7, s[28:31], s48 offen offset:0 sc1
s_waitcnt lgkmcnt(7)
M 112,40,144
TR 58,6,8960
s_waitcnt lgkmcnt(6)
M 112,44,152
TR 60,6,12544
MZ 116,32,132
TR 62,6,13056
M 116,36,140
TR 32,5,16384
M 116,40,148
TR 34,5,16896
M 116,44,156
TR 36,5,20480
s_waitcnt lgkmcnt(9)
MZ 120,48,128
TR 38,5,20992
s_waitcnt lgkmcnt(8)
M 120,52,136
TR 40,5,24576
s_waitcnt lgkmcnt(7)
M 120,56,144
TR 42,5,25088
s_waitcnt lgkmcnt(6)
M 120,60,152
TR 44,5,28672
MZ 124,48,132
s_add_u32 m0, s46, 0
s_nop 0
buffer_load_dwordx4 v4, s[20:23], s51 offen offset:3072  lds
TR 46,5,29184
M 124,52,140
TR 48,6,16384
M 124,56,148
TR 50,6,16896
M 124,60,156
TR 52,6,20480
s_waitcnt lgkmcnt(9)
M 96,32,160
TR 54,6,20992
s_waitcnt lgkmcnt(8)
M 96,36,168
TR 56,6,24576
s_waitcnt lgkmcnt(7)
M 96,40,176
TR 58,6,25088
s_waitcnt lgkmcnt(6)
M 96,44,184
TR 60,6,28672
M 100,32,164
TR 62,6,29184
M 100,36,172
TR 32,5,16640
M 100,40,180
TR 34,5,17152
M 100,44,188
TR 36,5,20736
s_cmp_lg_u32 s40, 0
s_cbranch_scc1 L_w0_7
s_branch L_chk_9
L_spin_8:
s_sleep 2
v_mov_b32 v13, 20
global_load_dword v13, v13, s[18:19] sc1
L_chk_9:
v_readfirstlane_b32 s59, v13
s_bitcmp1_b32 s59, 0
s_cbranch_scc1 L_ok_10
s_waitcnt vmcnt(0)
v_readfirstlane_b32 s59, v13
s_bitcmp1_b32 s59, 0
s_cbranch_scc0 L_spin_8
L_ok_10:
s_and_b32 s43, s2, 7
s_lshl_b32 s43, s43, 13
s_add_u32 s43, s43, 6848
v_lshrrev_b32 v13, 3, v0
v_lshlrev_b32 v13, 7, v13
v_and_b32 v15, 7, v0
v_lshl_add_u32 v13, v15, 2, v13
v_add_u32 v15, s43, v13
global_load_dword v13, v15, s[100:101] sc1
L_w0_7:
s_waitcnt lgkmcnt(9)
M 104,48,160
TR 38,5,21248
s_waitcnt lgkmcnt(8)
M 104,52,168
TR 40,5,24832
s_waitcnt lgkmcnt(7)
M 104,56,176
TR 42,5,25344
s_waitcnt lgkmcnt(6)
M 104,60,184
TR 44,5,28928
M 108,48,164
TR 46,5,29440
M 108,52,172
TR 48,6,16640
M 108,56,180
TR 50,6,17152
PK 80,80,81
M 108,60,188
TR 52,6,20736
PK 81,82,83
PK 82,88,89
s_waitcnt lgkmcnt(9)
M 112,32,160
TR 54,6,21248
PK 83,90,91
s_waitcnt lgkmcnt(8)
M 112,36,168
TR 56,6,24832
buffer_store_dwordx4 v[80:83], v7, s[28:31], s48 offen offset:1024 sc1
s_waitcnt lgkmcnt(7)
M 112,40,176
TR 58,6,25344
s_waitcnt lgkmcnt(6)
M 112,44,184
TR 60,6,28928
M 116,32,164
TR 62,6,29440
M 116,36,172
s_waitcnt vmcnt(9)
s_barrier
TR 32,5,32768
M 116,40,180
TR 34,5,33280
M 116,44,188
TR 36,5,36864
s_waitcnt lgkmcnt(9)
M 120,48,160
s_add_u32 s51, s60, 1
s_and_b32 s51, s51, 3
s_mul_i32 s51, s51, 1048576
s_add_u32 s51, s51, s57
s_cmp_gt_u32 s45, 4
s_cselect_b32 s62, 512, 0
s_add_u32 s51, s51, s62
s_add_u32 m0, s46, 32768
s_nop 0
buffer_load_dwordx4 v1, s[20:23], s51 offen offset:0  lds
TR 38,5,37376
s_waitcnt lgkmcnt(8)
M 120,52,168
TR 40,5,40960
s_waitcnt lgkmcnt(7)
M 120,56,176
TR 42,5,41472
s_waitcnt lgkmcnt(6)
M 120,60,184
TR 44,5,45056
M 124,48,164
TR 46,5,45568
M 124,52,172
TR 48,6,32768
M 124,56,180
TR 50,6,33280
M 124,60,188
TR 52,6,36864
s_waitcnt lgkmcnt(9)
M 96,32,192
TR 54,6,37376
s_waitcnt lgkmcnt(8)
M 96,36,200
TR 56,6,40960
s_waitcnt lgkmcnt(7)
M 96,40,208
TR 58,6,41472
s_waitcnt lgkmcnt(6)
M 96,44,216
TR 60,6,45056
M 100,32,196
s_add_u32 m0, s46, 32768
s_nop 0
buffer_load_dwordx4 v2, s[20:23], s51 offen offset:1024  lds
TR 62,6,45568
M 100,36,204
TR 32,5,33024
M 100,40,212
TR 34,5,33536
M 100,44,220
TR 36,5,37120
s_waitcnt lgkmcnt(9)
M 104,48,192
TR 38,5,37632
s_waitcnt lgkmcnt(8)
M 104,52,200
TR 40,5,41216
s_waitcnt lgkmcnt(7)
M 104,56,208
TR 42,5,41728
s_waitcnt lgkmcnt(6)
M 104,60,216
TR 44,5,45312
M 108,48,196
TR 46,5,45824
M 108,52,204
TR 48,6,33024
M 108,56,212
TR 50,6,33536
PK 68,68,69
M 108,60,220
TR 52,6,37120
PK 69,70,71
PK 70,76,77
s_waitcnt lgkmcnt(9)
M 112,32,192
s_add_u32 m0, s46, 32768
s_nop 0
buffer_load_dwordx4 v3, s[20:23], s51 offen offset:2048  lds
TR 54,6,37632
PK 71,78,79
s_waitcnt lgkmcnt(8)
M 112,36,200
TR 56,6,41216
buffer_store_dwordx4 v[68:71], v7, s[28:31], s50 offen offset:0 sc1
s_waitcnt lgkmcnt(7)
M 112,40,208
TR 58,6,41728
s_waitcnt lgkmcnt(6)
M 112,44,216
TR 60,6,45312
M 116,32,196
TR 62,6,45824
M 116,36,204
TR 32,5,49152
M 116,40,212
TR 34,5,49664
M 116,44,220
TR 36,5,53248
s_waitcnt lgkmcnt(9)
M 120,48,192
TR 38,5,53760
s_waitcnt lgkmcnt(8)
M 120,52,200
TR 40,5,57344
s_waitcnt lgkmcnt(7)
M 120,56,208
TR 42,5,57856
s_waitcnt lgkmcnt(6)
M 120,60,216
TR 44,5,61440
M 124,48,196
s_add_u32 m0, s46, 32768
s_nop 0
buffer_load_dwordx4 v4, s[20:23], s51 offen offset:3072  lds
TR 46,5,61952
M 124,52,204
TR 48,6,49152
M 124,56,212
TR 50,6,49664
M 124,60,220
TR 52,6,53248
s_waitcnt lgkmcnt(9)
M 96,32,224
TR 54,6,53760
s_waitcnt lgkmcnt(8)
M 96,36,232
TR 56,6,57344
s_waitcnt lgkmcnt(7)
M 96,40,240
TR 58,6,57856
s_waitcnt lgkmcnt(6)
M 96,44,248
TR 60,6,61440
M 100,32,228
TR 62,6,61952
M 100,36,236
TR 32,5,49408
M 100,40,244
TR 34,5,49920
M 100,44,252
TR 36,5,53504
s_waitcnt lgkmcnt(9)
M 104,48,224
TR 38,5,54016
s_waitcnt lgkmcnt(8)
M 104,52,232
TR 40,5,57600
s_waitcnt lgkmcnt(7)
M 104,56,240
TR 42,5,58112
s_waitcnt lgkmcnt(6)
M 104,60,248
TR 44,5,61696
M 108,48,228
TR 46,5,62208
M 108,52,236
TR 48,6,49408
M 108,56,244
TR 50,6,49920
PK 84,84,85
M 108,60,252
TR 52,6,53504
PK 85,86,87
PK 86,92,93
s_waitcnt lgkmcnt(9)
M 112,32,224
TR 54,6,54016
PK 87,94,95
s_waitcnt lgkmcnt(8)
M 112,36,232
TR 56,6,57600
buffer_store_dwordx4 v[84:87], v7, s[28:31], s50 offen offset:1024 sc1
s_waitcnt lgkmcnt(7)
M 112,40,240
TR 58,6,58112
s_waitcnt lgkmcnt(6)
M 112,44,248
TR 60,6,61696
M 116,32,228
TR 62,6,62208
M 116,36,236
s_waitcnt vmcnt(7)
s_barrier
v_xor_b32 v5, 0x10000, v5
v_xor_b32 v6, 0x10000, v6
TR 32,5,0
M 116,40,244
TR 34,5,512
M 116,44,252
TR 36,5,4096
s_waitcnt lgkmcnt(9)
M 120,48,224
s_add_u32 s51, s60, 2
s_and_b32 s51, s51, 3
s_mul_i32 s51, s51, 1048576
s_add_u32 s51, s51, s57
s_cmp_gt_u32 s45, 4
s_cselect_b32 s62, 512, 0
s_add_u32 s51, s51, s62
s_add_u32 m0, s46, 65536
s_nop 0
buffer_load_dwordx4 v1, s[20:23], s51 offen offset:0  lds
TR 38,5,4608
s_waitcnt lgkmcnt(8)
M 120,52,232
TR 40,5,8192
s_waitcnt lgkmcnt(7)
M 120,56,240
TR 42,5,8704
s_waitcnt lgkmcnt(6)
M 120,60,248
TR 44,5,12288
M 124,48,228
TR 46,5,12800
M 124,52,236
TR 48,6,0
M 124,56,244
TR 50,6,512
M 124,60,252
TR 52,6,4096
s_cmp_lt_u32 s42, 10
s_cbranch_scc1 L_cont_11
s_nop 7
s_add_u32 s48, s63, 3
s_cmp_ge_u32 s48, s45
s_cselect_b32 s62, s45, 0
s_sub_u32 s48, s48, s62
s_add_u32 s48, s48, s58
s_lshr_b32 s49, s48, 1
s_lshl_b32 s49, s49, 19
s_and_b32 s48, s48, 1
s_lshl_b32 s48, s48, 11
s_add_u32 s48, s48, s49
s_lshl_b32 s49, s41, 16
s_add_u32 s48, s48, s49
s_lshl_b32 s49, s40, 13
s_add_u32 s48, s48, s49
s_add_u32 s50, s48, 4096
PK 96,96,97
PK 97,98,99
PK 98,104,105
PK 99,106,107
buffer_store_dwordx4 v[96:99], v7, s[28:31], s48 offen offset:0 sc1
PK 112,112,113
PK 113,114,115
PK 114,120,121
PK 115,122,123
buffer_store_dwordx4 v[112:115], v7, s[28:31], s48 offen offset:1024 sc1
PK 100,100,101
PK 101,102,103
PK 102,108,109
PK 103,110,111
buffer_store_dwordx4 v[100:103], v7, s[28:31], s50 offen offset:0 sc1
PK 116,116,117
PK 117,118,119
PK 118,124,125
PK 119,126,127
buffer_store_dwordx4 v[116:119], v7, s[28:31], s50 offen offset:1024 sc1
s_add_u32 s58, s42, 0
s_lshl_b32 s58, s58, 7
s_lshl_b32 s49, s41, 2
s_add_u32 s58, s58, s49
s_branch L_p2
L_cont_11:
s_waitcnt lgkmcnt(9)
MZ 64,32,128
TR 54,6,4608
s_waitcnt lgkmcnt(8)
M 64,36,136
TR 56,6,8192
s_waitcnt lgkmcnt(7)
M 64,40,144
TR 58,6,8704
s_waitcnt lgkmcnt(6)
M 64,44,152
TR 60,6,12288
s_load_dwordx2 s[6:7], s[0:1], 64
s_lshr_b32 s55, s2, 3
s_mul_i32 s43, s55, 43
s_lshr_b32 s43, s43, 7
s_mul_i32 s47, s43, 3
s_sub_u32 s47, s55, s47
s_lshl_b32 s47, s47, 1
s_and_b32 s54, s2, 1
s_add_u32 s47, s47, s54
s_sub_u32 s54, s55, 24
s_cmp_ge_u32 s55, 24
s_cselect_b32 s43, s54, s43
s_cselect_b32 s55, 6, s47
s_and_b32 s54, s2, 6
s_and_b32 s47, s43, 1
s_add_u32 s54, s54, s47
s_lshr_b32 s43, s43, 1
s_lshl_b32 s43, s43, 3
s_add_u32 s54, s54, s43
s_sub_u32 s52, 15, s55
s_xor_b32 s53, s55, 1
s_add_u32 s53, s53, 4
s_cmp_eq_u32 s55, 6
s_cselect_b32 s52, 3, s52
s_cselect_b32 s53, 2, s53
s_mov_b32 s32, s8
s_mov_b32 s33, s9
s_mov_b32 s34, 4194304
s_mov_b32 s35, 0x20000
s_mov_b32 s36, s16
s_mov_b32 s37, s17
s_mov_b32 s38, 2097152
s_mov_b32 s39, 0x20000
s_lshl_b32 s54, s54, 8
s_and_b32 s43, s40, 3
s_lshl_b32 s47, s43, 18
s_add_u32 s54, s54, s47
s_lshr_b32 s47, s40, 2
s_cmp_eq_u32 s47, 0
s_cselect_b32 s55, s52, s53
s_lshl_b32 s47, s47, 7
s_add_u32 s54, s54, s47
s_lshl_b32 s55, s55, 17
s_lshl_b32 s43, s43, 15
s_add_u32 s55, s55, s43
s_waitcnt lgkmcnt(0)
MZ 68,32,132
s_add_u32 m0, s46, 65536
s_nop 0
buffer_load_dwordx4 v2, s[20:23], s51 offen offset:1024  lds
TR 62,6,12800
M 68,36,140
TR 32,5,256
M 68,40,148
TR 34,5,768
s_add_u32 s48, s63, 3
s_cmp_ge_u32 s48, s45
s_cselect_b32 s62, s45, 0
s_sub_u32 s48, s48, s62
M 68,44,156
TR 36,5,4352
s_add_u32 s48, s48, s58
s_lshr_b32 s49, s48, 1
MZ 72,48,128
TR 38,5,4864
s_lshl_b32 s49, s49, 19
M 72,52,136
TR 40,5,8448
s_and_b32 s48, s48, 1
s_lshl_b32 s48, s48, 11
M 72,56,144
TR 42,5,8960
s_add_u32 s48, s48, s49
s_waitcnt lgkmcnt(6)
M 72,60,152
TR 44,5,12544
s_lshl_b32 s49, s41, 16
MZ 76,48,132
TR 46,5,13056
s_add_u32 s48, s48, s49
M 76,52,140
TR 48,6,256
s_lshl_b32 s49, s40, 13
s_add_u32 s48, s48, s49
M 76,56,148
TR 50,6,768
s_add_u32 s50, s48, 4096
M 76,60,156
TR 52,6,4352
PK 16,96,97
s_waitcnt lgkmcnt(9)
MZ 80,32,128
s_add_u32 m0, s46, 65536
s_nop 0
buffer_load_dwordx4 v3, s[20:23], s51 offen offset:2048  lds
TR 54,6,4864
PK 17,98,99
s_waitcnt lgkmcnt(8)
M 80,36,136
TR 56,6,8448
PK 18,104,105
PK 19,106,107
s_waitcnt lgkmcnt(7)
M 80,40,144
TR 58,6,8960
PK 20,112,113
s_waitcnt lgkmcnt(6)
M 80,44,152
TR 60,6,12544
PK 21,114,115
MZ 84,32,132
TR 62,6,13056
PK 22,120,121
M 84,36,140
TR 32,5,16384
PK 23,122,123
PK 24,100,101
M 84,40,148
TR 34,5,16896
PK 25,102,103
M 84,44,156
TR 36,5,20480
PK 26,108,109
s_waitcnt lgkmcnt(9)
MZ 88,48,128
TR 38,5,20992
PK 27,110,111
s_waitcnt lgkmcnt(8)
M 88,52,136
TR 40,5,24576
PK 28,116,117
PK 29,118,119
s_waitcnt lgkmcnt(7)
M 88,56,144
TR 42,5,25088
PK 30,124,125
s_waitcnt lgkmcnt(6)
M 88,60,152
TR 44,5,28672
PK 31,126,127
MZ 92,48,132
s_add_u32 m0, s46, 65536
s_nop 0
buffer_load_dwordx4 v4, s[20:23], s51 offen offset:3072  lds
TR 46,5,29184
M 92,52,140
TR 48,6,16384
M 92,56,148
TR 50,6,16896
M 92,60,156
TR 52,6,20480
s_waitcnt lgkmcnt(9)
MZ 96,32,128
TR 54,6,20992
s_waitcnt lgkmcnt(8)
M 96,36,136
TR 56,6,24576
buffer_store_dwordx4 v[16:19], v7, s[28:31], s48 offen offset:0 sc1
s_waitcnt lgkmcnt(7)
M 96,40,144
TR 58,6,25088
s_waitcnt lgkmcnt(6)
M 96,44,152
TR 60,6,28672
MZ 100,32,132
TR 62,6,29184
M 100,36,140
TR 32,5,16640
M 100,40,148
TR 34,5,17152
M 100,44,156
TR 36,5,20736
s_waitcnt lgkmcnt(9)
MZ 104,48,128
TR 38,5,21248
s_waitcnt lgkmcnt(8)
M 104,52,136
TR 40,5,24832
s_waitcnt lgkmcnt(7)
M 104,56,144
TR 42,5,25344
s_waitcnt lgkmcnt(6)
M 104,60,152
TR 44,5,28928
MZ 108,48,132
TR 46,5,29440
M 108,52,140
TR 48,6,16640
M 108,56,148
TR 50,6,17152
M 108,60,156
TR 52,6,20736
s_waitcnt lgkmcnt(9)
MZ 112,32,128
TR 54,6,21248
s_waitcnt lgkmcnt(8)
M 112,36,136
TR 56,6,24832
s_waitcnt lgkmcnt(7)
M 112,40,144
TR 58,6,25344
s_waitcnt lgkmcnt(6)
M 112,44,152
TR 60,6,28928
MZ 116,32,132
TR 62,6,29440
M 116,36,140
s_waitcnt vmcnt(6)
s_cmp_lg_u32 s40, 0
s_cbranch_scc1 L_w0_12
s_branch L_chk_14
L_spin_13:
s_sleep 4
global_load_dword v13, v15, s[100:101] sc1
s_waitcnt vmcnt(0)
L_chk_14:
v_cmp_ne_u32 vcc, s59, v13
s_cbranch_vccnz L_spin_13
L_w0_12:
s_barrier
TR 32,5,32768
M 116,40,148
TR 34,5,33280
M 116,44,156
TR 36,5,36864
s_waitcnt lgkmcnt(9)
MZ 120,48,128
s_add_u32 s51, s60, 3
s_and_b32 s51, s51, 3
s_mul_i32 s51, s51, 1048576
s_add_u32 s51, s51, s57
s_cmp_gt_u32 s45, 4
s_cselect_b32 s62, 512, 0
s_add_u32 s51, s51, s62
s_add_u32 m0, s46, 98304
s_nop 0
buffer_load_dwordx4 v1, s[20:23], s51 offen offset:0  lds
TR 38,5,37376
s_waitcnt lgkmcnt(8)
M 120,52,136
TR 40,5,40960
s_waitcnt lgkmcnt(7)
M 120,56,144
TR 42,5,41472
s_waitcnt lgkmcnt(6)
M 120,60,152
TR 44,5,45056
MZ 124,48,132
TR 46,5,45568
M 124,52,140
TR 48,6,32768
M 124,56,148
TR 50,6,33280
M 124,60,156
TR 52,6,36864
s_waitcnt lgkmcnt(9)
M 64,32,160
TR 54,6,37376
s_waitcnt lgkmcnt(8)
M 64,36,168
TR 56,6,40960
s_waitcnt lgkmcnt(7)
M 64,40,176
TR 58,6,41472
s_waitcnt lgkmcnt(6)
M 64,44,184
TR 60,6,45056
M 68,32,164
s_add_u32 m0, s46, 98304
s_nop 0
buffer_load_dwordx4 v2, s[20:23], s51 offen offset:1024  lds
TR 62,6,45568
M 68,36,172
TR 32,5,33024
s_mov_b32 s52, 0
s_add_u32 s52, s52, 0
s_and_b32 s52, s52, 3
s_lshl_b32 s52, s52, 12
s_add_u32 s52, s52, s55
s_add_u32 s53, s52, 16384
buffer_load_dwordx4 v[128:131], v7, s[36:39], s52 offen offset:0 sc1
buffer_load_dwordx4 v[132:135], v7, s[36:39], s53 offen offset:0 sc1
M 68,40,180
TR 34,5,33536
M 68,44,188
TR 36,5,37120
s_waitcnt lgkmcnt(9)
M 72,48,160
TR 38,5,37632
s_waitcnt lgkmcnt(8)
M 72,52,168
TR 40,5,41216
s_waitcnt lgkmcnt(7)
M 72,56,176
TR 42,5,41728
s_waitcnt lgkmcnt(6)
M 72,60,184
TR 44,5,45312
M 76,48,164
TR 46,5,45824
M 76,52,172
TR 48,6,33024
M 76,56,180
TR 50,6,33536
M 76,60,188
TR 52,6,37120
s_waitcnt lgkmcnt(9)
M 80,32,160
s_add_u32 m0, s46, 98304
s_nop 0
buffer_load_dwordx4 v3, s[20:23], s51 offen offset:2048  lds
TR 54,6,37632
s_waitcnt lgkmcnt(8)
M 80,36,168
TR 56,6,41216
buffer_store_dwordx4 v[20:23], v7, s[28:31], s48 offen offset:1024 sc1
s_waitcnt lgkmcnt(7)
M 80,40,176
TR 58,6,41728
s_waitcnt lgkmcnt(6)
M 80,44,184
TR 60,6,45312
M 84,32,164
TR 62,6,45824
M 84,36,172
TR 32,5,49152
buffer_load_dwordx4 v[136:139], v7, s[36:39], s52 offen offset:1024 sc1
buffer_load_dwordx4 v[140:143], v7, s[36:39], s53 offen offset:1024 sc1
M 84,40,180
TR 34,5,49664
M 84,44,188
TR 36,5,53248
s_waitcnt lgkmcnt(9)
M 88,48,160
TR 38,5,53760
s_waitcnt lgkmcnt(8)
M 88,52,168
TR 40,5,57344
s_waitcnt lgkmcnt(7)
M 88,56,176
TR 42,5,57856
s_waitcnt lgkmcnt(6)
M 88,60,184
TR 44,5,61440
M 92,48,164
s_add_u32 m0, s46, 98304
s_nop 0
buffer_load_dwordx4 v4, s[20:23], s51 offen offset:3072  lds
TR 46,5,61952
M 92,52,172
TR 48,6,49152
M 92,56,180
TR 50,6,49664
M 92,60,188
TR 52,6,53248
s_waitcnt lgkmcnt(9)
M 96,32,160
TR 54,6,53760
s_waitcnt lgkmcnt(8)
M 96,36,168
TR 56,6,57344
s_waitcnt lgkmcnt(7)
M 96,40,176
TR 58,6,57856
s_waitcnt lgkmcnt(6)
M 96,44,184
TR 60,6,61440
M 100,32,164
TR 62,6,61952
M 100,36,172
TR 32,5,49408
buffer_load_dwordx4 v[144:147], v7, s[36:39], s52 offen offset:2048 sc1
buffer_load_dwordx4 v[148:151], v7, s[36:39], s53 offen offset:2048 sc1
M 100,40,180
TR 34,5,49920
M 100,44,188
TR 36,5,53504
s_waitcnt lgkmcnt(9)
M 104,48,160
TR 38,5,54016
s_waitcnt lgkmcnt(8)
M 104,52,168
TR 40,5,57600
s_waitcnt lgkmcnt(7)
M 104,56,176
TR 42,5,58112
s_waitcnt lgkmcnt(6)
M 104,60,184
TR 44,5,61696
M 108,48,164
TR 46,5,62208
M 108,52,172
TR 48,6,49408
M 108,56,180
TR 50,6,49920
M 108,60,188
TR 52,6,53504
s_waitcnt lgkmcnt(9)
M 112,32,160
TR 54,6,54016
s_waitcnt lgkmcnt(8)
M 112,36,168
TR 56,6,57600
s_waitcnt lgkmcnt(7)
M 112,40,176
TR 58,6,58112
s_waitcnt lgkmcnt(6)
M 112,44,184
TR 60,6,61696
M 116,32,164
TR 62,6,62208
M 116,36,172
s_waitcnt vmcnt(12)
s_barrier
v_xor_b32 v5, 0x10000, v5
v_xor_b32 v6, 0x10000, v6
TR 32,5,0
buffer_load_dwordx4 v[152:155], v7, s[36:39], s52 offen offset:3072 sc1
buffer_load_dwordx4 v[156:159], v7, s[36:39], s53 offen offset:3072 sc1
M 116,40,180
TR 34,5,512
M 116,44,188
TR 36,5,4096
s_waitcnt lgkmcnt(9)
M 120,48,160
s_mov_b32 s51, 0
s_add_u32 s51, s51, 0
s_and_b32 s51, s51, 3
s_lshl_b32 s51, s51, 20
s_add_u32 s51, s51, s54
s_add_u32 m0, s46, 0
s_nop 0
buffer_load_dwordx4 v1, s[32:35], s51 offen offset:0 lds
TR 38,5,4608
s_waitcnt lgkmcnt(8)
M 120,52,168
TR 40,5,8192
s_waitcnt lgkmcnt(7)
M 120,56,176
TR 42,5,8704
s_waitcnt lgkmcnt(6)
M 120,60,184
TR 44,5,12288
M 124,48,164
TR 46,5,12800
M 124,52,172
TR 48,6,0
M 124,56,180
TR 50,6,512
M 124,60,188
TR 52,6,4096
s_waitcnt lgkmcnt(9)
M 64,32,192
TR 54,6,4608
s_waitcnt lgkmcnt(8)
M 64,36,200
TR 56,6,8192
buffer_store_dwordx4 v[24:27], v7, s[28:31], s50 offen offset:0 sc1
s_waitcnt lgkmcnt(7)
M 64,40,208
TR 58,6,8704
s_waitcnt lgkmcnt(6)
M 64,44,216
TR 60,6,12288
M 68,32,196
s_add_u32 m0, s46, 0
s_nop 0
buffer_load_dwordx4 v2, s[32:35], s51 offen offset:1024 lds
TR 62,6,12800
M 68,36,204
TR 32,5,256
s_mov_b32 s52, 0
s_add_u32 s52, s52, 1
s_and_b32 s52, s52, 3
s_lshl_b32 s52, s52, 12
s_add_u32 s52, s52, s55
s_add_u32 s53, s52, 16384
buffer_load_dwordx4 v[160:163], v7, s[36:39], s52 offen offset:0 sc1
buffer_load_dwordx4 v[164:167], v7, s[36:39], s53 offen offset:0 sc1
M 68,40,212
TR 34,5,768
M 68,44,220
TR 36,5,4352
s_waitcnt lgkmcnt(9)
M 72,48,192
TR 38,5,4864
s_waitcnt lgkmcnt(8)
M 72,52,200
TR 40,5,8448
s_waitcnt lgkmcnt(7)
M 72,56,208
TR 42,5,8960
s_waitcnt lgkmcnt(6)
M 72,60,216
TR 44,5,12544
M 76,48,196
TR 46,5,13056
M 76,52,204
TR 48,6,256
M 76,56,212
TR 50,6,768
M 76,60,220
TR 52,6,4352
s_waitcnt lgkmcnt(9)
M 80,32,192
s_add_u32 m0, s46, 0
s_nop 0
buffer_load_dwordx4 v3, s[32:35], s51 offen offset:2048 lds
TR 54,6,4864
s_waitcnt lgkmcnt(8)
M 80,36,200
TR 56,6,8448
s_waitcnt lgkmcnt(7)
M 80,40,208
TR 58,6,8960
s_waitcnt lgkmcnt(6)
M 80,44,216
TR 60,6,12544
M 84,32,196
TR 62,6,13056
M 84,36,204
TR 32,5,16384
buffer_load_dwordx4 v[168:171], v7, s[36:39], s52 offen offset:1024 sc1
buffer_load_dwordx4 v[172:175], v7, s[36:39], s53 offen offset:1024 sc1
M 84,40,212
TR 34,5,16896
M 84,44,220
TR 36,5,20480
s_waitcnt lgkmcnt(9)
M 88,48,192
TR 38,5,20992
s_waitcnt lgkmcnt(8)
M 88,52,200
TR 40,5,24576
s_waitcnt lgkmcnt(7)
M 88,56,208
TR 42,5,25088
s_waitcnt lgkmcnt(6)
M 88,60,216
TR 44,5,28672
M 92,48,196
s_add_u32 m0, s46, 0
s_nop 0
buffer_load_dwordx4 v4, s[32:35], s51 offen offset:3072 lds
TR 46,5,29184
M 92,52,204
TR 48,6,16384
M 92,56,212
TR 50,6,16896
M 92,60,220
TR 52,6,20480
s_waitcnt lgkmcnt(9)
M 96,32,192
TR 54,6,20992
s_waitcnt lgkmcnt(8)
M 96,36,200
TR 56,6,24576
s_waitcnt lgkmcnt(7)
M 96,40,208
TR 58,6,25088
s_waitcnt lgkmcnt(6)
M 96,44,216
TR 60,6,28672
M 100,32,196
TR 62,6,29184
M 100,36,204
TR 32,5,16640
buffer_load_dwordx4 v[176:179], v7, s[36:39], s52 offen offset:2048 sc1
buffer_load_dwordx4 v[180:183], v7, s[36:39], s53 offen offset:2048 sc1
M 100,40,212
TR 34,5,17152
M 100,44,220
TR 36,5,20736
s_waitcnt lgkmcnt(9)
M 104,48,192
TR 38,5,21248
s_waitcnt lgkmcnt(8)
M 104,52,200
TR 40,5,24832
s_waitcnt lgkmcnt(7)
M 104,56,208
TR 42,5,25344
s_waitcnt lgkmcnt(6)
M 104,60,216
TR 44,5,28928
M 108,48,196
TR 46,5,29440
M 108,52,204
TR 48,6,16640
M 108,56,212
TR 50,6,17152
M 108,60,220
TR 52,6,20736
s_waitcnt lgkmcnt(9)
M 112,32,192
TR 54,6,21248
s_waitcnt lgkmcnt(8)
M 112,36,200
TR 56,6,24832
buffer_store_dwordx4 v[28:31], v7, s[28:31], s50 offen offset:1024 sc1
s_waitcnt lgkmcnt(7)
M 112,40,208
TR 58,6,25344
s_waitcnt lgkmcnt(6)
M 112,44,216
TR 60,6,28928
M 116,32,196
TR 62,6,29440
M 116,36,204
s_waitcnt vmcnt(16)
s_barrier
TR 32,5,32768
buffer_load_dwordx4 v[184:187], v7, s[36:39], s52 offen offset:3072 sc1
buffer_load_dwordx4 v[188:191], v7, s[36:39], s53 offen offset:3072 sc1
M 116,40,212
TR 34,5,33280
M 116,44,220
TR 36,5,36864
s_waitcnt lgkmcnt(9)
M 120,48,192
s_mov_b32 s51, 0
s_add_u32 s51, s51, 1
s_and_b32 s51, s51, 3
s_lshl_b32 s51, s51, 20
s_add_u32 s51, s51, s54
s_add_u32 m0, s46, 32768
s_nop 0
buffer_load_dwordx4 v1, s[32:35], s51 offen offset:0 lds
TR 38,5,37376
s_waitcnt lgkmcnt(8)
M 120,52,200
TR 40,5,40960
s_waitcnt lgkmcnt(7)
M 120,56,208
TR 42,5,41472
s_waitcnt lgkmcnt(6)
M 120,60,216
TR 44,5,45056
M 124,48,196
TR 46,5,45568
M 124,52,204
TR 48,6,32768
M 124,56,212
TR 50,6,33280
M 124,60,220
TR 52,6,36864
s_waitcnt lgkmcnt(9)
M 64,32,224
TR 54,6,37376
s_waitcnt lgkmcnt(8)
M 64,36,232
TR 56,6,40960
s_waitcnt lgkmcnt(7)
M 64,40,240
TR 58,6,41472
s_waitcnt lgkmcnt(6)
M 64,44,248
TR 60,6,45056
M 68,32,228
s_add_u32 m0, s46, 32768
s_nop 0
buffer_load_dwordx4 v2, s[32:35], s51 offen offset:1024 lds
TR 62,6,45568
M 68,36,236
TR 32,5,33024
s_mov_b32 s52, 0
s_add_u32 s52, s52, 2
s_and_b32 s52, s52, 3
s_lshl_b32 s52, s52, 12
s_add_u32 s52, s52, s55
s_add_u32 s53, s52, 16384
buffer_load_dwordx4 v[192:195], v7, s[36:39], s52 offen offset:0 sc1
buffer_load_dwordx4 v[196:199], v7, s[36:39], s53 offen offset:0 sc1
M 68,40,244
TR 34,5,33536
M 68,44,252
TR 36,5,37120
s_waitcnt lgkmcnt(9)
M 72,48,224
TR 38,5,37632
s_waitcnt lgkmcnt(8)
M 72,52,232
TR 40,5,41216
s_waitcnt lgkmcnt(7)
M 72,56,240
TR 42,5,41728
s_waitcnt lgkmcnt(6)
M 72,60,248
TR 44,5,45312
M 76,48,228
TR 46,5,45824
M 76,52,236
TR 48,6,33024
buffer_load_dwordx4 v[200:203], v7, s[36:39], s52 offen offset:1024 sc1
buffer_load_dwordx4 v[204:207], v7, s[36:39], s53 offen offset:1024 sc1
M 76,56,244
TR 50,6,33536
M 76,60,252
TR 52,6,37120
s_waitcnt lgkmcnt(9)
M 80,32,224
s_add_u32 m0, s46, 32768
s_nop 0
buffer_load_dwordx4 v3, s[32:35], s51 offen offset:2048 lds
TR 54,6,37632
s_waitcnt lgkmcnt(8)
M 80,36,232
TR 56,6,41216
s_waitcnt lgkmcnt(7)
M 80,40,240
TR 58,6,41728
s_waitcnt lgkmcnt(6)
M 80,44,248
TR 60,6,45312
M 84,32,228
TR 62,6,45824
M 84,36,236
TR 32,5,49152
buffer_load_dwordx4 v[208:211], v7, s[36:39], s52 offen offset:2048 sc1
buffer_load_dwordx4 v[212:215], v7, s[36:39], s53 offen offset:2048 sc1
M 84,40,244
TR 34,5,49664
M 84,44,252
TR 36,5,53248
s_waitcnt lgkmcnt(9)
M 88,48,224
TR 38,5,53760
s_waitcnt lgkmcnt(8)
M 88,52,232
TR 40,5,57344
s_waitcnt lgkmcnt(7)
M 88,56,240
TR 42,5,57856
s_waitcnt lgkmcnt(6)
M 88,60,248
TR 44,5,61440
M 92,48,228
s_add_u32 m0, s46, 32768
s_nop 0
buffer_load_dwordx4 v4, s[32:35], s51 offen offset:3072 lds
TR 46,5,61952
M 92,52,236
TR 48,6,49152
buffer_load_dwordx4 v[216:219], v7, s[36:39], s52 offen offset:3072 sc1
buffer_load_dwordx4 v[220:223], v7, s[36:39], s53 offen offset:3072 sc1
M 92,56,244
TR 50,6,49664
M 92,60,252
TR 52,6,53248
s_waitcnt lgkmcnt(9)
M 96,32,224
TR 54,6,53760
s_waitcnt lgkmcnt(8)
M 96,36,232
TR 56,6,57344
s_waitcnt lgkmcnt(7)
M 96,40,240
TR 58,6,57856
s_waitcnt lgkmcnt(6)
M 96,44,248
TR 60,6,61440
M 100,32,228
TR 62,6,61952
M 100,36,236
TR 32,5,49408
M 100,40,244
TR 34,5,49920
M 100,44,252
TR 36,5,53504
s_waitcnt lgkmcnt(9)
M 104,48,224
TR 38,5,54016
s_add_u32 s48, s63, 4
s_cmp_ge_u32 s48, s45
s_cselect_b32 s62, s45, 0
s_sub_u32 s48, s48, s62
s_waitcnt lgkmcnt(8)
M 104,52,232
TR 40,5,57600
s_add_u32 s48, s48, s58
s_lshr_b32 s49, s48, 1
s_waitcnt lgkmcnt(7)
M 104,56,240
TR 42,5,58112
s_lshl_b32 s49, s49, 19
s_waitcnt lgkmcnt(6)
M 104,60,248
TR 44,5,61696
s_and_b32 s48, s48, 1
s_lshl_b32 s48, s48, 11
M 108,48,228
TR 46,5,62208
s_add_u32 s48, s48, s49
M 108,52,236
TR 48,6,49408
s_lshl_b32 s49, s41, 16
M 108,56,244
TR 50,6,49920
s_add_u32 s48, s48, s49
M 108,60,252
TR 52,6,53504
s_lshl_b32 s49, s40, 13
s_add_u32 s48, s48, s49
s_waitcnt lgkmcnt(9)
M 112,32,224
TR 54,6,54016
s_add_u32 s50, s48, 4096
s_waitcnt lgkmcnt(8)
M 112,36,232
TR 56,6,57600
PK 16,64,65
PK 17,66,67
s_waitcnt lgkmcnt(7)
M 112,40,240
TR 58,6,58112
PK 18,72,73
s_waitcnt lgkmcnt(6)
M 112,44,248
TR 60,6,61696
PK 19,74,75
M 116,32,228
TR 62,6,62208
buffer_store_dwordx4 v[16:19], v7, s[28:31], s48 offen offset:0 sc1
M 116,36,236
PK 20,80,81
PK 21,82,83
M 116,40,244
PK 22,88,89
M 116,44,252
PK 23,90,91
buffer_store_dwordx4 v[20:23], v7, s[28:31], s48 offen offset:1024 sc1
s_waitcnt lgkmcnt(6)
M 120,48,224
PK 24,68,69
s_waitcnt lgkmcnt(4)
M 120,52,232
PK 25,70,71
s_waitcnt lgkmcnt(2)
M 120,56,240
PK 26,76,77
s_waitcnt lgkmcnt(0)
M 120,60,248
PK 27,78,79
buffer_store_dwordx4 v[24:27], v7, s[28:31], s50 offen offset:0 sc1
M 124,48,228
PK 28,84,85
M 124,52,236
PK 29,86,87
PK 30,92,93
M 124,56,244
PK 31,94,95
M 124,60,252
buffer_store_dwordx4 v[28:31], v7, s[28:31], s50 offen offset:1024 sc1
s_nop 7
s_add_u32 s48, s63, 5
s_cmp_ge_u32 s48, s45
s_cselect_b32 s62, s45, 0
s_sub_u32 s48, s48, s62
s_add_u32 s48, s48, s58
s_lshr_b32 s49, s48, 1
s_lshl_b32 s49, s49, 19
s_and_b32 s48, s48, 1
s_lshl_b32 s48, s48, 11
s_add_u32 s48, s48, s49
s_lshl_b32 s49, s41, 16
s_add_u32 s48, s48, s49
s_lshl_b32 s49, s40, 13
s_add_u32 s48, s48, s49
s_add_u32 s50, s48, 4096
PK 96,96,97
PK 97,98,99
PK 98,104,105
PK 99,106,107
buffer_store_dwordx4 v[96:99], v7, s[28:31], s48 offen offset:0 sc1
PK 112,112,113
PK 113,114,115
PK 114,120,121
PK 115,122,123
buffer_store_dwordx4 v[112:115], v7, s[28:31], s48 offen offset:1024 sc1
PK 100,100,101
PK 101,102,103
PK 102,108,109
PK 103,110,111
buffer_store_dwordx4 v[100:103], v7, s[28:31], s50 offen offset:0 sc1
PK 116,116,117
PK 117,118,119
PK 118,124,125
PK 119,126,127
buffer_store_dwordx4 v[116:119], v7, s[28:31], s50 offen offset:1024 sc1
s_add_u32 s58, s42, 0
s_lshl_b32 s58, s58, 7
s_lshl_b32 s49, s41, 2
s_add_u32 s58, s58, s49
s_branch L_p2f
L_k1_K_end:
L_k1_V:
s_getpc_b64 s[36:37]
L_pc_15:
v_lshlrev_b32 v26, 7, v0
v_min_u32 v26, L_k1_V_end-L_pc_15-4, v26
v_mov_b32 v27, s37
v_add_co_u32 v26, vcc, s36, v26
s_nop 1
v_addc_co_u32 v27, vcc, 0, v27, vcc
global_load_dword v14, v[26:27], off
v_bfe_u32 v28, v0, 5, 1
v_bfe_u32 v29, v0, 2, 2
v_lshl_add_u32 v28, v28, 2, v29
v_mul_u32_u24 v28, 8192, v28
v_bfe_u32 v29, v0, 4, 1
v_lshl_add_u32 v28, v29, 6, v28
v_and_b32 v29, 3, v0
v_xor_b32 v30, 2, v29
v_lshlrev_b32 v29, 4, v29
v_lshlrev_b32 v30, 4, v30
v_add_u32 v31, 0, v28
v_add_u32 v1, v31, v29
v_add_u32 v31, 64512, v28
v_add_u32 v2, v31, v30
v_add_u32 v31, 129024, v28
v_add_u32 v3, v31, v29
v_add_u32 v31, 193536, v28
v_add_u32 v4, v31, v30
s_waitcnt lgkmcnt(0)
s_add_u32 s100, s16, 79691776
s_addc_u32 s101, s17, 0
s_sub_u32 s42, s3, 11
v_and_b32 v28, 63, v0
v_lshlrev_b32 v7, 4, v28
s_mov_b32 s24, s6
s_mov_b32 s25, s7
s_mov_b32 s26, 2097152
s_mov_b32 s27, 0x20000
s_mov_b32 s20, s12
s_mov_b32 s21, s13
s_mov_b32 s22, 4194304
s_mov_b32 s23, 0x20000
s_mul_i32 s58, s42, 6
s_lshl_b32 s44, s58, 7
s_cmp_lt_u32 s42, 10
s_cselect_b32 s45, 6, 4
s_mov_b32 s63, 0
s_lshl_b32 s63, s63, 1
s_cmp_ge_u32 s63, s45
s_cselect_b32 s49, s45, 0
s_sub_u32 s63, s63, s49
s_lshl_b32 s46, s40, 12
s_bfe_u32 s60, s2, 0x20005
s_bfe_u32 s49, s2, 0x20003
s_add_u32 s60, s60, s49
s_and_b32 s60, s60, 3
s_lshl_b32 s49, s60, 2
s_add_u32 s49, s49, s40
s_and_b32 s50, s49, 15
s_mul_i32 s56, s50, 262144
s_xor_b32 s50, s50, 8
s_mul_i32 s61, s50, 262144
s_and_b32 s57, s40, 3
s_mul_i32 s57, s57, 262144
s_lshr_b32 s49, s40, 2
s_lshl_b32 s49, s49, 7
s_add_u32 s57, s57, s49
s_lshl_b32 s49, s63, 7
s_add_u32 s57, s57, s49
s_add_u32 s57, s57, s44
s_add_u32 s47, s60, 0
s_and_b32 s47, s47, 3
s_mul_i32 s47, s47, 1048576
s_add_u32 s47, s47, s57
s_add_u32 m0, s46, 0
s_nop 0
buffer_load_dwordx4 v1, s[20:23], s47 offen offset:0  lds
s_add_u32 m0, s46, 0
s_nop 0
buffer_load_dwordx4 v2, s[20:23], s47 offen offset:1024  lds
s_add_u32 m0, s46, 0
s_nop 0
buffer_load_dwordx4 v3, s[20:23], s47 offen offset:2048  lds
s_add_u32 m0, s46, 0
s_nop 0
buffer_load_dwordx4 v4, s[20:23], s47 offen offset:3072  lds
v_bfe_u32 v28, v0, 3, 3
v_and_b32 v29, 7, v0
v_lshrrev_b32 v30, 1, v28
v_xor_b32 v29, v29, v30
s_lshl_b32 s49, s41, 8
s_lshl_b32 s50, s40, 5
s_add_u32 s49, s49, s50
v_add_u32 v28, s49, v28
v_lshlrev_b32 v28, 10, v28
v_xor_b32 v30, 4, v29
v_lshl_add_u32 v29, v29, 4, v28
v_lshl_add_u32 v30, v30, 4, v28
v_add_u32 v20, 0, v29
v_add_u32 v21, 7168, v30
v_add_u32 v22, 14336, v29
v_add_u32 v23, 21504, v30
s_add_u32 s43, s60, 0
s_and_b32 s43, s43, 3
s_lshl_b32 s43, s43, 8
s_add_u32 m0, s46, 98304
s_nop 0
buffer_load_dwordx4 v20, s[24:27], s43 offen offset:0 lds
s_add_u32 m0, s46, 98304
s_nop 0
buffer_load_dwordx4 v21, s[24:27], s43 offen offset:1024 lds
s_add_u32 m0, s46, 98304
s_nop 0
buffer_load_dwordx4 v22, s[24:27], s43 offen offset:2048 lds
s_add_u32 m0, s46, 98304
s_nop 0
buffer_load_dwordx4 v23, s[24:27], s43 offen offset:3072 lds
s_barrier
s_add_u32 s43, s60, 0
s_and_b32 s43, s43, 3
s_lshl_b32 s43, s43, 8
s_add_u32 s43, s43, 128
s_add_u32 m0, s46, 131072
s_nop 0
buffer_load_dwordx4 v20, s[24:27], s43 offen offset:0 lds
s_add_u32 m0, s46, 131072
s_nop 0
buffer_load_dwordx4 v21, s[24:27], s43 offen offset:1024 lds
s_add_u32 m0, s46, 131072
s_nop 0
buffer_load_dwordx4 v22, s[24:27], s43 offen offset:2048 lds
s_add_u32 m0, s46, 131072
s_nop 0
buffer_load_dwordx4 v23, s[24:27], s43 offen offset:3072 lds
s_add_u32 s47, s60, 1
s_and_b32 s47, s47, 3
s_mul_i32 s47, s47, 1048576
s_add_u32 s47, s47, s57
s_add_u32 m0, s46, 32768
s_nop 0
buffer_load_dwordx4 v1, s[20:23], s47 offen offset:0  lds
s_add_u32 m0, s46, 32768
s_nop 0
buffer_load_dwordx4 v2, s[20:23], s47 offen offset:1024  lds
s_add_u32 m0, s46, 32768
s_nop 0
buffer_load_dwordx4 v3, s[20:23], s47 offen offset:2048  lds
s_add_u32 m0, s46, 32768
s_nop 0
buffer_load_dwordx4 v4, s[20:23], s47 offen offset:3072  lds
v_and_b32 v28, 15, v0
v_bfe_u32 v29, v0, 4, 2
v_lshrrev_b32 v30, 1, v28
v_xor_b32 v29, v29, v30
v_lshlrev_b32 v29, 4, v29
v_lshl_add_u32 v29, v28, 7, v29
s_add_u32 s49, s46, 0x10000
v_add_u32 v9, s49, v29
v_xor_b32 v10, 64, v9
v_add_u32 v11, 0x10000, v9
v_add_u32 v12, 0x10000, v10
s_add_u32 s28, s16, 18874368
s_addc_u32 s29, s17, 0
s_mov_b32 s30, 16777216
s_mov_b32 s31, 0x20000
v_bfe_u32 v28, v0, 4, 2
v_lshlrev_b32 v29, 10, v28
v_bfe_u32 v30, v0, 2, 2
v_lshl_add_u32 v29, v30, 6, v29
v_and_b32 v30, 3, v0
v_lshl_add_u32 v29, v30, 3, v29
v_and_b32 v28, 1, v28
v_lshl_add_u32 v5, v28, 5, v29
v_xor_b32 v6, 32, v5
s_waitcnt vmcnt(8)
DR 128,9,32768
DR 132,9,34816
DR 136,10,32768
DR 140,10,34816
s_waitcnt vmcnt(4)
DR 144,11,0
DR 148,11,2048
DR 152,12,0
DR 156,12,2048
s_barrier
TR 32,5,0
TR 34,5,512
TR 36,5,4096
TR 38,5,4608
TR 40,5,8192
TR 42,5,8704
TR 44,5,12288
TR 46,5,12800
TR 48,6,0
TR 50,6,512
TR 52,6,4096
TR 54,6,4608
TR 56,6,8192
TR 58,6,8704
TR 60,6,12288
TR 62,6,12800
s_waitcnt lgkmcnt(15)
s_add_u32 s43, s60, 1
s_and_b32 s43, s43, 3
s_lshl_b32 s43, s43, 8
s_add_u32 m0, s46, 98304
s_nop 0
buffer_load_dwordx4 v20, s[24:27], s43 offen offset:0 lds
s_waitcnt lgkmcnt(14)
MZ 64,128,32
s_waitcnt lgkmcnt(12)
M 64,136,36
s_add_u32 m0, s46, 98304
s_nop 0
buffer_load_dwordx4 v21, s[24:27], s43 offen offset:1024 lds
s_waitcnt lgkmcnt(10)
M 64,144,40
s_waitcnt lgkmcnt(8)
M 64,152,44
s_add_u32 m0, s46, 98304
s_nop 0
buffer_load_dwordx4 v22, s[24:27], s43 offen offset:2048 lds
MZ 68,132,32
M 68,140,36
TR 32,5,256
s_add_u32 m0, s46, 98304
s_nop 0
buffer_load_dwordx4 v23, s[24:27], s43 offen offset:3072 lds
M 68,148,40
TR 34,5,768
M 68,156,44
TR 36,5,4352
s_add_u32 s43, s60, 1
s_and_b32 s43, s43, 3
s_lshl_b32 s43, s43, 8
s_add_u32 s43, s43, 128
s_add_u32 m0, s46, 131072
s_nop 0
buffer_load_dwordx4 v20, s[24:27], s43 offen offset:0 lds
s_waitcnt lgkmcnt(9)
MZ 72,128,48
TR 38,5,4864
s_waitcnt lgkmcnt(8)
M 72,136,52
TR 40,5,8448
s_add_u32 m0, s46, 131072
s_nop 0
buffer_load_dwordx4 v21, s[24:27], s43 offen offset:1024 lds
s_waitcnt lgkmcnt(7)
M 72,144,56
TR 42,5,8960
s_waitcnt lgkmcnt(6)
M 72,152,60
TR 44,5,12544
s_add_u32 m0, s46, 131072
s_nop 0
buffer_load_dwordx4 v22, s[24:27], s43 offen offset:2048 lds
MZ 76,132,48
TR 46,5,13056
M 76,140,52
TR 48,6,256
s_add_u32 m0, s46, 131072
s_nop 0
buffer_load_dwordx4 v23, s[24:27], s43 offen offset:3072 lds
M 76,148,56
TR 50,6,768
M 76,156,60
TR 52,6,4352
s_add_u32 s47, s60, 2
s_and_b32 s47, s47, 3
s_mul_i32 s47, s47, 1048576
s_add_u32 s47, s47, s57
s_add_u32 m0, s46, 65536
s_nop 0
buffer_load_dwordx4 v1, s[20:23], s47 offen offset:0  lds
s_waitcnt lgkmcnt(9)
MZ 80,128,32
TR 54,6,4864
s_waitcnt lgkmcnt(8)
M 80,136,36
TR 56,6,8448
s_add_u32 m0, s46, 65536
s_nop 0
buffer_load_dwordx4 v2, s[20:23], s47 offen offset:1024  lds
s_waitcnt lgkmcnt(7)
M 80,144,40
TR 58,6,8960
s_waitcnt lgkmcnt(6)
M 80,152,44
TR 60,6,12544
s_add_u32 m0, s46, 65536
s_nop 0
buffer_load_dwordx4 v3, s[20:23], s47 offen offset:2048  lds
MZ 84,132,32
TR 62,6,13056
M 84,140,36
TR 32,5,16384
s_add_u32 m0, s46, 65536
s_nop 0
buffer_load_dwordx4 v4, s[20:23], s47 offen offset:3072  lds
M 84,148,40
TR 34,5,16896
M 84,156,44
TR 36,5,20480
s_waitcnt lgkmcnt(9)
MZ 88,128,48
TR 38,5,20992
s_waitcnt lgkmcnt(8)
M 88,136,52
TR 40,5,24576
s_waitcnt lgkmcnt(7)
M 88,144,56
TR 42,5,25088
s_waitcnt lgkmcnt(6)
M 88,152,60
TR 44,5,28672
MZ 92,132,48
TR 46,5,29184
M 92,140,52
TR 48,6,16384
M 92,148,56
TR 50,6,16896
M 92,156,60
TR 52,6,20480
s_waitcnt lgkmcnt(9)
MZ 96,128,32
TR 54,6,20992
s_waitcnt lgkmcnt(8)
M 96,136,36
TR 56,6,24576
s_waitcnt lgkmcnt(7)
M 96,144,40
TR 58,6,25088
s_waitcnt lgkmcnt(6)
M 96,152,44
TR 60,6,28672
MZ 100,132,32
TR 62,6,29184
M 100,140,36
TR 32,5,16640
M 100,148,40
TR 34,5,17152
M 100,156,44
TR 36,5,20736
s_waitcnt vmcnt(8)
DR 160,9,32768
DR 164,9,34816
DR 168,10,32768
DR 172,10,34816
s_waitcnt lgkmcnt(13)
MZ 104,128,48
TR 38,5,21248
s_waitcnt lgkmcnt(12)
M 104,136,52
TR 40,5,24832
s_waitcnt lgkmcnt(11)
M 104,144,56
TR 42,5,25344
s_waitcnt lgkmcnt(10)
M 104,152,60
TR 44,5,28928
MZ 108,132,48
TR 46,5,29440
M 108,140,52
TR 48,6,16640
M 108,148,56
TR 50,6,17152
M 108,156,60
TR 52,6,20736
s_waitcnt lgkmcnt(8)
s_add_u32 s43, s60, 2
s_and_b32 s43, s43, 3
s_lshl_b32 s43, s43, 8
s_add_u32 m0, s46, 98304
s_nop 0
buffer_load_dwordx4 v20, s[24:27], s43 offen offset:0 lds
MZ 112,128,32
TR 54,6,21248
s_waitcnt lgkmcnt(8)
M 112,136,36
TR 56,6,24832
s_add_u32 m0, s46, 98304
s_nop 0
buffer_load_dwordx4 v21, s[24:27], s43 offen offset:1024 lds
s_waitcnt lgkmcnt(7)
M 112,144,40
TR 58,6,25344
s_waitcnt lgkmcnt(6)
M 112,152,44
TR 60,6,28928
s_add_u32 m0, s46, 98304
s_nop 0
buffer_load_dwordx4 v22, s[24:27], s43 offen offset:2048 lds
MZ 116,132,32
TR 62,6,29440
M 116,140,36
s_barrier
TR 32,5,32768
s_add_u32 m0, s46, 98304
s_nop 0
buffer_load_dwordx4 v23, s[24:27], s43 offen offset:3072 lds
M 116,148,40
TR 34,5,33280
M 116,156,44
TR 36,5,36864
s_waitcnt vmcnt(8)
DR 176,11,0
DR 180,11,2048
DR 184,12,0
DR 188,12,2048
s_waitcnt lgkmcnt(13)
MZ 120,128,48
TR 38,5,37376
s_waitcnt lgkmcnt(12)
M 120,136,52
TR 40,5,40960
s_waitcnt lgkmcnt(11)
M 120,144,56
TR 42,5,41472
s_waitcnt lgkmcnt(10)
M 120,152,60
TR 44,5,45056
MZ 124,132,48
TR 46,5,45568
M 124,140,52
TR 48,6,32768
M 124,148,56
TR 50,6,33280
M 124,156,60
TR 52,6,36864
s_waitcnt lgkmcnt(8)
s_add_u32 s43, s60, 2
s_and_b32 s43, s43, 3
s_lshl_b32 s43, s43, 8
s_add_u32 s43, s43, 128
s_add_u32 m0, s46, 131072
s_nop 0
buffer_load_dwordx4 v20, s[24:27], s43 offen offset:0 lds
M 64,160,32
TR 54,6,37376
s_waitcnt lgkmcnt(8)
M 64,168,36
TR 56,6,40960
s_add_u32 m0, s46, 131072
s_nop 0
buffer_load_dwordx4 v21, s[24:27], s43 offen offset:1024 lds
s_waitcnt lgkmcnt(7)
M 64,176,40
TR 58,6,41472
s_waitcnt lgkmcnt(6)
M 64,184,44
TR 60,6,45056
s_add_u32 m0, s46, 131072
s_nop 0
buffer_load_dwordx4 v22, s[24:27], s43 offen offset:2048 lds
M 68,164,32
TR 62,6,45568
M 68,172,36
TR 32,5,33024
s_add_u32 m0, s46, 131072
s_nop 0
buffer_load_dwordx4 v23, s[24:27], s43 offen offset:3072 lds
M 68,180,40
TR 34,5,33536
M 68,188,44
TR 36,5,37120
s_waitcnt lgkmcnt(9)
M 72,160,48
TR 38,5,37632
s_waitcnt lgkmcnt(8)
M 72,168,52
TR 40,5,41216
s_waitcnt lgkmcnt(7)
M 72,176,56
TR 42,5,41728
s_waitcnt lgkmcnt(6)
M 72,184,60
TR 44,5,45312
M 76,164,48
TR 46,5,45824
M 76,172,52
TR 48,6,33024
M 76,180,56
TR 50,6,33536
M 76,188,60
TR 52,6,37120
s_waitcnt lgkmcnt(9)
M 80,160,32
TR 54,6,37632
s_waitcnt lgkmcnt(8)
M 80,168,36
TR 56,6,41216
s_waitcnt lgkmcnt(7)
M 80,176,40
TR 58,6,41728
s_waitcnt lgkmcnt(6)
M 80,184,44
TR 60,6,45312
s_waitcnt vmcnt(4)
DR 192,9,32768
DR 196,9,34816
DR 200,10,32768
DR 204,10,34816
M 84,164,32
TR 62,6,45824
M 84,172,36
TR 32,5,49152
M 84,180,40
TR 34,5,49664
M 84,188,44
TR 36,5,53248
s_waitcnt lgkmcnt(13)
M 88,160,48
TR 38,5,53760
s_waitcnt lgkmcnt(12)
M 88,168,52
TR 40,5,57344
s_waitcnt lgkmcnt(11)
M 88,176,56
TR 42,5,57856
s_waitcnt lgkmcnt(6)
M 88,184,60
TR 44,5,61440
s_add_u32 s47, s60, 3
s_and_b32 s47, s47, 3
s_mul_i32 s47, s47, 1048576
s_add_u32 s47, s47, s57
s_add_u32 m0, s46, 98304
s_nop 0
buffer_load_dwordx4 v1, s[20:23], s47 offen offset:0  lds
M 92,164,48
TR 46,5,61952
M 92,172,52
TR 48,6,49152
s_add_u32 m0, s46, 98304
s_nop 0
buffer_load_dwordx4 v2, s[20:23], s47 offen offset:1024  lds
M 92,180,56
TR 50,6,49664
M 92,188,60
TR 52,6,53248
s_add_u32 m0, s46, 98304
s_nop 0
buffer_load_dwordx4 v3, s[20:23], s47 offen offset:2048  lds
s_waitcnt lgkmcnt(9)
M 96,160,32
TR 54,6,53760
s_waitcnt lgkmcnt(8)
M 96,168,36
TR 56,6,57344
s_add_u32 m0, s46, 98304
s_nop 0
buffer_load_dwordx4 v4, s[20:23], s47 offen offset:3072  lds
s_waitcnt lgkmcnt(7)
M 96,176,40
TR 58,6,57856
s_waitcnt lgkmcnt(6)
M 96,184,44
TR 60,6,61440
s_waitcnt vmcnt(4)
DR 208,11,0
DR 212,11,2048
DR 216,12,0
DR 220,12,2048
M 100,164,32
TR 62,6,61952
M 100,172,36
TR 32,5,49408
M 100,180,40
TR 34,5,49920
M 100,188,44
TR 36,5,53504
s_waitcnt lgkmcnt(13)
M 104,160,48
TR 38,5,54016
s_waitcnt lgkmcnt(12)
M 104,168,52
TR 40,5,57600
s_waitcnt lgkmcnt(11)
M 104,176,56
TR 42,5,58112
s_waitcnt lgkmcnt(6)
M 104,184,60
TR 44,5,61696
s_add_u32 s43, s60, 3
s_and_b32 s43, s43, 3
s_lshl_b32 s43, s43, 8
s_add_u32 m0, s46, 131072
s_nop 0
buffer_load_dwordx4 v20, s[24:27], s43 offen offset:0 lds
M 108,164,48
TR 46,5,62208
M 108,172,52
TR 48,6,49408
s_add_u32 m0, s46, 131072
s_nop 0
buffer_load_dwordx4 v21, s[24:27], s43 offen offset:1024 lds
M 108,180,56
TR 50,6,49920
M 108,188,60
TR 52,6,53504
s_add_u32 m0, s46, 131072
s_nop 0
buffer_load_dwordx4 v22, s[24:27], s43 offen offset:2048 lds
s_waitcnt lgkmcnt(9)
M 112,160,32
TR 54,6,54016
s_waitcnt lgkmcnt(8)
M 112,168,36
TR 56,6,57600
s_add_u32 m0, s46, 131072
s_nop 0
buffer_load_dwordx4 v23, s[24:27], s43 offen offset:3072 lds
s_waitcnt lgkmcnt(7)
M 112,176,40
TR 58,6,58112
s_waitcnt lgkmcnt(6)
M 112,184,44
TR 60,6,61696
M 116,164,32
TR 62,6,62208
M 116,172,36
s_barrier
v_xor_b32 v5, 0x10000, v5
v_xor_b32 v6, 0x10000, v6
TR 32,5,0
M 116,180,40
TR 34,5,512
M 116,188,44
TR 36,5,4096
s_waitcnt lgkmcnt(9)
M 120,160,48
s_add_u32 s51, s63, 2
s_cmp_ge_u32 s51, s45
s_cselect_b32 s62, s45, 0
s_sub_u32 s51, s51, s62
s_lshl_b32 s51, s51, 7
s_add_u32 s51, s51, s44
s_add_u32 s51, s51, s56
s_add_u32 m0, s46, 0
s_nop 0
buffer_load_dwordx4 v1, s[20:23], s51 offen offset:0  lds
TR 38,5,4608
s_waitcnt lgkmcnt(8)
M 120,168,52
TR 40,5,8192
s_waitcnt lgkmcnt(7)
M 120,176,56
TR 42,5,8704
s_waitcnt lgkmcnt(6)
M 120,184,60
TR 44,5,12288
M 124,164,48
TR 46,5,12800
M 124,172,52
TR 48,6,0
M 124,180,56
TR 50,6,512
M 124,188,60
TR 52,6,4096
s_waitcnt lgkmcnt(9)
M 64,192,32
TR 54,6,4608
s_waitcnt lgkmcnt(8)
M 64,200,36
TR 56,6,8192
s_waitcnt lgkmcnt(7)
M 64,208,40
TR 58,6,8704
s_waitcnt lgkmcnt(6)
M 64,216,44
TR 60,6,12288
M 68,196,32
s_add_u32 m0, s46, 0
s_nop 0
buffer_load_dwordx4 v2, s[20:23], s51 offen offset:1024  lds
TR 62,6,12800
M 68,204,36
TR 32,5,256
M 68,212,40
TR 34,5,768
M 68,220,44
TR 36,5,4352
s_waitcnt lgkmcnt(9)
M 72,192,48
TR 38,5,4864
s_waitcnt lgkmcnt(8)
M 72,200,52
TR 40,5,8448
s_waitcnt lgkmcnt(7)
M 72,208,56
TR 42,5,8960
s_waitcnt lgkmcnt(6)
M 72,216,60
TR 44,5,12544
s_waitcnt vmcnt(2)
DR 224,11,0
DR 228,11,2048
DR 232,12,0
DR 236,12,2048
M 76,196,48
TR 46,5,13056
M 76,204,52
TR 48,6,256
M 76,212,56
TR 50,6,768
M 76,220,60
TR 52,6,4352
s_waitcnt lgkmcnt(13)
M 80,192,32
s_add_u32 m0, s46, 0
s_nop 0
buffer_load_dwordx4 v3, s[20:23], s51 offen offset:2048  lds
TR 54,6,4864
s_waitcnt lgkmcnt(12)
M 80,200,36
TR 56,6,8448
s_waitcnt lgkmcnt(11)
M 80,208,40
TR 58,6,8960
s_waitcnt lgkmcnt(6)
M 80,216,44
TR 60,6,12544
s_add_u32 s43, s60, 3
s_and_b32 s43, s43, 3
s_lshl_b32 s43, s43, 8
s_add_u32 s43, s43, 128
s_add_u32 m0, s46, 131072
s_nop 0
buffer_load_dwordx4 v20, s[24:27], s43 offen offset:0 lds
M 84,196,32
TR 62,6,13056
M 84,204,36
TR 32,5,16384
s_add_u32 m0, s46, 131072
s_nop 0
buffer_load_dwordx4 v21, s[24:27], s43 offen offset:1024 lds
M 84,212,40
TR 34,5,16896
M 84,220,44
TR 36,5,20480
s_add_u32 m0, s46, 131072
s_nop 0
buffer_load_dwordx4 v22, s[24:27], s43 offen offset:2048 lds
s_waitcnt lgkmcnt(9)
M 88,192,48
TR 38,5,20992
s_waitcnt lgkmcnt(8)
M 88,200,52
TR 40,5,24576
s_add_u32 m0, s46, 131072
s_nop 0
buffer_load_dwordx4 v23, s[24:27], s43 offen offset:3072 lds
s_waitcnt lgkmcnt(7)
M 88,208,56
TR 42,5,25088
s_waitcnt lgkmcnt(6)
M 88,216,60
TR 44,5,28672
M 92,196,48
s_add_u32 m0, s46, 0
s_nop 0
buffer_load_dwordx4 v4, s[20:23], s51 offen offset:3072  lds
TR 46,5,29184
M 92,204,52
TR 48,6,16384
M 92,212,56
TR 50,6,16896
M 92,220,60
TR 52,6,20480
s_waitcnt lgkmcnt(9)
M 96,192,32
TR 54,6,20992
s_waitcnt lgkmcnt(8)
M 96,200,36
TR 56,6,24576
s_waitcnt lgkmcnt(7)
M 96,208,40
TR 58,6,25088
s_waitcnt lgkmcnt(6)
M 96,216,44
TR 60,6,28672
M 100,196,32
TR 62,6,29184
M 100,204,36
TR 32,5,16640
M 100,212,40
TR 34,5,17152
M 100,220,44
TR 36,5,20736
s_waitcnt lgkmcnt(9)
M 104,192,48
TR 38,5,21248
s_waitcnt lgkmcnt(8)
M 104,200,52
TR 40,5,24832
s_waitcnt lgkmcnt(7)
M 104,208,56
TR 42,5,25344
s_waitcnt lgkmcnt(6)
M 104,216,60
TR 44,5,28928
M 108,196,48
TR 46,5,29440
M 108,204,52
TR 48,6,16640
M 108,212,56
TR 50,6,17152
M 108,220,60
TR 52,6,20736
s_waitcnt lgkmcnt(9)
M 112,192,32
TR 54,6,21248
s_waitcnt lgkmcnt(8)
M 112,200,36
TR 56,6,24832
s_waitcnt lgkmcnt(7)
M 112,208,40
TR 58,6,25344
s_waitcnt lgkmcnt(6)
M 112,216,44
TR 60,6,28928
M 116,196,32
TR 62,6,29440
M 116,204,36
s_barrier
TR 32,5,32768
M 116,212,40
TR 34,5,33280
M 116,220,44
TR 36,5,36864
s_waitcnt vmcnt(1)
DR 240,11,0
DR 244,11,2048
DR 248,12,0
DR 252,12,2048
s_waitcnt lgkmcnt(13)
M 120,192,48
s_add_u32 s51, s63, 2
s_cmp_ge_u32 s51, s45
s_cselect_b32 s62, s45, 0
s_sub_u32 s51, s51, s62
s_lshl_b32 s51, s51, 7
s_add_u32 s51, s51, s44
s_add_u32 s51, s51, s61
s_add_u32 m0, s46, 32768
s_nop 0
buffer_load_dwordx4 v1, s[20:23], s51 offen offset:0  lds
TR 38,5,37376
s_waitcnt lgkmcnt(12)
M 120,200,52
TR 40,5,40960
s_waitcnt lgkmcnt(11)
M 120,208,56
TR 42,5,41472
s_waitcnt lgkmcnt(10)
M 120,216,60
TR 44,5,45056
M 124,196,48
TR 46,5,45568
M 124,204,52
TR 48,6,32768
M 124,212,56
TR 50,6,33280
M 124,220,60
TR 52,6,36864
s_waitcnt lgkmcnt(8)
M 64,224,32
TR 54,6,37376
s_waitcnt lgkmcnt(8)
M 64,232,36
TR 56,6,40960
s_mov_b32 s32, s8
s_mov_b32 s33, s9
s_mov_b32 s34, 4194304
s_mov_b32 s35, 0x20000
s_and_b32 s43, s2, 0xf8
s_add_u32 s43, s43, s40
s_lshl_b32 s43, s43, 14
s_and_b32 s47, s2, 6
s_lshl_b32 s47, s47, 8
s_add_u32 s47, s47, s43
v_and_b32 v14, 3, v0
v_lshlrev_b32 v14, 7, v14
v_bfe_u32 v15, v0, 2, 3
v_lshl_add_u32 v14, v15, 11, v14
v_bfe_u32 v15, v0, 5, 1
v_lshl_add_u32 v15, v15, 28, v14
buffer_load_dword v14, v15, s[32:35], s47 offen
s_cmp_lt_u32 s2, 8
s_cbranch_scc0 L_nocode_16
s_getpc_b64 s[36:37]
L_pc_17:
s_add_u32 s36, s36, L_p2-L_pc_17
s_addc_u32 s37, s37, 0
v_lshlrev_b32 v26, 7, v0
v_min_u32 v26, L_all_end-L_p2-4, v26
v_mov_b32 v27, s37
v_add_co_u32 v26, vcc, s36, v26
s_nop 1
v_addc_co_u32 v27, vcc, 0, v27, vcc
global_load_dword v14, v[26:27], off
L_nocode_16:
s_cmp_lt_u32 s2, 192
s_cbranch_scc1 L_nosp_18
s_bitcmp1_b32 s2, 0
s_cbranch_scc1 L_nosp_18
s_load_dwordx2 s[36:37], s[0:1], 64
s_and_b32 s43, s2, 56
s_add_u32 s43, s43, s40
s_lshl_b32 s43, s43, 15
s_and_b32 s47, s2, 7
s_lshl_b32 s47, s47, 20
s_add_u32 s43, s43, s47
v_bfe_u32 v13, v0, 3, 3
v_lshlrev_b32 v13, 12, v13
v_and_b32 v15, 7, v0
v_lshl_add_u32 v13, v15, 7, v13
s_waitcnt lgkmcnt(0)
s_mov_b32 s38, 8388608
s_mov_b32 s39, 0x20000
buffer_load_dword v14, v13, s[36:39], s43 offen offset:0
L_nosp_18:
s_waitcnt lgkmcnt(7)
M 64,240,40
TR 58,6,41472
s_waitcnt lgkmcnt(6)
M 64,248,44
TR 60,6,45056
M 68,228,32
s_add_u32 m0, s46, 32768
s_nop 0
buffer_load_dwordx4 v2, s[20:23], s51 offen offset:1024  lds
TR 62,6,45568
M 68,236,36
TR 32,5,33024
M 68,244,40
TR 34,5,33536
M 68,252,44
TR 36,5,37120
s_waitcnt lgkmcnt(9)
M 72,224,48
TR 38,5,37632
s_waitcnt lgkmcnt(8)
M 72,232,52
TR 40,5,41216
s_waitcnt lgkmcnt(7)
M 72,240,56
TR 42,5,41728
s_waitcnt lgkmcnt(6)
M 72,248,60
TR 44,5,45312
M 76,228,48
TR 46,5,45824
M 76,236,52
TR 48,6,33024
M 76,244,56
TR 50,6,33536
M 76,252,60
TR 52,6,37120
s_waitcnt lgkmcnt(9)
M 80,224,32
s_add_u32 m0, s46, 32768
s_nop 0
buffer_load_dwordx4 v3, s[20:23], s51 offen offset:2048  lds
TR 54,6,37632
s_waitcnt lgkmcnt(8)
M 80,232,36
TR 56,6,41216
s_waitcnt lgkmcnt(7)
M 80,240,40
TR 58,6,41728
s_waitcnt lgkmcnt(6)
M 80,248,44
TR 60,6,45312
M 84,228,32
TR 62,6,45824
M 84,236,36
TR 32,5,49152
M 84,244,40
TR 34,5,49664
M 84,252,44
TR 36,5,53248
s_waitcnt lgkmcnt(9)
M 88,224,48
TR 38,5,53760
s_waitcnt lgkmcnt(8)
M 88,232,52
TR 40,5,57344
s_waitcnt lgkmcnt(7)
M 88,240,56
TR 42,5,57856
s_waitcnt lgkmcnt(6)
M 88,248,60
TR 44,5,61440
M 92,228,48
s_add_u32 m0, s46, 32768
s_nop 0
buffer_load_dwordx4 v4, s[20:23], s51 offen offset:3072  lds
TR 46,5,61952
M 92,236,52
TR 48,6,49152
M 92,244,56
TR 50,6,49664
M 92,252,60
TR 52,6,53248
s_waitcnt lgkmcnt(9)
M 96,224,32
TR 54,6,53760
s_waitcnt lgkmcnt(8)
M 96,232,36
TR 56,6,57344
s_waitcnt lgkmcnt(7)
M 96,240,40
TR 58,6,57856
s_waitcnt lgkmcnt(6)
M 96,248,44
TR 60,6,61440
M 100,228,32
TR 62,6,61952
M 100,236,36
TR 32,5,49408
M 100,244,40
TR 34,5,49920
M 100,252,44
TR 36,5,53504
s_waitcnt lgkmcnt(9)
M 104,224,48
TR 38,5,54016
s_add_u32 s48, s63, 0
s_cmp_ge_u32 s48, s45
s_cselect_b32 s62, s45, 0
s_sub_u32 s48, s48, s62
s_waitcnt lgkmcnt(8)
M 104,232,52
TR 40,5,57600
s_add_u32 s48, s48, s58
s_lshr_b32 s49, s48, 1
s_waitcnt lgkmcnt(7)
M 104,240,56
TR 42,5,58112
s_lshl_b32 s49, s49, 19
s_waitcnt lgkmcnt(6)
M 104,248,60
TR 44,5,61696
s_and_b32 s48, s48, 1
s_lshl_b32 s48, s48, 12
M 108,228,48
TR 46,5,62208
s_add_u32 s48, s48, s49
M 108,236,52
TR 48,6,49408
s_lshl_b32 s49, s41, 16
M 108,244,56
TR 50,6,49920
s_add_u32 s48, s48, s49
M 108,252,60
TR 52,6,53504
s_lshl_b32 s49, s40, 13
s_add_u32 s48, s48, s49
s_waitcnt lgkmcnt(9)
M 112,224,32
TR 54,6,54016
s_add_u32 s50, s48, 4096
s_waitcnt lgkmcnt(8)
M 112,232,36
TR 56,6,57600
PK 16,64,65
s_waitcnt lgkmcnt(7)
M 112,240,40
TR 58,6,58112
PK 17,66,67
s_waitcnt lgkmcnt(6)
M 112,248,44
TR 60,6,61696
PK 18,68,69
PK 19,70,71
M 116,228,32
TR 62,6,62208
PK 20,72,73
M 116,236,36
s_waitcnt vmcnt(5)
s_barrier
v_xor_b32 v5, 0x10000, v5
v_xor_b32 v6, 0x10000, v6
TR 32,5,0
PK 21,74,75
M 116,244,40
TR 34,5,512
PK 22,76,77
M 116,252,44
TR 36,5,4096
PK 23,78,79
PK 24,80,81
s_waitcnt lgkmcnt(9)
M 120,224,48
s_add_u32 s51, s63, 3
s_cmp_ge_u32 s51, s45
s_cselect_b32 s62, s45, 0
s_sub_u32 s51, s51, s62
s_lshl_b32 s51, s51, 7
s_add_u32 s51, s51, s44
s_add_u32 s51, s51, s56
s_add_u32 m0, s46, 65536
s_nop 0
buffer_load_dwordx4 v1, s[20:23], s51 offen offset:0  lds
TR 38,5,4608
PK 25,82,83
s_waitcnt lgkmcnt(8)
M 120,232,52
TR 40,5,8192
PK 26,84,85
s_waitcnt lgkmcnt(7)
M 120,240,56
TR 42,5,8704
PK 27,86,87
s_waitcnt lgkmcnt(6)
M 120,248,60
TR 44,5,12288
PK 28,88,89
PK 29,90,91
M 124,228,48
TR 46,5,12800
PK 30,92,93
M 124,236,52
TR 48,6,0
PK 31,94,95
M 124,244,56
TR 50,6,512
M 124,252,60
TR 52,6,4096
buffer_store_dwordx4 v[16:19], v7, s[28:31], s48 offen offset:0 sc1
s_waitcnt lgkmcnt(9)
MZ 64,128,32
TR 54,6,4608
s_waitcnt lgkmcnt(8)
M 64,136,36
TR 56,6,8192
s_waitcnt lgkmcnt(7)
M 64,144,40
TR 58,6,8704
s_waitcnt lgkmcnt(6)
M 64,152,44
TR 60,6,12288
MZ 68,132,32
s_add_u32 m0, s46, 65536
s_nop 0
buffer_load_dwordx4 v2, s[20:23], s51 offen offset:1024  lds
TR 62,6,12800
M 68,140,36
TR 32,5,256
M 68,148,40
TR 34,5,768
M 68,156,44
TR 36,5,4352
s_waitcnt lgkmcnt(9)
MZ 72,128,48
TR 38,5,4864
s_waitcnt lgkmcnt(8)
M 72,136,52
TR 40,5,8448
s_waitcnt lgkmcnt(7)
M 72,144,56
TR 42,5,8960
s_waitcnt lgkmcnt(6)
M 72,152,60
TR 44,5,12544
MZ 76,132,48
TR 46,5,13056
M 76,140,52
TR 48,6,256
M 76,148,56
TR 50,6,768
M 76,156,60
TR 52,6,4352
s_waitcnt lgkmcnt(9)
MZ 80,128,32
s_add_u32 m0, s46, 65536
s_nop 0
buffer_load_dwordx4 v3, s[20:23], s51 offen offset:2048  lds
TR 54,6,4864
s_waitcnt lgkmcnt(8)
M 80,136,36
TR 56,6,8448
s_waitcnt lgkmcnt(7)
M 80,144,40
TR 58,6,8960
s_waitcnt lgkmcnt(6)
M 80,152,44
TR 60,6,12544
MZ 84,132,32
TR 62,6,13056
M 84,140,36
TR 32,5,16384
buffer_store_dwordx4 v[20:23], v7, s[28:31], s48 offen offset:1024 sc1
M 84,148,40
TR 34,5,16896
M 84,156,44
TR 36,5,20480
s_waitcnt lgkmcnt(9)
MZ 88,128,48
TR 38,5,20992
s_waitcnt lgkmcnt(8)
M 88,136,52
TR 40,5,24576
s_waitcnt lgkmcnt(7)
M 88,144,56
TR 42,5,25088
s_waitcnt lgkmcnt(6)
M 88,152,60
TR 44,5,28672
MZ 92,132,48
s_add_u32 m0, s46, 65536
s_nop 0
buffer_load_dwordx4 v4, s[20:23], s51 offen offset:3072  lds
TR 46,5,29184
M 92,140,52
TR 48,6,16384
M 92,148,56
TR 50,6,16896
M 92,156,60
TR 52,6,20480
s_waitcnt lgkmcnt(9)
M 64,160,32
TR 54,6,20992
s_waitcnt lgkmcnt(8)
M 64,168,36
TR 56,6,24576
s_waitcnt lgkmcnt(7)
M 64,176,40
TR 58,6,25088
s_waitcnt lgkmcnt(6)
M 64,184,44
TR 60,6,28672
M 68,164,32
TR 62,6,29184
M 68,172,36
TR 32,5,16640
M 68,180,40
TR 34,5,17152
M 68,188,44
TR 36,5,20736
s_waitcnt lgkmcnt(9)
M 72,160,48
TR 38,5,21248
s_waitcnt lgkmcnt(8)
M 72,168,52
TR 40,5,24832
s_waitcnt lgkmcnt(7)
M 72,176,56
TR 42,5,25344
s_waitcnt lgkmcnt(6)
M 72,184,60
TR 44,5,28928
buffer_store_dwordx4 v[24:27], v7, s[28:31], s48 offen offset:2048 sc1
v_mov_b32 v13, 20
s_cmp_lg_u32 s40, 0
s_cbranch_scc1 L_w0_19
global_load_dword v13, v13, s[18:19] sc1
L_w0_19:
M 76,164,48
TR 46,5,29440
M 76,172,52
TR 48,6,16640
M 76,180,56
TR 50,6,17152
M 76,188,60
TR 52,6,20736
s_waitcnt lgkmcnt(9)
M 80,160,32
TR 54,6,21248
s_waitcnt lgkmcnt(8)
M 80,168,36
TR 56,6,24832
s_waitcnt lgkmcnt(7)
M 80,176,40
TR 58,6,25344
s_waitcnt lgkmcnt(6)
M 80,184,44
TR 60,6,28928
M 84,164,32
TR 62,6,29440
M 84,172,36
s_waitcnt vmcnt(7)
s_barrier
TR 32,5,32768
M 84,180,40
TR 34,5,33280
M 84,188,44
TR 36,5,36864
s_waitcnt lgkmcnt(9)
M 88,160,48
s_add_u32 s51, s63, 3
s_cmp_ge_u32 s51, s45
s_cselect_b32 s62, s45, 0
s_sub_u32 s51, s51, s62
s_lshl_b32 s51, s51, 7
s_add_u32 s51, s51, s44
s_add_u32 s51, s51, s61
s_add_u32 m0, s46, 98304
s_nop 0
buffer_load_dwordx4 v1, s[20:23], s51 offen offset:0  lds
TR 38,5,37376
s_waitcnt lgkmcnt(8)
M 88,168,52
TR 40,5,40960
s_waitcnt lgkmcnt(7)
M 88,176,56
TR 42,5,41472
s_waitcnt lgkmcnt(6)
M 88,184,60
TR 44,5,45056
M 92,164,48
TR 46,5,45568
M 92,172,52
TR 48,6,32768
M 92,180,56
TR 50,6,33280
M 92,188,60
TR 52,6,36864
s_waitcnt lgkmcnt(9)
M 64,192,32
TR 54,6,37376
s_waitcnt lgkmcnt(8)
M 64,200,36
TR 56,6,40960
buffer_store_dwordx4 v[28:31], v7, s[28:31], s48 offen offset:3072 sc1
s_waitcnt lgkmcnt(7)
M 64,208,40
TR 58,6,41472
s_waitcnt lgkmcnt(6)
M 64,216,44
TR 60,6,45056
M 68,196,32
s_add_u32 m0, s46, 98304
s_nop 0
buffer_load_dwordx4 v2, s[20:23], s51 offen offset:1024  lds
TR 62,6,45568
s_add_u32 s48, s63, 1
s_cmp_ge_u32 s48, s45
s_cselect_b32 s62, s45, 0
s_sub_u32 s48, s48, s62
s_add_u32 s48, s48, s58
M 68,204,36
TR 32,5,33024
s_lshr_b32 s49, s48, 1
s_lshl_b32 s49, s49, 19
M 68,212,40
TR 34,5,33536
s_and_b32 s48, s48, 1
s_lshl_b32 s48, s48, 12
M 68,220,44
TR 36,5,37120
s_add_u32 s48, s48, s49
s_lshl_b32 s49, s41, 16
s_waitcnt lgkmcnt(9)
M 72,192,48
TR 38,5,37632
s_add_u32 s48, s48, s49
s_lshl_b32 s49, s40, 13
s_waitcnt lgkmcnt(8)
M 72,200,52
TR 40,5,41216
s_add_u32 s48, s48, s49
s_add_u32 s50, s48, 4096
s_waitcnt lgkmcnt(7)
M 72,208,56
TR 42,5,41728
PK 96,96,97
s_waitcnt lgkmcnt(6)
M 72,216,60
TR 44,5,45312
PK 97,98,99
PK 98,100,101
M 76,196,48
TR 46,5,45824
PK 99,102,103
M 76,204,52
TR 48,6,33024
buffer_store_dwordx4 v[96:99], v7, s[28:31], s48 offen offset:0 sc1
M 76,212,56
TR 50,6,33536
M 76,220,60
TR 52,6,37120
s_waitcnt lgkmcnt(9)
M 80,192,32
s_add_u32 m0, s46, 98304
s_nop 0
buffer_load_dwordx4 v3, s[20:23], s51 offen offset:2048  lds
TR 54,6,37632
s_waitcnt lgkmcnt(8)
M 80,200,36
TR 56,6,41216
s_waitcnt lgkmcnt(7)
M 80,208,40
TR 58,6,41728
s_waitcnt lgkmcnt(6)
M 80,216,44
TR 60,6,45312
M 84,196,32
TR 62,6,45824
M 84,204,36
TR 32,5,49152
M 84,212,40
TR 34,5,49664
M 84,220,44
TR 36,5,53248
s_waitcnt lgkmcnt(9)
M 88,192,48
TR 38,5,53760
s_waitcnt lgkmcnt(8)
M 88,200,52
TR 40,5,57344
s_waitcnt lgkmcnt(7)
M 88,208,56
TR 42,5,57856
PK 104,104,105
s_waitcnt lgkmcnt(6)
M 88,216,60
TR 44,5,61440
PK 105,106,107
PK 106,108,109
M 92,196,48
s_add_u32 m0, s46, 98304
s_nop 0
buffer_load_dwordx4 v4, s[20:23], s51 offen offset:3072  lds
TR 46,5,61952
PK 107,110,111
M 92,204,52
TR 48,6,49152
buffer_store_dwordx4 v[104:107], v7, s[28:31], s48 offen offset:1024 sc1
M 92,212,56
TR 50,6,49664
M 92,220,60
TR 52,6,53248
s_waitcnt lgkmcnt(9)
M 64,224,32
TR 54,6,53760
s_waitcnt lgkmcnt(8)
M 64,232,36
TR 56,6,57344
s_waitcnt lgkmcnt(7)
M 64,240,40
TR 58,6,57856
s_waitcnt lgkmcnt(6)
M 64,248,44
TR 60,6,61440
M 68,228,32
TR 62,6,61952
M 68,236,36
TR 32,5,49408
M 68,244,40
TR 34,5,49920
M 68,252,44
TR 36,5,53504
s_waitcnt lgkmcnt(9)
M 72,224,48
TR 38,5,54016
s_waitcnt lgkmcnt(8)
M 72,232,52
TR 40,5,57600
s_waitcnt lgkmcnt(7)
M 72,240,56
TR 42,5,58112
PK 112,112,113
s_waitcnt lgkmcnt(6)
M 72,248,60
TR 44,5,61696
PK 113,114,115
PK 114,116,117
M 76,228,48
TR 46,5,62208
PK 115,118,119
M 76,236,52
TR 48,6,49408
buffer_store_dwordx4 v[112:115], v7, s[28:31], s48 offen offset:2048 sc1
M 76,244,56
TR 50,6,49920
M 76,252,60
TR 52,6,53504
s_waitcnt lgkmcnt(9)
M 80,224,32
TR 54,6,54016
s_waitcnt lgkmcnt(8)
M 80,232,36
TR 56,6,57600
s_waitcnt lgkmcnt(7)
M 80,240,40
TR 58,6,58112
s_waitcnt lgkmcnt(6)
M 80,248,44
TR 60,6,61696
M 84,228,32
TR 62,6,62208
M 84,236,36
s_waitcnt vmcnt(9)
s_barrier
v_xor_b32 v5, 0x10000, v5
v_xor_b32 v6, 0x10000, v6
TR 32,5,0
M 84,244,40
TR 34,5,512
M 84,252,44
TR 36,5,4096
s_waitcnt lgkmcnt(9)
M 88,224,48
s_add_u32 s51, s60, 0
s_and_b32 s51, s51, 3
s_mul_i32 s51, s51, 1048576
s_add_u32 s51, s51, s57
s_cmp_gt_u32 s45, 4
s_cselect_b32 s62, 512, 0
s_add_u32 s51, s51, s62
s_add_u32 m0, s46, 0
s_nop 0
buffer_load_dwordx4 v1, s[20:23], s51 offen offset:0  lds
TR 38,5,4608
PK 120,120,121
s_waitcnt lgkmcnt(8)
M 88,232,52
TR 40,5,8192
PK 121,122,123
PK 122,124,125
s_waitcnt lgkmcnt(7)
M 88,240,56
TR 42,5,8704
PK 123,126,127
s_waitcnt lgkmcnt(6)
M 88,248,60
TR 44,5,12288
buffer_store_dwordx4 v[120:123], v7, s[28:31], s48 offen offset:3072 sc1
M 92,228,48
TR 46,5,12800
M 92,236,52
TR 48,6,0
M 92,244,56
TR 50,6,512
M 92,252,60
TR 52,6,4096
s_waitcnt lgkmcnt(9)
MZ 96,128,32
TR 54,6,4608
s_waitcnt lgkmcnt(8)
M 96,136,36
TR 56,6,8192
s_waitcnt lgkmcnt(7)
M 96,144,40
TR 58,6,8704
s_waitcnt lgkmcnt(6)
M 96,152,44
TR 60,6,12288
MZ 100,132,32
s_add_u32 m0, s46, 0
s_nop 0
buffer_load_dwordx4 v2, s[20:23], s51 offen offset:1024  lds
TR 62,6,12800
M 100,140,36
TR 32,5,256
M 100,148,40
TR 34,5,768
M 100,156,44
TR 36,5,4352
s_waitcnt lgkmcnt(9)
MZ 104,128,48
TR 38,5,4864
s_add_u32 s48, s63, 2
s_cmp_ge_u32 s48, s45
s_cselect_b32 s62, s45, 0
s_sub_u32 s48, s48, s62
s_add_u32 s48, s48, s58
s_waitcnt lgkmcnt(8)
M 104,136,52
TR 40,5,8448
s_lshr_b32 s49, s48, 1
s_lshl_b32 s49, s49, 19
s_waitcnt lgkmcnt(7)
M 104,144,56
TR 42,5,8960
s_and_b32 s48, s48, 1
s_lshl_b32 s48, s48, 12
s_waitcnt lgkmcnt(6)
M 104,152,60
TR 44,5,12544
s_add_u32 s48, s48, s49
s_lshl_b32 s49, s41, 16
MZ 108,132,48
TR 46,5,13056
s_add_u32 s48, s48, s49
s_lshl_b32 s49, s40, 13
M 108,140,52
TR 48,6,256
s_add_u32 s48, s48, s49
s_add_u32 s50, s48, 4096
M 108,148,56
TR 50,6,768
PK 64,64,65
M 108,156,60
TR 52,6,4352
PK 65,66,67
PK 66,68,69
s_waitcnt lgkmcnt(9)
MZ 112,128,32
s_add_u32 m0, s46, 0
s_nop 0
buffer_load_dwordx4 v3, s[20:23], s51 offen offset:2048  lds
TR 54,6,4864
PK 67,70,71
s_waitcnt lgkmcnt(8)
M 112,136,36
TR 56,6,8448
buffer_store_dwordx4 v[64:67], v7, s[28:31], s48 offen offset:0 sc1
s_waitcnt lgkmcnt(7)
M 112,144,40
TR 58,6,8960
s_waitcnt lgkmcnt(6)
M 112,152,44
TR 60,6,12544
MZ 116,132,32
TR 62,6,13056
M 116,140,36
TR 32,5,16384
M 116,148,40
TR 34,5,16896
M 116,156,44
TR 36,5,20480
s_waitcnt lgkmcnt(9)
MZ 120,128,48
TR 38,5,20992
s_waitcnt lgkmcnt(8)
M 120,136,52
TR 40,5,24576
s_waitcnt lgkmcnt(7)
M 120,144,56
TR 42,5,25088
s_waitcnt lgkmcnt(6)
M 120,152,60
TR 44,5,28672
MZ 124,132,48
s_add_u32 m0, s46, 0
s_nop 0
buffer_load_dwordx4 v4, s[20:23], s51 offen offset:3072  lds
TR 46,5,29184
M 124,140,52
TR 48,6,16384
M 124,148,56
TR 50,6,16896
M 124,156,60
TR 52,6,20480
s_waitcnt lgkmcnt(9)
M 96,160,32
TR 54,6,20992
s_waitcnt lgkmcnt(8)
M 96,168,36
TR 56,6,24576
s_waitcnt lgkmcnt(7)
M 96,176,40
TR 58,6,25088
s_waitcnt lgkmcnt(6)
M 96,184,44
TR 60,6,28672
M 100,164,32
TR 62,6,29184
M 100,172,36
TR 32,5,16640
M 100,180,40
TR 34,5,17152
M 100,188,44
TR 36,5,20736
s_cmp_lg_u32 s40, 0
s_cbranch_scc1 L_w0_20
s_branch L_chk_22
L_spin_21:
s_sleep 2
v_mov_b32 v13, 20
global_load_dword v13, v13, s[18:19] sc1
L_chk_22:
v_readfirstlane_b32 s59, v13
s_bitcmp1_b32 s59, 0
s_cbranch_scc1 L_ok_23
s_waitcnt vmcnt(0)
v_readfirstlane_b32 s59, v13
s_bitcmp1_b32 s59, 0
s_cbranch_scc0 L_spin_21
L_ok_23:
s_and_b32 s43, s2, 7
s_lshl_b32 s43, s43, 13
s_add_u32 s43, s43, 6848
v_lshrrev_b32 v13, 3, v0
v_lshlrev_b32 v13, 7, v13
v_and_b32 v15, 7, v0
v_lshl_add_u32 v13, v15, 2, v13
v_add_u32 v15, s43, v13
global_load_dword v13, v15, s[100:101] sc1
L_w0_20:
s_waitcnt lgkmcnt(9)
M 104,160,48
TR 38,5,21248
s_waitcnt lgkmcnt(8)
M 104,168,52
TR 40,5,24832
s_waitcnt lgkmcnt(7)
M 104,176,56
TR 42,5,25344
s_waitcnt lgkmcnt(6)
M 104,184,60
TR 44,5,28928
M 108,164,48
TR 46,5,29440
M 108,172,52
TR 48,6,16640
M 108,180,56
TR 50,6,17152
PK 72,72,73
M 108,188,60
TR 52,6,20736
PK 73,74,75
PK 74,76,77
s_waitcnt lgkmcnt(9)
M 112,160,32
TR 54,6,21248
PK 75,78,79
s_waitcnt lgkmcnt(8)
M 112,168,36
TR 56,6,24832
buffer_store_dwordx4 v[72:75], v7, s[28:31], s48 offen offset:1024 sc1
s_waitcnt lgkmcnt(7)
M 112,176,40
TR 58,6,25344
s_waitcnt lgkmcnt(6)
M 112,184,44
TR 60,6,28928
M 116,164,32
TR 62,6,29440
M 116,172,36
s_waitcnt vmcnt(9)
s_barrier
TR 32,5,32768
M 116,180,40
TR 34,5,33280
M 116,188,44
TR 36,5,36864
s_waitcnt lgkmcnt(9)
M 120,160,48
s_add_u32 s51, s60, 1
s_and_b32 s51, s51, 3
s_mul_i32 s51, s51, 1048576
s_add_u32 s51, s51, s57
s_cmp_gt_u32 s45, 4
s_cselect_b32 s62, 512, 0
s_add_u32 s51, s51, s62
s_add_u32 m0, s46, 32768
s_nop 0
buffer_load_dwordx4 v1, s[20:23], s51 offen offset:0  lds
TR 38,5,37376
s_waitcnt lgkmcnt(8)
M 120,168,52
TR 40,5,40960
s_waitcnt lgkmcnt(7)
M 120,176,56
TR 42,5,41472
s_waitcnt lgkmcnt(6)
M 120,184,60
TR 44,5,45056
M 124,164,48
TR 46,5,45568
M 124,172,52
TR 48,6,32768
M 124,180,56
TR 50,6,33280
M 124,188,60
TR 52,6,36864
s_waitcnt lgkmcnt(9)
M 96,192,32
TR 54,6,37376
s_waitcnt lgkmcnt(8)
M 96,200,36
TR 56,6,40960
s_waitcnt lgkmcnt(7)
M 96,208,40
TR 58,6,41472
s_waitcnt lgkmcnt(6)
M 96,216,44
TR 60,6,45056
M 100,196,32
s_add_u32 m0, s46, 32768
s_nop 0
buffer_load_dwordx4 v2, s[20:23], s51 offen offset:1024  lds
TR 62,6,45568
M 100,204,36
TR 32,5,33024
M 100,212,40
TR 34,5,33536
M 100,220,44
TR 36,5,37120
s_waitcnt lgkmcnt(9)
M 104,192,48
TR 38,5,37632
s_waitcnt lgkmcnt(8)
M 104,200,52
TR 40,5,41216
s_waitcnt lgkmcnt(7)
M 104,208,56
TR 42,5,41728
s_waitcnt lgkmcnt(6)
M 104,216,60
TR 44,5,45312
M 108,196,48
TR 46,5,45824
M 108,204,52
TR 48,6,33024
M 108,212,56
TR 50,6,33536
PK 80,80,81
M 108,220,60
TR 52,6,37120
PK 81,82,83
PK 82,84,85
s_waitcnt lgkmcnt(9)
M 112,192,32
s_add_u32 m0, s46, 32768
s_nop 0
buffer_load_dwordx4 v3, s[20:23], s51 offen offset:2048  lds
TR 54,6,37632
PK 83,86,87
s_waitcnt lgkmcnt(8)
M 112,200,36
TR 56,6,41216
buffer_store_dwordx4 v[80:83], v7, s[28:31], s48 offen offset:2048 sc1
s_waitcnt lgkmcnt(7)
M 112,208,40
TR 58,6,41728
s_waitcnt lgkmcnt(6)
M 112,216,44
TR 60,6,45312
M 116,196,32
TR 62,6,45824
M 116,204,36
TR 32,5,49152
M 116,212,40
TR 34,5,49664
M 116,220,44
TR 36,5,53248
s_waitcnt lgkmcnt(9)
M 120,192,48
TR 38,5,53760
s_waitcnt lgkmcnt(8)
M 120,200,52
TR 40,5,57344
s_waitcnt lgkmcnt(7)
M 120,208,56
TR 42,5,57856
s_waitcnt lgkmcnt(6)
M 120,216,60
TR 44,5,61440
M 124,196,48
s_add_u32 m0, s46, 32768
s_nop 0
buffer_load_dwordx4 v4, s[20:23], s51 offen offset:3072  lds
TR 46,5,61952
M 124,204,52
TR 48,6,49152
M 124,212,56
TR 50,6,49664
M 124,220,60
TR 52,6,53248
s_waitcnt lgkmcnt(9)
M 96,224,32
TR 54,6,53760
s_waitcnt lgkmcnt(8)
M 96,232,36
TR 56,6,57344
s_waitcnt lgkmcnt(7)
M 96,240,40
TR 58,6,57856
s_waitcnt lgkmcnt(6)
M 96,248,44
TR 60,6,61440
M 100,228,32
TR 62,6,61952
M 100,236,36
TR 32,5,49408
M 100,244,40
TR 34,5,49920
M 100,252,44
TR 36,5,53504
s_waitcnt lgkmcnt(9)
M 104,224,48
TR 38,5,54016
s_waitcnt lgkmcnt(8)
M 104,232,52
TR 40,5,57600
s_waitcnt lgkmcnt(7)
M 104,240,56
TR 42,5,58112
s_waitcnt lgkmcnt(6)
M 104,248,60
TR 44,5,61696
M 108,228,48
TR 46,5,62208
M 108,236,52
TR 48,6,49408
M 108,244,56
TR 50,6,49920
PK 88,88,89
M 108,252,60
TR 52,6,53504
PK 89,90,91
PK 90,92,93
s_waitcnt lgkmcnt(9)
M 112,224,32
TR 54,6,54016
PK 91,94,95
s_waitcnt lgkmcnt(8)
M 112,232,36
TR 56,6,57600
buffer_store_dwordx4 v[88:91], v7, s[28:31], s48 offen offset:3072 sc1
s_waitcnt lgkmcnt(7)
M 112,240,40
TR 58,6,58112
s_waitcnt lgkmcnt(6)
M 112,248,44
TR 60,6,61696
M 116,228,32
TR 62,6,62208
M 116,236,36
s_waitcnt vmcnt(7)
s_barrier
v_xor_b32 v5, 0x10000, v5
v_xor_b32 v6, 0x10000, v6
TR 32,5,0
M 116,244,40
TR 34,5,512
M 116,252,44
TR 36,5,4096
s_waitcnt lgkmcnt(9)
M 120,224,48
s_add_u32 s51, s60, 2
s_and_b32 s51, s51, 3
s_mul_i32 s51, s51, 1048576
s_add_u32 s51, s51, s57
s_cmp_gt_u32 s45, 4
s_cselect_b32 s62, 512, 0
s_add_u32 s51, s51, s62
s_add_u32 m0, s46, 65536
s_nop 0
buffer_load_dwordx4 v1, s[20:23], s51 offen offset:0  lds
TR 38,5,4608
s_waitcnt lgkmcnt(8)
M 120,232,52
TR 40,5,8192
s_waitcnt lgkmcnt(7)
M 120,240,56
TR 42,5,8704
s_waitcnt lgkmcnt(6)
M 120,248,60
TR 44,5,12288
M 124,228,48
TR 46,5,12800
M 124,236,52
TR 48,6,0
M 124,244,56
TR 50,6,512
M 124,252,60
TR 52,6,4096
s_cmp_lt_u32 s42, 10
s_cbranch_scc1 L_cont_24
s_nop 7
s_add_u32 s48, s63, 3
s_cmp_ge_u32 s48, s45
s_cselect_b32 s62, s45, 0
s_sub_u32 s48, s48, s62
s_add_u32 s48, s48, s58
s_lshr_b32 s49, s48, 1
s_lshl_b32 s49, s49, 19
s_and_b32 s48, s48, 1
s_lshl_b32 s48, s48, 12
s_add_u32 s48, s48, s49
s_lshl_b32 s49, s41, 16
s_add_u32 s48, s48, s49
s_lshl_b32 s49, s40, 13
s_add_u32 s48, s48, s49
s_add_u32 s50, s48, 4096
PK 96,96,97
PK 97,98,99
PK 98,100,101
PK 99,102,103
buffer_store_dwordx4 v[96:99], v7, s[28:31], s48 offen offset:0 sc1
PK 104,104,105
PK 105,106,107
PK 106,108,109
PK 107,110,111
buffer_store_dwordx4 v[104:107], v7, s[28:31], s48 offen offset:1024 sc1
PK 112,112,113
PK 113,114,115
PK 114,116,117
PK 115,118,119
buffer_store_dwordx4 v[112:115], v7, s[28:31], s48 offen offset:2048 sc1
PK 120,120,121
PK 121,122,123
PK 122,124,125
PK 123,126,127
buffer_store_dwordx4 v[120:123], v7, s[28:31], s48 offen offset:3072 sc1
s_add_u32 s58, s42, 0
s_lshl_b32 s58, s58, 7
s_lshl_b32 s49, s41, 2
s_add_u32 s58, s58, s49
s_add_u32 s58, s58, 32
s_branch L_p2
L_cont_24:
s_waitcnt lgkmcnt(9)
MZ 64,128,32
TR 54,6,4608
s_waitcnt lgkmcnt(8)
M 64,136,36
TR 56,6,8192
s_waitcnt lgkmcnt(7)
M 64,144,40
TR 58,6,8704
s_waitcnt lgkmcnt(6)
M 64,152,44
TR 60,6,12288
s_load_dwordx2 s[6:7], s[0:1], 64
s_lshr_b32 s55, s2, 3
s_mul_i32 s43, s55, 43
s_lshr_b32 s43, s43, 7
s_mul_i32 s47, s43, 3
s_sub_u32 s47, s55, s47
s_lshl_b32 s47, s47, 1
s_and_b32 s54, s2, 1
s_add_u32 s47, s47, s54
s_sub_u32 s54, s55, 24
s_cmp_ge_u32 s55, 24
s_cselect_b32 s43, s54, s43
s_cselect_b32 s55, 6, s47
s_and_b32 s54, s2, 6
s_and_b32 s47, s43, 1
s_add_u32 s54, s54, s47
s_lshr_b32 s43, s43, 1
s_lshl_b32 s43, s43, 3
s_add_u32 s54, s54, s43
s_sub_u32 s52, 15, s55
s_xor_b32 s53, s55, 1
s_add_u32 s53, s53, 4
s_cmp_eq_u32 s55, 6
s_cselect_b32 s52, 3, s52
s_cselect_b32 s53, 2, s53
s_mov_b32 s32, s8
s_mov_b32 s33, s9
s_mov_b32 s34, 4194304
s_mov_b32 s35, 0x20000
s_mov_b32 s36, s16
s_mov_b32 s37, s17
s_mov_b32 s38, 2097152
s_mov_b32 s39, 0x20000
s_lshl_b32 s54, s54, 8
s_and_b32 s43, s40, 3
s_lshl_b32 s47, s43, 18
s_add_u32 s54, s54, s47
s_lshr_b32 s47, s40, 2
s_cmp_eq_u32 s47, 0
s_cselect_b32 s55, s52, s53
s_lshl_b32 s47, s47, 7
s_add_u32 s54, s54, s47
s_lshl_b32 s55, s55, 17
s_lshl_b32 s43, s43, 15
s_add_u32 s55, s55, s43
s_waitcnt lgkmcnt(0)
MZ 68,132,32
s_add_u32 m0, s46, 65536
s_nop 0
buffer_load_dwordx4 v2, s[20:23], s51 offen offset:1024  lds
TR 62,6,12800
M 68,140,36
TR 32,5,256
M 68,148,40
TR 34,5,768
s_add_u32 s48, s63, 3
s_cmp_ge_u32 s48, s45
s_cselect_b32 s62, s45, 0
s_sub_u32 s48, s48, s62
M 68,156,44
TR 36,5,4352
s_add_u32 s48, s48, s58
s_lshr_b32 s49, s48, 1
MZ 72,128,48
TR 38,5,4864
s_lshl_b32 s49, s49, 19
M 72,136,52
TR 40,5,8448
s_and_b32 s48, s48, 1
s_lshl_b32 s48, s48, 12
M 72,144,56
TR 42,5,8960
s_add_u32 s48, s48, s49
s_waitcnt lgkmcnt(6)
M 72,152,60
TR 44,5,12544
s_lshl_b32 s49, s41, 16
MZ 76,132,48
TR 46,5,13056
s_add_u32 s48, s48, s49
M 76,140,52
TR 48,6,256
s_lshl_b32 s49, s40, 13
s_add_u32 s48, s48, s49
M 76,148,56
TR 50,6,768
s_add_u32 s50, s48, 4096
M 76,156,60
TR 52,6,4352
PK 16,96,97
s_waitcnt lgkmcnt(9)
MZ 80,128,32
s_add_u32 m0, s46, 65536
s_nop 0
buffer_load_dwordx4 v3, s[20:23], s51 offen offset:2048  lds
TR 54,6,4864
PK 17,98,99
s_waitcnt lgkmcnt(8)
M 80,136,36
TR 56,6,8448
PK 18,100,101
PK 19,102,103
s_waitcnt lgkmcnt(7)
M 80,144,40
TR 58,6,8960
PK 20,104,105
s_waitcnt lgkmcnt(6)
M 80,152,44
TR 60,6,12544
PK 21,106,107
MZ 84,132,32
TR 62,6,13056
PK 22,108,109
M 84,140,36
TR 32,5,16384
PK 23,110,111
PK 24,112,113
M 84,148,40
TR 34,5,16896
PK 25,114,115
M 84,156,44
TR 36,5,20480
PK 26,116,117
s_waitcnt lgkmcnt(9)
MZ 88,128,48
TR 38,5,20992
PK 27,118,119
s_waitcnt lgkmcnt(8)
M 88,136,52
TR 40,5,24576
PK 28,120,121
PK 29,122,123
s_waitcnt lgkmcnt(7)
M 88,144,56
TR 42,5,25088
PK 30,124,125
s_waitcnt lgkmcnt(6)
M 88,152,60
TR 44,5,28672
PK 31,126,127
MZ 92,132,48
s_add_u32 m0, s46, 65536
s_nop 0
buffer_load_dwordx4 v4, s[20:23], s51 offen offset:3072  lds
TR 46,5,29184
M 92,140,52
TR 48,6,16384
M 92,148,56
TR 50,6,16896
M 92,156,60
TR 52,6,20480
s_waitcnt lgkmcnt(9)
MZ 96,128,32
TR 54,6,20992
s_waitcnt lgkmcnt(8)
M 96,136,36
TR 56,6,24576
buffer_store_dwordx4 v[16:19], v7, s[28:31], s48 offen offset:0 sc1
s_waitcnt lgkmcnt(7)
M 96,144,40
TR 58,6,25088
s_waitcnt lgkmcnt(6)
M 96,152,44
TR 60,6,28672
MZ 100,132,32
TR 62,6,29184
M 100,140,36
TR 32,5,16640
M 100,148,40
TR 34,5,17152
M 100,156,44
TR 36,5,20736
s_waitcnt lgkmcnt(9)
MZ 104,128,48
TR 38,5,21248
s_waitcnt lgkmcnt(8)
M 104,136,52
TR 40,5,24832
s_waitcnt lgkmcnt(7)
M 104,144,56
TR 42,5,25344
s_waitcnt lgkmcnt(6)
M 104,152,60
TR 44,5,28928
MZ 108,132,48
TR 46,5,29440
M 108,140,52
TR 48,6,16640
M 108,148,56
TR 50,6,17152
M 108,156,60
TR 52,6,20736
s_waitcnt lgkmcnt(9)
MZ 112,128,32
TR 54,6,21248
s_waitcnt lgkmcnt(8)
M 112,136,36
TR 56,6,24832
s_waitcnt lgkmcnt(7)
M 112,144,40
TR 58,6,25344
s_waitcnt lgkmcnt(6)
M 112,152,44
TR 60,6,28928
MZ 116,132,32
TR 62,6,29440
M 116,140,36
s_waitcnt vmcnt(6)
s_cmp_lg_u32 s40, 0
s_cbranch_scc1 L_w0_25
s_branch L_chk_27
L_spin_26:
s_sleep 4
global_load_dword v13, v15, s[100:101] sc1
s_waitcnt vmcnt(0)
L_chk_27:
v_cmp_ne_u32 vcc, s59, v13
s_cbranch_vccnz L_spin_26
L_w0_25:
s_barrier
TR 32,5,32768
M 116,148,40
TR 34,5,33280
M 116,156,44
TR 36,5,36864
s_waitcnt lgkmcnt(9)
MZ 120,128,48
s_add_u32 s51, s60, 3
s_and_b32 s51, s51, 3
s_mul_i32 s51, s51, 1048576
s_add_u32 s51, s51, s57
s_cmp_gt_u32 s45, 4
s_cselect_b32 s62, 512, 0
s_add_u32 s51, s51, s62
s_add_u32 m0, s46, 98304
s_nop 0
buffer_load_dwordx4 v1, s[20:23], s51 offen offset:0  lds
TR 38,5,37376
s_waitcnt lgkmcnt(8)
M 120,136,52
TR 40,5,40960
s_waitcnt lgkmcnt(7)
M 120,144,56
TR 42,5,41472
s_waitcnt lgkmcnt(6)
M 120,152,60
TR 44,5,45056
MZ 124,132,48
TR 46,5,45568
M 124,140,52
TR 48,6,32768
M 124,148,56
TR 50,6,33280
M 124,156,60
TR 52,6,36864
s_waitcnt lgkmcnt(9)
M 64,160,32
TR 54,6,37376
s_waitcnt lgkmcnt(8)
M 64,168,36
TR 56,6,40960
s_waitcnt lgkmcnt(7)
M 64,176,40
TR 58,6,41472
s_waitcnt lgkmcnt(6)
M 64,184,44
TR 60,6,45056
M 68,164,32
s_add_u32 m0, s46, 98304
s_nop 0
buffer_load_dwordx4 v2, s[20:23], s51 offen offset:1024  lds
TR 62,6,45568
M 68,172,36
TR 32,5,33024
s_mov_b32 s52, 0
s_add_u32 s52, s52, 0
s_and_b32 s52, s52, 3
s_lshl_b32 s52, s52, 12
s_add_u32 s52, s52, s55
s_add_u32 s53, s52, 16384
buffer_load_dwordx4 v[128:131], v7, s[36:39], s52 offen offset:0 sc1
buffer_load_dwordx4 v[132:135], v7, s[36:39], s53 offen offset:0 sc1
M 68,180,40
TR 34,5,33536
M 68,188,44
TR 36,5,37120
s_waitcnt lgkmcnt(9)
M 72,160,48
TR 38,5,37632
s_waitcnt lgkmcnt(8)
M 72,168,52
TR 40,5,41216
s_waitcnt lgkmcnt(7)
M 72,176,56
TR 42,5,41728
s_waitcnt lgkmcnt(6)
M 72,184,60
TR 44,5,45312
M 76,164,48
TR 46,5,45824
M 76,172,52
TR 48,6,33024
M 76,180,56
TR 50,6,33536
M 76,188,60
TR 52,6,37120
s_waitcnt lgkmcnt(9)
M 80,160,32
s_add_u32 m0, s46, 98304
s_nop 0
buffer_load_dwordx4 v3, s[20:23], s51 offen offset:2048  lds
TR 54,6,37632
s_waitcnt lgkmcnt(8)
M 80,168,36
TR 56,6,41216
buffer_store_dwordx4 v[20:23], v7, s[28:31], s48 offen offset:1024 sc1
s_waitcnt lgkmcnt(7)
M 80,176,40
TR 58,6,41728
s_waitcnt lgkmcnt(6)
M 80,184,44
TR 60,6,45312
M 84,164,32
TR 62,6,45824
M 84,172,36
TR 32,5,49152
buffer_load_dwordx4 v[136:139], v7, s[36:39], s52 offen offset:1024 sc1
buffer_load_dwordx4 v[140:143], v7, s[36:39], s53 offen offset:1024 sc1
M 84,180,40
TR 34,5,49664
M 84,188,44
TR 36,5,53248
s_waitcnt lgkmcnt(9)
M 88,160,48
TR 38,5,53760
s_waitcnt lgkmcnt(8)
M 88,168,52
TR 40,5,57344
s_waitcnt lgkmcnt(7)
M 88,176,56
TR 42,5,57856
s_waitcnt lgkmcnt(6)
M 88,184,60
TR 44,5,61440
M 92,164,48
s_add_u32 m0, s46, 98304
s_nop 0
buffer_load_dwordx4 v4, s[20:23], s51 offen offset:3072  lds
TR 46,5,61952
M 92,172,52
TR 48,6,49152
M 92,180,56
TR 50,6,49664
M 92,188,60
TR 52,6,53248
s_waitcnt lgkmcnt(9)
M 96,160,32
TR 54,6,53760
s_waitcnt lgkmcnt(8)
M 96,168,36
TR 56,6,57344
s_waitcnt lgkmcnt(7)
M 96,176,40
TR 58,6,57856
s_waitcnt lgkmcnt(6)
M 96,184,44
TR 60,6,61440
M 100,164,32
TR 62,6,61952
M 100,172,36
TR 32,5,49408
buffer_load_dwordx4 v[144:147], v7, s[36:39], s52 offen offset:2048 sc1
buffer_load_dwordx4 v[148:151], v7, s[36:39], s53 offen offset:2048 sc1
M 100,180,40
TR 34,5,49920
M 100,188,44
TR 36,5,53504
s_waitcnt lgkmcnt(9)
M 104,160,48
TR 38,5,54016
s_waitcnt lgkmcnt(8)
M 104,168,52
TR 40,5,57600
s_waitcnt lgkmcnt(7)
M 104,176,56
TR 42,5,58112
s_waitcnt lgkmcnt(6)
M 104,184,60
TR 44,5,61696
M 108,164,48
TR 46,5,62208
M 108,172,52
TR 48,6,49408
M 108,180,56
TR 50,6,49920
M 108,188,60
TR 52,6,53504
s_waitcnt lgkmcnt(9)
M 112,160,32
TR 54,6,54016
s_waitcnt lgkmcnt(8)
M 112,168,36
TR 56,6,57600
s_waitcnt lgkmcnt(7)
M 112,176,40
TR 58,6,58112
s_waitcnt lgkmcnt(6)
M 112,184,44
TR 60,6,61696
M 116,164,32
TR 62,6,62208
M 116,172,36
s_waitcnt vmcnt(12)
s_barrier
v_xor_b32 v5, 0x10000, v5
v_xor_b32 v6, 0x10000, v6
TR 32,5,0
buffer_load_dwordx4 v[152:155], v7, s[36:39], s52 offen offset:3072 sc1
buffer_load_dwordx4 v[156:159], v7, s[36:39], s53 offen offset:3072 sc1
M 116,180,40
TR 34,5,512
M 116,188,44
TR 36,5,4096
s_waitcnt lgkmcnt(9)
M 120,160,48
s_mov_b32 s51, 0
s_add_u32 s51, s51, 0
s_and_b32 s51, s51, 3
s_lshl_b32 s51, s51, 20
s_add_u32 s51, s51, s54
s_add_u32 m0, s46, 0
s_nop 0
buffer_load_dwordx4 v1, s[32:35], s51 offen offset:0 lds
TR 38,5,4608
s_waitcnt lgkmcnt(8)
M 120,168,52
TR 40,5,8192
s_waitcnt lgkmcnt(7)
M 120,176,56
TR 42,5,8704
s_waitcnt lgkmcnt(6)
M 120,184,60
TR 44,5,12288
M 124,164,48
TR 46,5,12800
M 124,172,52
TR 48,6,0
M 124,180,56
TR 50,6,512
M 124,188,60
TR 52,6,4096
s_waitcnt lgkmcnt(9)
M 64,192,32
TR 54,6,4608
s_waitcnt lgkmcnt(8)
M 64,200,36
TR 56,6,8192
buffer_store_dwordx4 v[24:27], v7, s[28:31], s48 offen offset:2048 sc1
s_waitcnt lgkmcnt(7)
M 64,208,40
TR 58,6,8704
s_waitcnt lgkmcnt(6)
M 64,216,44
TR 60,6,12288
M 68,196,32
s_add_u32 m0, s46, 0
s_nop 0
buffer_load_dwordx4 v2, s[32:35], s51 offen offset:1024 lds
TR 62,6,12800
M 68,204,36
TR 32,5,256
s_mov_b32 s52, 0
s_add_u32 s52, s52, 1
s_and_b32 s52, s52, 3
s_lshl_b32 s52, s52, 12
s_add_u32 s52, s52, s55
s_add_u32 s53, s52, 16384
buffer_load_dwordx4 v[160:163], v7, s[36:39], s52 offen offset:0 sc1
buffer_load_dwordx4 v[164:167], v7, s[36:39], s53 offen offset:0 sc1
M 68,212,40
TR 34,5,768
M 68,220,44
TR 36,5,4352
s_waitcnt lgkmcnt(9)
M 72,192,48
TR 38,5,4864
s_waitcnt lgkmcnt(8)
M 72,200,52
TR 40,5,8448
s_waitcnt lgkmcnt(7)
M 72,208,56
TR 42,5,8960
s_waitcnt lgkmcnt(6)
M 72,216,60
TR 44,5,12544
M 76,196,48
TR 46,5,13056
M 76,204,52
TR 48,6,256
M 76,212,56
TR 50,6,768
M 76,220,60
TR 52,6,4352
s_waitcnt lgkmcnt(9)
M 80,192,32
s_add_u32 m0, s46, 0
s_nop 0
buffer_load_dwordx4 v3, s[32:35], s51 offen offset:2048 lds
TR 54,6,4864
s_waitcnt lgkmcnt(8)
M 80,200,36
TR 56,6,8448
s_waitcnt lgkmcnt(7)
M 80,208,40
TR 58,6,8960
s_waitcnt lgkmcnt(6)
M 80,216,44
TR 60,6,12544
M 84,196,32
TR 62,6,13056
M 84,204,36
TR 32,5,16384
buffer_load_dwordx4 v[168:171], v7, s[36:39], s52 offen offset:1024 sc1
buffer_load_dwordx4 v[172:175], v7, s[36:39], s53 offen offset:1024 sc1
M 84,212,40
TR 34,5,16896
M 84,220,44
TR 36,5,20480
s_waitcnt lgkmcnt(9)
M 88,192,48
TR 38,5,20992
s_waitcnt lgkmcnt(8)
M 88,200,52
TR 40,5,24576
s_waitcnt lgkmcnt(7)
M 88,208,56
TR 42,5,25088
s_waitcnt lgkmcnt(6)
M 88,216,60
TR 44,5,28672
M 92,196,48
s_add_u32 m0, s46, 0
s_nop 0
buffer_load_dwordx4 v4, s[32:35], s51 offen offset:3072 lds
TR 46,5,29184
M 92,204,52
TR 48,6,16384
M 92,212,56
TR 50,6,16896
M 92,220,60
TR 52,6,20480
s_waitcnt lgkmcnt(9)
M 96,192,32
TR 54,6,20992
s_waitcnt lgkmcnt(8)
M 96,200,36
TR 56,6,24576
s_waitcnt lgkmcnt(7)
M 96,208,40
TR 58,6,25088
s_waitcnt lgkmcnt(6)
M 96,216,44
TR 60,6,28672
M 100,196,32
TR 62,6,29184
M 100,204,36
TR 32,5,16640
buffer_load_dwordx4 v[176:179], v7, s[36:39], s52 offen offset:2048 sc1
buffer_load_dwordx4 v[180:183], v7, s[36:39], s53 offen offset:2048 sc1
M 100,212,40
TR 34,5,17152
M 100,220,44
TR 36,5,20736
s_waitcnt lgkmcnt(9)
M 104,192,48
TR 38,5,21248
s_waitcnt lgkmcnt(8)
M 104,200,52
TR 40,5,24832
s_waitcnt lgkmcnt(7)
M 104,208,56
TR 42,5,25344
s_waitcnt lgkmcnt(6)
M 104,216,60
TR 44,5,28928
M 108,196,48
TR 46,5,29440
M 108,204,52
TR 48,6,16640
M 108,212,56
TR 50,6,17152
M 108,220,60
TR 52,6,20736
s_waitcnt lgkmcnt(9)
M 112,192,32
TR 54,6,21248
s_waitcnt lgkmcnt(8)
M 112,200,36
TR 56,6,24832
buffer_store_dwordx4 v[28:31], v7, s[28:31], s48 offen offset:3072 sc1
s_waitcnt lgkmcnt(7)
M 112,208,40
TR 58,6,25344
s_waitcnt lgkmcnt(6)
M 112,216,44
TR 60,6,28928
M 116,196,32
TR 62,6,29440
M 116,204,36
s_waitcnt vmcnt(16)
s_barrier
TR 32,5,32768
buffer_load_dwordx4 v[184:187], v7, s[36:39], s52 offen offset:3072 sc1
buffer_load_dwordx4 v[188:191], v7, s[36:39], s53 offen offset:3072 sc1
M 116,212,40
TR 34,5,33280
M 116,220,44
TR 36,5,36864
s_waitcnt lgkmcnt(9)
M 120,192,48
s_mov_b32 s51, 0
s_add_u32 s51, s51, 1
s_and_b32 s51, s51, 3
s_lshl_b32 s51, s51, 20
s_add_u32 s51, s51, s54
s_add_u32 m0, s46, 32768
s_nop 0
buffer_load_dwordx4 v1, s[32:35], s51 offen offset:0 lds
TR 38,5,37376
s_waitcnt lgkmcnt(8)
M 120,200,52
TR 40,5,40960
s_waitcnt lgkmcnt(7)
M 120,208,56
TR 42,5,41472
s_waitcnt lgkmcnt(6)
M 120,216,60
TR 44,5,45056
M 124,196,48
TR 46,5,45568
M 124,204,52
TR 48,6,32768
M 124,212,56
TR 50,6,33280
M 124,220,60
TR 52,6,36864
s_waitcnt lgkmcnt(9)
M 64,224,32
TR 54,6,37376
s_waitcnt lgkmcnt(8)
M 64,232,36
TR 56,6,40960
s_waitcnt lgkmcnt(7)
M 64,240,40
TR 58,6,41472
s_waitcnt lgkmcnt(6)
M 64,248,44
TR 60,6,45056
M 68,228,32
s_add_u32 m0, s46, 32768
s_nop 0
buffer_load_dwordx4 v2, s[32:35], s51 offen offset:1024 lds
TR 62,6,45568
M 68,236,36
TR 32,5,33024
s_mov_b32 s52, 0
s_add_u32 s52, s52, 2
s_and_b32 s52, s52, 3
s_lshl_b32 s52, s52, 12
s_add_u32 s52, s52, s55
s_add_u32 s53, s52, 16384
buffer_load_dwordx4 v[192:195], v7, s[36:39], s52 offen offset:0 sc1
buffer_load_dwordx4 v[196:199], v7, s[36:39], s53 offen offset:0 sc1
M 68,244,40
TR 34,5,33536
M 68,252,44
TR 36,5,37120
s_waitcnt lgkmcnt(9)
M 72,224,48
TR 38,5,37632
s_waitcnt lgkmcnt(8)
M 72,232,52
TR 40,5,41216
s_waitcnt lgkmcnt(7)
M 72,240,56
TR 42,5,41728
s_waitcnt lgkmcnt(6)
M 72,248,60
TR 44,5,45312
M 76,228,48
TR 46,5,45824
M 76,236,52
TR 48,6,33024
buffer_load_dwordx4 v[200:203], v7, s[36:39], s52 offen offset:1024 sc1
buffer_load_dwordx4 v[204:207], v7, s[36:39], s53 offen offset:1024 sc1
M 76,244,56
TR 50,6,33536
M 76,252,60
TR 52,6,37120
s_waitcnt lgkmcnt(9)
M 80,224,32
s_add_u32 m0, s46, 32768
s_nop 0
buffer_load_dwordx4 v3, s[32:35], s51 offen offset:2048 lds
TR 54,6,37632
s_waitcnt lgkmcnt(8)
M 80,232,36
TR 56,6,41216
s_waitcnt lgkmcnt(7)
M 80,240,40
TR 58,6,41728
s_waitcnt lgkmcnt(6)
M 80,248,44
TR 60,6,45312
M 84,228,32
TR 62,6,45824
M 84,236,36
TR 32,5,49152
buffer_load_dwordx4 v[208:211], v7, s[36:39], s52 offen offset:2048 sc1
buffer_load_dwordx4 v[212:215], v7, s[36:39], s53 offen offset:2048 sc1
M 84,244,40
TR 34,5,49664
M 84,252,44
TR 36,5,53248
s_waitcnt lgkmcnt(9)
M 88,224,48
TR 38,5,53760
s_waitcnt lgkmcnt(8)
M 88,232,52
TR 40,5,57344
s_waitcnt lgkmcnt(7)
M 88,240,56
TR 42,5,57856
s_waitcnt lgkmcnt(6)
M 88,248,60
TR 44,5,61440
M 92,228,48
s_add_u32 m0, s46, 32768
s_nop 0
buffer_load_dwordx4 v4, s[32:35], s51 offen offset:3072 lds
TR 46,5,61952
M 92,236,52
TR 48,6,49152
buffer_load_dwordx4 v[216:219], v7, s[36:39], s52 offen offset:3072 sc1
buffer_load_dwordx4 v[220:223], v7, s[36:39], s53 offen offset:3072 sc1
M 92,244,56
TR 50,6,49664
M 92,252,60
TR 52,6,53248
s_waitcnt lgkmcnt(9)
M 96,224,32
TR 54,6,53760
s_waitcnt lgkmcnt(8)
M 96,232,36
TR 56,6,57344
s_waitcnt lgkmcnt(7)
M 96,240,40
TR 58,6,57856
s_waitcnt lgkmcnt(6)
M 96,248,44
TR 60,6,61440
M 100,228,32
TR 62,6,61952
M 100,236,36
TR 32,5,49408
M 100,244,40
TR 34,5,49920
M 100,252,44
TR 36,5,53504
s_waitcnt lgkmcnt(9)
M 104,224,48
TR 38,5,54016
s_add_u32 s48, s63, 4
s_cmp_ge_u32 s48, s45
s_cselect_b32 s62, s45, 0
s_sub_u32 s48, s48, s62
s_waitcnt lgkmcnt(8)
M 104,232,52
TR 40,5,57600
s_add_u32 s48, s48, s58
s_lshr_b32 s49, s48, 1
s_waitcnt lgkmcnt(7)
M 104,240,56
TR 42,5,58112
s_lshl_b32 s49, s49, 19
s_waitcnt lgkmcnt(6)
M 104,248,60
TR 44,5,61696
s_and_b32 s48, s48, 1
s_lshl_b32 s48, s48, 12
M 108,228,48
TR 46,5,62208
s_add_u32 s48, s48, s49
M 108,236,52
TR 48,6,49408
s_lshl_b32 s49, s41, 16
M 108,244,56
TR 50,6,49920
s_add_u32 s48, s48, s49
M 108,252,60
TR 52,6,53504
s_lshl_b32 s49, s40, 13
s_add_u32 s48, s48, s49
s_waitcnt lgkmcnt(9)
M 112,224,32
TR 54,6,54016
s_add_u32 s50, s48, 4096
s_waitcnt lgkmcnt(8)
M 112,232,36
TR 56,6,57600
PK 16,64,65
PK 17,66,67
s_waitcnt lgkmcnt(7)
M 112,240,40
TR 58,6,58112
PK 18,68,69
s_waitcnt lgkmcnt(6)
M 112,248,44
TR 60,6,61696
PK 19,70,71
M 116,228,32
TR 62,6,62208
buffer_store_dwordx4 v[16:19], v7, s[28:31], s48 offen offset:0 sc1
M 116,236,36
PK 20,72,73
PK 21,74,75
M 116,244,40
PK 22,76,77
M 116,252,44
PK 23,78,79
buffer_store_dwordx4 v[20:23], v7, s[28:31], s48 offen offset:1024 sc1
s_waitcnt lgkmcnt(6)
M 120,224,48
PK 24,80,81
s_waitcnt lgkmcnt(4)
M 120,232,52
PK 25,82,83
s_waitcnt lgkmcnt(2)
M 120,240,56
PK 26,84,85
s_waitcnt lgkmcnt(0)
M 120,248,60
PK 27,86,87
buffer_store_dwordx4 v[24:27], v7, s[28:31], s48 offen offset:2048 sc1
M 124,228,48
PK 28,88,89
M 124,236,52
PK 29,90,91
PK 30,92,93
M 124,244,56
PK 31,94,95
M 124,252,60
buffer_store_dwordx4 v[28:31], v7, s[28:31], s48 offen offset:3072 sc1
s_nop 7
s_add_u32 s48, s63, 5
s_cmp_ge_u32 s48, s45
s_cselect_b32 s62, s45, 0
s_sub_u32 s48, s48, s62
s_add_u32 s48, s48, s58
s_lshr_b32 s49, s48, 1
s_lshl_b32 s49, s49, 19
s_and_b32 s48, s48, 1
s_lshl_b32 s48, s48, 12
s_add_u32 s48, s48, s49
s_lshl_b32 s49, s41, 16
s_add_u32 s48, s48, s49
s_lshl_b32 s49, s40, 13
s_add_u32 s48, s48, s49
s_add_u32 s50, s48, 4096
PK 96,96,97
PK 97,98,99
PK 98,100,101
PK 99,102,103
buffer_store_dwordx4 v[96:99], v7, s[28:31], s48 offen offset:0 sc1
PK 104,104,105
PK 105,106,107
PK 106,108,109
PK 107,110,111
buffer_store_dwordx4 v[104:107], v7, s[28:31], s48 offen offset:1024 sc1
PK 112,112,113
PK 113,114,115
PK 114,116,117
PK 115,118,119
buffer_store_dwordx4 v[112:115], v7, s[28:31], s48 offen offset:2048 sc1
PK 120,120,121
PK 121,122,123
PK 122,124,125
PK 123,126,127
buffer_store_dwordx4 v[120:123], v7, s[28:31], s48 offen offset:3072 sc1
s_add_u32 s58, s42, 0
s_lshl_b32 s58, s58, 7
s_lshl_b32 s49, s41, 2
s_add_u32 s58, s58, s49
s_add_u32 s58, s58, 32
s_branch L_p2f
L_k1_V_end:
L_k1_Z1:
s_getpc_b64 s[36:37]
L_pc_28:
v_lshlrev_b32 v26, 7, v0
v_min_u32 v26, L_k1_Z1_end-L_pc_28-4, v26
v_mov_b32 v27, s37
v_add_co_u32 v26, vcc, s36, v26
s_nop 1
v_addc_co_u32 v27, vcc, 0, v27, vcc
global_load_dword v255, v[26:27], off
v_bfe_u32 v28, v0, 5, 1
v_bfe_u32 v29, v0, 2, 2
v_lshl_add_u32 v28, v28, 2, v29
v_mul_u32_u24 v28, 3584, v28
v_bfe_u32 v29, v0, 4, 1
v_lshl_add_u32 v28, v29, 6, v28
v_and_b32 v29, 3, v0
v_xor_b32 v30, 2, v29
v_lshlrev_b32 v29, 4, v29
v_lshlrev_b32 v30, 4, v30
v_add_u32 v31, 0, v28
v_add_u32 v1, v31, v29
v_add_u32 v31, 27648, v28
v_add_u32 v2, v31, v30
v_add_u32 v31, 55296, v28
v_add_u32 v3, v31, v29
v_add_u32 v31, 82944, v28
v_add_u32 v4, v31, v30
s_waitcnt lgkmcnt(0)
s_add_u32 s100, s16, 79691776
s_addc_u32 s101, s17, 0
s_sub_u32 s42, s3, 22
v_and_b32 v28, 63, v0
v_lshlrev_b32 v7, 4, v28
s_mov_b32 s24, s4
s_mov_b32 s25, s5
s_mov_b32 s26, 2097152
s_mov_b32 s27, 0x20000
s_sub_u32 s54, s3, 22
s_and_b32 s49, s54, 7
s_lshl_b32 s49, s49, 5
s_lshl_b32 s50, s41, 8
s_add_u32 s49, s49, s50
s_lshl_b32 s50, s40, 2
s_add_u32 s55, s49, s50
s_lshl_b32 s49, s55, 10
v_and_b32 v28, 3, v0
v_lshlrev_b32 v30, 4, v28
v_bfe_u32 v29, v0, 2, 2
v_lshl_add_u32 v30, v29, 10, v30
v_bfe_u32 v29, v0, 4, 2
v_lshl_add_u32 v30, v29, 6, v30
buffer_load_dwordx4 v[64:67], v30, s[24:27], s49 offen offset:0
buffer_load_dwordx4 v[68:71], v30, s[24:27], s49 offen offset:256
buffer_load_dwordx4 v[72:75], v30, s[24:27], s49 offen offset:512
buffer_load_dwordx4 v[76:79], v30, s[24:27], s49 offen offset:768
s_mov_b32 s20, s14
s_mov_b32 s21, s15
s_mov_b32 s22, 1835008
s_mov_b32 s23, 0x20000
s_lshl_b32 s58, s42, 1
s_add_u32 s58, s58, 8
s_cmp_eq_u32 s42, 0
s_cselect_b32 s58, 7, s58
s_lshl_b32 s44, s58, 7
s_mov_b32 s45, 1664
s_lshl_b32 s46, s40, 12
s_bfe_u32 s60, s2, 0x20005
s_bfe_u32 s49, s2, 0x20003
s_add_u32 s60, s60, s49
s_and_b32 s60, s60, 3
s_lshl_b32 s49, s60, 2
s_add_u32 s49, s49, s40
s_and_b32 s50, s49, 15
s_mul_i32 s56, s50, 114688
s_xor_b32 s50, s50, 8
s_mul_i32 s61, s50, 114688
s_and_b32 s57, s40, 3
s_mul_i32 s57, s57, 114688
s_lshr_b32 s49, s40, 2
s_lshl_b32 s49, s49, 7
s_add_u32 s57, s57, s49
s_add_u32 s57, s57, s44
s_mov_b32 s24, s16
s_mov_b32 s25, s17
s_mov_b32 s26, 79691776
s_mov_b32 s27, 0x20000
s_mov_b32 s53, 0xffff0000
s_mov_b32 s52, 3184710632
v_mov_b32 v8, 3222493025
s_lshr_b32 s55, s55, 5
s_lshl_b32 s55, s55, 15
s_add_u32 s55, s55, s46
s_add_u32 s62, s55, 77594624
s_lshr_b32 s49, s40, 2
s_lshl_b32 s49, s49, 14
s_and_b32 s50, s40, 3
s_lshl_b32 s50, s50, 6
s_add_u32 s49, s49, s50
s_add_u32 s49, s49, 0x20000
v_bfe_u32 v28, v0, 2, 2
v_lshlrev_b32 v28, 4, v28
v_and_b32 v30, 3, v0
v_lshl_add_u32 v28, v30, 8, v28
v_bfe_u32 v29, v0, 4, 2
v_lshl_add_u32 v28, v29, 10, v28
v_add_u32 v13, s49, v28
v_lshlrev_b32 v30, 5, v30
v_xor_b32 v13, v13, v30
s_and_b32 s49, s46, 0x3fff
s_lshr_b32 s50, s40, 2
s_lshl_b32 s50, s50, 6
s_add_u32 s49, s49, s50
s_add_u32 s49, s49, 0x20000
v_bfe_u32 v17, v0, 3, 1
v_lshlrev_b32 v17, 14, v17
v_bfe_u32 v28, v0, 2, 1
v_lshl_add_u32 v17, v28, 7, v17
v_and_b32 v28, 0x33, v0
v_lshl_add_u32 v17, v28, 4, v17
v_add_u32 v17, s49, v17
v_lshlrev_b32 v29, 5, v29
v_xor_b32 v17, v17, v29
s_add_u32 s49, s41, 53
s_lshl_b32 s49, s49, 7
s_and_b32 s50, s2, 7
s_lshl_b32 s50, s50, 13
s_add_u32 s49, s49, s50
v_min_u32 v15, 7, v0
v_lshl_add_u32 v15, v15, 2, s49
s_cmp_ge_u32 s54, 8
s_cbranch_scc1 L_noln_29
v_mov_b32 v9, 0
v_mov_b32 v10, 0
v_mov_b32 v11, 0
v_mov_b32 v12, 0
v_mov_b32 v16, 0x3f803f80
s_waitcnt vmcnt(0)
v_mov_b32 v14, 20
s_cmp_lg_u32 s40, 0
s_cbranch_scc1 L_w0_30
global_load_dword v14, v14, s[18:19] sc1
L_w0_30:
v_dot2c_f32_bf16 v9, v16, v64
v_dot2c_f32_bf16 v10, v64, v64
v_dot2c_f32_bf16 v11, v16, v65
v_dot2c_f32_bf16 v12, v65, v65
v_dot2c_f32_bf16 v9, v16, v66
v_dot2c_f32_bf16 v10, v66, v66
v_dot2c_f32_bf16 v11, v16, v67
v_dot2c_f32_bf16 v12, v67, v67
v_dot2c_f32_bf16 v9, v16, v68
v_dot2c_f32_bf16 v10, v68, v68
v_dot2c_f32_bf16 v11, v16, v69
v_dot2c_f32_bf16 v12, v69, v69
v_dot2c_f32_bf16 v9, v16, v70
v_dot2c_f32_bf16 v10, v70, v70
v_dot2c_f32_bf16 v11, v16, v71
v_dot2c_f32_bf16 v12, v71, v71
v_dot2c_f32_bf16 v9, v16, v72
v_dot2c_f32_bf16 v10, v72, v72
v_dot2c_f32_bf16 v11, v16, v73
v_dot2c_f32_bf16 v12, v73, v73
v_dot2c_f32_bf16 v9, v16, v74
v_dot2c_f32_bf16 v10, v74, v74
v_dot2c_f32_bf16 v11, v16, v75
v_dot2c_f32_bf16 v12, v75, v75
v_dot2c_f32_bf16 v9, v16, v76
v_dot2c_f32_bf16 v10, v76, v76
v_dot2c_f32_bf16 v11, v16, v77
v_dot2c_f32_bf16 v12, v77, v77
v_dot2c_f32_bf16 v9, v16, v78
v_dot2c_f32_bf16 v10, v78, v78
v_dot2c_f32_bf16 v11, v16, v79
v_dot2c_f32_bf16 v12, v79, v79
v_lshlrev_b32 v96, 16, v64
v_and_b32 v97, s53, v64
v_lshlrev_b32 v98, 16, v65
v_and_b32 v99, s53, v65
v_lshlrev_b32 v100, 16, v66
v_and_b32 v101, s53, v66
v_lshlrev_b32 v102, 16, v67
v_and_b32 v103, s53, v67
v_add_f32 v9, v9, v11
v_add_f32 v10, v10, v12
v_lshlrev_b32 v104, 16, v68
v_and_b32 v105, s53, v68
v_lshlrev_b32 v106, 16, v69
v_and_b32 v107, s53, v69
v_lshlrev_b32 v108, 16, v70
v_and_b32 v109, s53, v70
v_lshlrev_b32 v110, 16, v71
v_and_b32 v111, s53, v71
v_lshlrev_b32 v112, 16, v72
v_and_b32 v113, s53, v72
v_lshlrev_b32 v114, 16, v73
v_and_b32 v115, s53, v73
v_add_f32_dpp v9, v9, v9 quad_perm:[1,0,3,2] row_mask:0xf bank_mask:0xf
v_add_f32_dpp v10, v10, v10 quad_perm:[1,0,3,2] row_mask:0xf bank_mask:0xf
v_lshlrev_b32 v116, 16, v74
v_and_b32 v117, s53, v74
v_lshlrev_b32 v118, 16, v75
v_and_b32 v119, s53, v75
v_lshlrev_b32 v120, 16, v76
v_and_b32 v121, s53, v76
v_lshlrev_b32 v122, 16, v77
v_and_b32 v123, s53, v77
v_lshlrev_b32 v124, 16, v78
v_and_b32 v125, s53, v78
v_lshlrev_b32 v126, 16, v79
v_and_b32 v127, s53, v79
v_add_f32_dpp v9, v9, v9 quad_perm:[2,3,0,1] row_mask:0xf bank_mask:0xf
v_add_f32_dpp v10, v10, v10 quad_perm:[2,3,0,1] row_mask:0xf bank_mask:0xf
v_mov_b32 v11, v9
v_mov_b32 v12, v10
s_nop 1
v_permlane32_swap_b32 v11, v9
v_permlane32_swap_b32 v12, v10
s_nop 1
v_add_f32 v9, v9, v11
v_add_f32 v10, v10, v12
v_mov_b32 v11, v9
v_mov_b32 v12, v10
s_nop 1
v_permlane16_swap_b32 v11, v9
v_permlane16_swap_b32 v12, v10
s_nop 1
v_add_f32 v9, v9, v11
v_add_f32 v10, v10, v12
v_mul_f32 v9, 989855744, v9
v_mul_f32 v10, 989855744, v10
v_fma_f32 v10, -v9, v9, v10
v_max_f32 v10, 0, v10
PK 9,9,9
PK 10,10,10
v_and_b32 v9, 0xffff0000, v9
v_and_b32 v10, 0xffff0000, v10
v_add_f32 v10, 925353388, v10
PK 10,10,10
v_and_b32 v10, 0xffff0000, v10
v_sqrt_f32 v10, v10
s_nop 0
PK 10,10,10
v_and_b32 v10, 0xffff0000, v10
v_rcp_f32 v10, v10
s_nop 0
v_mul_f32 v9, v9, v10
v_fma_f32 v96, v96, v10, -v9
v_fma_f32 v97, v97, v10, -v9
v_fma_f32 v98, v98, v10, -v9
v_fma_f32 v99, v99, v10, -v9
v_fma_f32 v100, v100, v10, -v9
v_fma_f32 v101, v101, v10, -v9
v_fma_f32 v102, v102, v10, -v9
v_fma_f32 v103, v103, v10, -v9
PK 64,96,97
PK 65,98,99
PK 66,100,101
PK 67,102,103
DW 13,64,0
v_fma_f32 v104, v104, v10, -v9
v_fma_f32 v105, v105, v10, -v9
v_fma_f32 v106, v106, v10, -v9
v_fma_f32 v107, v107, v10, -v9
v_fma_f32 v108, v108, v10, -v9
v_fma_f32 v109, v109, v10, -v9
v_fma_f32 v110, v110, v10, -v9
v_fma_f32 v111, v111, v10, -v9
PK 68,104,105
PK 69,106,107
PK 70,108,109
PK 71,110,111
DW 13,68,4096
v_fma_f32 v112, v112, v10, -v9
v_fma_f32 v113, v113, v10, -v9
v_fma_f32 v114, v114, v10, -v9
v_fma_f32 v115, v115, v10, -v9
v_fma_f32 v116, v116, v10, -v9
v_fma_f32 v117, v117, v10, -v9
v_fma_f32 v118, v118, v10, -v9
v_fma_f32 v119, v119, v10, -v9
PK 72,112,113
PK 73,114,115
PK 74,116,117
PK 75,118,119
DW 13,72,8192
v_fma_f32 v120, v120, v10, -v9
v_fma_f32 v121, v121, v10, -v9
v_fma_f32 v122, v122, v10, -v9
v_fma_f32 v123, v123, v10, -v9
v_fma_f32 v124, v124, v10, -v9
v_fma_f32 v125, v125, v10, -v9
v_fma_f32 v126, v126, v10, -v9
v_fma_f32 v127, v127, v10, -v9
PK 76,120,121
PK 77,122,123
PK 78,124,125
PK 79,126,127
DW 13,76,12288
s_waitcnt lgkmcnt(0)
s_barrier
DR 96,17,0
DR 100,17,1024
DR 104,17,2048
DR 108,17,3072
s_waitcnt lgkmcnt(3)
buffer_store_dwordx4 v[96:99], v7, s[24:27], s62 offen offset:0 sc1
s_waitcnt lgkmcnt(2)
buffer_store_dwordx4 v[100:103], v7, s[24:27], s62 offen offset:1024 sc1
s_waitcnt lgkmcnt(1)
buffer_store_dwordx4 v[104:107], v7, s[24:27], s62 offen offset:2048 sc1
s_waitcnt lgkmcnt(0)
buffer_store_dwordx4 v[108:111], v7, s[24:27], s62 offen offset:3072 sc1
v_mov_b32 v11, 1
s_waitcnt vmcnt(0)
s_barrier
s_cmp_lg_u32 s40, 0
s_cbranch_scc1 L_sdone_31
s_branch L_chk_34
L_spin_33:
s_sleep 2
v_mov_b32 v14, 20
global_load_dword v14, v14, s[18:19] sc1
L_chk_34:
v_readfirstlane_b32 s59, v14
s_bitcmp1_b32 s59, 0
s_cbranch_scc1 L_ok_35
s_waitcnt vmcnt(0)
v_readfirstlane_b32 s59, v14
s_bitcmp1_b32 s59, 0
s_cbranch_scc0 L_spin_33
L_ok_35:
s_add_u32 s47, s41, 53
s_lshl_b32 s47, s47, 7
s_lshl_b32 s49, s54, 2
s_add_u32 s47, s47, s49
v_lshlrev_b32 v10, 13, v0
v_add_u32 v10, s47, v10
v_mov_b32 v11, s59
s_mov_b64 exec, 0xff
global_store_dword v10, v11, s[100:101] sc1
s_mov_b64 exec, -1
s_branch L_schk_32
L_noln_29:
s_cmp_lg_u32 s40, 0
s_cbranch_scc1 L_sdone_31
L_spin_36:
s_sleep 2
v_mov_b32 v14, 20
global_load_dword v14, v14, s[18:19] sc1
L_chk_37:
s_waitcnt vmcnt(0)
v_readfirstlane_b32 s59, v14
s_bitcmp1_b32 s59, 0
s_cbranch_scc0 L_spin_36
L_schk_32:
L_spin_38:
s_sleep 4
global_load_dword v11, v15, s[100:101] sc1
s_waitcnt vmcnt(0)
L_chk_39:
v_cmp_ne_u32 vcc, s59, v11
s_cbranch_vccnz L_spin_38
L_sdone_31:
s_add_u32 s47, s60, 0
s_and_b32 s47, s47, 3
s_mul_i32 s47, s47, 458752
s_add_u32 s47, s47, s57
s_add_u32 m0, s46, 0
s_nop 0
buffer_load_dwordx4 v1, s[20:23], s47 offen offset:0  lds
s_add_u32 m0, s46, 0
s_nop 0
buffer_load_dwordx4 v2, s[20:23], s47 offen offset:1024  lds
s_add_u32 m0, s46, 0
s_nop 0
buffer_load_dwordx4 v3, s[20:23], s47 offen offset:2048  lds
s_add_u32 m0, s46, 0
s_nop 0
buffer_load_dwordx4 v4, s[20:23], s47 offen offset:3072  lds
s_mov_b32 s62, s55
s_mov_b32 s48, s54
s_lshl_b32 s49, s41, 18
s_lshl_b32 s50, s40, 15
s_add_u32 s54, s49, s50
s_add_u32 s54, s54, 77594624
s_barrier
s_add_u32 s63, s60, 0
s_and_b32 s63, s63, 3
s_lshl_b32 s63, s63, 12
s_add_u32 s63, s63, s54
s_add_u32 s55, s63, 16384
buffer_load_dwordx4 v[128:131], v7, s[24:27], s63 offen offset:0 sc1
buffer_load_dwordx4 v[132:135], v7, s[24:27], s55 offen offset:0 sc1
buffer_load_dwordx4 v[136:139], v7, s[24:27], s63 offen offset:1024 sc1
buffer_load_dwordx4 v[140:143], v7, s[24:27], s55 offen offset:1024 sc1
buffer_load_dwordx4 v[144:147], v7, s[24:27], s63 offen offset:2048 sc1
buffer_load_dwordx4 v[148:151], v7, s[24:27], s55 offen offset:2048 sc1
buffer_load_dwordx4 v[152:155], v7, s[24:27], s63 offen offset:3072 sc1
buffer_load_dwordx4 v[156:159], v7, s[24:27], s55 offen offset:3072 sc1
s_add_u32 s28, s16, 35651584
s_addc_u32 s29, s17, 0
s_mov_b32 s30, 3670016
s_mov_b32 s31, 0x20000
v_bfe_u32 v28, v0, 4, 2
v_lshlrev_b32 v29, 10, v28
v_bfe_u32 v30, v0, 2, 2
v_lshl_add_u32 v29, v30, 6, v29
v_and_b32 v30, 3, v0
v_lshl_add_u32 v29, v30, 3, v29
v_and_b32 v28, 1, v28
v_lshl_add_u32 v5, v28, 5, v29
v_xor_b32 v6, 32, v5
v_bfe_u32 v16, v0, 3, 1
v_lshlrev_b32 v16, 6, v16
v_bfe_u32 v18, v0, 2, 1
v_lshl_add_u32 v16, v18, 7, v16
v_and_b32 v18, 0x33, v0
v_lshl_add_u32 v16, v18, 4, v16
s_waitcnt vmcnt(8)
s_barrier
TR 32,5,0
TR 34,5,512
TR 36,5,4096
TR 38,5,4608
TR 40,5,8192
TR 42,5,8704
TR 44,5,12288
TR 46,5,12800
TR 48,6,0
TR 50,6,512
TR 52,6,4096
TR 54,6,4608
TR 56,6,8192
TR 58,6,8704
TR 60,6,12288
TR 62,6,12800
s_waitcnt vmcnt(6)
s_waitcnt vmcnt(4)
s_waitcnt vmcnt(2)
s_waitcnt vmcnt(0)
s_waitcnt lgkmcnt(14)
MZ 64,32,128
s_waitcnt lgkmcnt(12)
M 64,36,136
s_add_u32 s47, s60, 1
s_and_b32 s47, s47, 3
s_mul_i32 s47, s47, 458752
s_add_u32 s47, s47, s57
s_add_u32 m0, s46, 32768
s_nop 0
buffer_load_dwordx4 v1, s[20:23], s47 offen offset:0  lds
s_waitcnt lgkmcnt(10)
M 64,40,144
s_waitcnt lgkmcnt(8)
M 64,44,152
s_add_u32 m0, s46, 32768
s_nop 0
buffer_load_dwordx4 v2, s[20:23], s47 offen offset:1024  lds
MZ 68,32,132
M 68,36,140
TR 32,5,256
s_add_u32 m0, s46, 32768
s_nop 0
buffer_load_dwordx4 v3, s[20:23], s47 offen offset:2048  lds
M 68,40,148
TR 34,5,768
M 68,44,156
TR 36,5,4352
s_add_u32 m0, s46, 32768
s_nop 0
buffer_load_dwordx4 v4, s[20:23], s47 offen offset:3072  lds
s_waitcnt lgkmcnt(9)
MZ 72,48,128
TR 38,5,4864
s_waitcnt lgkmcnt(8)
M 72,52,136
TR 40,5,8448
s_add_u32 s63, s60, 1
s_and_b32 s63, s63, 3
s_lshl_b32 s63, s63, 12
s_add_u32 s63, s63, s54
s_add_u32 s55, s63, 16384
buffer_load_dwordx4 v[160:163], v7, s[24:27], s63 offen offset:0 sc1
buffer_load_dwordx4 v[164:167], v7, s[24:27], s55 offen offset:0 sc1
s_waitcnt lgkmcnt(7)
M 72,56,144
TR 42,5,8960
s_waitcnt lgkmcnt(6)
M 72,60,152
TR 44,5,12544
MZ 76,48,132
TR 46,5,13056
M 76,52,140
TR 48,6,256
M 76,56,148
TR 50,6,768
M 76,60,156
TR 52,6,4352
s_waitcnt lgkmcnt(9)
MZ 80,32,128
TR 54,6,4864
s_waitcnt lgkmcnt(8)
M 80,36,136
TR 56,6,8448
buffer_load_dwordx4 v[168:171], v7, s[24:27], s63 offen offset:1024 sc1
buffer_load_dwordx4 v[172:175], v7, s[24:27], s55 offen offset:1024 sc1
s_waitcnt lgkmcnt(7)
M 80,40,144
TR 58,6,8960
s_waitcnt lgkmcnt(6)
M 80,44,152
TR 60,6,12544
MZ 84,32,132
TR 62,6,13056
M 84,36,140
TR 32,5,16384
M 84,40,148
TR 34,5,16896
M 84,44,156
TR 36,5,20480
s_waitcnt lgkmcnt(9)
MZ 88,48,128
TR 38,5,20992
s_waitcnt lgkmcnt(8)
M 88,52,136
TR 40,5,24576
buffer_load_dwordx4 v[176:179], v7, s[24:27], s63 offen offset:2048 sc1
buffer_load_dwordx4 v[180:183], v7, s[24:27], s55 offen offset:2048 sc1
s_waitcnt lgkmcnt(7)
M 88,56,144
TR 42,5,25088
s_waitcnt lgkmcnt(6)
M 88,60,152
TR 44,5,28672
MZ 92,48,132
TR 46,5,29184
M 92,52,140
TR 48,6,16384
M 92,56,148
TR 50,6,16896
M 92,60,156
TR 52,6,20480
s_waitcnt lgkmcnt(9)
MZ 96,32,128
TR 54,6,20992
s_waitcnt lgkmcnt(8)
M 96,36,136
TR 56,6,24576
buffer_load_dwordx4 v[184:187], v7, s[24:27], s63 offen offset:3072 sc1
buffer_load_dwordx4 v[188:191], v7, s[24:27], s55 offen offset:3072 sc1
s_waitcnt lgkmcnt(7)
M 96,40,144
TR 58,6,25088
s_waitcnt lgkmcnt(6)
M 96,44,152
TR 60,6,28672
MZ 100,32,132
TR 62,6,29184
M 100,36,140
TR 32,5,16640
M 100,40,148
TR 34,5,17152
M 100,44,156
TR 36,5,20736
s_add_u32 s49, s46, 131072
v_add_u32 v14, s49, v7
v_bfe_u32 v15, v0, 4, 2
v_lshlrev_b32 v15, 5, v15
v_xor_b32 v14, v14, v15
s_cmp_ge_u32 s48, 8
s_cselect_b32 s49, 0x40000000, 0
v_add_u32 v15, s49, v7
DR 10,14,0
s_waitcnt lgkmcnt(10)
MZ 104,48,128
TR 38,5,21248
s_waitcnt lgkmcnt(9)
M 104,52,136
TR 40,5,24832
s_waitcnt lgkmcnt(8)
M 104,56,144
TR 42,5,25344
s_waitcnt lgkmcnt(7)
M 104,60,152
TR 44,5,28928
MZ 108,48,132
TR 46,5,29440
M 108,52,140
TR 48,6,16640
s_add_u32 s47, s60, 2
s_and_b32 s47, s47, 3
s_mul_i32 s47, s47, 458752
s_add_u32 s47, s47, s57
s_add_u32 m0, s46, 65536
s_nop 0
buffer_load_dwordx4 v1, s[20:23], s47 offen offset:0  lds
M 108,56,148
TR 50,6,17152
M 108,60,156
TR 52,6,20736
s_add_u32 m0, s46, 65536
s_nop 0
buffer_load_dwordx4 v2, s[20:23], s47 offen offset:1024  lds
s_waitcnt lgkmcnt(10)
MZ 112,32,128
TR 54,6,21248
s_waitcnt lgkmcnt(8)
M 112,36,136
TR 56,6,24832
s_add_u32 m0, s46, 65536
s_nop 0
buffer_load_dwordx4 v3, s[20:23], s47 offen offset:2048  lds
s_waitcnt lgkmcnt(7)
M 112,40,144
TR 58,6,25344
buffer_store_dwordx4 v[10:13], v15, s[24:27], s62 offen offset:0 sc1
s_waitcnt lgkmcnt(6)
M 112,44,152
TR 60,6,28928
s_add_u32 m0, s46, 65536
s_nop 0
buffer_load_dwordx4 v4, s[20:23], s47 offen offset:3072  lds
MZ 116,32,132
TR 62,6,29440
M 116,36,140
s_waitcnt vmcnt(13)
s_barrier
TR 32,5,32768
M 116,40,148
TR 34,5,33280
M 116,44,156
TR 36,5,36864
s_waitcnt lgkmcnt(9)
MZ 120,48,128
TR 38,5,37376
s_waitcnt lgkmcnt(8)
M 120,52,136
TR 40,5,40960
s_add_u32 s63, s60, 2
s_and_b32 s63, s63, 3
s_lshl_b32 s63, s63, 12
s_add_u32 s63, s63, s54
s_add_u32 s55, s63, 16384
buffer_load_dwordx4 v[192:195], v7, s[24:27], s63 offen offset:0 sc1
buffer_load_dwordx4 v[196:199], v7, s[24:27], s55 offen offset:0 sc1
s_waitcnt lgkmcnt(7)
M 120,56,144
TR 42,5,41472
s_waitcnt lgkmcnt(6)
M 120,60,152
TR 44,5,45056
MZ 124,48,132
TR 46,5,45568
M 124,52,140
TR 48,6,32768
M 124,56,148
TR 50,6,33280
M 124,60,156
TR 52,6,36864
DR 10,14,1024
s_waitcnt vmcnt(13)
s_waitcnt vmcnt(11)
s_waitcnt vmcnt(9)
s_waitcnt vmcnt(7)
s_waitcnt lgkmcnt(10)
M 64,32,160
TR 54,6,37376
s_waitcnt lgkmcnt(9)
M 64,36,168
TR 56,6,40960
s_waitcnt lgkmcnt(8)
M 64,40,176
TR 58,6,41472
s_waitcnt lgkmcnt(7)
M 64,44,184
TR 60,6,45056
M 68,32,164
TR 62,6,45568
M 68,36,172
TR 32,5,33024
buffer_load_dwordx4 v[200:203], v7, s[24:27], s63 offen offset:1024 sc1
buffer_load_dwordx4 v[204:207], v7, s[24:27], s55 offen offset:1024 sc1
M 68,40,180
TR 34,5,33536
M 68,44,188
TR 36,5,37120
s_waitcnt lgkmcnt(10)
M 72,48,160
TR 38,5,37632
s_waitcnt lgkmcnt(8)
M 72,52,168
TR 40,5,41216
s_waitcnt lgkmcnt(7)
M 72,56,176
TR 42,5,41728
s_waitcnt lgkmcnt(6)
M 72,60,184
TR 44,5,45312
buffer_store_dwordx4 v[10:13], v15, s[24:27], s62 offen offset:1024 sc1
M 76,48,164
TR 46,5,45824
M 76,52,172
TR 48,6,33024
M 76,56,180
TR 50,6,33536
M 76,60,188
TR 52,6,37120
s_waitcnt lgkmcnt(9)
M 80,32,160
TR 54,6,37632
s_waitcnt lgkmcnt(8)
M 80,36,168
TR 56,6,41216
buffer_load_dwordx4 v[208:211], v7, s[24:27], s63 offen offset:2048 sc1
buffer_load_dwordx4 v[212:215], v7, s[24:27], s55 offen offset:2048 sc1
s_waitcnt lgkmcnt(7)
M 80,40,176
TR 58,6,41728
s_waitcnt lgkmcnt(6)
M 80,44,184
TR 60,6,45312
M 84,32,164
TR 62,6,45824
M 84,36,172
TR 32,5,49152
M 84,40,180
TR 34,5,49664
M 84,44,188
TR 36,5,53248
DR 10,14,2048
s_waitcnt lgkmcnt(10)
M 88,48,160
TR 38,5,53760
s_waitcnt lgkmcnt(9)
M 88,52,168
TR 40,5,57344
s_waitcnt lgkmcnt(8)
M 88,56,176
TR 42,5,57856
s_waitcnt lgkmcnt(7)
M 88,60,184
TR 44,5,61440
M 92,48,164
TR 46,5,61952
M 92,52,172
TR 48,6,49152
buffer_load_dwordx4 v[216:219], v7, s[24:27], s63 offen offset:3072 sc1
buffer_load_dwordx4 v[220:223], v7, s[24:27], s55 offen offset:3072 sc1
M 92,56,180
TR 50,6,49664
M 92,60,188
TR 52,6,53248
s_waitcnt lgkmcnt(10)
M 96,32,160
TR 54,6,53760
s_waitcnt lgkmcnt(8)
M 96,36,168
TR 56,6,57344
s_waitcnt lgkmcnt(7)
M 96,40,176
TR 58,6,57856
s_waitcnt lgkmcnt(6)
M 96,44,184
TR 60,6,61440
buffer_store_dwordx4 v[10:13], v15, s[24:27], s62 offen offset:2048 sc1
M 100,32,164
TR 62,6,61952
M 100,36,172
TR 32,5,49408
s_add_u32 s47, s60, 3
s_and_b32 s47, s47, 3
s_mul_i32 s47, s47, 458752
s_add_u32 s47, s47, s57
s_add_u32 m0, s46, 98304
s_nop 0
buffer_load_dwordx4 v1, s[20:23], s47 offen offset:0  lds
M 100,40,180
TR 34,5,49920
M 100,44,188
TR 36,5,53504
s_add_u32 m0, s46, 98304
s_nop 0
buffer_load_dwordx4 v2, s[20:23], s47 offen offset:1024  lds
s_waitcnt lgkmcnt(9)
M 104,48,160
TR 38,5,54016
s_waitcnt lgkmcnt(8)
M 104,52,168
TR 40,5,57600
s_add_u32 m0, s46, 98304
s_nop 0
buffer_load_dwordx4 v3, s[20:23], s47 offen offset:2048  lds
s_waitcnt lgkmcnt(7)
M 104,56,176
TR 42,5,58112
s_waitcnt lgkmcnt(6)
M 104,60,184
TR 44,5,61696
s_add_u32 m0, s46, 98304
s_nop 0
buffer_load_dwordx4 v4, s[20:23], s47 offen offset:3072  lds
M 108,48,164
TR 46,5,62208
M 108,52,172
TR 48,6,49408
M 108,56,180
TR 50,6,49920
M 108,60,188
TR 52,6,53504
DR 10,14,3072
s_waitcnt lgkmcnt(10)
M 112,32,160
TR 54,6,54016
s_waitcnt lgkmcnt(9)
M 112,36,168
TR 56,6,57600
s_add_u32 s63, s60, 3
s_and_b32 s63, s63, 3
s_lshl_b32 s63, s63, 12
s_add_u32 s63, s63, s54
s_add_u32 s55, s63, 16384
buffer_load_dwordx4 v[224:227], v7, s[24:27], s63 offen offset:0 sc1
buffer_load_dwordx4 v[228:231], v7, s[24:27], s55 offen offset:0 sc1
s_waitcnt lgkmcnt(8)
M 112,40,176
TR 58,6,58112
s_waitcnt lgkmcnt(7)
M 112,44,184
TR 60,6,61696
M 116,32,164
TR 62,6,62208
M 116,36,172
s_waitcnt vmcnt(16)
s_barrier
v_xor_b32 v5, 0x10000, v5
v_xor_b32 v6, 0x10000, v6
TR 32,5,0
M 116,40,180
TR 34,5,512
M 116,44,188
TR 36,5,4096
s_waitcnt lgkmcnt(10)
M 120,48,160
s_add_u32 s51, s44, 256
s_min_u32 s51, s51, s45
s_add_u32 s51, s51, s56
s_add_u32 m0, s46, 0
s_nop 0
buffer_load_dwordx4 v1, s[20:23], s51 offen offset:0  lds
TR 38,5,4608
s_waitcnt lgkmcnt(8)
M 120,52,168
TR 40,5,8192
s_waitcnt lgkmcnt(7)
M 120,56,176
TR 42,5,8704
s_waitcnt lgkmcnt(6)
M 120,60,184
TR 44,5,12288
buffer_store_dwordx4 v[10:13], v15, s[24:27], s62 offen offset:3072 sc1
M 124,48,164
TR 46,5,12800
M 124,52,172
TR 48,6,0
M 124,56,180
TR 50,6,512
M 124,60,188
TR 52,6,4096
s_waitcnt vmcnt(16)
s_waitcnt vmcnt(14)
s_waitcnt vmcnt(11)
s_waitcnt vmcnt(9)
s_waitcnt lgkmcnt(9)
M 64,32,192
TR 54,6,4608
s_waitcnt lgkmcnt(8)
M 64,36,200
TR 56,6,8192
buffer_load_dwordx4 v[232:235], v7, s[24:27], s63 offen offset:1024 sc1
buffer_load_dwordx4 v[236:239], v7, s[24:27], s55 offen offset:1024 sc1
s_waitcnt lgkmcnt(7)
M 64,40,208
TR 58,6,8704
s_waitcnt lgkmcnt(6)
M 64,44,216
TR 60,6,12288
M 68,32,196
s_add_u32 m0, s46, 0
s_nop 0
buffer_load_dwordx4 v2, s[20:23], s51 offen offset:1024  lds
TR 62,6,12800
M 68,36,204
TR 32,5,256
M 68,40,212
TR 34,5,768
M 68,44,220
TR 36,5,4352
s_waitcnt lgkmcnt(9)
M 72,48,192
TR 38,5,4864
s_waitcnt lgkmcnt(8)
M 72,52,200
TR 40,5,8448
s_waitcnt lgkmcnt(7)
M 72,56,208
TR 42,5,8960
s_waitcnt lgkmcnt(6)
M 72,60,216
TR 44,5,12544
M 76,48,196
TR 46,5,13056
M 76,52,204
TR 48,6,256
buffer_load_dwordx4 v[240:243], v7, s[24:27], s63 offen offset:2048 sc1
buffer_load_dwordx4 v[244:247], v7, s[24:27], s55 offen offset:2048 sc1
M 76,56,212
TR 50,6,768
M 76,60,220
TR 52,6,4352
s_waitcnt lgkmcnt(9)
M 80,32,192
s_add_u32 m0, s46, 0
s_nop 0
buffer_load_dwordx4 v3, s[20:23], s51 offen offset:2048  lds
TR 54,6,4864
s_waitcnt lgkmcnt(8)
M 80,36,200
TR 56,6,8448
s_waitcnt lgkmcnt(7)
M 80,40,208
TR 58,6,8960
s_waitcnt lgkmcnt(6)
M 80,44,216
TR 60,6,12544
M 84,32,196
TR 62,6,13056
M 84,36,204
TR 32,5,16384
buffer_load_dwordx4 v[248:251], v7, s[24:27], s63 offen offset:3072 sc1
buffer_load_dwordx4 v[252:255], v7, s[24:27], s55 offen offset:3072 sc1
M 84,40,212
TR 34,5,16896
M 84,44,220
TR 36,5,20480
s_waitcnt lgkmcnt(9)
M 88,48,192
TR 38,5,20992
s_waitcnt lgkmcnt(8)
M 88,52,200
TR 40,5,24576
s_waitcnt lgkmcnt(7)
M 88,56,208
TR 42,5,25088
s_waitcnt lgkmcnt(6)
M 88,60,216
TR 44,5,28672
M 92,48,196
s_add_u32 m0, s46, 0
s_nop 0
buffer_load_dwordx4 v4, s[20:23], s51 offen offset:3072  lds
TR 46,5,29184
M 92,52,204
TR 48,6,16384
M 92,56,212
TR 50,6,16896
M 92,60,220
TR 52,6,20480
s_waitcnt lgkmcnt(9)
M 96,32,192
TR 54,6,20992
s_waitcnt lgkmcnt(8)
M 96,36,200
TR 56,6,24576
s_waitcnt lgkmcnt(7)
M 96,40,208
TR 58,6,25088
s_waitcnt lgkmcnt(6)
M 96,44,216
TR 60,6,28672
M 100,32,196
TR 62,6,29184
M 100,36,204
TR 32,5,16640
M 100,40,212
TR 34,5,17152
M 100,44,220
TR 36,5,20736
s_waitcnt lgkmcnt(9)
M 104,48,192
TR 38,5,21248
s_waitcnt lgkmcnt(8)
M 104,52,200
TR 40,5,24832
s_waitcnt lgkmcnt(7)
M 104,56,208
TR 42,5,25344
s_waitcnt lgkmcnt(6)
M 104,60,216
TR 44,5,28928
M 108,48,196
TR 46,5,29440
M 108,52,204
TR 48,6,16640
M 108,56,212
TR 50,6,17152
M 108,60,220
TR 52,6,20736
s_waitcnt lgkmcnt(9)
M 112,32,192
TR 54,6,21248
s_waitcnt lgkmcnt(8)
M 112,36,200
TR 56,6,24832
s_waitcnt lgkmcnt(7)
M 112,40,208
TR 58,6,25344
s_waitcnt lgkmcnt(6)
M 112,44,216
TR 60,6,28928
M 116,32,196
TR 62,6,29440
M 116,36,204
s_waitcnt vmcnt(9)
s_barrier
s_cmp_lg_u32 s40, 0
s_cbranch_scc1 L_w0_40
s_cmp_ge_u32 s48, 8
s_cbranch_scc1 L_nonf_41
s_add_u32 s43, s41, 53
s_lshl_b32 s43, s43, 7
s_add_u32 s43, s43, 64
s_lshl_b32 s49, s48, 2
s_add_u32 s43, s43, s49
v_lshlrev_b32 v10, 13, v0
v_add_u32 v10, s43, v10
v_mov_b32 v11, s59
s_mov_b64 exec, 0xff
global_store_dword v10, v11, s[100:101] sc1
s_mov_b64 exec, -1
L_nonf_41:
L_w0_40:
TR 32,5,32768
M 116,40,212
TR 34,5,33280
M 116,44,220
TR 36,5,36864
s_waitcnt lgkmcnt(9)
M 120,48,192
s_add_u32 s51, s44, 256
s_min_u32 s51, s51, s45
s_add_u32 s51, s51, s61
s_add_u32 m0, s46, 32768
s_nop 0
buffer_load_dwordx4 v1, s[20:23], s51 offen offset:0  lds
TR 38,5,37376
s_waitcnt lgkmcnt(8)
M 120,52,200
TR 40,5,40960
s_waitcnt lgkmcnt(7)
M 120,56,208
TR 42,5,41472
s_waitcnt lgkmcnt(6)
M 120,60,216
TR 44,5,45056
M 124,48,196
TR 46,5,45568
M 124,52,204
TR 48,6,32768
M 124,56,212
TR 50,6,33280
M 124,60,220
TR 52,6,36864
s_waitcnt vmcnt(8)
s_waitcnt vmcnt(5)
s_waitcnt vmcnt(2)
s_waitcnt lgkmcnt(9)
M 64,32,224
TR 54,6,37376
s_waitcnt lgkmcnt(8)
M 64,36,232
TR 56,6,40960
s_mov_b32 s32, s8
s_mov_b32 s33, s9
s_mov_b32 s34, 4194304
s_mov_b32 s35, 0x20000
s_and_b32 s43, s2, 0xf8
s_add_u32 s43, s43, s40
s_lshl_b32 s43, s43, 14
s_and_b32 s47, s2, 6
s_lshl_b32 s47, s47, 8
s_add_u32 s47, s47, s43
v_and_b32 v14, 3, v0
v_lshlrev_b32 v14, 7, v14
v_bfe_u32 v15, v0, 2, 3
v_lshl_add_u32 v14, v15, 11, v14
v_bfe_u32 v15, v0, 5, 1
v_lshl_add_u32 v15, v15, 28, v14
buffer_load_dword v14, v15, s[32:35], s47 offen
s_cmp_lt_u32 s2, 192
s_cbranch_scc1 L_nosp_42
s_bitcmp1_b32 s2, 0
s_cbranch_scc1 L_nosp_42
s_load_dwordx2 s[36:37], s[0:1], 64
s_and_b32 s43, s2, 56
s_add_u32 s43, s43, s40
s_lshl_b32 s43, s43, 15
s_and_b32 s47, s2, 7
s_lshl_b32 s47, s47, 20
s_add_u32 s43, s43, s47
v_bfe_u32 v13, v0, 3, 3
v_lshlrev_b32 v13, 12, v13
v_and_b32 v15, 7, v0
v_lshl_add_u32 v13, v15, 7, v13
s_waitcnt lgkmcnt(0)
s_mov_b32 s38, 8388608
s_mov_b32 s39, 0x20000
buffer_load_dword v14, v13, s[36:39], s43 offen offset:0
L_nosp_42:
s_waitcnt lgkmcnt(7)
M 64,40,240
TR 58,6,41472
s_waitcnt lgkmcnt(6)
M 64,44,248
TR 60,6,45056
M 68,32,228
s_add_u32 m0, s46, 32768
s_nop 0
buffer_load_dwordx4 v2, s[20:23], s51 offen offset:1024  lds
TR 62,6,45568
M 68,36,236
TR 32,5,33024
M 68,40,244
TR 34,5,33536
M 68,44,252
TR 36,5,37120
s_waitcnt lgkmcnt(9)
M 72,48,224
TR 38,5,37632
s_waitcnt lgkmcnt(8)
M 72,52,232
TR 40,5,41216
s_waitcnt lgkmcnt(7)
M 72,56,240
TR 42,5,41728
s_waitcnt lgkmcnt(6)
M 72,60,248
TR 44,5,45312
M 76,48,228
TR 46,5,45824
M 76,52,236
TR 48,6,33024
M 76,56,244
TR 50,6,33536
M 76,60,252
TR 52,6,37120
s_waitcnt lgkmcnt(9)
M 80,32,224
s_add_u32 m0, s46, 32768
s_nop 0
buffer_load_dwordx4 v3, s[20:23], s51 offen offset:2048  lds
TR 54,6,37632
s_waitcnt lgkmcnt(8)
M 80,36,232
TR 56,6,41216
s_waitcnt lgkmcnt(7)
M 80,40,240
TR 58,6,41728
s_waitcnt lgkmcnt(6)
M 80,44,248
TR 60,6,45312
M 84,32,228
TR 62,6,45824
M 84,36,236
TR 32,5,49152
M 84,40,244
TR 34,5,49664
M 84,44,252
TR 36,5,53248
s_waitcnt lgkmcnt(9)
M 88,48,224
TR 38,5,53760
s_waitcnt lgkmcnt(8)
M 88,52,232
TR 40,5,57344
s_waitcnt lgkmcnt(7)
M 88,56,240
TR 42,5,57856
s_waitcnt lgkmcnt(6)
M 88,60,248
TR 44,5,61440
M 92,48,228
s_add_u32 m0, s46, 32768
s_nop 0
buffer_load_dwordx4 v4, s[20:23], s51 offen offset:3072  lds
TR 46,5,61952
M 92,52,236
TR 48,6,49152
M 92,56,244
TR 50,6,49664
M 92,60,252
TR 52,6,53248
s_waitcnt lgkmcnt(9)
M 96,32,224
TR 54,6,53760
s_waitcnt lgkmcnt(8)
M 96,36,232
TR 56,6,57344
s_waitcnt lgkmcnt(7)
M 96,40,240
TR 58,6,57856
s_waitcnt lgkmcnt(6)
M 96,44,248
TR 60,6,61440
s_cmp_lg_u32 s40, 0
s_cbranch_scc1 L_w0_43
s_and_b32 s43, s2, 7
s_lshl_b32 s43, s43, 13
s_add_u32 s43, s43, 6848
v_lshrrev_b32 v13, 3, v0
v_lshlrev_b32 v13, 7, v13
v_and_b32 v15, 7, v0
v_lshl_add_u32 v13, v15, 2, v13
v_add_u32 v15, s43, v13
global_load_dword v13, v15, s[100:101] sc1
L_w0_43:
M 100,32,228
TR 62,6,61952
M 100,36,236
TR 32,5,49408
M 100,40,244
TR 34,5,49920
M 100,44,252
TR 36,5,53504
s_waitcnt lgkmcnt(9)
M 104,48,224
TR 38,5,54016
s_add_u32 s48, s58, 0
s_lshl_b32 s48, s48, 11
s_lshl_b32 s49, s41, 3
s_add_u32 s49, s49, s40
s_mul_i32 s49, s49, 57344
s_add_u32 s48, s48, s49
s_add_u32 s50, s48, 28672
v_mul_f32 v9, v64, v64
v_mul_f32 v10, v65, v65
v_mul_f32 v11, v66, v66
v_mul_f32 v12, v67, v67
s_waitcnt lgkmcnt(8)
M 104,52,232
TR 40,5,57600
v_fma_f32 v9, v9, s52, v8
v_fma_f32 v10, v10, s52, v8
v_fma_f32 v11, v11, s52, v8
v_fma_f32 v12, v12, s52, v8
v_mul_f32 v9, v9, v64
v_mul_f32 v10, v10, v65
v_mul_f32 v11, v11, v66
v_mul_f32 v12, v12, v67
v_exp_f32 v9, v9
v_exp_f32 v10, v10
v_exp_f32 v11, v11
v_exp_f32 v12, v12
s_waitcnt lgkmcnt(7)
M 104,56,240
TR 42,5,58112
v_add_f32 v9, 1.0, v9
v_add_f32 v10, 1.0, v10
v_add_f32 v11, 1.0, v11
v_add_f32 v12, 1.0, v12
v_rcp_f32 v9, v9
v_rcp_f32 v10, v10
v_rcp_f32 v11, v11
v_rcp_f32 v12, v12
v_mul_f32 v64, v64, v9
v_mul_f32 v65, v65, v10
v_mul_f32 v66, v66, v11
s_waitcnt lgkmcnt(6)
M 104,60,248
TR 44,5,61696
v_mul_f32 v67, v67, v12
v_mul_f32 v9, v72, v72
v_mul_f32 v10, v73, v73
v_mul_f32 v11, v74, v74
v_mul_f32 v12, v75, v75
v_fma_f32 v9, v9, s52, v8
v_fma_f32 v10, v10, s52, v8
v_fma_f32 v11, v11, s52, v8
v_fma_f32 v12, v12, s52, v8
v_mul_f32 v9, v9, v72
v_mul_f32 v10, v10, v73
v_mul_f32 v11, v11, v74
M 108,48,228
TR 46,5,62208
v_mul_f32 v12, v12, v75
v_exp_f32 v9, v9
v_exp_f32 v10, v10
v_exp_f32 v11, v11
v_exp_f32 v12, v12
v_add_f32 v9, 1.0, v9
v_add_f32 v10, 1.0, v10
v_add_f32 v11, 1.0, v11
v_add_f32 v12, 1.0, v12
v_rcp_f32 v9, v9
v_rcp_f32 v10, v10
M 108,52,236
TR 48,6,49408
v_rcp_f32 v11, v11
v_rcp_f32 v12, v12
v_mul_f32 v72, v72, v9
v_mul_f32 v73, v73, v10
v_mul_f32 v74, v74, v11
v_mul_f32 v75, v75, v12
PK 64,64,65
PK 65,66,67
PK 66,72,73
PK 67,74,75
v_mul_f32 v9, v68, v68
M 108,56,244
TR 50,6,49920
v_mul_f32 v10, v69, v69
v_mul_f32 v11, v70, v70
v_mul_f32 v12, v71, v71
v_fma_f32 v9, v9, s52, v8
v_fma_f32 v10, v10, s52, v8
v_fma_f32 v11, v11, s52, v8
v_fma_f32 v12, v12, s52, v8
v_mul_f32 v9, v9, v68
v_mul_f32 v10, v10, v69
v_mul_f32 v11, v11, v70
v_mul_f32 v12, v12, v71
M 108,60,252
TR 52,6,53504
v_exp_f32 v9, v9
v_exp_f32 v10, v10
v_exp_f32 v11, v11
v_exp_f32 v12, v12
v_add_f32 v9, 1.0, v9
v_add_f32 v10, 1.0, v10
v_add_f32 v11, 1.0, v11
v_add_f32 v12, 1.0, v12
v_rcp_f32 v9, v9
v_rcp_f32 v10, v10
v_rcp_f32 v11, v11
v_rcp_f32 v12, v12
s_waitcnt lgkmcnt(9)
M 112,32,224
TR 54,6,54016
v_mul_f32 v68, v68, v9
v_mul_f32 v69, v69, v10
v_mul_f32 v70, v70, v11
v_mul_f32 v71, v71, v12
v_mul_f32 v9, v76, v76
v_mul_f32 v10, v77, v77
v_mul_f32 v11, v78, v78
v_mul_f32 v12, v79, v79
v_fma_f32 v9, v9, s52, v8
v_fma_f32 v10, v10, s52, v8
v_fma_f32 v11, v11, s52, v8
s_waitcnt lgkmcnt(8)
M 112,36,232
TR 56,6,57600
v_fma_f32 v12, v12, s52, v8
v_mul_f32 v9, v9, v76
v_mul_f32 v10, v10, v77
v_mul_f32 v11, v11, v78
v_mul_f32 v12, v12, v79
v_exp_f32 v9, v9
v_exp_f32 v10, v10
v_exp_f32 v11, v11
v_exp_f32 v12, v12
v_add_f32 v9, 1.0, v9
v_add_f32 v10, 1.0, v10
v_add_f32 v11, 1.0, v11
s_waitcnt lgkmcnt(7)
M 112,40,240
TR 58,6,58112
v_add_f32 v12, 1.0, v12
v_rcp_f32 v9, v9
v_rcp_f32 v10, v10
v_rcp_f32 v11, v11
v_rcp_f32 v12, v12
v_mul_f32 v76, v76, v9
v_mul_f32 v77, v77, v10
v_mul_f32 v78, v78, v11
v_mul_f32 v79, v79, v12
PK 68,68,69
PK 69,70,71
s_waitcnt lgkmcnt(6)
M 112,44,248
TR 60,6,61696
PK 70,76,77
PK 71,78,79
v_mov_b32 v9, v64
v_mov_b32 v10, v65
v_mov_b32 v11, v66
v_mov_b32 v12, v67
v_mov_b32_dpp v64, v68 row_ror:8 row_mask:0xf bank_mask:0xc
v_mov_b32_dpp v65, v69 row_ror:8 row_mask:0xf bank_mask:0xc
v_mov_b32_dpp v66, v70 row_ror:8 row_mask:0xf bank_mask:0xc
v_mov_b32_dpp v67, v71 row_ror:8 row_mask:0xf bank_mask:0xc
v_mov_b32_dpp v68, v9 row_ror:8 row_mask:0xf bank_mask:0x3
v_mov_b32_dpp v69, v10 row_ror:8 row_mask:0xf bank_mask:0x3
v_mov_b32_dpp v70, v11 row_ror:8 row_mask:0xf bank_mask:0x3
v_mov_b32_dpp v71, v12 row_ror:8 row_mask:0xf bank_mask:0x3
buffer_store_dwordx4 v[64:67], v16, s[28:31], s48 offen offset:0 sc1
buffer_store_dwordx4 v[68:71], v16, s[28:31], s50 offen offset:0 sc1
v_mul_f32 v9, v80, v80
v_mul_f32 v10, v81, v81
v_mul_f32 v11, v82, v82
v_mul_f32 v12, v83, v83
v_fma_f32 v9, v9, s52, v8
v_fma_f32 v10, v10, s52, v8
v_fma_f32 v11, v11, s52, v8
v_fma_f32 v12, v12, s52, v8
M 116,32,228
TR 62,6,62208
v_mul_f32 v9, v9, v80
v_mul_f32 v10, v10, v81
v_mul_f32 v11, v11, v82
v_mul_f32 v12, v12, v83
v_exp_f32 v9, v9
v_exp_f32 v10, v10
v_exp_f32 v11, v11
v_exp_f32 v12, v12
v_add_f32 v9, 1.0, v9
v_add_f32 v10, 1.0, v10
v_add_f32 v11, 1.0, v11
M 116,36,236
s_waitcnt vmcnt(7)
s_barrier
v_xor_b32 v5, 0x10000, v5
v_xor_b32 v6, 0x10000, v6
TR 32,5,0
v_add_f32 v12, 1.0, v12
v_rcp_f32 v9, v9
v_rcp_f32 v10, v10
v_rcp_f32 v11, v11
v_rcp_f32 v12, v12
v_mul_f32 v80, v80, v9
v_mul_f32 v81, v81, v10
v_mul_f32 v82, v82, v11
v_mul_f32 v83, v83, v12
v_mul_f32 v9, v88, v88
v_mul_f32 v10, v89, v89
v_mul_f32 v11, v90, v90
M 116,40,244
TR 34,5,512
v_mul_f32 v12, v91, v91
v_fma_f32 v9, v9, s52, v8
v_fma_f32 v10, v10, s52, v8
v_fma_f32 v11, v11, s52, v8
v_fma_f32 v12, v12, s52, v8
v_mul_f32 v9, v9, v88
v_mul_f32 v10, v10, v89
v_mul_f32 v11, v11, v90
v_mul_f32 v12, v12, v91
v_exp_f32 v9, v9
v_exp_f32 v10, v10
M 116,44,252
TR 36,5,4096
v_exp_f32 v11, v11
v_exp_f32 v12, v12
v_add_f32 v9, 1.0, v9
v_add_f32 v10, 1.0, v10
v_add_f32 v11, 1.0, v11
v_add_f32 v12, 1.0, v12
v_rcp_f32 v9, v9
v_rcp_f32 v10, v10
v_rcp_f32 v11, v11
v_rcp_f32 v12, v12
v_mul_f32 v88, v88, v9
v_mul_f32 v89, v89, v10
s_waitcnt lgkmcnt(9)
M 120,48,224
TR 38,5,4608
v_mul_f32 v90, v90, v11
v_mul_f32 v91, v91, v12
PK 80,80,81
PK 81,82,83
PK 82,88,89
PK 83,90,91
v_mul_f32 v9, v84, v84
v_mul_f32 v10, v85, v85
v_mul_f32 v11, v86, v86
v_mul_f32 v12, v87, v87
s_waitcnt lgkmcnt(8)
M 120,52,232
TR 40,5,8192
v_fma_f32 v9, v9, s52, v8
v_fma_f32 v10, v10, s52, v8
v_fma_f32 v11, v11, s52, v8
v_fma_f32 v12, v12, s52, v8
v_mul_f32 v9, v9, v84
v_mul_f32 v10, v10, v85
v_mul_f32 v11, v11, v86
v_mul_f32 v12, v12, v87
v_exp_f32 v9, v9
v_exp_f32 v10, v10
v_exp_f32 v11, v11
v_exp_f32 v12, v12
s_waitcnt lgkmcnt(7)
M 120,56,240
TR 42,5,8704
v_add_f32 v9, 1.0, v9
v_add_f32 v10, 1.0, v10
v_add_f32 v11, 1.0, v11
v_add_f32 v12, 1.0, v12
v_rcp_f32 v9, v9
v_rcp_f32 v10, v10
v_rcp_f32 v11, v11
v_rcp_f32 v12, v12
v_mul_f32 v84, v84, v9
v_mul_f32 v85, v85, v10
v_mul_f32 v86, v86, v11
s_waitcnt lgkmcnt(6)
M 120,60,248
TR 44,5,12288
v_mul_f32 v87, v87, v12
v_mul_f32 v9, v92, v92
v_mul_f32 v10, v93, v93
v_mul_f32 v11, v94, v94
v_mul_f32 v12, v95, v95
v_fma_f32 v9, v9, s52, v8
v_fma_f32 v10, v10, s52, v8
v_fma_f32 v11, v11, s52, v8
v_fma_f32 v12, v12, s52, v8
v_mul_f32 v9, v9, v92
v_mul_f32 v10, v10, v93
v_mul_f32 v11, v11, v94
M 124,48,228
TR 46,5,12800
v_mul_f32 v12, v12, v95
v_exp_f32 v9, v9
v_exp_f32 v10, v10
v_exp_f32 v11, v11
v_exp_f32 v12, v12
v_add_f32 v9, 1.0, v9
v_add_f32 v10, 1.0, v10
v_add_f32 v11, 1.0, v11
v_add_f32 v12, 1.0, v12
v_rcp_f32 v9, v9
v_rcp_f32 v10, v10
M 124,52,236
TR 48,6,0
v_rcp_f32 v11, v11
v_rcp_f32 v12, v12
v_mul_f32 v92, v92, v9
v_mul_f32 v93, v93, v10
v_mul_f32 v94, v94, v11
v_mul_f32 v95, v95, v12
PK 84,84,85
PK 85,86,87
PK 86,92,93
PK 87,94,95
v_mov_b32 v9, v80
v_mov_b32 v10, v81
v_mov_b32 v11, v82
v_mov_b32 v12, v83
v_mov_b32_dpp v80, v84 row_ror:8 row_mask:0xf bank_mask:0xc
v_mov_b32_dpp v81, v85 row_ror:8 row_mask:0xf bank_mask:0xc
v_mov_b32_dpp v82, v86 row_ror:8 row_mask:0xf bank_mask:0xc
v_mov_b32_dpp v83, v87 row_ror:8 row_mask:0xf bank_mask:0xc
v_mov_b32_dpp v84, v9 row_ror:8 row_mask:0xf bank_mask:0x3
v_mov_b32_dpp v85, v10 row_ror:8 row_mask:0xf bank_mask:0x3
v_mov_b32_dpp v86, v11 row_ror:8 row_mask:0xf bank_mask:0x3
v_mov_b32_dpp v87, v12 row_ror:8 row_mask:0xf bank_mask:0x3
buffer_store_dwordx4 v[80:83], v16, s[28:31], s48 offen offset:1024 sc1
buffer_store_dwordx4 v[84:87], v16, s[28:31], s50 offen offset:1024 sc1
M 124,56,244
TR 50,6,512
M 124,60,252
TR 52,6,4096
s_cmp_lt_u32 s42, 1
s_cbranch_scc1 L_cont_44
s_nop 7
s_add_u32 s48, s58, 1
s_lshl_b32 s48, s48, 11
s_lshl_b32 s49, s41, 3
s_add_u32 s49, s49, s40
s_mul_i32 s49, s49, 57344
s_add_u32 s48, s48, s49
s_add_u32 s50, s48, 28672
v_mul_f32 v9, v96, v96
v_mul_f32 v10, v97, v97
v_mul_f32 v11, v98, v98
v_mul_f32 v12, v99, v99
v_fma_f32 v9, v9, s52, v8
v_fma_f32 v10, v10, s52, v8
v_fma_f32 v11, v11, s52, v8
v_fma_f32 v12, v12, s52, v8
v_mul_f32 v9, v9, v96
v_mul_f32 v10, v10, v97
v_mul_f32 v11, v11, v98
v_mul_f32 v12, v12, v99
v_exp_f32 v9, v9
v_exp_f32 v10, v10
v_exp_f32 v11, v11
v_exp_f32 v12, v12
v_add_f32 v9, 1.0, v9
v_add_f32 v10, 1.0, v10
v_add_f32 v11, 1.0, v11
v_add_f32 v12, 1.0, v12
v_rcp_f32 v9, v9
v_rcp_f32 v10, v10
v_rcp_f32 v11, v11
v_rcp_f32 v12, v12
v_mul_f32 v96, v96, v9
v_mul_f32 v97, v97, v10
v_mul_f32 v98, v98, v11
v_mul_f32 v99, v99, v12
v_mul_f32 v9, v104, v104
v_mul_f32 v10, v105, v105
v_mul_f32 v11, v106, v106
v_mul_f32 v12, v107, v107
v_fma_f32 v9, v9, s52, v8
v_fma_f32 v10, v10, s52, v8
v_fma_f32 v11, v11, s52, v8
v_fma_f32 v12, v12, s52, v8
v_mul_f32 v9, v9, v104
v_mul_f32 v10, v10, v105
v_mul_f32 v11, v11, v106
v_mul_f32 v12, v12, v107
v_exp_f32 v9, v9
v_exp_f32 v10, v10
v_exp_f32 v11, v11
v_exp_f32 v12, v12
v_add_f32 v9, 1.0, v9
v_add_f32 v10, 1.0, v10
v_add_f32 v11, 1.0, v11
v_add_f32 v12, 1.0, v12
v_rcp_f32 v9, v9
v_rcp_f32 v10, v10
v_rcp_f32 v11, v11
v_rcp_f32 v12, v12
v_mul_f32 v104, v104, v9
v_mul_f32 v105, v105, v10
v_mul_f32 v106, v106, v11
v_mul_f32 v107, v107, v12
PK 96,96,97
PK 97,98,99
PK 98,104,105
PK 99,106,107
v_mul_f32 v9, v100, v100
v_mul_f32 v10, v101, v101
v_mul_f32 v11, v102, v102
v_mul_f32 v12, v103, v103
v_fma_f32 v9, v9, s52, v8
v_fma_f32 v10, v10, s52, v8
v_fma_f32 v11, v11, s52, v8
v_fma_f32 v12, v12, s52, v8
v_mul_f32 v9, v9, v100
v_mul_f32 v10, v10, v101
v_mul_f32 v11, v11, v102
v_mul_f32 v12, v12, v103
v_exp_f32 v9, v9
v_exp_f32 v10, v10
v_exp_f32 v11, v11
v_exp_f32 v12, v12
v_add_f32 v9, 1.0, v9
v_add_f32 v10, 1.0, v10
v_add_f32 v11, 1.0, v11
v_add_f32 v12, 1.0, v12
v_rcp_f32 v9, v9
v_rcp_f32 v10, v10
v_rcp_f32 v11, v11
v_rcp_f32 v12, v12
v_mul_f32 v100, v100, v9
v_mul_f32 v101, v101, v10
v_mul_f32 v102, v102, v11
v_mul_f32 v103, v103, v12
v_mul_f32 v9, v108, v108
v_mul_f32 v10, v109, v109
v_mul_f32 v11, v110, v110
v_mul_f32 v12, v111, v111
v_fma_f32 v9, v9, s52, v8
v_fma_f32 v10, v10, s52, v8
v_fma_f32 v11, v11, s52, v8
v_fma_f32 v12, v12, s52, v8
v_mul_f32 v9, v9, v108
v_mul_f32 v10, v10, v109
v_mul_f32 v11, v11, v110
v_mul_f32 v12, v12, v111
v_exp_f32 v9, v9
v_exp_f32 v10, v10
v_exp_f32 v11, v11
v_exp_f32 v12, v12
v_add_f32 v9, 1.0, v9
v_add_f32 v10, 1.0, v10
v_add_f32 v11, 1.0, v11
v_add_f32 v12, 1.0, v12
v_rcp_f32 v9, v9
v_rcp_f32 v10, v10
v_rcp_f32 v11, v11
v_rcp_f32 v12, v12
v_mul_f32 v108, v108, v9
v_mul_f32 v109, v109, v10
v_mul_f32 v110, v110, v11
v_mul_f32 v111, v111, v12
PK 100,100,101
PK 101,102,103
PK 102,108,109
PK 103,110,111
v_mov_b32 v9, v96
v_mov_b32 v10, v97
v_mov_b32 v11, v98
v_mov_b32 v12, v99
v_mov_b32_dpp v96, v100 row_ror:8 row_mask:0xf bank_mask:0xc
v_mov_b32_dpp v97, v101 row_ror:8 row_mask:0xf bank_mask:0xc
v_mov_b32_dpp v98, v102 row_ror:8 row_mask:0xf bank_mask:0xc
v_mov_b32_dpp v99, v103 row_ror:8 row_mask:0xf bank_mask:0xc
v_mov_b32_dpp v100, v9 row_ror:8 row_mask:0xf bank_mask:0x3
v_mov_b32_dpp v101, v10 row_ror:8 row_mask:0xf bank_mask:0x3
v_mov_b32_dpp v102, v11 row_ror:8 row_mask:0xf bank_mask:0x3
v_mov_b32_dpp v103, v12 row_ror:8 row_mask:0xf bank_mask:0x3
buffer_store_dwordx4 v[96:99], v16, s[28:31], s48 offen offset:0 sc1
buffer_store_dwordx4 v[100:103], v16, s[28:31], s50 offen offset:0 sc1
v_mul_f32 v9, v112, v112
v_mul_f32 v10, v113, v113
v_mul_f32 v11, v114, v114
v_mul_f32 v12, v115, v115
v_fma_f32 v9, v9, s52, v8
v_fma_f32 v10, v10, s52, v8
v_fma_f32 v11, v11, s52, v8
v_fma_f32 v12, v12, s52, v8
v_mul_f32 v9, v9, v112
v_mul_f32 v10, v10, v113
v_mul_f32 v11, v11, v114
v_mul_f32 v12, v12, v115
v_exp_f32 v9, v9
v_exp_f32 v10, v10
v_exp_f32 v11, v11
v_exp_f32 v12, v12
v_add_f32 v9, 1.0, v9
v_add_f32 v10, 1.0, v10
v_add_f32 v11, 1.0, v11
v_add_f32 v12, 1.0, v12
v_rcp_f32 v9, v9
v_rcp_f32 v10, v10
v_rcp_f32 v11, v11
v_rcp_f32 v12, v12
v_mul_f32 v112, v112, v9
v_mul_f32 v113, v113, v10
v_mul_f32 v114, v114, v11
v_mul_f32 v115, v115, v12
v_mul_f32 v9, v120, v120
v_mul_f32 v10, v121, v121
v_mul_f32 v11, v122, v122
v_mul_f32 v12, v123, v123
v_fma_f32 v9, v9, s52, v8
v_fma_f32 v10, v10, s52, v8
v_fma_f32 v11, v11, s52, v8
v_fma_f32 v12, v12, s52, v8
v_mul_f32 v9, v9, v120
v_mul_f32 v10, v10, v121
v_mul_f32 v11, v11, v122
v_mul_f32 v12, v12, v123
v_exp_f32 v9, v9
v_exp_f32 v10, v10
v_exp_f32 v11, v11
v_exp_f32 v12, v12
v_add_f32 v9, 1.0, v9
v_add_f32 v10, 1.0, v10
v_add_f32 v11, 1.0, v11
v_add_f32 v12, 1.0, v12
v_rcp_f32 v9, v9
v_rcp_f32 v10, v10
v_rcp_f32 v11, v11
v_rcp_f32 v12, v12
v_mul_f32 v120, v120, v9
v_mul_f32 v121, v121, v10
v_mul_f32 v122, v122, v11
v_mul_f32 v123, v123, v12
PK 112,112,113
PK 113,114,115
PK 114,120,121
PK 115,122,123
v_mul_f32 v9, v116, v116
v_mul_f32 v10, v117, v117
v_mul_f32 v11, v118, v118
v_mul_f32 v12, v119, v119
v_fma_f32 v9, v9, s52, v8
v_fma_f32 v10, v10, s52, v8
v_fma_f32 v11, v11, s52, v8
v_fma_f32 v12, v12, s52, v8
v_mul_f32 v9, v9, v116
v_mul_f32 v10, v10, v117
v_mul_f32 v11, v11, v118
v_mul_f32 v12, v12, v119
v_exp_f32 v9, v9
v_exp_f32 v10, v10
v_exp_f32 v11, v11
v_exp_f32 v12, v12
v_add_f32 v9, 1.0, v9
v_add_f32 v10, 1.0, v10
v_add_f32 v11, 1.0, v11
v_add_f32 v12, 1.0, v12
v_rcp_f32 v9, v9
v_rcp_f32 v10, v10
v_rcp_f32 v11, v11
v_rcp_f32 v12, v12
v_mul_f32 v116, v116, v9
v_mul_f32 v117, v117, v10
v_mul_f32 v118, v118, v11
v_mul_f32 v119, v119, v12
v_mul_f32 v9, v124, v124
v_mul_f32 v10, v125, v125
v_mul_f32 v11, v126, v126
v_mul_f32 v12, v127, v127
v_fma_f32 v9, v9, s52, v8
v_fma_f32 v10, v10, s52, v8
v_fma_f32 v11, v11, s52, v8
v_fma_f32 v12, v12, s52, v8
v_mul_f32 v9, v9, v124
v_mul_f32 v10, v10, v125
v_mul_f32 v11, v11, v126
v_mul_f32 v12, v12, v127
v_exp_f32 v9, v9
v_exp_f32 v10, v10
v_exp_f32 v11, v11
v_exp_f32 v12, v12
v_add_f32 v9, 1.0, v9
v_add_f32 v10, 1.0, v10
v_add_f32 v11, 1.0, v11
v_add_f32 v12, 1.0, v12
v_rcp_f32 v9, v9
v_rcp_f32 v10, v10
v_rcp_f32 v11, v11
v_rcp_f32 v12, v12
v_mul_f32 v124, v124, v9
v_mul_f32 v125, v125, v10
v_mul_f32 v126, v126, v11
v_mul_f32 v127, v127, v12
PK 116,116,117
PK 117,118,119
PK 118,124,125
PK 119,126,127
v_mov_b32 v9, v112
v_mov_b32 v10, v113
v_mov_b32 v11, v114
v_mov_b32 v12, v115
v_mov_b32_dpp v112, v116 row_ror:8 row_mask:0xf bank_mask:0xc
v_mov_b32_dpp v113, v117 row_ror:8 row_mask:0xf bank_mask:0xc
v_mov_b32_dpp v114, v118 row_ror:8 row_mask:0xf bank_mask:0xc
v_mov_b32_dpp v115, v119 row_ror:8 row_mask:0xf bank_mask:0xc
v_mov_b32_dpp v116, v9 row_ror:8 row_mask:0xf bank_mask:0x3
v_mov_b32_dpp v117, v10 row_ror:8 row_mask:0xf bank_mask:0x3
v_mov_b32_dpp v118, v11 row_ror:8 row_mask:0xf bank_mask:0x3
v_mov_b32_dpp v119, v12 row_ror:8 row_mask:0xf bank_mask:0x3
buffer_store_dwordx4 v[112:115], v16, s[28:31], s48 offen offset:1024 sc1
buffer_store_dwordx4 v[116:119], v16, s[28:31], s50 offen offset:1024 sc1
s_add_u32 s58, s42, 11
s_lshl_b32 s58, s58, 7
s_lshl_b32 s49, s41, 2
s_add_u32 s58, s58, s49
s_branch L_p2
L_cont_44:
s_waitcnt lgkmcnt(9)
MZ 64,32,128
TR 54,6,4608
s_waitcnt lgkmcnt(8)
M 64,36,136
TR 56,6,8192
s_waitcnt lgkmcnt(7)
M 64,40,144
TR 58,6,8704
s_waitcnt lgkmcnt(6)
M 64,44,152
TR 60,6,12288
MZ 68,32,132
TR 62,6,12800
M 68,36,140
TR 32,5,256
M 68,40,148
TR 34,5,768
s_add_u32 s48, s58, 1
s_lshl_b32 s48, s48, 11
M 68,44,156
TR 36,5,4352
s_lshl_b32 s49, s41, 3
s_add_u32 s49, s49, s40
s_mul_i32 s49, s49, 57344
s_waitcnt lgkmcnt(9)
MZ 72,48,128
TR 38,5,4864
s_add_u32 s48, s48, s49
s_add_u32 s50, s48, 28672
s_waitcnt lgkmcnt(8)
M 72,52,136
TR 40,5,8448
v_mul_f32 v9, v96, v96
v_mul_f32 v10, v97, v97
s_waitcnt lgkmcnt(7)
M 72,56,144
TR 42,5,8960
v_mul_f32 v11, v98, v98
v_mul_f32 v12, v99, v99
s_waitcnt lgkmcnt(6)
M 72,60,152
TR 44,5,12544
v_fma_f32 v9, v9, s52, v8
v_fma_f32 v10, v10, s52, v8
MZ 76,48,132
TR 46,5,13056
v_fma_f32 v11, v11, s52, v8
v_fma_f32 v12, v12, s52, v8
M 76,52,140
TR 48,6,256
v_mul_f32 v9, v9, v96
v_mul_f32 v10, v10, v97
M 76,56,148
TR 50,6,768
v_mul_f32 v11, v11, v98
v_mul_f32 v12, v12, v99
M 76,60,156
TR 52,6,4352
v_exp_f32 v9, v9
v_exp_f32 v10, v10
s_waitcnt lgkmcnt(9)
MZ 80,32,128
TR 54,6,4864
v_exp_f32 v11, v11
v_exp_f32 v12, v12
s_waitcnt lgkmcnt(8)
M 80,36,136
TR 56,6,8448
v_add_f32 v9, 1.0, v9
v_add_f32 v10, 1.0, v10
v_add_f32 v11, 1.0, v11
s_waitcnt lgkmcnt(7)
M 80,40,144
TR 58,6,8960
v_add_f32 v12, 1.0, v12
v_rcp_f32 v9, v9
s_waitcnt lgkmcnt(6)
M 80,44,152
TR 60,6,12544
v_rcp_f32 v10, v10
v_rcp_f32 v11, v11
MZ 84,32,132
TR 62,6,13056
v_rcp_f32 v12, v12
v_mul_f32 v96, v96, v9
M 84,36,140
TR 32,5,16384
v_mul_f32 v97, v97, v10
v_mul_f32 v98, v98, v11
M 84,40,148
TR 34,5,16896
v_mul_f32 v99, v99, v12
v_mul_f32 v9, v104, v104
M 84,44,156
TR 36,5,20480
v_mul_f32 v10, v105, v105
v_mul_f32 v11, v106, v106
s_waitcnt lgkmcnt(9)
MZ 88,48,128
TR 38,5,20992
v_mul_f32 v12, v107, v107
v_fma_f32 v9, v9, s52, v8
s_waitcnt lgkmcnt(8)
M 88,52,136
TR 40,5,24576
v_fma_f32 v10, v10, s52, v8
v_fma_f32 v11, v11, s52, v8
s_waitcnt lgkmcnt(7)
M 88,56,144
TR 42,5,25088
v_fma_f32 v12, v12, s52, v8
v_mul_f32 v9, v9, v104
s_waitcnt lgkmcnt(6)
M 88,60,152
TR 44,5,28672
v_mul_f32 v10, v10, v105
v_mul_f32 v11, v11, v106
v_mul_f32 v12, v12, v107
MZ 92,48,132
TR 46,5,29184
v_exp_f32 v9, v9
v_exp_f32 v10, v10
M 92,52,140
TR 48,6,16384
v_exp_f32 v11, v11
v_exp_f32 v12, v12
M 92,56,148
TR 50,6,16896
v_add_f32 v9, 1.0, v9
v_add_f32 v10, 1.0, v10
M 92,60,156
TR 52,6,20480
v_add_f32 v11, 1.0, v11
v_add_f32 v12, 1.0, v12
s_waitcnt lgkmcnt(9)
M 64,32,160
TR 54,6,20992
v_rcp_f32 v9, v9
v_rcp_f32 v10, v10
s_waitcnt lgkmcnt(8)
M 64,36,168
TR 56,6,24576
v_rcp_f32 v11, v11
v_rcp_f32 v12, v12
s_waitcnt lgkmcnt(7)
M 64,40,176
TR 58,6,25088
v_mul_f32 v104, v104, v9
v_mul_f32 v105, v105, v10
s_waitcnt lgkmcnt(6)
M 64,44,184
TR 60,6,28672
v_mul_f32 v106, v106, v11
v_mul_f32 v107, v107, v12
M 68,32,164
TR 62,6,29184
PK 96,96,97
PK 97,98,99
M 68,36,172
TR 32,5,16640
PK 98,104,105
PK 99,106,107
M 68,40,180
TR 34,5,17152
v_mul_f32 v9, v100, v100
M 68,44,188
TR 36,5,20736
v_mul_f32 v10, v101, v101
v_mul_f32 v11, v102, v102
v_mul_f32 v12, v103, v103
s_waitcnt lgkmcnt(9)
M 72,48,160
TR 38,5,21248
v_fma_f32 v9, v9, s52, v8
v_fma_f32 v10, v10, s52, v8
s_waitcnt lgkmcnt(8)
M 72,52,168
TR 40,5,24832
v_fma_f32 v11, v11, s52, v8
v_fma_f32 v12, v12, s52, v8
s_waitcnt lgkmcnt(7)
M 72,56,176
TR 42,5,25344
v_mul_f32 v9, v9, v100
v_mul_f32 v10, v10, v101
s_waitcnt lgkmcnt(6)
M 72,60,184
TR 44,5,28928
v_mul_f32 v11, v11, v102
v_mul_f32 v12, v12, v103
M 76,48,164
TR 46,5,29440
v_exp_f32 v9, v9
v_exp_f32 v10, v10
M 76,52,172
TR 48,6,16640
v_exp_f32 v11, v11
v_exp_f32 v12, v12
M 76,56,180
TR 50,6,17152
v_add_f32 v9, 1.0, v9
v_add_f32 v10, 1.0, v10
M 76,60,188
TR 52,6,20736
v_add_f32 v11, 1.0, v11
v_add_f32 v12, 1.0, v12
s_waitcnt lgkmcnt(9)
M 80,32,160
TR 54,6,21248
v_rcp_f32 v9, v9
v_rcp_f32 v10, v10
s_waitcnt lgkmcnt(8)
M 80,36,168
TR 56,6,24832
v_rcp_f32 v11, v11
v_rcp_f32 v12, v12
v_mul_f32 v100, v100, v9
s_waitcnt lgkmcnt(7)
M 80,40,176
TR 58,6,25344
v_mul_f32 v101, v101, v10
v_mul_f32 v102, v102, v11
s_waitcnt lgkmcnt(6)
M 80,44,184
TR 60,6,28928
v_mul_f32 v103, v103, v12
v_mul_f32 v9, v108, v108
M 84,32,164
TR 62,6,29440
v_mul_f32 v10, v109, v109
v_mul_f32 v11, v110, v110
M 84,36,172
s_waitcnt vmcnt(4)
s_barrier
TR 32,5,32768
v_mul_f32 v12, v111, v111
v_fma_f32 v9, v9, s52, v8
M 84,40,180
TR 34,5,33280
v_fma_f32 v10, v10, s52, v8
v_fma_f32 v11, v11, s52, v8
M 84,44,188
TR 36,5,36864
v_fma_f32 v12, v12, s52, v8
v_mul_f32 v9, v9, v108
s_waitcnt lgkmcnt(9)
M 88,48,160
TR 38,5,37376
v_mul_f32 v10, v10, v109
v_mul_f32 v11, v11, v110
s_waitcnt lgkmcnt(8)
M 88,52,168
TR 40,5,40960
v_mul_f32 v12, v12, v111
v_exp_f32 v9, v9
s_waitcnt lgkmcnt(7)
M 88,56,176
TR 42,5,41472
v_exp_f32 v10, v10
v_exp_f32 v11, v11
s_waitcnt lgkmcnt(6)
M 88,60,184
TR 44,5,45056
v_exp_f32 v12, v12
v_add_f32 v9, 1.0, v9
M 92,48,164
TR 46,5,45568
v_add_f32 v10, 1.0, v10
v_add_f32 v11, 1.0, v11
M 92,52,172
TR 48,6,32768
v_add_f32 v12, 1.0, v12
v_rcp_f32 v9, v9
v_rcp_f32 v10, v10
M 92,56,180
TR 50,6,33280
v_rcp_f32 v11, v11
v_rcp_f32 v12, v12
M 92,60,188
TR 52,6,36864
v_mul_f32 v108, v108, v9
v_mul_f32 v109, v109, v10
s_waitcnt lgkmcnt(9)
M 64,32,192
TR 54,6,37376
v_mul_f32 v110, v110, v11
v_mul_f32 v111, v111, v12
s_waitcnt lgkmcnt(8)
M 64,36,200
TR 56,6,40960
PK 100,100,101
PK 101,102,103
s_waitcnt lgkmcnt(7)
M 64,40,208
TR 58,6,41472
PK 102,108,109
PK 103,110,111
s_waitcnt lgkmcnt(6)
M 64,44,216
TR 60,6,45056
v_mov_b32 v9, v96
v_mov_b32 v10, v97
v_mov_b32 v11, v98
v_mov_b32 v12, v99
v_mov_b32_dpp v96, v100 row_ror:8 row_mask:0xf bank_mask:0xc
v_mov_b32_dpp v97, v101 row_ror:8 row_mask:0xf bank_mask:0xc
v_mov_b32_dpp v98, v102 row_ror:8 row_mask:0xf bank_mask:0xc
v_mov_b32_dpp v99, v103 row_ror:8 row_mask:0xf bank_mask:0xc
v_mov_b32_dpp v100, v9 row_ror:8 row_mask:0xf bank_mask:0x3
v_mov_b32_dpp v101, v10 row_ror:8 row_mask:0xf bank_mask:0x3
v_mov_b32_dpp v102, v11 row_ror:8 row_mask:0xf bank_mask:0x3
v_mov_b32_dpp v103, v12 row_ror:8 row_mask:0xf bank_mask:0x3
buffer_store_dwordx4 v[96:99], v16, s[28:31], s48 offen offset:0 sc1
buffer_store_dwordx4 v[100:103], v16, s[28:31], s50 offen offset:0 sc1
v_mul_f32 v9, v112, v112
M 68,32,196
TR 62,6,45568
v_mul_f32 v10, v113, v113
v_mul_f32 v11, v114, v114
M 68,36,204
TR 32,5,33024
v_mul_f32 v12, v115, v115
v_fma_f32 v9, v9, s52, v8
M 68,40,212
TR 34,5,33536
v_fma_f32 v10, v10, s52, v8
v_fma_f32 v11, v11, s52, v8
M 68,44,220
TR 36,5,37120
v_fma_f32 v12, v12, s52, v8
v_mul_f32 v9, v9, v112
v_mul_f32 v10, v10, v113
s_waitcnt lgkmcnt(9)
M 72,48,192
TR 38,5,37632
v_mul_f32 v11, v11, v114
v_mul_f32 v12, v12, v115
s_waitcnt lgkmcnt(8)
M 72,52,200
TR 40,5,41216
v_exp_f32 v9, v9
v_exp_f32 v10, v10
s_waitcnt lgkmcnt(7)
M 72,56,208
TR 42,5,41728
v_exp_f32 v11, v11
v_exp_f32 v12, v12
s_waitcnt lgkmcnt(6)
M 72,60,216
TR 44,5,45312
v_add_f32 v9, 1.0, v9
v_add_f32 v10, 1.0, v10
M 76,48,196
TR 46,5,45824
v_add_f32 v11, 1.0, v11
v_add_f32 v12, 1.0, v12
M 76,52,204
TR 48,6,33024
v_rcp_f32 v9, v9
v_rcp_f32 v10, v10
M 76,56,212
TR 50,6,33536
v_rcp_f32 v11, v11
v_rcp_f32 v12, v12
M 76,60,220
TR 52,6,37120
v_mul_f32 v112, v112, v9
v_mul_f32 v113, v113, v10
s_waitcnt lgkmcnt(9)
M 80,32,192
TR 54,6,37632
v_mul_f32 v114, v114, v11
v_mul_f32 v115, v115, v12
s_waitcnt lgkmcnt(8)
M 80,36,200
TR 56,6,41216
v_mul_f32 v9, v120, v120
v_mul_f32 v10, v121, v121
s_waitcnt lgkmcnt(7)
M 80,40,208
TR 58,6,41728
v_mul_f32 v11, v122, v122
v_mul_f32 v12, v123, v123
s_waitcnt lgkmcnt(6)
M 80,44,216
TR 60,6,45312
v_fma_f32 v9, v9, s52, v8
v_fma_f32 v10, v10, s52, v8
v_fma_f32 v11, v11, s52, v8
M 84,32,196
TR 62,6,45824
v_fma_f32 v12, v12, s52, v8
v_mul_f32 v9, v9, v120
M 84,36,204
TR 32,5,49152
v_mul_f32 v10, v10, v121
v_mul_f32 v11, v11, v122
M 84,40,212
TR 34,5,49664
v_mul_f32 v12, v12, v123
v_exp_f32 v9, v9
M 84,44,220
TR 36,5,53248
v_exp_f32 v10, v10
v_exp_f32 v11, v11
s_waitcnt lgkmcnt(9)
M 88,48,192
TR 38,5,53760
v_exp_f32 v12, v12
v_add_f32 v9, 1.0, v9
s_waitcnt lgkmcnt(8)
M 88,52,200
TR 40,5,57344
v_add_f32 v10, 1.0, v10
v_add_f32 v11, 1.0, v11
s_waitcnt lgkmcnt(7)
M 88,56,208
TR 42,5,57856
v_add_f32 v12, 1.0, v12
v_rcp_f32 v9, v9
s_waitcnt lgkmcnt(6)
M 88,60,216
TR 44,5,61440
v_rcp_f32 v10, v10
v_rcp_f32 v11, v11
M 92,48,196
TR 46,5,61952
v_rcp_f32 v12, v12
v_mul_f32 v120, v120, v9
M 92,52,204
TR 48,6,49152
v_mul_f32 v121, v121, v10
v_mul_f32 v122, v122, v11
v_mul_f32 v123, v123, v12
M 92,56,212
TR 50,6,49664
PK 112,112,113
PK 113,114,115
M 92,60,220
TR 52,6,53248
PK 114,120,121
PK 115,122,123
s_waitcnt lgkmcnt(9)
M 64,32,224
TR 54,6,53760
v_mul_f32 v9, v116, v116
s_waitcnt lgkmcnt(8)
M 64,36,232
TR 56,6,57344
v_mul_f32 v10, v117, v117
v_mul_f32 v11, v118, v118
s_waitcnt lgkmcnt(7)
M 64,40,240
TR 58,6,57856
v_mul_f32 v12, v119, v119
v_fma_f32 v9, v9, s52, v8
s_waitcnt lgkmcnt(6)
M 64,44,248
TR 60,6,61440
v_fma_f32 v10, v10, s52, v8
v_fma_f32 v11, v11, s52, v8
M 68,32,228
TR 62,6,61952
v_fma_f32 v12, v12, s52, v8
v_mul_f32 v9, v9, v116
M 68,36,236
TR 32,5,49408
v_mul_f32 v10, v10, v117
v_mul_f32 v11, v11, v118
M 68,40,244
TR 34,5,49920
v_mul_f32 v12, v12, v119
v_exp_f32 v9, v9
M 68,44,252
TR 36,5,53504
v_exp_f32 v10, v10
v_exp_f32 v11, v11
s_waitcnt lgkmcnt(9)
M 72,48,224
TR 38,5,54016
v_exp_f32 v12, v12
v_add_f32 v9, 1.0, v9
s_waitcnt lgkmcnt(8)
M 72,52,232
TR 40,5,57600
v_add_f32 v10, 1.0, v10
v_add_f32 v11, 1.0, v11
v_add_f32 v12, 1.0, v12
s_waitcnt lgkmcnt(7)
M 72,56,240
TR 42,5,58112
v_rcp_f32 v9, v9
v_rcp_f32 v10, v10
s_waitcnt lgkmcnt(6)
M 72,60,248
TR 44,5,61696
v_rcp_f32 v11, v11
v_rcp_f32 v12, v12
M 76,48,228
TR 46,5,62208
v_mul_f32 v116, v116, v9
v_mul_f32 v117, v117, v10
M 76,52,236
TR 48,6,49408
v_mul_f32 v118, v118, v11
v_mul_f32 v119, v119, v12
M 76,56,244
TR 50,6,49920
v_mul_f32 v9, v124, v124
v_mul_f32 v10, v125, v125
M 76,60,252
TR 52,6,53504
v_mul_f32 v11, v126, v126
v_mul_f32 v12, v127, v127
s_waitcnt lgkmcnt(9)
M 80,32,224
TR 54,6,54016
v_fma_f32 v9, v9, s52, v8
v_fma_f32 v10, v10, s52, v8
s_waitcnt lgkmcnt(8)
M 80,36,232
TR 56,6,57600
v_fma_f32 v11, v11, s52, v8
v_fma_f32 v12, v12, s52, v8
s_waitcnt lgkmcnt(7)
M 80,40,240
TR 58,6,58112
v_mul_f32 v9, v9, v124
v_mul_f32 v10, v10, v125
s_waitcnt lgkmcnt(6)
M 80,44,248
TR 60,6,61696
v_mul_f32 v11, v11, v126
v_mul_f32 v12, v12, v127
v_exp_f32 v9, v9
M 84,32,228
TR 62,6,62208
v_exp_f32 v10, v10
v_exp_f32 v11, v11
M 84,36,236
v_exp_f32 v12, v12
v_add_f32 v9, 1.0, v9
M 84,40,244
v_add_f32 v10, 1.0, v10
v_add_f32 v11, 1.0, v11
M 84,44,252
v_add_f32 v12, 1.0, v12
v_rcp_f32 v9, v9
s_waitcnt lgkmcnt(6)
M 88,48,224
v_rcp_f32 v10, v10
v_rcp_f32 v11, v11
s_waitcnt lgkmcnt(4)
M 88,52,232
v_rcp_f32 v12, v12
v_mul_f32 v124, v124, v9
s_waitcnt lgkmcnt(2)
M 88,56,240
v_mul_f32 v125, v125, v10
v_mul_f32 v126, v126, v11
s_waitcnt lgkmcnt(0)
M 88,60,248
v_mul_f32 v127, v127, v12
PK 116,116,117
M 92,48,228
PK 117,118,119
PK 118,124,125
M 92,52,236
PK 119,126,127
v_mov_b32 v9, v112
v_mov_b32 v10, v113
v_mov_b32 v11, v114
v_mov_b32 v12, v115
v_mov_b32_dpp v112, v116 row_ror:8 row_mask:0xf bank_mask:0xc
v_mov_b32_dpp v113, v117 row_ror:8 row_mask:0xf bank_mask:0xc
v_mov_b32_dpp v114, v118 row_ror:8 row_mask:0xf bank_mask:0xc
v_mov_b32_dpp v115, v119 row_ror:8 row_mask:0xf bank_mask:0xc
v_mov_b32_dpp v116, v9 row_ror:8 row_mask:0xf bank_mask:0x3
v_mov_b32_dpp v117, v10 row_ror:8 row_mask:0xf bank_mask:0x3
v_mov_b32_dpp v118, v11 row_ror:8 row_mask:0xf bank_mask:0x3
v_mov_b32_dpp v119, v12 row_ror:8 row_mask:0xf bank_mask:0x3
buffer_store_dwordx4 v[112:115], v16, s[28:31], s48 offen offset:1024 sc1
buffer_store_dwordx4 v[116:119], v16, s[28:31], s50 offen offset:1024 sc1
M 92,56,244
M 92,60,252
s_nop 7
s_add_u32 s48, s58, 2
s_lshl_b32 s48, s48, 11
s_lshl_b32 s49, s41, 3
s_add_u32 s49, s49, s40
s_mul_i32 s49, s49, 57344
s_add_u32 s48, s48, s49
s_add_u32 s50, s48, 28672
v_mul_f32 v9, v64, v64
v_mul_f32 v10, v65, v65
v_mul_f32 v11, v66, v66
v_mul_f32 v12, v67, v67
v_fma_f32 v9, v9, s52, v8
v_fma_f32 v10, v10, s52, v8
v_fma_f32 v11, v11, s52, v8
v_fma_f32 v12, v12, s52, v8
v_mul_f32 v9, v9, v64
v_mul_f32 v10, v10, v65
v_mul_f32 v11, v11, v66
v_mul_f32 v12, v12, v67
v_exp_f32 v9, v9
v_exp_f32 v10, v10
v_exp_f32 v11, v11
v_exp_f32 v12, v12
v_add_f32 v9, 1.0, v9
v_add_f32 v10, 1.0, v10
v_add_f32 v11, 1.0, v11
v_add_f32 v12, 1.0, v12
v_rcp_f32 v9, v9
v_rcp_f32 v10, v10
v_rcp_f32 v11, v11
v_rcp_f32 v12, v12
v_mul_f32 v64, v64, v9
v_mul_f32 v65, v65, v10
v_mul_f32 v66, v66, v11
v_mul_f32 v67, v67, v12
v_mul_f32 v9, v72, v72
v_mul_f32 v10, v73, v73
v_mul_f32 v11, v74, v74
v_mul_f32 v12, v75, v75
v_fma_f32 v9, v9, s52, v8
v_fma_f32 v10, v10, s52, v8
v_fma_f32 v11, v11, s52, v8
v_fma_f32 v12, v12, s52, v8
v_mul_f32 v9, v9, v72
v_mul_f32 v10, v10, v73
v_mul_f32 v11, v11, v74
v_mul_f32 v12, v12, v75
v_exp_f32 v9, v9
v_exp_f32 v10, v10
v_exp_f32 v11, v11
v_exp_f32 v12, v12
v_add_f32 v9, 1.0, v9
v_add_f32 v10, 1.0, v10
v_add_f32 v11, 1.0, v11
v_add_f32 v12, 1.0, v12
v_rcp_f32 v9, v9
v_rcp_f32 v10, v10
v_rcp_f32 v11, v11
v_rcp_f32 v12, v12
v_mul_f32 v72, v72, v9
v_mul_f32 v73, v73, v10
v_mul_f32 v74, v74, v11
v_mul_f32 v75, v75, v12
PK 64,64,65
PK 65,66,67
PK 66,72,73
PK 67,74,75
v_mul_f32 v9, v68, v68
v_mul_f32 v10, v69, v69
v_mul_f32 v11, v70, v70
v_mul_f32 v12, v71, v71
v_fma_f32 v9, v9, s52, v8
v_fma_f32 v10, v10, s52, v8
v_fma_f32 v11, v11, s52, v8
v_fma_f32 v12, v12, s52, v8
v_mul_f32 v9, v9, v68
v_mul_f32 v10, v10, v69
v_mul_f32 v11, v11, v70
v_mul_f32 v12, v12, v71
v_exp_f32 v9, v9
v_exp_f32 v10, v10
v_exp_f32 v11, v11
v_exp_f32 v12, v12
v_add_f32 v9, 1.0, v9
v_add_f32 v10, 1.0, v10
v_add_f32 v11, 1.0, v11
v_add_f32 v12, 1.0, v12
v_rcp_f32 v9, v9
v_rcp_f32 v10, v10
v_rcp_f32 v11, v11
v_rcp_f32 v12, v12
v_mul_f32 v68, v68, v9
v_mul_f32 v69, v69, v10
v_mul_f32 v70, v70, v11
v_mul_f32 v71, v71, v12
v_mul_f32 v9, v76, v76
v_mul_f32 v10, v77, v77
v_mul_f32 v11, v78, v78
v_mul_f32 v12, v79, v79
v_fma_f32 v9, v9, s52, v8
v_fma_f32 v10, v10, s52, v8
v_fma_f32 v11, v11, s52, v8
v_fma_f32 v12, v12, s52, v8
v_mul_f32 v9, v9, v76
v_mul_f32 v10, v10, v77
v_mul_f32 v11, v11, v78
v_mul_f32 v12, v12, v79
v_exp_f32 v9, v9
v_exp_f32 v10, v10
v_exp_f32 v11, v11
v_exp_f32 v12, v12
v_add_f32 v9, 1.0, v9
v_add_f32 v10, 1.0, v10
v_add_f32 v11, 1.0, v11
v_add_f32 v12, 1.0, v12
v_rcp_f32 v9, v9
v_rcp_f32 v10, v10
v_rcp_f32 v11, v11
v_rcp_f32 v12, v12
v_mul_f32 v76, v76, v9
v_mul_f32 v77, v77, v10
v_mul_f32 v78, v78, v11
v_mul_f32 v79, v79, v12
PK 68,68,69
PK 69,70,71
PK 70,76,77
PK 71,78,79
v_mov_b32 v9, v64
v_mov_b32 v10, v65
v_mov_b32 v11, v66
v_mov_b32 v12, v67
v_mov_b32_dpp v64, v68 row_ror:8 row_mask:0xf bank_mask:0xc
v_mov_b32_dpp v65, v69 row_ror:8 row_mask:0xf bank_mask:0xc
v_mov_b32_dpp v66, v70 row_ror:8 row_mask:0xf bank_mask:0xc
v_mov_b32_dpp v67, v71 row_ror:8 row_mask:0xf bank_mask:0xc
v_mov_b32_dpp v68, v9 row_ror:8 row_mask:0xf bank_mask:0x3
v_mov_b32_dpp v69, v10 row_ror:8 row_mask:0xf bank_mask:0x3
v_mov_b32_dpp v70, v11 row_ror:8 row_mask:0xf bank_mask:0x3
v_mov_b32_dpp v71, v12 row_ror:8 row_mask:0xf bank_mask:0x3
buffer_store_dwordx4 v[64:67], v16, s[28:31], s48 offen offset:0 sc1
buffer_store_dwordx4 v[68:71], v16, s[28:31], s50 offen offset:0 sc1
v_mul_f32 v9, v80, v80
v_mul_f32 v10, v81, v81
v_mul_f32 v11, v82, v82
v_mul_f32 v12, v83, v83
v_fma_f32 v9, v9, s52, v8
v_fma_f32 v10, v10, s52, v8
v_fma_f32 v11, v11, s52, v8
v_fma_f32 v12, v12, s52, v8
v_mul_f32 v9, v9, v80
v_mul_f32 v10, v10, v81
v_mul_f32 v11, v11, v82
v_mul_f32 v12, v12, v83
v_exp_f32 v9, v9
v_exp_f32 v10, v10
v_exp_f32 v11, v11
v_exp_f32 v12, v12
v_add_f32 v9, 1.0, v9
v_add_f32 v10, 1.0, v10
v_add_f32 v11, 1.0, v11
v_add_f32 v12, 1.0, v12
v_rcp_f32 v9, v9
v_rcp_f32 v10, v10
v_rcp_f32 v11, v11
v_rcp_f32 v12, v12
v_mul_f32 v80, v80, v9
v_mul_f32 v81, v81, v10
v_mul_f32 v82, v82, v11
v_mul_f32 v83, v83, v12
v_mul_f32 v9, v88, v88
v_mul_f32 v10, v89, v89
v_mul_f32 v11, v90, v90
v_mul_f32 v12, v91, v91
v_fma_f32 v9, v9, s52, v8
v_fma_f32 v10, v10, s52, v8
v_fma_f32 v11, v11, s52, v8
v_fma_f32 v12, v12, s52, v8
v_mul_f32 v9, v9, v88
v_mul_f32 v10, v10, v89
v_mul_f32 v11, v11, v90
v_mul_f32 v12, v12, v91
v_exp_f32 v9, v9
v_exp_f32 v10, v10
v_exp_f32 v11, v11
v_exp_f32 v12, v12
v_add_f32 v9, 1.0, v9
v_add_f32 v10, 1.0, v10
v_add_f32 v11, 1.0, v11
v_add_f32 v12, 1.0, v12
v_rcp_f32 v9, v9
v_rcp_f32 v10, v10
v_rcp_f32 v11, v11
v_rcp_f32 v12, v12
v_mul_f32 v88, v88, v9
v_mul_f32 v89, v89, v10
v_mul_f32 v90, v90, v11
v_mul_f32 v91, v91, v12
PK 80,80,81
PK 81,82,83
PK 82,88,89
PK 83,90,91
v_mul_f32 v9, v84, v84
v_mul_f32 v10, v85, v85
v_mul_f32 v11, v86, v86
v_mul_f32 v12, v87, v87
v_fma_f32 v9, v9, s52, v8
v_fma_f32 v10, v10, s52, v8
v_fma_f32 v11, v11, s52, v8
v_fma_f32 v12, v12, s52, v8
v_mul_f32 v9, v9, v84
v_mul_f32 v10, v10, v85
v_mul_f32 v11, v11, v86
v_mul_f32 v12, v12, v87
v_exp_f32 v9, v9
v_exp_f32 v10, v10
v_exp_f32 v11, v11
v_exp_f32 v12, v12
v_add_f32 v9, 1.0, v9
v_add_f32 v10, 1.0, v10
v_add_f32 v11, 1.0, v11
v_add_f32 v12, 1.0, v12
v_rcp_f32 v9, v9
v_rcp_f32 v10, v10
v_rcp_f32 v11, v11
v_rcp_f32 v12, v12
v_mul_f32 v84, v84, v9
v_mul_f32 v85, v85, v10
v_mul_f32 v86, v86, v11
v_mul_f32 v87, v87, v12
v_mul_f32 v9, v92, v92
v_mul_f32 v10, v93, v93
v_mul_f32 v11, v94, v94
v_mul_f32 v12, v95, v95
v_fma_f32 v9, v9, s52, v8
v_fma_f32 v10, v10, s52, v8
v_fma_f32 v11, v11, s52, v8
v_fma_f32 v12, v12, s52, v8
v_mul_f32 v9, v9, v92
v_mul_f32 v10, v10, v93
v_mul_f32 v11, v11, v94
v_mul_f32 v12, v12, v95
v_exp_f32 v9, v9
v_exp_f32 v10, v10
v_exp_f32 v11, v11
v_exp_f32 v12, v12
v_add_f32 v9, 1.0, v9
v_add_f32 v10, 1.0, v10
v_add_f32 v11, 1.0, v11
v_add_f32 v12, 1.0, v12
v_rcp_f32 v9, v9
v_rcp_f32 v10, v10
v_rcp_f32 v11, v11
v_rcp_f32 v12, v12
v_mul_f32 v92, v92, v9
v_mul_f32 v93, v93, v10
v_mul_f32 v94, v94, v11
v_mul_f32 v95, v95, v12
PK 84,84,85
PK 85,86,87
PK 86,92,93
PK 87,94,95
v_mov_b32 v9, v80
v_mov_b32 v10, v81
v_mov_b32 v11, v82
v_mov_b32 v12, v83
v_mov_b32_dpp v80, v84 row_ror:8 row_mask:0xf bank_mask:0xc
v_mov_b32_dpp v81, v85 row_ror:8 row_mask:0xf bank_mask:0xc
v_mov_b32_dpp v82, v86 row_ror:8 row_mask:0xf bank_mask:0xc
v_mov_b32_dpp v83, v87 row_ror:8 row_mask:0xf bank_mask:0xc
v_mov_b32_dpp v84, v9 row_ror:8 row_mask:0xf bank_mask:0x3
v_mov_b32_dpp v85, v10 row_ror:8 row_mask:0xf bank_mask:0x3
v_mov_b32_dpp v86, v11 row_ror:8 row_mask:0xf bank_mask:0x3
v_mov_b32_dpp v87, v12 row_ror:8 row_mask:0xf bank_mask:0x3
buffer_store_dwordx4 v[80:83], v16, s[28:31], s48 offen offset:1024 sc1
buffer_store_dwordx4 v[84:87], v16, s[28:31], s50 offen offset:1024 sc1
s_add_u32 s58, s42, 11
s_lshl_b32 s58, s58, 7
s_lshl_b32 s49, s41, 2
s_add_u32 s58, s58, s49
s_branch L_p2
L_k1_Z1_end:
L_k1_Z2:
s_getpc_b64 s[36:37]
L_pc_45:
v_lshlrev_b32 v26, 7, v0
v_min_u32 v26, L_k1_Z2_end-L_pc_45-4, v26
v_mov_b32 v27, s37
v_add_co_u32 v26, vcc, s36, v26
s_nop 1
v_addc_co_u32 v27, vcc, 0, v27, vcc
global_load_dword v255, v[26:27], off
v_bfe_u32 v28, v0, 5, 1
v_bfe_u32 v29, v0, 2, 2
v_lshl_add_u32 v28, v28, 2, v29
v_mul_u32_u24 v28, 3584, v28
v_bfe_u32 v29, v0, 4, 1
v_lshl_add_u32 v28, v29, 6, v28
v_and_b32 v29, 3, v0
v_xor_b32 v30, 2, v29
v_lshlrev_b32 v29, 4, v29
v_lshlrev_b32 v30, 4, v30
v_add_u32 v31, 0, v28
v_add_u32 v1, v31, v29
v_add_u32 v31, 27648, v28
v_add_u32 v2, v31, v30
v_add_u32 v31, 55296, v28
v_add_u32 v3, v31, v29
v_add_u32 v31, 82944, v28
v_add_u32 v4, v31, v30
s_waitcnt lgkmcnt(0)
s_add_u32 s100, s16, 79691776
s_addc_u32 s101, s17, 0
s_sub_u32 s42, s3, 25
v_and_b32 v28, 63, v0
v_lshlrev_b32 v7, 4, v28
s_mov_b32 s24, s4
s_mov_b32 s25, s5
s_mov_b32 s26, 2097152
s_mov_b32 s27, 0x20000
s_sub_u32 s54, s3, 22
s_and_b32 s49, s54, 7
s_lshl_b32 s49, s49, 5
s_lshl_b32 s50, s41, 8
s_add_u32 s49, s49, s50
s_lshl_b32 s50, s40, 2
s_add_u32 s55, s49, s50
s_lshl_b32 s49, s55, 10
v_and_b32 v28, 3, v0
v_lshlrev_b32 v30, 4, v28
v_bfe_u32 v29, v0, 2, 2
v_lshl_add_u32 v30, v29, 10, v30
v_bfe_u32 v29, v0, 4, 2
v_lshl_add_u32 v30, v29, 6, v30
buffer_load_dwordx4 v[64:67], v30, s[24:27], s49 offen offset:0
buffer_load_dwordx4 v[68:71], v30, s[24:27], s49 offen offset:256
buffer_load_dwordx4 v[72:75], v30, s[24:27], s49 offen offset:512
buffer_load_dwordx4 v[76:79], v30, s[24:27], s49 offen offset:768
s_mov_b32 s20, s14
s_mov_b32 s21, s15
s_mov_b32 s22, 1835008
s_mov_b32 s23, 0x20000
s_lshl_b32 s58, s42, 1
s_lshl_b32 s44, s58, 7
s_add_u32 s44, s44, 1792
s_mov_b32 s45, 3456
s_lshl_b32 s46, s40, 12
s_bfe_u32 s60, s2, 0x20005
s_bfe_u32 s49, s2, 0x20003
s_add_u32 s60, s60, s49
s_and_b32 s60, s60, 3
s_lshl_b32 s49, s60, 2
s_add_u32 s49, s49, s40
s_and_b32 s50, s49, 15
s_mul_i32 s56, s50, 114688
s_xor_b32 s50, s50, 8
s_mul_i32 s61, s50, 114688
s_and_b32 s57, s40, 3
s_mul_i32 s57, s57, 114688
s_lshr_b32 s49, s40, 2
s_lshl_b32 s49, s49, 7
s_add_u32 s57, s57, s49
s_add_u32 s57, s57, s44
s_mov_b32 s24, s16
s_mov_b32 s25, s17
s_mov_b32 s26, 79691776
s_mov_b32 s27, 0x20000
s_mov_b32 s53, 0xffff0000
s_mov_b32 s52, 3184710632
v_mov_b32 v8, 3222493025
s_lshr_b32 s55, s55, 5
s_lshl_b32 s55, s55, 15
s_add_u32 s55, s55, s46
s_add_u32 s62, s55, 77594624
s_lshr_b32 s49, s40, 2
s_lshl_b32 s49, s49, 14
s_and_b32 s50, s40, 3
s_lshl_b32 s50, s50, 6
s_add_u32 s49, s49, s50
s_add_u32 s49, s49, 0x20000
v_bfe_u32 v28, v0, 2, 2
v_lshlrev_b32 v28, 4, v28
v_and_b32 v30, 3, v0
v_lshl_add_u32 v28, v30, 8, v28
v_bfe_u32 v29, v0, 4, 2
v_lshl_add_u32 v28, v29, 10, v28
v_add_u32 v13, s49, v28
v_lshlrev_b32 v30, 5, v30
v_xor_b32 v13, v13, v30
s_and_b32 s49, s46, 0x3fff
s_lshr_b32 s50, s40, 2
s_lshl_b32 s50, s50, 6
s_add_u32 s49, s49, s50
s_add_u32 s49, s49, 0x20000
v_bfe_u32 v17, v0, 3, 1
v_lshlrev_b32 v17, 14, v17
v_bfe_u32 v28, v0, 2, 1
v_lshl_add_u32 v17, v28, 7, v17
v_and_b32 v28, 0x33, v0
v_lshl_add_u32 v17, v28, 4, v17
v_add_u32 v17, s49, v17
v_lshlrev_b32 v29, 5, v29
v_xor_b32 v17, v17, v29
s_add_u32 s49, s41, 53
s_lshl_b32 s49, s49, 7
s_and_b32 s50, s2, 7
s_lshl_b32 s50, s50, 13
s_add_u32 s49, s49, s50
v_min_u32 v15, 7, v0
v_lshl_add_u32 v15, v15, 2, s49
s_cmp_ge_u32 s54, 8
s_cbranch_scc1 L_noln_46
v_mov_b32 v9, 0
v_mov_b32 v10, 0
v_mov_b32 v11, 0
v_mov_b32 v12, 0
v_mov_b32 v16, 0x3f803f80
s_waitcnt vmcnt(0)
v_mov_b32 v14, 20
s_cmp_lg_u32 s40, 0
s_cbranch_scc1 L_w0_47
global_load_dword v14, v14, s[18:19] sc1
L_w0_47:
v_dot2c_f32_bf16 v9, v16, v64
v_dot2c_f32_bf16 v10, v64, v64
v_dot2c_f32_bf16 v11, v16, v65
v_dot2c_f32_bf16 v12, v65, v65
v_dot2c_f32_bf16 v9, v16, v66
v_dot2c_f32_bf16 v10, v66, v66
v_dot2c_f32_bf16 v11, v16, v67
v_dot2c_f32_bf16 v12, v67, v67
v_dot2c_f32_bf16 v9, v16, v68
v_dot2c_f32_bf16 v10, v68, v68
v_dot2c_f32_bf16 v11, v16, v69
v_dot2c_f32_bf16 v12, v69, v69
v_dot2c_f32_bf16 v9, v16, v70
v_dot2c_f32_bf16 v10, v70, v70
v_dot2c_f32_bf16 v11, v16, v71
v_dot2c_f32_bf16 v12, v71, v71
v_dot2c_f32_bf16 v9, v16, v72
v_dot2c_f32_bf16 v10, v72, v72
v_dot2c_f32_bf16 v11, v16, v73
v_dot2c_f32_bf16 v12, v73, v73
v_dot2c_f32_bf16 v9, v16, v74
v_dot2c_f32_bf16 v10, v74, v74
v_dot2c_f32_bf16 v11, v16, v75
v_dot2c_f32_bf16 v12, v75, v75
v_dot2c_f32_bf16 v9, v16, v76
v_dot2c_f32_bf16 v10, v76, v76
v_dot2c_f32_bf16 v11, v16, v77
v_dot2c_f32_bf16 v12, v77, v77
v_dot2c_f32_bf16 v9, v16, v78
v_dot2c_f32_bf16 v10, v78, v78
v_dot2c_f32_bf16 v11, v16, v79
v_dot2c_f32_bf16 v12, v79, v79
v_lshlrev_b32 v96, 16, v64
v_and_b32 v97, s53, v64
v_lshlrev_b32 v98, 16, v65
v_and_b32 v99, s53, v65
v_lshlrev_b32 v100, 16, v66
v_and_b32 v101, s53, v66
v_lshlrev_b32 v102, 16, v67
v_and_b32 v103, s53, v67
v_add_f32 v9, v9, v11
v_add_f32 v10, v10, v12
v_lshlrev_b32 v104, 16, v68
v_and_b32 v105, s53, v68
v_lshlrev_b32 v106, 16, v69
v_and_b32 v107, s53, v69
v_lshlrev_b32 v108, 16, v70
v_and_b32 v109, s53, v70
v_lshlrev_b32 v110, 16, v71
v_and_b32 v111, s53, v71
v_lshlrev_b32 v112, 16, v72
v_and_b32 v113, s53, v72
v_lshlrev_b32 v114, 16, v73
v_and_b32 v115, s53, v73
v_add_f32_dpp v9, v9, v9 quad_perm:[1,0,3,2] row_mask:0xf bank_mask:0xf
v_add_f32_dpp v10, v10, v10 quad_perm:[1,0,3,2] row_mask:0xf bank_mask:0xf
v_lshlrev_b32 v116, 16, v74
v_and_b32 v117, s53, v74
v_lshlrev_b32 v118, 16, v75
v_and_b32 v119, s53, v75
v_lshlrev_b32 v120, 16, v76
v_and_b32 v121, s53, v76
v_lshlrev_b32 v122, 16, v77
v_and_b32 v123, s53, v77
v_lshlrev_b32 v124, 16, v78
v_and_b32 v125, s53, v78
v_lshlrev_b32 v126, 16, v79
v_and_b32 v127, s53, v79
v_add_f32_dpp v9, v9, v9 quad_perm:[2,3,0,1] row_mask:0xf bank_mask:0xf
v_add_f32_dpp v10, v10, v10 quad_perm:[2,3,0,1] row_mask:0xf bank_mask:0xf
v_mov_b32 v11, v9
v_mov_b32 v12, v10
s_nop 1
v_permlane32_swap_b32 v11, v9
v_permlane32_swap_b32 v12, v10
s_nop 1
v_add_f32 v9, v9, v11
v_add_f32 v10, v10, v12
v_mov_b32 v11, v9
v_mov_b32 v12, v10
s_nop 1
v_permlane16_swap_b32 v11, v9
v_permlane16_swap_b32 v12, v10
s_nop 1
v_add_f32 v9, v9, v11
v_add_f32 v10, v10, v12
v_mul_f32 v9, 989855744, v9
v_mul_f32 v10, 989855744, v10
v_fma_f32 v10, -v9, v9, v10
v_max_f32 v10, 0, v10
PK 9,9,9
PK 10,10,10
v_and_b32 v9, 0xffff0000, v9
v_and_b32 v10, 0xffff0000, v10
v_add_f32 v10, 925353388, v10
PK 10,10,10
v_and_b32 v10, 0xffff0000, v10
v_sqrt_f32 v10, v10
s_nop 0
PK 10,10,10
v_and_b32 v10, 0xffff0000, v10
v_rcp_f32 v10, v10
s_nop 0
v_mul_f32 v9, v9, v10
v_fma_f32 v96, v96, v10, -v9
v_fma_f32 v97, v97, v10, -v9
v_fma_f32 v98, v98, v10, -v9
v_fma_f32 v99, v99, v10, -v9
v_fma_f32 v100, v100, v10, -v9
v_fma_f32 v101, v101, v10, -v9
v_fma_f32 v102, v102, v10, -v9
v_fma_f32 v103, v103, v10, -v9
PK 64,96,97
PK 65,98,99
PK 66,100,101
PK 67,102,103
DW 13,64,0
v_fma_f32 v104, v104, v10, -v9
v_fma_f32 v105, v105, v10, -v9
v_fma_f32 v106, v106, v10, -v9
v_fma_f32 v107, v107, v10, -v9
v_fma_f32 v108, v108, v10, -v9
v_fma_f32 v109, v109, v10, -v9
v_fma_f32 v110, v110, v10, -v9
v_fma_f32 v111, v111, v10, -v9
PK 68,104,105
PK 69,106,107
PK 70,108,109
PK 71,110,111
DW 13,68,4096
v_fma_f32 v112, v112, v10, -v9
v_fma_f32 v113, v113, v10, -v9
v_fma_f32 v114, v114, v10, -v9
v_fma_f32 v115, v115, v10, -v9
v_fma_f32 v116, v116, v10, -v9
v_fma_f32 v117, v117, v10, -v9
v_fma_f32 v118, v118, v10, -v9
v_fma_f32 v119, v119, v10, -v9
PK 72,112,113
PK 73,114,115
PK 74,116,117
PK 75,118,119
DW 13,72,8192
v_fma_f32 v120, v120, v10, -v9
v_fma_f32 v121, v121, v10, -v9
v_fma_f32 v122, v122, v10, -v9
v_fma_f32 v123, v123, v10, -v9
v_fma_f32 v124, v124, v10, -v9
v_fma_f32 v125, v125, v10, -v9
v_fma_f32 v126, v126, v10, -v9
v_fma_f32 v127, v127, v10, -v9
PK 76,120,121
PK 77,122,123
PK 78,124,125
PK 79,126,127
DW 13,76,12288
s_waitcnt lgkmcnt(0)
s_barrier
DR 96,17,0
DR 100,17,1024
DR 104,17,2048
DR 108,17,3072
s_waitcnt lgkmcnt(3)
buffer_store_dwordx4 v[96:99], v7, s[24:27], s62 offen offset:0 sc1
s_waitcnt lgkmcnt(2)
buffer_store_dwordx4 v[100:103], v7, s[24:27], s62 offen offset:1024 sc1
s_waitcnt lgkmcnt(1)
buffer_store_dwordx4 v[104:107], v7, s[24:27], s62 offen offset:2048 sc1
s_waitcnt lgkmcnt(0)
buffer_store_dwordx4 v[108:111], v7, s[24:27], s62 offen offset:3072 sc1
v_mov_b32 v11, 1
s_waitcnt vmcnt(0)
s_barrier
s_cmp_lg_u32 s40, 0
s_cbranch_scc1 L_sdone_48
s_branch L_chk_51
L_spin_50:
s_sleep 2
v_mov_b32 v14, 20
global_load_dword v14, v14, s[18:19] sc1
L_chk_51:
v_readfirstlane_b32 s59, v14
s_bitcmp1_b32 s59, 0
s_cbranch_scc1 L_ok_52
s_waitcnt vmcnt(0)
v_readfirstlane_b32 s59, v14
s_bitcmp1_b32 s59, 0
s_cbranch_scc0 L_spin_50
L_ok_52:
s_add_u32 s47, s41, 53
s_lshl_b32 s47, s47, 7
s_lshl_b32 s49, s54, 2
s_add_u32 s47, s47, s49
v_lshlrev_b32 v10, 13, v0
v_add_u32 v10, s47, v10
v_mov_b32 v11, s59
s_mov_b64 exec, 0xff
global_store_dword v10, v11, s[100:101] sc1
s_mov_b64 exec, -1
s_branch L_schk_49
L_noln_46:
s_cmp_lg_u32 s40, 0
s_cbranch_scc1 L_sdone_48
L_spin_53:
s_sleep 2
v_mov_b32 v14, 20
global_load_dword v14, v14, s[18:19] sc1
L_chk_54:
s_waitcnt vmcnt(0)
v_readfirstlane_b32 s59, v14
s_bitcmp1_b32 s59, 0
s_cbranch_scc0 L_spin_53
L_schk_49:
L_spin_55:
s_sleep 4
global_load_dword v11, v15, s[100:101] sc1
s_waitcnt vmcnt(0)
L_chk_56:
v_cmp_ne_u32 vcc, s59, v11
s_cbranch_vccnz L_spin_55
L_sdone_48:
s_add_u32 s47, s60, 0
s_and_b32 s47, s47, 3
s_mul_i32 s47, s47, 458752
s_add_u32 s47, s47, s57
s_add_u32 m0, s46, 0
s_nop 0
buffer_load_dwordx4 v1, s[20:23], s47 offen offset:0  lds
s_add_u32 m0, s46, 0
s_nop 0
buffer_load_dwordx4 v2, s[20:23], s47 offen offset:1024  lds
s_add_u32 m0, s46, 0
s_nop 0
buffer_load_dwordx4 v3, s[20:23], s47 offen offset:2048  lds
s_add_u32 m0, s46, 0
s_nop 0
buffer_load_dwordx4 v4, s[20:23], s47 offen offset:3072  lds
s_mov_b32 s62, s55
s_mov_b32 s48, s54
s_lshl_b32 s49, s41, 18
s_lshl_b32 s50, s40, 15
s_add_u32 s54, s49, s50
s_add_u32 s54, s54, 77594624
s_barrier
s_add_u32 s63, s60, 0
s_and_b32 s63, s63, 3
s_lshl_b32 s63, s63, 12
s_add_u32 s63, s63, s54
s_add_u32 s55, s63, 16384
buffer_load_dwordx4 v[128:131], v7, s[24:27], s63 offen offset:0 sc1
buffer_load_dwordx4 v[132:135], v7, s[24:27], s55 offen offset:0 sc1
buffer_load_dwordx4 v[136:139], v7, s[24:27], s63 offen offset:1024 sc1
buffer_load_dwordx4 v[140:143], v7, s[24:27], s55 offen offset:1024 sc1
buffer_load_dwordx4 v[144:147], v7, s[24:27], s63 offen offset:2048 sc1
buffer_load_dwordx4 v[148:151], v7, s[24:27], s55 offen offset:2048 sc1
buffer_load_dwordx4 v[152:155], v7, s[24:27], s63 offen offset:3072 sc1
buffer_load_dwordx4 v[156:159], v7, s[24:27], s55 offen offset:3072 sc1
s_add_u32 s28, s16, 39845888
s_addc_u32 s29, s17, 0
s_mov_b32 s30, 3670016
s_mov_b32 s31, 0x20000
v_bfe_u32 v28, v0, 4, 2
v_lshlrev_b32 v29, 10, v28
v_bfe_u32 v30, v0, 2, 2
v_lshl_add_u32 v29, v30, 6, v29
v_and_b32 v30, 3, v0
v_lshl_add_u32 v29, v30, 3, v29
v_and_b32 v28, 1, v28
v_lshl_add_u32 v5, v28, 5, v29
v_xor_b32 v6, 32, v5
v_mov_b32 v16, 0
v_mov_b32 v17, 0
v_mov_b32 v18, 0
v_mov_b32 v19, 0
v_mov_b32 v20, 0
v_mov_b32 v21, 0
v_mov_b32 v22, 0
v_mov_b32 v23, 0
v_mov_b32 v24, 0
v_mov_b32 v25, 0
v_mov_b32 v26, 0
v_mov_b32 v27, 0
v_mov_b32 v28, 0
v_mov_b32 v29, 0
v_mov_b32 v30, 0
v_mov_b32 v31, 0
s_add_u32 s49, s46, 131072
v_add_u32 v13, s49, v7
s_waitcnt vmcnt(8)
s_barrier
TR 32,5,0
TR 34,5,512
TR 36,5,4096
TR 38,5,4608
TR 40,5,8192
TR 42,5,8704
TR 44,5,12288
TR 46,5,12800
TR 48,6,0
TR 50,6,512
TR 52,6,4096
TR 54,6,4608
TR 56,6,8192
TR 58,6,8704
TR 60,6,12288
TR 62,6,12800
s_waitcnt vmcnt(6)
s_waitcnt vmcnt(4)
s_waitcnt vmcnt(2)
s_waitcnt vmcnt(0)
s_waitcnt lgkmcnt(14)
MZ 64,128,32
s_waitcnt lgkmcnt(12)
M 64,136,36
s_add_u32 s47, s60, 1
s_and_b32 s47, s47, 3
s_mul_i32 s47, s47, 458752
s_add_u32 s47, s47, s57
s_add_u32 m0, s46, 32768
s_nop 0
buffer_load_dwordx4 v1, s[20:23], s47 offen offset:0  lds
s_waitcnt lgkmcnt(10)
M 64,144,40
s_waitcnt lgkmcnt(8)
M 64,152,44
s_add_u32 m0, s46, 32768
s_nop 0
buffer_load_dwordx4 v2, s[20:23], s47 offen offset:1024  lds
MZ 68,132,32
M 68,140,36
TR 32,5,256
s_add_u32 m0, s46, 32768
s_nop 0
buffer_load_dwordx4 v3, s[20:23], s47 offen offset:2048  lds
M 68,148,40
TR 34,5,768
M 68,156,44
TR 36,5,4352
s_add_u32 m0, s46, 32768
s_nop 0
buffer_load_dwordx4 v4, s[20:23], s47 offen offset:3072  lds
s_waitcnt lgkmcnt(9)
MZ 72,128,48
TR 38,5,4864
s_waitcnt lgkmcnt(8)
M 72,136,52
TR 40,5,8448
s_add_u32 s63, s60, 1
s_and_b32 s63, s63, 3
s_lshl_b32 s63, s63, 12
s_add_u32 s63, s63, s54
s_add_u32 s55, s63, 16384
buffer_load_dwordx4 v[160:163], v7, s[24:27], s63 offen offset:0 sc1
buffer_load_dwordx4 v[164:167], v7, s[24:27], s55 offen offset:0 sc1
s_waitcnt lgkmcnt(7)
M 72,144,56
TR 42,5,8960
s_waitcnt lgkmcnt(6)
M 72,152,60
TR 44,5,12544
MZ 76,132,48
TR 46,5,13056
M 76,140,52
TR 48,6,256
M 76,148,56
TR 50,6,768
M 76,156,60
TR 52,6,4352
s_waitcnt lgkmcnt(9)
MZ 80,128,32
TR 54,6,4864
s_waitcnt lgkmcnt(8)
M 80,136,36
TR 56,6,8448
buffer_load_dwordx4 v[168:171], v7, s[24:27], s63 offen offset:1024 sc1
buffer_load_dwordx4 v[172:175], v7, s[24:27], s55 offen offset:1024 sc1
s_waitcnt lgkmcnt(7)
M 80,144,40
TR 58,6,8960
s_waitcnt lgkmcnt(6)
M 80,152,44
TR 60,6,12544
MZ 84,132,32
TR 62,6,13056
M 84,140,36
TR 32,5,16384
M 84,148,40
TR 34,5,16896
M 84,156,44
TR 36,5,20480
s_waitcnt lgkmcnt(9)
MZ 88,128,48
TR 38,5,20992
s_waitcnt lgkmcnt(8)
M 88,136,52
TR 40,5,24576
buffer_load_dwordx4 v[176:179], v7, s[24:27], s63 offen offset:2048 sc1
buffer_load_dwordx4 v[180:183], v7, s[24:27], s55 offen offset:2048 sc1
s_waitcnt lgkmcnt(7)
M 88,144,56
TR 42,5,25088
s_waitcnt lgkmcnt(6)
M 88,152,60
TR 44,5,28672
MZ 92,132,48
TR 46,5,29184
M 92,140,52
TR 48,6,16384
M 92,148,56
TR 50,6,16896
M 92,156,60
TR 52,6,20480
s_waitcnt lgkmcnt(9)
MZ 96,128,32
TR 54,6,20992
s_waitcnt lgkmcnt(8)
M 96,136,36
TR 56,6,24576
buffer_load_dwordx4 v[184:187], v7, s[24:27], s63 offen offset:3072 sc1
buffer_load_dwordx4 v[188:191], v7, s[24:27], s55 offen offset:3072 sc1
s_waitcnt lgkmcnt(7)
M 96,144,40
TR 58,6,25088
s_waitcnt lgkmcnt(6)
M 96,152,44
TR 60,6,28672
MZ 100,132,32
TR 62,6,29184
M 100,140,36
TR 32,5,16640
M 100,148,40
TR 34,5,17152
M 100,156,44
TR 36,5,20736
s_add_u32 s49, s46, 131072
v_add_u32 v14, s49, v7
v_bfe_u32 v15, v0, 4, 2
v_lshlrev_b32 v15, 5, v15
v_xor_b32 v14, v14, v15
s_cmp_ge_u32 s48, 8
s_cselect_b32 s49, 0x40000000, 0
v_add_u32 v15, s49, v7
DR 10,14,0
s_waitcnt lgkmcnt(10)
MZ 104,128,48
TR 38,5,21248
s_waitcnt lgkmcnt(9)
M 104,136,52
TR 40,5,24832
s_waitcnt lgkmcnt(8)
M 104,144,56
TR 42,5,25344
s_waitcnt lgkmcnt(7)
M 104,152,60
TR 44,5,28928
MZ 108,132,48
TR 46,5,29440
M 108,140,52
TR 48,6,16640
s_add_u32 s47, s60, 2
s_and_b32 s47, s47, 3
s_mul_i32 s47, s47, 458752
s_add_u32 s47, s47, s57
s_add_u32 m0, s46, 65536
s_nop 0
buffer_load_dwordx4 v1, s[20:23], s47 offen offset:0  lds
M 108,148,56
TR 50,6,17152
M 108,156,60
TR 52,6,20736
s_add_u32 m0, s46, 65536
s_nop 0
buffer_load_dwordx4 v2, s[20:23], s47 offen offset:1024  lds
s_waitcnt lgkmcnt(10)
MZ 112,128,32
TR 54,6,21248
s_waitcnt lgkmcnt(8)
M 112,136,36
TR 56,6,24832
s_add_u32 m0, s46, 65536
s_nop 0
buffer_load_dwordx4 v3, s[20:23], s47 offen offset:2048  lds
s_waitcnt lgkmcnt(7)
M 112,144,40
TR 58,6,25344
buffer_store_dwordx4 v[10:13], v15, s[24:27], s62 offen offset:0 sc1
s_waitcnt lgkmcnt(6)
M 112,152,44
TR 60,6,28928
s_add_u32 m0, s46, 65536
s_nop 0
buffer_load_dwordx4 v4, s[20:23], s47 offen offset:3072  lds
MZ 116,132,32
TR 62,6,29440
M 116,140,36
s_waitcnt vmcnt(13)
s_barrier
TR 32,5,32768
M 116,148,40
TR 34,5,33280
M 116,156,44
TR 36,5,36864
s_waitcnt lgkmcnt(9)
MZ 120,128,48
TR 38,5,37376
s_waitcnt lgkmcnt(8)
M 120,136,52
TR 40,5,40960
s_add_u32 s63, s60, 2
s_and_b32 s63, s63, 3
s_lshl_b32 s63, s63, 12
s_add_u32 s63, s63, s54
s_add_u32 s55, s63, 16384
buffer_load_dwordx4 v[192:195], v7, s[24:27], s63 offen offset:0 sc1
buffer_load_dwordx4 v[196:199], v7, s[24:27], s55 offen offset:0 sc1
s_waitcnt lgkmcnt(7)
M 120,144,56
TR 42,5,41472
s_waitcnt lgkmcnt(6)
M 120,152,60
TR 44,5,45056
MZ 124,132,48
TR 46,5,45568
M 124,140,52
TR 48,6,32768
M 124,148,56
TR 50,6,33280
M 124,156,60
TR 52,6,36864
DR 10,14,1024
s_waitcnt vmcnt(13)
s_waitcnt vmcnt(11)
s_waitcnt vmcnt(9)
s_waitcnt vmcnt(7)
s_waitcnt lgkmcnt(10)
M 64,160,32
TR 54,6,37376
s_waitcnt lgkmcnt(9)
M 64,168,36
TR 56,6,40960
s_waitcnt lgkmcnt(8)
M 64,176,40
TR 58,6,41472
s_waitcnt lgkmcnt(7)
M 64,184,44
TR 60,6,45056
M 68,164,32
TR 62,6,45568
M 68,172,36
TR 32,5,33024
buffer_load_dwordx4 v[200:203], v7, s[24:27], s63 offen offset:1024 sc1
buffer_load_dwordx4 v[204:207], v7, s[24:27], s55 offen offset:1024 sc1
M 68,180,40
TR 34,5,33536
M 68,188,44
TR 36,5,37120
s_waitcnt lgkmcnt(10)
M 72,160,48
TR 38,5,37632
s_waitcnt lgkmcnt(8)
M 72,168,52
TR 40,5,41216
s_waitcnt lgkmcnt(7)
M 72,176,56
TR 42,5,41728
s_waitcnt lgkmcnt(6)
M 72,184,60
TR 44,5,45312
buffer_store_dwordx4 v[10:13], v15, s[24:27], s62 offen offset:1024 sc1
M 76,164,48
TR 46,5,45824
M 76,172,52
TR 48,6,33024
M 76,180,56
TR 50,6,33536
M 76,188,60
TR 52,6,37120
s_waitcnt lgkmcnt(9)
M 80,160,32
TR 54,6,37632
s_waitcnt lgkmcnt(8)
M 80,168,36
TR 56,6,41216
buffer_load_dwordx4 v[208:211], v7, s[24:27], s63 offen offset:2048 sc1
buffer_load_dwordx4 v[212:215], v7, s[24:27], s55 offen offset:2048 sc1
s_waitcnt lgkmcnt(7)
M 80,176,40
TR 58,6,41728
s_waitcnt lgkmcnt(6)
M 80,184,44
TR 60,6,45312
M 84,164,32
TR 62,6,45824
M 84,172,36
TR 32,5,49152
M 84,180,40
TR 34,5,49664
M 84,188,44
TR 36,5,53248
DR 10,14,2048
s_waitcnt lgkmcnt(10)
M 88,160,48
TR 38,5,53760
s_waitcnt lgkmcnt(9)
M 88,168,52
TR 40,5,57344
s_waitcnt lgkmcnt(8)
M 88,176,56
TR 42,5,57856
s_waitcnt lgkmcnt(7)
M 88,184,60
TR 44,5,61440
M 92,164,48
TR 46,5,61952
M 92,172,52
TR 48,6,49152
buffer_load_dwordx4 v[216:219], v7, s[24:27], s63 offen offset:3072 sc1
buffer_load_dwordx4 v[220:223], v7, s[24:27], s55 offen offset:3072 sc1
M 92,180,56
TR 50,6,49664
M 92,188,60
TR 52,6,53248
s_waitcnt lgkmcnt(10)
M 96,160,32
TR 54,6,53760
s_waitcnt lgkmcnt(8)
M 96,168,36
TR 56,6,57344
s_waitcnt lgkmcnt(7)
M 96,176,40
TR 58,6,57856
s_waitcnt lgkmcnt(6)
M 96,184,44
TR 60,6,61440
buffer_store_dwordx4 v[10:13], v15, s[24:27], s62 offen offset:2048 sc1
M 100,164,32
TR 62,6,61952
M 100,172,36
TR 32,5,49408
s_add_u32 s47, s60, 3
s_and_b32 s47, s47, 3
s_mul_i32 s47, s47, 458752
s_add_u32 s47, s47, s57
s_add_u32 m0, s46, 98304
s_nop 0
buffer_load_dwordx4 v1, s[20:23], s47 offen offset:0  lds
M 100,180,40
TR 34,5,49920
M 100,188,44
TR 36,5,53504
s_add_u32 m0, s46, 98304
s_nop 0
buffer_load_dwordx4 v2, s[20:23], s47 offen offset:1024  lds
s_waitcnt lgkmcnt(9)
M 104,160,48
TR 38,5,54016
s_waitcnt lgkmcnt(8)
M 104,168,52
TR 40,5,57600
s_add_u32 m0, s46, 98304
s_nop 0
buffer_load_dwordx4 v3, s[20:23], s47 offen offset:2048  lds
s_waitcnt lgkmcnt(7)
M 104,176,56
TR 42,5,58112
s_waitcnt lgkmcnt(6)
M 104,184,60
TR 44,5,61696
s_add_u32 m0, s46, 98304
s_nop 0
buffer_load_dwordx4 v4, s[20:23], s47 offen offset:3072  lds
M 108,164,48
TR 46,5,62208
M 108,172,52
TR 48,6,49408
M 108,180,56
TR 50,6,49920
M 108,188,60
TR 52,6,53504
DR 10,14,3072
s_waitcnt lgkmcnt(10)
M 112,160,32
TR 54,6,54016
s_waitcnt lgkmcnt(9)
M 112,168,36
TR 56,6,57600
s_add_u32 s63, s60, 3
s_and_b32 s63, s63, 3
s_lshl_b32 s63, s63, 12
s_add_u32 s63, s63, s54
s_add_u32 s55, s63, 16384
buffer_load_dwordx4 v[224:227], v7, s[24:27], s63 offen offset:0 sc1
buffer_load_dwordx4 v[228:231], v7, s[24:27], s55 offen offset:0 sc1
s_waitcnt lgkmcnt(8)
M 112,176,40
TR 58,6,58112
s_waitcnt lgkmcnt(7)
M 112,184,44
TR 60,6,61696
M 116,164,32
TR 62,6,62208
M 116,172,36
s_waitcnt vmcnt(16)
s_barrier
v_xor_b32 v5, 0x10000, v5
v_xor_b32 v6, 0x10000, v6
TR 32,5,0
M 116,180,40
TR 34,5,512
M 116,188,44
TR 36,5,4096
s_waitcnt lgkmcnt(10)
M 120,160,48
s_lshl_b32 s51, s42, 7
s_add_u32 s51, s51, s56
s_add_u32 m0, s46, 0
s_nop 0
buffer_load_dwordx4 v1, s[20:23], s51 offen offset:0  lds
TR 38,5,4608
s_waitcnt lgkmcnt(8)
M 120,168,52
TR 40,5,8192
s_waitcnt lgkmcnt(7)
M 120,176,56
TR 42,5,8704
s_waitcnt lgkmcnt(6)
M 120,184,60
TR 44,5,12288
buffer_store_dwordx4 v[10:13], v15, s[24:27], s62 offen offset:3072 sc1
M 124,164,48
TR 46,5,12800
M 124,172,52
TR 48,6,0
M 124,180,56
TR 50,6,512
M 124,188,60
TR 52,6,4096
s_waitcnt vmcnt(16)
s_waitcnt vmcnt(14)
s_waitcnt vmcnt(11)
s_waitcnt vmcnt(9)
s_waitcnt lgkmcnt(9)
M 64,192,32
TR 54,6,4608
s_waitcnt lgkmcnt(8)
M 64,200,36
TR 56,6,8192
buffer_load_dwordx4 v[232:235], v7, s[24:27], s63 offen offset:1024 sc1
buffer_load_dwordx4 v[236:239], v7, s[24:27], s55 offen offset:1024 sc1
s_waitcnt lgkmcnt(7)
M 64,208,40
TR 58,6,8704
s_waitcnt lgkmcnt(6)
M 64,216,44
TR 60,6,12288
M 68,196,32
s_add_u32 m0, s46, 0
s_nop 0
buffer_load_dwordx4 v2, s[20:23], s51 offen offset:1024  lds
TR 62,6,12800
M 68,204,36
TR 32,5,256
v_mov_b32 v13, v14
M 68,212,40
TR 34,5,768
M 68,220,44
TR 36,5,4352
s_waitcnt lgkmcnt(9)
M 72,192,48
TR 38,5,4864
s_waitcnt lgkmcnt(8)
M 72,200,52
TR 40,5,8448
s_waitcnt lgkmcnt(7)
M 72,208,56
TR 42,5,8960
s_waitcnt lgkmcnt(6)
M 72,216,60
TR 44,5,12544
M 76,196,48
TR 46,5,13056
M 76,204,52
TR 48,6,256
buffer_load_dwordx4 v[240:243], v7, s[24:27], s63 offen offset:2048 sc1
buffer_load_dwordx4 v[244:247], v7, s[24:27], s55 offen offset:2048 sc1
M 76,212,56
TR 50,6,768
M 76,220,60
TR 52,6,4352
s_waitcnt lgkmcnt(9)
M 80,192,32
s_add_u32 m0, s46, 0
s_nop 0
buffer_load_dwordx4 v3, s[20:23], s51 offen offset:2048  lds
TR 54,6,4864
s_waitcnt lgkmcnt(8)
M 80,200,36
TR 56,6,8448
s_waitcnt lgkmcnt(7)
M 80,208,40
TR 58,6,8960
s_waitcnt lgkmcnt(6)
M 80,216,44
TR 60,6,12544
M 84,196,32
TR 62,6,13056
M 84,204,36
TR 32,5,16384
buffer_load_dwordx4 v[248:251], v7, s[24:27], s63 offen offset:3072 sc1
buffer_load_dwordx4 v[252:255], v7, s[24:27], s55 offen offset:3072 sc1
M 84,212,40
TR 34,5,16896
M 84,220,44
TR 36,5,20480
s_waitcnt lgkmcnt(9)
M 88,192,48
TR 38,5,20992
s_waitcnt lgkmcnt(8)
M 88,200,52
TR 40,5,24576
s_waitcnt lgkmcnt(7)
M 88,208,56
TR 42,5,25088
s_waitcnt lgkmcnt(6)
M 88,216,60
TR 44,5,28672
M 92,196,48
s_add_u32 m0, s46, 0
s_nop 0
buffer_load_dwordx4 v4, s[20:23], s51 offen offset:3072  lds
TR 46,5,29184
M 92,204,52
TR 48,6,16384
M 92,212,56
TR 50,6,16896
M 92,220,60
TR 52,6,20480
s_waitcnt lgkmcnt(9)
M 96,192,32
TR 54,6,20992
s_waitcnt lgkmcnt(8)
M 96,200,36
TR 56,6,24576
s_waitcnt lgkmcnt(7)
M 96,208,40
TR 58,6,25088
s_waitcnt lgkmcnt(6)
M 96,216,44
TR 60,6,28672
M 100,196,32
TR 62,6,29184
M 100,204,36
TR 32,5,16640
M 100,212,40
TR 34,5,17152
M 100,220,44
TR 36,5,20736
s_waitcnt lgkmcnt(9)
M 104,192,48
TR 38,5,21248
s_waitcnt lgkmcnt(8)
M 104,200,52
TR 40,5,24832
s_waitcnt lgkmcnt(7)
M 104,208,56
TR 42,5,25344
s_waitcnt lgkmcnt(6)
M 104,216,60
TR 44,5,28928
M 108,196,48
TR 46,5,29440
M 108,204,52
TR 48,6,16640
M 108,212,56
TR 50,6,17152
M 108,220,60
TR 52,6,20736
s_waitcnt lgkmcnt(9)
M 112,192,32
TR 54,6,21248
s_waitcnt lgkmcnt(8)
M 112,200,36
TR 56,6,24832
s_waitcnt lgkmcnt(7)
M 112,208,40
TR 58,6,25344
s_waitcnt lgkmcnt(6)
M 112,216,44
TR 60,6,28928
M 116,196,32
TR 62,6,29440
M 116,204,36
s_waitcnt vmcnt(9)
s_barrier
s_cmp_lg_u32 s40, 0
s_cbranch_scc1 L_w0_57
s_cmp_ge_u32 s48, 8
s_cbranch_scc1 L_nonf_58
s_add_u32 s43, s41, 53
s_lshl_b32 s43, s43, 7
s_add_u32 s43, s43, 64
s_lshl_b32 s49, s48, 2
s_add_u32 s43, s43, s49
v_lshlrev_b32 v10, 13, v0
v_add_u32 v10, s43, v10
v_mov_b32 v11, s59
s_mov_b64 exec, 0xff
global_store_dword v10, v11, s[100:101] sc1
s_mov_b64 exec, -1
L_nonf_58:
L_w0_57:
TR 32,5,32768
M 116,212,40
TR 34,5,33280
M 116,220,44
TR 36,5,36864
s_waitcnt lgkmcnt(9)
M 120,192,48
s_lshl_b32 s51, s42, 7
s_add_u32 s51, s51, s61
s_add_u32 m0, s46, 32768
s_nop 0
buffer_load_dwordx4 v1, s[20:23], s51 offen offset:0  lds
TR 38,5,37376
s_waitcnt lgkmcnt(8)
M 120,200,52
TR 40,5,40960
s_waitcnt lgkmcnt(7)
M 120,208,56
TR 42,5,41472
s_waitcnt lgkmcnt(6)
M 120,216,60
TR 44,5,45056
M 124,196,48
TR 46,5,45568
M 124,204,52
TR 48,6,32768
M 124,212,56
TR 50,6,33280
M 124,220,60
TR 52,6,36864
s_waitcnt vmcnt(8)
s_waitcnt vmcnt(5)
s_waitcnt vmcnt(2)
s_waitcnt lgkmcnt(9)
M 64,224,32
TR 54,6,37376
s_waitcnt lgkmcnt(8)
M 64,232,36
TR 56,6,40960
s_mov_b32 s36, s8
s_mov_b32 s37, s9
s_mov_b32 s38, 4194304
s_mov_b32 s39, 0x20000
s_and_b32 s43, s2, 0xf8
s_add_u32 s43, s43, s40
s_lshl_b32 s43, s43, 14
s_and_b32 s47, s2, 6
s_lshl_b32 s47, s47, 8
s_add_u32 s47, s47, s43
v_and_b32 v14, 3, v0
v_lshlrev_b32 v14, 7, v14
v_bfe_u32 v15, v0, 2, 3
v_lshl_add_u32 v14, v15, 11, v14
v_bfe_u32 v15, v0, 5, 1
v_lshl_add_u32 v15, v15, 28, v14
buffer_load_dword v14, v15, s[36:39], s47 offen
s_waitcnt lgkmcnt(7)
M 64,240,40
TR 58,6,41472
s_waitcnt lgkmcnt(6)
M 64,248,44
TR 60,6,45056
M 68,228,32
s_add_u32 m0, s46, 32768
s_nop 0
buffer_load_dwordx4 v2, s[20:23], s51 offen offset:1024  lds
TR 62,6,45568
M 68,236,36
TR 32,5,33024
M 68,244,40
TR 34,5,33536
M 68,252,44
TR 36,5,37120
s_waitcnt lgkmcnt(9)
M 72,224,48
TR 38,5,37632
s_waitcnt lgkmcnt(8)
M 72,232,52
TR 40,5,41216
s_waitcnt lgkmcnt(7)
M 72,240,56
TR 42,5,41728
s_waitcnt lgkmcnt(6)
M 72,248,60
TR 44,5,45312
M 76,228,48
TR 46,5,45824
M 76,236,52
TR 48,6,33024
M 76,244,56
TR 50,6,33536
M 76,252,60
TR 52,6,37120
s_waitcnt lgkmcnt(9)
M 80,224,32
s_add_u32 m0, s46, 32768
s_nop 0
buffer_load_dwordx4 v3, s[20:23], s51 offen offset:2048  lds
TR 54,6,37632
s_waitcnt lgkmcnt(8)
M 80,232,36
TR 56,6,41216
s_waitcnt lgkmcnt(7)
M 80,240,40
TR 58,6,41728
s_waitcnt lgkmcnt(6)
M 80,248,44
TR 60,6,45312
M 84,228,32
TR 62,6,45824
M 84,236,36
TR 32,5,49152
M 84,244,40
TR 34,5,49664
M 84,252,44
TR 36,5,53248
s_waitcnt lgkmcnt(9)
M 88,224,48
TR 38,5,53760
s_waitcnt lgkmcnt(8)
M 88,232,52
TR 40,5,57344
s_waitcnt lgkmcnt(7)
M 88,240,56
TR 42,5,57856
s_waitcnt lgkmcnt(6)
M 88,248,60
TR 44,5,61440
M 92,228,48
s_add_u32 m0, s46, 32768
s_nop 0
buffer_load_dwordx4 v4, s[20:23], s51 offen offset:3072  lds
TR 46,5,61952
M 92,236,52
TR 48,6,49152
M 92,244,56
TR 50,6,49664
M 92,252,60
TR 52,6,53248
s_waitcnt lgkmcnt(9)
M 96,224,32
TR 54,6,53760
s_waitcnt lgkmcnt(8)
M 96,232,36
TR 56,6,57344
s_waitcnt lgkmcnt(7)
M 96,240,40
TR 58,6,57856
s_waitcnt lgkmcnt(6)
M 96,248,44
TR 60,6,61440
M 100,228,32
TR 62,6,61952
M 100,236,36
TR 32,5,49408
M 100,244,40
TR 34,5,49920
M 100,252,44
TR 36,5,53504
s_waitcnt lgkmcnt(9)
M 104,224,48
TR 38,5,54016
v_mul_f32 v9, v64, v64
v_mul_f32 v10, v65, v65
v_mul_f32 v11, v66, v66
v_mul_f32 v12, v67, v67
v_fma_f32 v9, v9, s52, v8
v_fma_f32 v10, v10, s52, v8
v_fma_f32 v11, v11, s52, v8
v_fma_f32 v12, v12, s52, v8
v_mul_f32 v9, v9, v64
v_mul_f32 v10, v10, v65
v_mul_f32 v11, v11, v66
v_mul_f32 v12, v12, v67
v_exp_f32 v9, v9
v_exp_f32 v10, v10
s_waitcnt lgkmcnt(8)
M 104,232,52
TR 40,5,57600
v_exp_f32 v11, v11
v_exp_f32 v12, v12
v_add_f32 v9, 1.0, v9
v_add_f32 v10, 1.0, v10
v_add_f32 v11, 1.0, v11
v_add_f32 v12, 1.0, v12
v_rcp_f32 v9, v9
v_rcp_f32 v10, v10
v_rcp_f32 v11, v11
v_rcp_f32 v12, v12
v_mul_f32 v64, v64, v9
v_mul_f32 v65, v65, v10
v_mul_f32 v66, v66, v11
v_mul_f32 v67, v67, v12
s_waitcnt lgkmcnt(7)
M 104,240,56
TR 42,5,58112
v_add_f32 v16, v16, v64
v_add_f32 v18, v18, v65
v_add_f32 v20, v20, v66
v_add_f32 v22, v22, v67
v_fmac_f32 v17, v64, v64
v_fmac_f32 v19, v65, v65
v_fmac_f32 v21, v66, v66
v_fmac_f32 v23, v67, v67
v_mul_f32 v9, v68, v68
v_mul_f32 v10, v69, v69
v_mul_f32 v11, v70, v70
v_mul_f32 v12, v71, v71
v_fma_f32 v9, v9, s52, v8
v_fma_f32 v10, v10, s52, v8
s_waitcnt lgkmcnt(6)
M 104,248,60
TR 44,5,61696
v_fma_f32 v11, v11, s52, v8
v_fma_f32 v12, v12, s52, v8
v_mul_f32 v9, v9, v68
v_mul_f32 v10, v10, v69
v_mul_f32 v11, v11, v70
v_mul_f32 v12, v12, v71
v_exp_f32 v9, v9
v_exp_f32 v10, v10
v_exp_f32 v11, v11
v_exp_f32 v12, v12
v_add_f32 v9, 1.0, v9
v_add_f32 v10, 1.0, v10
v_add_f32 v11, 1.0, v11
v_add_f32 v12, 1.0, v12
M 108,228,48
TR 46,5,62208
v_rcp_f32 v9, v9
v_rcp_f32 v10, v10
v_rcp_f32 v11, v11
v_rcp_f32 v12, v12
v_mul_f32 v68, v68, v9
v_mul_f32 v69, v69, v10
v_mul_f32 v70, v70, v11
v_mul_f32 v71, v71, v12
v_add_f32 v24, v24, v68
v_add_f32 v26, v26, v69
v_add_f32 v28, v28, v70
v_add_f32 v30, v30, v71
v_fmac_f32 v25, v68, v68
v_fmac_f32 v27, v69, v69
M 108,236,52
TR 48,6,49408
v_fmac_f32 v29, v70, v70
v_fmac_f32 v31, v71, v71
PK 64,64,65
PK 65,66,67
PK 66,68,69
PK 67,70,71
DW 13,64,0
v_mul_f32 v9, v72, v72
v_mul_f32 v10, v73, v73
v_mul_f32 v11, v74, v74
v_mul_f32 v12, v75, v75
v_fma_f32 v9, v9, s52, v8
v_fma_f32 v10, v10, s52, v8
v_fma_f32 v11, v11, s52, v8
M 108,244,56
TR 50,6,49920
v_fma_f32 v12, v12, s52, v8
v_mul_f32 v9, v9, v72
v_mul_f32 v10, v10, v73
v_mul_f32 v11, v11, v74
v_mul_f32 v12, v12, v75
v_exp_f32 v9, v9
v_exp_f32 v10, v10
v_exp_f32 v11, v11
v_exp_f32 v12, v12
v_add_f32 v9, 1.0, v9
v_add_f32 v10, 1.0, v10
v_add_f32 v11, 1.0, v11
v_add_f32 v12, 1.0, v12
v_rcp_f32 v9, v9
M 108,252,60
TR 52,6,53504
v_rcp_f32 v10, v10
v_rcp_f32 v11, v11
v_rcp_f32 v12, v12
v_mul_f32 v72, v72, v9
v_mul_f32 v73, v73, v10
v_mul_f32 v74, v74, v11
v_mul_f32 v75, v75, v12
v_add_f32 v16, v16, v72
v_add_f32 v18, v18, v73
v_add_f32 v20, v20, v74
v_add_f32 v22, v22, v75
v_fmac_f32 v17, v72, v72
v_fmac_f32 v19, v73, v73
v_fmac_f32 v21, v74, v74
s_waitcnt lgkmcnt(10)
M 112,224,32
TR 54,6,54016
v_fmac_f32 v23, v75, v75
v_mul_f32 v9, v76, v76
v_mul_f32 v10, v77, v77
v_mul_f32 v11, v78, v78
v_mul_f32 v12, v79, v79
v_fma_f32 v9, v9, s52, v8
v_fma_f32 v10, v10, s52, v8
v_fma_f32 v11, v11, s52, v8
v_fma_f32 v12, v12, s52, v8
v_mul_f32 v9, v9, v76
v_mul_f32 v10, v10, v77
v_mul_f32 v11, v11, v78
v_mul_f32 v12, v12, v79
v_exp_f32 v9, v9
s_waitcnt lgkmcnt(9)
M 112,232,36
TR 56,6,57600
v_exp_f32 v10, v10
v_exp_f32 v11, v11
v_exp_f32 v12, v12
v_add_f32 v9, 1.0, v9
v_add_f32 v10, 1.0, v10
v_add_f32 v11, 1.0, v11
v_add_f32 v12, 1.0, v12
v_rcp_f32 v9, v9
v_rcp_f32 v10, v10
v_rcp_f32 v11, v11
v_rcp_f32 v12, v12
v_mul_f32 v76, v76, v9
v_mul_f32 v77, v77, v10
v_mul_f32 v78, v78, v11
s_waitcnt lgkmcnt(8)
M 112,240,40
TR 58,6,58112
v_mul_f32 v79, v79, v12
v_add_f32 v24, v24, v76
v_add_f32 v26, v26, v77
v_add_f32 v28, v28, v78
v_add_f32 v30, v30, v79
v_fmac_f32 v25, v76, v76
v_fmac_f32 v27, v77, v77
v_fmac_f32 v29, v78, v78
v_fmac_f32 v31, v79, v79
PK 72,72,73
PK 73,74,75
PK 74,76,77
PK 75,78,79
DW 13,72,1024
s_waitcnt lgkmcnt(8)
M 112,248,44
TR 60,6,61696
v_mul_f32 v9, v80, v80
v_mul_f32 v10, v81, v81
v_mul_f32 v11, v82, v82
v_mul_f32 v12, v83, v83
v_fma_f32 v9, v9, s52, v8
v_fma_f32 v10, v10, s52, v8
v_fma_f32 v11, v11, s52, v8
v_fma_f32 v12, v12, s52, v8
v_mul_f32 v9, v9, v80
v_mul_f32 v10, v10, v81
v_mul_f32 v11, v11, v82
v_mul_f32 v12, v12, v83
v_exp_f32 v9, v9
v_exp_f32 v10, v10
M 116,228,32
TR 62,6,62208
v_exp_f32 v11, v11
v_exp_f32 v12, v12
v_add_f32 v9, 1.0, v9
v_add_f32 v10, 1.0, v10
v_add_f32 v11, 1.0, v11
v_add_f32 v12, 1.0, v12
v_rcp_f32 v9, v9
v_rcp_f32 v10, v10
v_rcp_f32 v11, v11
v_rcp_f32 v12, v12
v_mul_f32 v80, v80, v9
v_mul_f32 v81, v81, v10
v_mul_f32 v82, v82, v11
v_mul_f32 v83, v83, v12
M 116,236,36
s_waitcnt vmcnt(5)
s_barrier
v_xor_b32 v5, 0x10000, v5
v_xor_b32 v6, 0x10000, v6
TR 32,5,0
v_add_f32 v16, v16, v80
v_add_f32 v18, v18, v81
v_add_f32 v20, v20, v82
v_add_f32 v22, v22, v83
v_fmac_f32 v17, v80, v80
v_fmac_f32 v19, v81, v81
v_fmac_f32 v21, v82, v82
v_fmac_f32 v23, v83, v83
v_mul_f32 v9, v84, v84
v_mul_f32 v10, v85, v85
v_mul_f32 v11, v86, v86
v_mul_f32 v12, v87, v87
v_fma_f32 v9, v9, s52, v8
v_fma_f32 v10, v10, s52, v8
M 116,244,40
TR 34,5,512
v_fma_f32 v11, v11, s52, v8
v_fma_f32 v12, v12, s52, v8
v_mul_f32 v9, v9, v84
v_mul_f32 v10, v10, v85
v_mul_f32 v11, v11, v86
v_mul_f32 v12, v12, v87
v_exp_f32 v9, v9
v_exp_f32 v10, v10
v_exp_f32 v11, v11
v_exp_f32 v12, v12
v_add_f32 v9, 1.0, v9
v_add_f32 v10, 1.0, v10
v_add_f32 v11, 1.0, v11
v_add_f32 v12, 1.0, v12
M 116,252,44
TR 36,5,4096
v_rcp_f32 v9, v9
v_rcp_f32 v10, v10
v_rcp_f32 v11, v11
v_rcp_f32 v12, v12
v_mul_f32 v84, v84, v9
v_mul_f32 v85, v85, v10
v_mul_f32 v86, v86, v11
v_mul_f32 v87, v87, v12
v_add_f32 v24, v24, v84
v_add_f32 v26, v26, v85
v_add_f32 v28, v28, v86
v_add_f32 v30, v30, v87
v_fmac_f32 v25, v84, v84
v_fmac_f32 v27, v85, v85
s_waitcnt lgkmcnt(10)
M 120,224,48
TR 38,5,4608
v_fmac_f32 v29, v86, v86
v_fmac_f32 v31, v87, v87
PK 80,80,81
PK 81,82,83
PK 82,84,85
PK 83,86,87
DW 13,80,2048
v_mul_f32 v9, v88, v88
v_mul_f32 v10, v89, v89
v_mul_f32 v11, v90, v90
v_mul_f32 v12, v91, v91
v_fma_f32 v9, v9, s52, v8
v_fma_f32 v10, v10, s52, v8
v_fma_f32 v11, v11, s52, v8
s_waitcnt lgkmcnt(10)
M 120,232,52
TR 40,5,8192
v_fma_f32 v12, v12, s52, v8
v_mul_f32 v9, v9, v88
v_mul_f32 v10, v10, v89
v_mul_f32 v11, v11, v90
v_mul_f32 v12, v12, v91
v_exp_f32 v9, v9
v_exp_f32 v10, v10
v_exp_f32 v11, v11
v_exp_f32 v12, v12
v_add_f32 v9, 1.0, v9
v_add_f32 v10, 1.0, v10
v_add_f32 v11, 1.0, v11
v_add_f32 v12, 1.0, v12
v_rcp_f32 v9, v9
s_waitcnt lgkmcnt(9)
M 120,240,56
TR 42,5,8704
v_rcp_f32 v10, v10
v_rcp_f32 v11, v11
v_rcp_f32 v12, v12
v_mul_f32 v88, v88, v9
v_mul_f32 v89, v89, v10
v_mul_f32 v90, v90, v11
v_mul_f32 v91, v91, v12
v_add_f32 v16, v16, v88
v_add_f32 v18, v18, v89
v_add_f32 v20, v20, v90
v_add_f32 v22, v22, v91
v_fmac_f32 v17, v88, v88
v_fmac_f32 v19, v89, v89
v_fmac_f32 v21, v90, v90
s_waitcnt lgkmcnt(7)
M 120,248,60
TR 44,5,12288
v_fmac_f32 v23, v91, v91
v_mul_f32 v9, v92, v92
v_mul_f32 v10, v93, v93
v_mul_f32 v11, v94, v94
v_mul_f32 v12, v95, v95
v_fma_f32 v9, v9, s52, v8
v_fma_f32 v10, v10, s52, v8
v_fma_f32 v11, v11, s52, v8
v_fma_f32 v12, v12, s52, v8
v_mul_f32 v9, v9, v92
v_mul_f32 v10, v10, v93
v_mul_f32 v11, v11, v94
v_mul_f32 v12, v12, v95
v_exp_f32 v9, v9
M 124,228,48
TR 46,5,12800
v_exp_f32 v10, v10
v_exp_f32 v11, v11
v_exp_f32 v12, v12
v_add_f32 v9, 1.0, v9
v_add_f32 v10, 1.0, v10
v_add_f32 v11, 1.0, v11
v_add_f32 v12, 1.0, v12
v_rcp_f32 v9, v9
v_rcp_f32 v10, v10
v_rcp_f32 v11, v11
v_rcp_f32 v12, v12
v_mul_f32 v92, v92, v9
v_mul_f32 v93, v93, v10
v_mul_f32 v94, v94, v11
M 124,236,52
TR 48,6,0
v_mul_f32 v95, v95, v12
v_add_f32 v24, v24, v92
v_add_f32 v26, v26, v93
v_add_f32 v28, v28, v94
v_add_f32 v30, v30, v95
v_fmac_f32 v25, v92, v92
v_fmac_f32 v27, v93, v93
v_fmac_f32 v29, v94, v94
v_fmac_f32 v31, v95, v95
PK 88,88,89
PK 89,90,91
PK 90,92,93
PK 91,94,95
DW 13,88,3072
M 124,244,56
TR 50,6,512
M 124,252,60
TR 52,6,4096
s_waitcnt lgkmcnt(11)
MZ 64,32,128
TR 54,6,4608
s_waitcnt lgkmcnt(10)
M 64,36,136
TR 56,6,8192
s_waitcnt lgkmcnt(8)
M 64,40,144
TR 58,6,8704
s_waitcnt lgkmcnt(7)
M 64,44,152
TR 60,6,12288
MZ 68,32,132
TR 62,6,12800
M 68,36,140
TR 32,5,256
M 68,40,148
TR 34,5,768
v_mul_f32 v9, v96, v96
v_mul_f32 v10, v97, v97
v_mul_f32 v11, v98, v98
v_mul_f32 v12, v99, v99
v_fma_f32 v9, v9, s52, v8
v_fma_f32 v10, v10, s52, v8
v_fma_f32 v11, v11, s52, v8
v_fma_f32 v12, v12, s52, v8
v_mul_f32 v9, v9, v96
v_mul_f32 v10, v10, v97
M 68,44,156
TR 36,5,4352
v_mul_f32 v11, v11, v98
v_mul_f32 v12, v12, v99
v_exp_f32 v9, v9
v_exp_f32 v10, v10
v_exp_f32 v11, v11
v_exp_f32 v12, v12
v_add_f32 v9, 1.0, v9
v_add_f32 v10, 1.0, v10
v_add_f32 v11, 1.0, v11
v_add_f32 v12, 1.0, v12
s_waitcnt lgkmcnt(9)
MZ 72,48,128
TR 38,5,4864
v_rcp_f32 v9, v9
v_rcp_f32 v10, v10
v_rcp_f32 v11, v11
v_rcp_f32 v12, v12
v_mul_f32 v96, v96, v9
v_mul_f32 v97, v97, v10
v_mul_f32 v98, v98, v11
v_mul_f32 v99, v99, v12
v_add_f32 v16, v16, v96
s_waitcnt lgkmcnt(8)
M 72,52,136
TR 40,5,8448
v_add_f32 v18, v18, v97
v_add_f32 v20, v20, v98
v_add_f32 v22, v22, v99
v_fmac_f32 v17, v96, v96
v_fmac_f32 v19, v97, v97
v_fmac_f32 v21, v98, v98
v_fmac_f32 v23, v99, v99
v_mul_f32 v9, v100, v100
v_mul_f32 v10, v101, v101
v_mul_f32 v11, v102, v102
s_waitcnt lgkmcnt(7)
M 72,56,144
TR 42,5,8960
v_mul_f32 v12, v103, v103
v_fma_f32 v9, v9, s52, v8
v_fma_f32 v10, v10, s52, v8
v_fma_f32 v11, v11, s52, v8
v_fma_f32 v12, v12, s52, v8
v_mul_f32 v9, v9, v100
v_mul_f32 v10, v10, v101
v_mul_f32 v11, v11, v102
v_mul_f32 v12, v12, v103
s_waitcnt lgkmcnt(6)
M 72,60,152
TR 44,5,12544
v_exp_f32 v9, v9
v_exp_f32 v10, v10
v_exp_f32 v11, v11
v_exp_f32 v12, v12
v_add_f32 v9, 1.0, v9
v_add_f32 v10, 1.0, v10
v_add_f32 v11, 1.0, v11
v_add_f32 v12, 1.0, v12
v_rcp_f32 v9, v9
v_rcp_f32 v10, v10
MZ 76,48,132
TR 46,5,13056
v_rcp_f32 v11, v11
v_rcp_f32 v12, v12
v_mul_f32 v100, v100, v9
v_mul_f32 v101, v101, v10
v_mul_f32 v102, v102, v11
v_mul_f32 v103, v103, v12
v_add_f32 v24, v24, v100
v_add_f32 v26, v26, v101
v_add_f32 v28, v28, v102
M 76,52,140
TR 48,6,256
v_add_f32 v30, v30, v103
v_fmac_f32 v25, v100, v100
v_fmac_f32 v27, v101, v101
v_fmac_f32 v29, v102, v102
v_fmac_f32 v31, v103, v103
PK 96,96,97
PK 97,98,99
PK 98,100,101
PK 99,102,103
v_mul_f32 v9, v104, v104
M 76,56,148
TR 50,6,768
v_mul_f32 v10, v105, v105
v_mul_f32 v11, v106, v106
v_mul_f32 v12, v107, v107
v_fma_f32 v9, v9, s52, v8
v_fma_f32 v10, v10, s52, v8
v_fma_f32 v11, v11, s52, v8
v_fma_f32 v12, v12, s52, v8
v_mul_f32 v9, v9, v104
v_mul_f32 v10, v10, v105
M 76,60,156
TR 52,6,4352
v_mul_f32 v11, v11, v106
v_mul_f32 v12, v12, v107
v_exp_f32 v9, v9
v_exp_f32 v10, v10
v_exp_f32 v11, v11
v_exp_f32 v12, v12
v_add_f32 v9, 1.0, v9
v_add_f32 v10, 1.0, v10
v_add_f32 v11, 1.0, v11
v_add_f32 v12, 1.0, v12
s_waitcnt lgkmcnt(9)
MZ 80,32,128
TR 54,6,4864
v_rcp_f32 v9, v9
v_rcp_f32 v10, v10
v_rcp_f32 v11, v11
v_rcp_f32 v12, v12
v_mul_f32 v104, v104, v9
v_mul_f32 v105, v105, v10
v_mul_f32 v106, v106, v11
v_mul_f32 v107, v107, v12
v_add_f32 v16, v16, v104
s_waitcnt lgkmcnt(8)
M 80,36,136
TR 56,6,8448
v_add_f32 v18, v18, v105
v_add_f32 v20, v20, v106
v_add_f32 v22, v22, v107
v_fmac_f32 v17, v104, v104
v_fmac_f32 v19, v105, v105
v_fmac_f32 v21, v106, v106
v_fmac_f32 v23, v107, v107
v_mul_f32 v9, v108, v108
v_mul_f32 v10, v109, v109
v_mul_f32 v11, v110, v110
s_waitcnt lgkmcnt(7)
M 80,40,144
TR 58,6,8960
v_mul_f32 v12, v111, v111
v_fma_f32 v9, v9, s52, v8
v_fma_f32 v10, v10, s52, v8
v_fma_f32 v11, v11, s52, v8
v_fma_f32 v12, v12, s52, v8
v_mul_f32 v9, v9, v108
v_mul_f32 v10, v10, v109
v_mul_f32 v11, v11, v110
v_mul_f32 v12, v12, v111
v_exp_f32 v9, v9
s_waitcnt lgkmcnt(6)
M 80,44,152
TR 60,6,12544
v_exp_f32 v10, v10
v_exp_f32 v11, v11
v_exp_f32 v12, v12
v_add_f32 v9, 1.0, v9
v_add_f32 v10, 1.0, v10
v_add_f32 v11, 1.0, v11
v_add_f32 v12, 1.0, v12
v_rcp_f32 v9, v9
v_rcp_f32 v10, v10
v_rcp_f32 v11, v11
MZ 84,32,132
TR 62,6,13056
v_rcp_f32 v12, v12
v_mul_f32 v108, v108, v9
v_mul_f32 v109, v109, v10
v_mul_f32 v110, v110, v11
v_mul_f32 v111, v111, v12
v_add_f32 v24, v24, v108
v_add_f32 v26, v26, v109
v_add_f32 v28, v28, v110
v_add_f32 v30, v30, v111
M 84,36,140
TR 32,5,16384
v_fmac_f32 v25, v108, v108
v_fmac_f32 v27, v109, v109
v_fmac_f32 v29, v110, v110
v_fmac_f32 v31, v111, v111
PK 104,104,105
PK 105,106,107
PK 106,108,109
PK 107,110,111
v_mul_f32 v9, v112, v112
v_mul_f32 v10, v113, v113
M 84,40,148
TR 34,5,16896
v_mul_f32 v11, v114, v114
v_mul_f32 v12, v115, v115
v_fma_f32 v9, v9, s52, v8
v_fma_f32 v10, v10, s52, v8
v_fma_f32 v11, v11, s52, v8
v_fma_f32 v12, v12, s52, v8
v_mul_f32 v9, v9, v112
v_mul_f32 v10, v10, v113
v_mul_f32 v11, v11, v114
M 84,44,156
TR 36,5,20480
v_mul_f32 v12, v12, v115
v_exp_f32 v9, v9
v_exp_f32 v10, v10
v_exp_f32 v11, v11
v_exp_f32 v12, v12
v_add_f32 v9, 1.0, v9
v_add_f32 v10, 1.0, v10
v_add_f32 v11, 1.0, v11
v_add_f32 v12, 1.0, v12
v_rcp_f32 v9, v9
s_waitcnt lgkmcnt(9)
MZ 88,48,128
TR 38,5,20992
v_rcp_f32 v10, v10
v_rcp_f32 v11, v11
v_rcp_f32 v12, v12
v_mul_f32 v112, v112, v9
v_mul_f32 v113, v113, v10
v_mul_f32 v114, v114, v11
v_mul_f32 v115, v115, v12
v_add_f32 v16, v16, v112
v_add_f32 v18, v18, v113
s_waitcnt lgkmcnt(8)
M 88,52,136
TR 40,5,24576
v_add_f32 v20, v20, v114
v_add_f32 v22, v22, v115
v_fmac_f32 v17, v112, v112
v_fmac_f32 v19, v113, v113
v_fmac_f32 v21, v114, v114
v_fmac_f32 v23, v115, v115
v_mul_f32 v9, v116, v116
v_mul_f32 v10, v117, v117
v_mul_f32 v11, v118, v118
v_mul_f32 v12, v119, v119
s_waitcnt lgkmcnt(7)
M 88,56,144
TR 42,5,25088
v_fma_f32 v9, v9, s52, v8
v_fma_f32 v10, v10, s52, v8
v_fma_f32 v11, v11, s52, v8
v_fma_f32 v12, v12, s52, v8
v_mul_f32 v9, v9, v116
v_mul_f32 v10, v10, v117
v_mul_f32 v11, v11, v118
v_mul_f32 v12, v12, v119
v_exp_f32 v9, v9
s_waitcnt lgkmcnt(6)
M 88,60,152
TR 44,5,28672
v_exp_f32 v10, v10
v_exp_f32 v11, v11
v_exp_f32 v12, v12
v_add_f32 v9, 1.0, v9
v_add_f32 v10, 1.0, v10
v_add_f32 v11, 1.0, v11
v_add_f32 v12, 1.0, v12
v_rcp_f32 v9, v9
v_rcp_f32 v10, v10
v_rcp_f32 v11, v11
MZ 92,48,132
TR 46,5,29184
v_rcp_f32 v12, v12
v_mul_f32 v116, v116, v9
v_mul_f32 v117, v117, v10
v_mul_f32 v118, v118, v11
v_mul_f32 v119, v119, v12
v_add_f32 v24, v24, v116
v_add_f32 v26, v26, v117
v_add_f32 v28, v28, v118
v_add_f32 v30, v30, v119
M 92,52,140
TR 48,6,16384
v_fmac_f32 v25, v116, v116
v_fmac_f32 v27, v117, v117
v_fmac_f32 v29, v118, v118
v_fmac_f32 v31, v119, v119
PK 112,112,113
PK 113,114,115
PK 114,116,117
PK 115,118,119
v_mul_f32 v9, v120, v120
v_mul_f32 v10, v121, v121
M 92,56,148
TR 50,6,16896
v_mul_f32 v11, v122, v122
v_mul_f32 v12, v123, v123
v_fma_f32 v9, v9, s52, v8
v_fma_f32 v10, v10, s52, v8
v_fma_f32 v11, v11, s52, v8
v_fma_f32 v12, v12, s52, v8
v_mul_f32 v9, v9, v120
v_mul_f32 v10, v10, v121
v_mul_f32 v11, v11, v122
M 92,60,156
TR 52,6,20480
v_mul_f32 v12, v12, v123
v_exp_f32 v9, v9
v_exp_f32 v10, v10
v_exp_f32 v11, v11
v_exp_f32 v12, v12
v_add_f32 v9, 1.0, v9
v_add_f32 v10, 1.0, v10
v_add_f32 v11, 1.0, v11
v_add_f32 v12, 1.0, v12
v_rcp_f32 v9, v9
s_waitcnt lgkmcnt(9)
M 64,32,160
TR 54,6,20992
v_rcp_f32 v10, v10
v_rcp_f32 v11, v11
v_rcp_f32 v12, v12
v_mul_f32 v120, v120, v9
v_mul_f32 v121, v121, v10
v_mul_f32 v122, v122, v11
v_mul_f32 v123, v123, v12
v_add_f32 v16, v16, v120
v_add_f32 v18, v18, v121
v_add_f32 v20, v20, v122
s_waitcnt lgkmcnt(8)
M 64,36,168
TR 56,6,24576
v_add_f32 v22, v22, v123
v_fmac_f32 v17, v120, v120
v_fmac_f32 v19, v121, v121
v_fmac_f32 v21, v122, v122
v_fmac_f32 v23, v123, v123
v_mul_f32 v9, v124, v124
v_mul_f32 v10, v125, v125
v_mul_f32 v11, v126, v126
v_mul_f32 v12, v127, v127
v_fma_f32 v9, v9, s52, v8
s_waitcnt lgkmcnt(7)
M 64,40,176
TR 58,6,25088
v_fma_f32 v10, v10, s52, v8
v_fma_f32 v11, v11, s52, v8
v_fma_f32 v12, v12, s52, v8
v_mul_f32 v9, v9, v124
v_mul_f32 v10, v10, v125
v_mul_f32 v11, v11, v126
v_mul_f32 v12, v12, v127
v_exp_f32 v9, v9
v_exp_f32 v10, v10
s_waitcnt lgkmcnt(6)
M 64,44,184
TR 60,6,28672
v_exp_f32 v11, v11
v_exp_f32 v12, v12
v_add_f32 v9, 1.0, v9
v_add_f32 v10, 1.0, v10
v_add_f32 v11, 1.0, v11
v_add_f32 v12, 1.0, v12
v_rcp_f32 v9, v9
v_rcp_f32 v10, v10
v_rcp_f32 v11, v11
v_rcp_f32 v12, v12
M 68,32,164
TR 62,6,29184
v_mul_f32 v124, v124, v9
v_mul_f32 v125, v125, v10
v_mul_f32 v126, v126, v11
v_mul_f32 v127, v127, v12
v_add_f32 v24, v24, v124
v_add_f32 v26, v26, v125
v_add_f32 v28, v28, v126
v_add_f32 v30, v30, v127
v_fmac_f32 v25, v124, v124
M 68,36,172
TR 32,5,16640
v_fmac_f32 v27, v125, v125
v_fmac_f32 v29, v126, v126
v_fmac_f32 v31, v127, v127
PK 120,120,121
PK 121,122,123
PK 122,124,125
PK 123,126,127
s_nop 1
v_add_f32_dpp v16, v16, v16 row_ror:8 row_mask:0xf bank_mask:0xf
v_add_f32_dpp v17, v17, v17 row_ror:8 row_mask:0xf bank_mask:0xf
M 68,40,180
TR 34,5,17152
v_add_f32_dpp v18, v18, v18 row_ror:8 row_mask:0xf bank_mask:0xf
v_add_f32_dpp v19, v19, v19 row_ror:8 row_mask:0xf bank_mask:0xf
v_add_f32_dpp v20, v20, v20 row_ror:8 row_mask:0xf bank_mask:0xf
v_add_f32_dpp v21, v21, v21 row_ror:8 row_mask:0xf bank_mask:0xf
v_add_f32_dpp v22, v22, v22 row_ror:8 row_mask:0xf bank_mask:0xf
v_add_f32_dpp v23, v23, v23 row_ror:8 row_mask:0xf bank_mask:0xf
v_add_f32_dpp v24, v24, v24 row_ror:8 row_mask:0xf bank_mask:0xf
v_add_f32_dpp v25, v25, v25 row_ror:8 row_mask:0xf bank_mask:0xf
v_add_f32_dpp v26, v26, v26 row_ror:8 row_mask:0xf bank_mask:0xf
M 68,44,188
TR 36,5,20736
v_add_f32_dpp v27, v27, v27 row_ror:8 row_mask:0xf bank_mask:0xf
v_add_f32_dpp v28, v28, v28 row_ror:8 row_mask:0xf bank_mask:0xf
v_add_f32_dpp v29, v29, v29 row_ror:8 row_mask:0xf bank_mask:0xf
v_add_f32_dpp v30, v30, v30 row_ror:8 row_mask:0xf bank_mask:0xf
v_add_f32_dpp v31, v31, v31 row_ror:8 row_mask:0xf bank_mask:0xf
v_add_f32_dpp v16, v16, v16 row_ror:4 row_mask:0xf bank_mask:0xf
v_add_f32_dpp v17, v17, v17 row_ror:4 row_mask:0xf bank_mask:0xf
v_add_f32_dpp v18, v18, v18 row_ror:4 row_mask:0xf bank_mask:0xf
v_add_f32_dpp v19, v19, v19 row_ror:4 row_mask:0xf bank_mask:0xf
v_add_f32_dpp v20, v20, v20 row_ror:4 row_mask:0xf bank_mask:0xf
s_waitcnt lgkmcnt(9)
M 72,48,160
TR 38,5,21248
v_add_f32_dpp v21, v21, v21 row_ror:4 row_mask:0xf bank_mask:0xf
v_add_f32_dpp v22, v22, v22 row_ror:4 row_mask:0xf bank_mask:0xf
v_add_f32_dpp v23, v23, v23 row_ror:4 row_mask:0xf bank_mask:0xf
v_add_f32_dpp v24, v24, v24 row_ror:4 row_mask:0xf bank_mask:0xf
v_add_f32_dpp v25, v25, v25 row_ror:4 row_mask:0xf bank_mask:0xf
v_add_f32_dpp v26, v26, v26 row_ror:4 row_mask:0xf bank_mask:0xf
v_add_f32_dpp v27, v27, v27 row_ror:4 row_mask:0xf bank_mask:0xf
v_add_f32_dpp v28, v28, v28 row_ror:4 row_mask:0xf bank_mask:0xf
v_add_f32_dpp v29, v29, v29 row_ror:4 row_mask:0xf bank_mask:0xf
s_waitcnt lgkmcnt(8)
M 72,52,168
TR 40,5,24832
v_add_f32_dpp v30, v30, v30 row_ror:4 row_mask:0xf bank_mask:0xf
v_add_f32_dpp v31, v31, v31 row_ror:4 row_mask:0xf bank_mask:0xf
v_add_f32_dpp v16, v16, v16 row_ror:2 row_mask:0xf bank_mask:0xf
v_add_f32_dpp v17, v17, v17 row_ror:2 row_mask:0xf bank_mask:0xf
v_add_f32_dpp v18, v18, v18 row_ror:2 row_mask:0xf bank_mask:0xf
v_add_f32_dpp v19, v19, v19 row_ror:2 row_mask:0xf bank_mask:0xf
v_add_f32_dpp v20, v20, v20 row_ror:2 row_mask:0xf bank_mask:0xf
v_add_f32_dpp v21, v21, v21 row_ror:2 row_mask:0xf bank_mask:0xf
v_add_f32_dpp v22, v22, v22 row_ror:2 row_mask:0xf bank_mask:0xf
v_add_f32_dpp v23, v23, v23 row_ror:2 row_mask:0xf bank_mask:0xf
s_waitcnt lgkmcnt(7)
M 72,56,176
TR 42,5,25344
v_add_f32_dpp v24, v24, v24 row_ror:2 row_mask:0xf bank_mask:0xf
v_add_f32_dpp v25, v25, v25 row_ror:2 row_mask:0xf bank_mask:0xf
v_add_f32_dpp v26, v26, v26 row_ror:2 row_mask:0xf bank_mask:0xf
v_add_f32_dpp v27, v27, v27 row_ror:2 row_mask:0xf bank_mask:0xf
v_add_f32_dpp v28, v28, v28 row_ror:2 row_mask:0xf bank_mask:0xf
v_add_f32_dpp v29, v29, v29 row_ror:2 row_mask:0xf bank_mask:0xf
v_add_f32_dpp v30, v30, v30 row_ror:2 row_mask:0xf bank_mask:0xf
v_add_f32_dpp v31, v31, v31 row_ror:2 row_mask:0xf bank_mask:0xf
v_add_f32_dpp v16, v16, v16 row_ror:1 row_mask:0xf bank_mask:0xf
s_waitcnt lgkmcnt(6)
M 72,60,184
TR 44,5,28928
v_add_f32_dpp v17, v17, v17 row_ror:1 row_mask:0xf bank_mask:0xf
v_add_f32_dpp v18, v18, v18 row_ror:1 row_mask:0xf bank_mask:0xf
v_add_f32_dpp v19, v19, v19 row_ror:1 row_mask:0xf bank_mask:0xf
v_add_f32_dpp v20, v20, v20 row_ror:1 row_mask:0xf bank_mask:0xf
v_add_f32_dpp v21, v21, v21 row_ror:1 row_mask:0xf bank_mask:0xf
v_add_f32_dpp v22, v22, v22 row_ror:1 row_mask:0xf bank_mask:0xf
v_add_f32_dpp v23, v23, v23 row_ror:1 row_mask:0xf bank_mask:0xf
v_add_f32_dpp v24, v24, v24 row_ror:1 row_mask:0xf bank_mask:0xf
v_add_f32_dpp v25, v25, v25 row_ror:1 row_mask:0xf bank_mask:0xf
v_add_f32_dpp v26, v26, v26 row_ror:1 row_mask:0xf bank_mask:0xf
M 76,48,164
TR 46,5,29440
v_add_f32_dpp v27, v27, v27 row_ror:1 row_mask:0xf bank_mask:0xf
v_add_f32_dpp v28, v28, v28 row_ror:1 row_mask:0xf bank_mask:0xf
v_add_f32_dpp v29, v29, v29 row_ror:1 row_mask:0xf bank_mask:0xf
v_add_f32_dpp v30, v30, v30 row_ror:1 row_mask:0xf bank_mask:0xf
v_add_f32_dpp v31, v31, v31 row_ror:1 row_mask:0xf bank_mask:0xf
s_add_u32 s36, s16, 44040192
s_addc_u32 s37, s17, 0
s_mov_b32 s38, 114688
s_mov_b32 s39, 0x20000
v_bfe_u32 v9, v0, 4, 2
v_lshlrev_b32 v9, 6, v9
v_and_b32 v10, 15, v0
M 76,52,172
TR 48,6,16640
v_lshl_add_u32 v10, v10, 24, v9
s_lshl_b32 s63, s41, 11
s_lshl_b32 s49, s40, 8
s_add_u32 s63, s63, s49
s_lshl_b32 s49, s42, 14
s_add_u32 s49, s49, s63
buffer_store_dwordx4 v[16:19], v10, s[36:39], s49 offen offset:0 sc1
buffer_store_dwordx4 v[20:23], v10, s[36:39], s49 offen offset:16 sc1
buffer_store_dwordx4 v[24:27], v10, s[36:39], s49 offen offset:32 sc1
buffer_store_dwordx4 v[28:31], v10, s[36:39], s49 offen offset:48 sc1
M 76,56,180
TR 50,6,17152
M 76,60,188
TR 52,6,20736
s_waitcnt lgkmcnt(9)
M 80,32,160
TR 54,6,21248
s_waitcnt lgkmcnt(8)
M 80,36,168
TR 56,6,24832
s_waitcnt lgkmcnt(7)
M 80,40,176
TR 58,6,25344
s_waitcnt lgkmcnt(6)
M 80,44,184
TR 60,6,28928
M 84,32,164
TR 62,6,29440
M 84,36,172
s_waitcnt vmcnt(4)
s_barrier
TR 32,5,32768
M 84,40,180
TR 34,5,33280
M 84,44,188
TR 36,5,36864
s_waitcnt lgkmcnt(9)
M 88,48,160
TR 38,5,37376
s_waitcnt lgkmcnt(8)
M 88,52,168
TR 40,5,40960
s_waitcnt lgkmcnt(7)
M 88,56,176
TR 42,5,41472
s_waitcnt lgkmcnt(6)
M 88,60,184
TR 44,5,45056
M 92,48,164
TR 46,5,45568
M 92,52,172
TR 48,6,32768
M 92,56,180
TR 50,6,33280
M 92,60,188
TR 52,6,36864
s_waitcnt lgkmcnt(9)
M 64,32,192
TR 54,6,37376
s_waitcnt lgkmcnt(8)
M 64,36,200
TR 56,6,40960
s_waitcnt lgkmcnt(7)
M 64,40,208
TR 58,6,41472
s_waitcnt lgkmcnt(6)
M 64,44,216
TR 60,6,45056
s_waitcnt vmcnt(0)
s_barrier
s_cmp_lg_u32 s40, 0
s_cbranch_scc1 L_w0_59
s_add_u32 s47, s41, 53
s_lshl_b32 s47, s47, 7
s_add_u32 s47, s47, 32
s_lshl_b32 s49, s42, 2
s_add_u32 s47, s47, s49
v_lshlrev_b32 v10, 13, v0
v_add_u32 v10, s47, v10
v_mov_b32 v11, s59
s_mov_b64 exec, 0xff
global_store_dword v10, v11, s[100:101] sc1
s_mov_b64 exec, -1
s_add_u32 s49, s41, 53
s_lshl_b32 s49, s49, 7
s_add_u32 s49, s49, 32
s_and_b32 s50, s2, 7
s_lshl_b32 s50, s50, 13
s_add_u32 s49, s49, s50
v_min_u32 v15, 6, v0
v_lshl_add_u32 v15, v15, 2, s49
v_mov_b32 v14, 0
L_w0_59:
M 68,32,196
TR 62,6,45568
M 68,36,204
TR 32,5,33024
M 68,40,212
TR 34,5,33536
M 68,44,220
TR 36,5,37120
s_waitcnt lgkmcnt(9)
M 72,48,192
TR 38,5,37632
s_waitcnt lgkmcnt(8)
M 72,52,200
TR 40,5,41216
s_waitcnt lgkmcnt(7)
M 72,56,208
TR 42,5,41728
s_waitcnt lgkmcnt(6)
M 72,60,216
TR 44,5,45312
M 76,48,196
TR 46,5,45824
M 76,52,204
TR 48,6,33024
M 76,56,212
TR 50,6,33536
M 76,60,220
TR 52,6,37120
s_waitcnt lgkmcnt(9)
M 80,32,192
TR 54,6,37632
s_waitcnt lgkmcnt(8)
M 80,36,200
TR 56,6,41216
s_waitcnt lgkmcnt(7)
M 80,40,208
TR 58,6,41728
s_waitcnt lgkmcnt(6)
M 80,44,216
TR 60,6,45312
M 84,32,196
TR 62,6,45824
M 84,36,204
TR 32,5,49152
M 84,40,212
TR 34,5,49664
M 84,44,220
TR 36,5,53248
s_waitcnt lgkmcnt(9)
M 88,48,192
TR 38,5,53760
s_waitcnt lgkmcnt(8)
M 88,52,200
TR 40,5,57344
s_waitcnt lgkmcnt(7)
M 88,56,208
TR 42,5,57856
s_waitcnt lgkmcnt(6)
M 88,60,216
TR 44,5,61440
s_cmp_lg_u32 s40, 0
s_cbranch_scc1 L_w0_60
global_load_dword v14, v15, s[100:101] sc1
L_w0_60:
M 92,48,196
TR 46,5,61952
M 92,52,204
TR 48,6,49152
M 92,56,212
TR 50,6,49664
M 92,60,220
TR 52,6,53248
s_waitcnt lgkmcnt(9)
M 64,32,224
TR 54,6,53760
s_waitcnt lgkmcnt(8)
M 64,36,232
TR 56,6,57344
s_waitcnt lgkmcnt(7)
M 64,40,240
TR 58,6,57856
s_waitcnt lgkmcnt(6)
M 64,44,248
TR 60,6,61440
M 68,32,228
TR 62,6,61952
M 68,36,236
TR 32,5,49408
M 68,40,244
TR 34,5,49920
M 68,44,252
TR 36,5,53504
s_waitcnt lgkmcnt(9)
M 72,48,224
TR 38,5,54016
s_waitcnt lgkmcnt(8)
M 72,52,232
TR 40,5,57600
s_waitcnt lgkmcnt(7)
M 72,56,240
TR 42,5,58112
s_waitcnt lgkmcnt(6)
M 72,60,248
TR 44,5,61696
M 76,48,228
TR 46,5,62208
M 76,52,236
TR 48,6,49408
M 76,56,244
TR 50,6,49920
M 76,60,252
TR 52,6,53504
s_waitcnt lgkmcnt(9)
M 80,32,224
TR 54,6,54016
s_waitcnt lgkmcnt(8)
M 80,36,232
TR 56,6,57600
s_waitcnt lgkmcnt(7)
M 80,40,240
TR 58,6,58112
s_waitcnt lgkmcnt(6)
M 80,44,248
TR 60,6,61696
s_cmp_lg_u32 s40, 0
s_cbranch_scc1 L_w0_61
s_branch L_chk_63
L_spin_62:
s_sleep 4
global_load_dword v14, v15, s[100:101] sc1
s_waitcnt vmcnt(0)
L_chk_63:
v_cmp_ne_u32 vcc, s59, v14
s_cbranch_vccnz L_spin_62
L_w0_61:
s_barrier
v_and_b32 v9, 31, v0
v_lshlrev_b32 v9, 3, v9
s_add_u32 s49, s63, 0
buffer_load_dwordx2 v[16:17], v9, s[36:39], s49 offen sc1
s_add_u32 s49, s63, 16384
buffer_load_dwordx2 v[18:19], v9, s[36:39], s49 offen sc1
s_add_u32 s49, s63, 32768
buffer_load_dwordx2 v[20:21], v9, s[36:39], s49 offen sc1
s_add_u32 s49, s63, 49152
buffer_load_dwordx2 v[22:23], v9, s[36:39], s49 offen sc1
s_add_u32 s49, s63, 65536
buffer_load_dwordx2 v[24:25], v9, s[36:39], s49 offen sc1
s_add_u32 s49, s63, 81920
buffer_load_dwordx2 v[26:27], v9, s[36:39], s49 offen sc1
s_add_u32 s49, s63, 98304
buffer_load_dwordx2 v[28:29], v9, s[36:39], s49 offen sc1
M 84,32,228
TR 62,6,62208
M 84,36,236
M 84,40,244
M 84,44,252
s_waitcnt lgkmcnt(6)
M 88,48,224
s_waitcnt lgkmcnt(4)
M 88,52,232
s_waitcnt lgkmcnt(2)
M 88,56,240
s_waitcnt lgkmcnt(0)
M 88,60,248
M 92,48,228
M 92,52,236
M 92,56,244
M 92,60,252
s_nop 7
DR 224,13,0
DR 228,13,1024
DR 232,13,2048
DR 236,13,3072
s_add_u32 s49, s46, 131072
v_add_u32 v9, s49, v9
v_bfe_u32 v10, v0, 4, 2
v_lshl_add_u32 v10, v10, 6, s49
s_waitcnt vmcnt(0) lgkmcnt(0)
v_add_f32 v16, v16, v18
v_add_f32 v17, v17, v19
v_add_f32 v16, v16, v20
v_add_f32 v17, v17, v21
v_add_f32 v16, v16, v22
v_add_f32 v17, v17, v23
v_add_f32 v16, v16, v24
v_add_f32 v17, v17, v25
v_add_f32 v16, v16, v26
v_add_f32 v17, v17, v27
v_add_f32 v16, v16, v28
v_add_f32 v17, v17, v29
v_mul_f32 v16, 982665509, v16
v_mul_f32 v17, 982665509, v17
v_fma_f32 v17, -v16, v16, v17
v_max_f32 v17, 0, v17
PK 16,16,16
PK 17,17,17
v_and_b32 v16, 0xffff0000, v16
v_and_b32 v17, 0xffff0000, v17
v_add_f32 v17, 925353388, v17
PK 17,17,17
v_and_b32 v17, 0xffff0000, v17
v_sqrt_f32 v17, v17
s_nop 0
PK 17,17,17
v_and_b32 v17, 0xffff0000, v17
v_rcp_f32 v17, v17
s_nop 0
v_mul_f32 v16, v16, v17
ds_write_b64 v9, v[16:17]
s_waitcnt lgkmcnt(0)
DR 240,10,0
DR 244,10,16
DR 248,10,32
DR 252,10,48
s_cmp_lg_u32 s40, 0
s_cbranch_scc1 L_w0_64
s_and_b32 s43, s2, 7
s_lshl_b32 s43, s43, 13
s_add_u32 s43, s43, 6848
v_lshrrev_b32 v13, 3, v0
v_lshlrev_b32 v13, 7, v13
v_and_b32 v15, 7, v0
v_lshl_add_u32 v13, v15, 2, v13
v_add_u32 v15, s43, v13
global_load_dword v13, v15, s[100:101] sc1
L_w0_64:
s_waitcnt lgkmcnt(0)
s_add_u32 s48, s58, 0
s_lshl_b32 s48, s48, 12
s_lshl_b32 s49, s41, 3
s_add_u32 s49, s49, s40
s_mul_i32 s49, s49, 57344
s_add_u32 s48, s48, s49
s_add_u32 s50, s48, 28672
v_lshlrev_b32 v16, 16, v224
v_lshlrev_b32 v18, 16, v225
v_lshlrev_b32 v20, 16, v226
v_lshlrev_b32 v22, 16, v227
v_and_b32 v17, s53, v224
v_and_b32 v19, s53, v225
v_and_b32 v21, s53, v226
v_and_b32 v23, s53, v227
v_fma_f32 v16, v16, v241, -v240
v_fma_f32 v17, v17, v243, -v242
v_fma_f32 v18, v18, v245, -v244
v_fma_f32 v19, v19, v247, -v246
v_fma_f32 v20, v20, v249, -v248
v_fma_f32 v21, v21, v251, -v250
v_fma_f32 v22, v22, v253, -v252
v_fma_f32 v23, v23, v255, -v254
PK 224,16,17
PK 225,18,19
PK 226,20,21
PK 227,22,23
buffer_store_dwordx4 v[224:227], v7, s[28:31], s48 offen offset:0 sc1
v_lshlrev_b32 v24, 16, v228
v_lshlrev_b32 v26, 16, v229
v_lshlrev_b32 v28, 16, v230
v_lshlrev_b32 v30, 16, v231
v_and_b32 v25, s53, v228
v_and_b32 v27, s53, v229
v_and_b32 v29, s53, v230
v_and_b32 v31, s53, v231
v_fma_f32 v24, v24, v241, -v240
v_fma_f32 v25, v25, v243, -v242
v_fma_f32 v26, v26, v245, -v244
v_fma_f32 v27, v27, v247, -v246
v_fma_f32 v28, v28, v249, -v248
v_fma_f32 v29, v29, v251, -v250
v_fma_f32 v30, v30, v253, -v252
v_fma_f32 v31, v31, v255, -v254
PK 228,24,25
PK 229,26,27
PK 230,28,29
PK 231,30,31
buffer_store_dwordx4 v[228:231], v7, s[28:31], s48 offen offset:1024 sc1
v_lshlrev_b32 v16, 16, v232
v_lshlrev_b32 v18, 16, v233
v_lshlrev_b32 v20, 16, v234
v_lshlrev_b32 v22, 16, v235
v_and_b32 v17, s53, v232
v_and_b32 v19, s53, v233
v_and_b32 v21, s53, v234
v_and_b32 v23, s53, v235
v_fma_f32 v16, v16, v241, -v240
v_fma_f32 v17, v17, v243, -v242
v_fma_f32 v18, v18, v245, -v244
v_fma_f32 v19, v19, v247, -v246
v_fma_f32 v20, v20, v249, -v248
v_fma_f32 v21, v21, v251, -v250
v_fma_f32 v22, v22, v253, -v252
v_fma_f32 v23, v23, v255, -v254
PK 232,16,17
PK 233,18,19
PK 234,20,21
PK 235,22,23
buffer_store_dwordx4 v[232:235], v7, s[28:31], s48 offen offset:2048 sc1
v_lshlrev_b32 v24, 16, v236
v_lshlrev_b32 v26, 16, v237
v_lshlrev_b32 v28, 16, v238
v_lshlrev_b32 v30, 16, v239
v_and_b32 v25, s53, v236
v_and_b32 v27, s53, v237
v_and_b32 v29, s53, v238
v_and_b32 v31, s53, v239
v_fma_f32 v24, v24, v241, -v240
v_fma_f32 v25, v25, v243, -v242
v_fma_f32 v26, v26, v245, -v244
v_fma_f32 v27, v27, v247, -v246
v_fma_f32 v28, v28, v249, -v248
v_fma_f32 v29, v29, v251, -v250
v_fma_f32 v30, v30, v253, -v252
v_fma_f32 v31, v31, v255, -v254
PK 236,24,25
PK 237,26,27
PK 238,28,29
PK 239,30,31
buffer_store_dwordx4 v[236:239], v7, s[28:31], s48 offen offset:3072 sc1
s_add_u32 s48, s58, 1
s_lshl_b32 s48, s48, 12
s_lshl_b32 s49, s41, 3
s_add_u32 s49, s49, s40
s_mul_i32 s49, s49, 57344
s_add_u32 s48, s48, s49
s_add_u32 s50, s48, 28672
v_lshlrev_b32 v16, 16, v96
v_lshlrev_b32 v18, 16, v97
v_lshlrev_b32 v20, 16, v98
v_lshlrev_b32 v22, 16, v99
v_and_b32 v17, s53, v96
v_and_b32 v19, s53, v97
v_and_b32 v21, s53, v98
v_and_b32 v23, s53, v99
v_fma_f32 v16, v16, v241, -v240
v_fma_f32 v17, v17, v243, -v242
v_fma_f32 v18, v18, v245, -v244
v_fma_f32 v19, v19, v247, -v246
v_fma_f32 v20, v20, v249, -v248
v_fma_f32 v21, v21, v251, -v250
v_fma_f32 v22, v22, v253, -v252
v_fma_f32 v23, v23, v255, -v254
PK 96,16,17
PK 97,18,19
PK 98,20,21
PK 99,22,23
buffer_store_dwordx4 v[96:99], v7, s[28:31], s48 offen offset:0 sc1
v_lshlrev_b32 v24, 16, v104
v_lshlrev_b32 v26, 16, v105
v_lshlrev_b32 v28, 16, v106
v_lshlrev_b32 v30, 16, v107
v_and_b32 v25, s53, v104
v_and_b32 v27, s53, v105
v_and_b32 v29, s53, v106
v_and_b32 v31, s53, v107
v_fma_f32 v24, v24, v241, -v240
v_fma_f32 v25, v25, v243, -v242
v_fma_f32 v26, v26, v245, -v244
v_fma_f32 v27, v27, v247, -v246
v_fma_f32 v28, v28, v249, -v248
v_fma_f32 v29, v29, v251, -v250
v_fma_f32 v30, v30, v253, -v252
v_fma_f32 v31, v31, v255, -v254
PK 104,24,25
PK 105,26,27
PK 106,28,29
PK 107,30,31
buffer_store_dwordx4 v[104:107], v7, s[28:31], s48 offen offset:1024 sc1
v_lshlrev_b32 v16, 16, v112
v_lshlrev_b32 v18, 16, v113
v_lshlrev_b32 v20, 16, v114
v_lshlrev_b32 v22, 16, v115
v_and_b32 v17, s53, v112
v_and_b32 v19, s53, v113
v_and_b32 v21, s53, v114
v_and_b32 v23, s53, v115
v_fma_f32 v16, v16, v241, -v240
v_fma_f32 v17, v17, v243, -v242
v_fma_f32 v18, v18, v245, -v244
v_fma_f32 v19, v19, v247, -v246
v_fma_f32 v20, v20, v249, -v248
v_fma_f32 v21, v21, v251, -v250
v_fma_f32 v22, v22, v253, -v252
v_fma_f32 v23, v23, v255, -v254
PK 112,16,17
PK 113,18,19
PK 114,20,21
PK 115,22,23
buffer_store_dwordx4 v[112:115], v7, s[28:31], s48 offen offset:2048 sc1
v_lshlrev_b32 v24, 16, v120
v_lshlrev_b32 v26, 16, v121
v_lshlrev_b32 v28, 16, v122
v_lshlrev_b32 v30, 16, v123
v_and_b32 v25, s53, v120
v_and_b32 v27, s53, v121
v_and_b32 v29, s53, v122
v_and_b32 v31, s53, v123
v_fma_f32 v24, v24, v241, -v240
v_fma_f32 v25, v25, v243, -v242
v_fma_f32 v26, v26, v245, -v244
v_fma_f32 v27, v27, v247, -v246
v_fma_f32 v28, v28, v249, -v248
v_fma_f32 v29, v29, v251, -v250
v_fma_f32 v30, v30, v253, -v252
v_fma_f32 v31, v31, v255, -v254
PK 120,24,25
PK 121,26,27
PK 122,28,29
PK 123,30,31
buffer_store_dwordx4 v[120:123], v7, s[28:31], s48 offen offset:3072 sc1
v_mul_f32 v9, v64, v64
v_mul_f32 v10, v65, v65
v_mul_f32 v11, v66, v66
v_mul_f32 v12, v67, v67
v_fma_f32 v9, v9, s52, v8
v_fma_f32 v10, v10, s52, v8
v_fma_f32 v11, v11, s52, v8
v_fma_f32 v12, v12, s52, v8
v_mul_f32 v9, v9, v64
v_mul_f32 v10, v10, v65
v_mul_f32 v11, v11, v66
v_mul_f32 v12, v12, v67
v_exp_f32 v9, v9
v_exp_f32 v10, v10
v_exp_f32 v11, v11
v_exp_f32 v12, v12
v_add_f32 v9, 1.0, v9
v_add_f32 v10, 1.0, v10
v_add_f32 v11, 1.0, v11
v_add_f32 v12, 1.0, v12
v_rcp_f32 v9, v9
v_rcp_f32 v10, v10
v_rcp_f32 v11, v11
v_rcp_f32 v12, v12
v_mul_f32 v64, v64, v9
v_mul_f32 v65, v65, v10
v_mul_f32 v66, v66, v11
v_mul_f32 v67, v67, v12
v_mul_f32 v9, v72, v72
v_mul_f32 v10, v73, v73
v_mul_f32 v11, v74, v74
v_mul_f32 v12, v75, v75
v_fma_f32 v9, v9, s52, v8
v_fma_f32 v10, v10, s52, v8
v_fma_f32 v11, v11, s52, v8
v_fma_f32 v12, v12, s52, v8
v_mul_f32 v9, v9, v72
v_mul_f32 v10, v10, v73
v_mul_f32 v11, v11, v74
v_mul_f32 v12, v12, v75
v_exp_f32 v9, v9
v_exp_f32 v10, v10
v_exp_f32 v11, v11
v_exp_f32 v12, v12
v_add_f32 v9, 1.0, v9
v_add_f32 v10, 1.0, v10
v_add_f32 v11, 1.0, v11
v_add_f32 v12, 1.0, v12
v_rcp_f32 v9, v9
v_rcp_f32 v10, v10
v_rcp_f32 v11, v11
v_rcp_f32 v12, v12
v_mul_f32 v72, v72, v9
v_mul_f32 v73, v73, v10
v_mul_f32 v74, v74, v11
v_mul_f32 v75, v75, v12
PK 64,64,65
PK 65,66,67
PK 66,72,73
PK 67,74,75
v_mul_f32 v9, v68, v68
v_mul_f32 v10, v69, v69
v_mul_f32 v11, v70, v70
v_mul_f32 v12, v71, v71
v_fma_f32 v9, v9, s52, v8
v_fma_f32 v10, v10, s52, v8
v_fma_f32 v11, v11, s52, v8
v_fma_f32 v12, v12, s52, v8
v_mul_f32 v9, v9, v68
v_mul_f32 v10, v10, v69
v_mul_f32 v11, v11, v70
v_mul_f32 v12, v12, v71
v_exp_f32 v9, v9
v_exp_f32 v10, v10
v_exp_f32 v11, v11
v_exp_f32 v12, v12
v_add_f32 v9, 1.0, v9
v_add_f32 v10, 1.0, v10
v_add_f32 v11, 1.0, v11
v_add_f32 v12, 1.0, v12
v_rcp_f32 v9, v9
v_rcp_f32 v10, v10
v_rcp_f32 v11, v11
v_rcp_f32 v12, v12
v_mul_f32 v68, v68, v9
v_mul_f32 v69, v69, v10
v_mul_f32 v70, v70, v11
v_mul_f32 v71, v71, v12
v_mul_f32 v9, v76, v76
v_mul_f32 v10, v77, v77
v_mul_f32 v11, v78, v78
v_mul_f32 v12, v79, v79
v_fma_f32 v9, v9, s52, v8
v_fma_f32 v10, v10, s52, v8
v_fma_f32 v11, v11, s52, v8
v_fma_f32 v12, v12, s52, v8
v_mul_f32 v9, v9, v76
v_mul_f32 v10, v10, v77
v_mul_f32 v11, v11, v78
v_mul_f32 v12, v12, v79
v_exp_f32 v9, v9
v_exp_f32 v10, v10
v_exp_f32 v11, v11
v_exp_f32 v12, v12
v_add_f32 v9, 1.0, v9
v_add_f32 v10, 1.0, v10
v_add_f32 v11, 1.0, v11
v_add_f32 v12, 1.0, v12
v_rcp_f32 v9, v9
v_rcp_f32 v10, v10
v_rcp_f32 v11, v11
v_rcp_f32 v12, v12
v_mul_f32 v76, v76, v9
v_mul_f32 v77, v77, v10
v_mul_f32 v78, v78, v11
v_mul_f32 v79, v79, v12
PK 68,68,69
PK 69,70,71
PK 70,76,77
PK 71,78,79
s_waitcnt vmcnt(0)
s_barrier
s_cmp_lg_u32 s40, 0
s_cbranch_scc1 L_w0_65
s_add_u32 s47, s42, 14
s_lshl_b32 s47, s47, 7
s_lshl_b32 s49, s41, 2
s_add_u32 s47, s47, s49
s_add_u32 s47, s47, 32
v_lshlrev_b32 v16, 13, v0
v_add_u32 v16, s47, v16
v_mov_b32 v17, s59
s_mov_b64 exec, 0xff
global_store_dword v16, v17, s[100:101] sc1
s_mov_b64 exec, -1
L_w0_65:
s_add_u32 s24, s16, 35651584
s_addc_u32 s25, s17, 0
s_mov_b32 s26, 3670016
s_mov_b32 s27, 0x20000
v_bfe_u32 v14, v0, 3, 1
v_lshlrev_b32 v14, 6, v14
v_bfe_u32 v18, v0, 2, 1
v_lshl_add_u32 v14, v18, 7, v14
v_and_b32 v18, 0x33, v0
v_lshl_add_u32 v14, v18, 4, v14
s_mov_b32 s48, s42
s_lshl_b32 s48, s48, 11
s_lshl_b32 s49, s41, 3
s_add_u32 s49, s49, s40
s_mul_i32 s49, s49, 57344
s_add_u32 s48, s48, s49
s_add_u32 s50, s48, 28672
v_mov_b32 v9, v64
v_mov_b32 v10, v65
v_mov_b32 v11, v66
v_mov_b32 v12, v67
v_mov_b32_dpp v64, v68 row_ror:8 row_mask:0xf bank_mask:0xc
v_mov_b32_dpp v65, v69 row_ror:8 row_mask:0xf bank_mask:0xc
v_mov_b32_dpp v66, v70 row_ror:8 row_mask:0xf bank_mask:0xc
v_mov_b32_dpp v67, v71 row_ror:8 row_mask:0xf bank_mask:0xc
v_mov_b32_dpp v68, v9 row_ror:8 row_mask:0xf bank_mask:0x3
v_mov_b32_dpp v69, v10 row_ror:8 row_mask:0xf bank_mask:0x3
v_mov_b32_dpp v70, v11 row_ror:8 row_mask:0xf bank_mask:0x3
v_mov_b32_dpp v71, v12 row_ror:8 row_mask:0xf bank_mask:0x3
buffer_store_dwordx4 v[64:67], v14, s[24:27], s48 offen offset:0 sc1
buffer_store_dwordx4 v[68:71], v14, s[24:27], s50 offen offset:0 sc1
v_mul_f32 v9, v80, v80
v_mul_f32 v10, v81, v81
v_mul_f32 v11, v82, v82
v_mul_f32 v12, v83, v83
v_fma_f32 v9, v9, s52, v8
v_fma_f32 v10, v10, s52, v8
v_fma_f32 v11, v11, s52, v8
v_fma_f32 v12, v12, s52, v8
v_mul_f32 v9, v9, v80
v_mul_f32 v10, v10, v81
v_mul_f32 v11, v11, v82
v_mul_f32 v12, v12, v83
v_exp_f32 v9, v9
v_exp_f32 v10, v10
v_exp_f32 v11, v11
v_exp_f32 v12, v12
v_add_f32 v9, 1.0, v9
v_add_f32 v10, 1.0, v10
v_add_f32 v11, 1.0, v11
v_add_f32 v12, 1.0, v12
v_rcp_f32 v9, v9
v_rcp_f32 v10, v10
v_rcp_f32 v11, v11
v_rcp_f32 v12, v12
v_mul_f32 v80, v80, v9
v_mul_f32 v81, v81, v10
v_mul_f32 v82, v82, v11
v_mul_f32 v83, v83, v12
v_mul_f32 v9, v88, v88
v_mul_f32 v10, v89, v89
v_mul_f32 v11, v90, v90
v_mul_f32 v12, v91, v91
v_fma_f32 v9, v9, s52, v8
v_fma_f32 v10, v10, s52, v8
v_fma_f32 v11, v11, s52, v8
v_fma_f32 v12, v12, s52, v8
v_mul_f32 v9, v9, v88
v_mul_f32 v10, v10, v89
v_mul_f32 v11, v11, v90
v_mul_f32 v12, v12, v91
v_exp_f32 v9, v9
v_exp_f32 v10, v10
v_exp_f32 v11, v11
v_exp_f32 v12, v12
v_add_f32 v9, 1.0, v9
v_add_f32 v10, 1.0, v10
v_add_f32 v11, 1.0, v11
v_add_f32 v12, 1.0, v12
v_rcp_f32 v9, v9
v_rcp_f32 v10, v10
v_rcp_f32 v11, v11
v_rcp_f32 v12, v12
v_mul_f32 v88, v88, v9
v_mul_f32 v89, v89, v10
v_mul_f32 v90, v90, v11
v_mul_f32 v91, v91, v12
PK 80,80,81
PK 81,82,83
PK 82,88,89
PK 83,90,91
v_mul_f32 v9, v84, v84
v_mul_f32 v10, v85, v85
v_mul_f32 v11, v86, v86
v_mul_f32 v12, v87, v87
v_fma_f32 v9, v9, s52, v8
v_fma_f32 v10, v10, s52, v8
v_fma_f32 v11, v11, s52, v8
v_fma_f32 v12, v12, s52, v8
v_mul_f32 v9, v9, v84
v_mul_f32 v10, v10, v85
v_mul_f32 v11, v11, v86
v_mul_f32 v12, v12, v87
v_exp_f32 v9, v9
v_exp_f32 v10, v10
v_exp_f32 v11, v11
v_exp_f32 v12, v12
v_add_f32 v9, 1.0, v9
v_add_f32 v10, 1.0, v10
v_add_f32 v11, 1.0, v11
v_add_f32 v12, 1.0, v12
v_rcp_f32 v9, v9
v_rcp_f32 v10, v10
v_rcp_f32 v11, v11
v_rcp_f32 v12, v12
v_mul_f32 v84, v84, v9
v_mul_f32 v85, v85, v10
v_mul_f32 v86, v86, v11
v_mul_f32 v87, v87, v12
v_mul_f32 v9, v92, v92
v_mul_f32 v10, v93, v93
v_mul_f32 v11, v94, v94
v_mul_f32 v12, v95, v95
v_fma_f32 v9, v9, s52, v8
v_fma_f32 v10, v10, s52, v8
v_fma_f32 v11, v11, s52, v8
v_fma_f32 v12, v12, s52, v8
v_mul_f32 v9, v9, v92
v_mul_f32 v10, v10, v93
v_mul_f32 v11, v11, v94
v_mul_f32 v12, v12, v95
v_exp_f32 v9, v9
v_exp_f32 v10, v10
v_exp_f32 v11, v11
v_exp_f32 v12, v12
v_add_f32 v9, 1.0, v9
v_add_f32 v10, 1.0, v10
v_add_f32 v11, 1.0, v11
v_add_f32 v12, 1.0, v12
v_rcp_f32 v9, v9
v_rcp_f32 v10, v10
v_rcp_f32 v11, v11
v_rcp_f32 v12, v12
v_mul_f32 v92, v92, v9
v_mul_f32 v93, v93, v10
v_mul_f32 v94, v94, v11
v_mul_f32 v95, v95, v12
PK 84,84,85
PK 85,86,87
PK 86,92,93
PK 87,94,95
v_mov_b32 v9, v80
v_mov_b32 v10, v81
v_mov_b32 v11, v82
v_mov_b32 v12, v83
v_mov_b32_dpp v80, v84 row_ror:8 row_mask:0xf bank_mask:0xc
v_mov_b32_dpp v81, v85 row_ror:8 row_mask:0xf bank_mask:0xc
v_mov_b32_dpp v82, v86 row_ror:8 row_mask:0xf bank_mask:0xc
v_mov_b32_dpp v83, v87 row_ror:8 row_mask:0xf bank_mask:0xc
v_mov_b32_dpp v84, v9 row_ror:8 row_mask:0xf bank_mask:0x3
v_mov_b32_dpp v85, v10 row_ror:8 row_mask:0xf bank_mask:0x3
v_mov_b32_dpp v86, v11 row_ror:8 row_mask:0xf bank_mask:0x3
v_mov_b32_dpp v87, v12 row_ror:8 row_mask:0xf bank_mask:0x3
buffer_store_dwordx4 v[80:83], v14, s[24:27], s48 offen offset:1024 sc1
buffer_store_dwordx4 v[84:87], v14, s[24:27], s50 offen offset:1024 sc1
s_add_u32 s58, s42, 14
s_lshl_b32 s58, s58, 7
s_lshl_b32 s49, s41, 2
s_add_u32 s58, s58, s49
s_branch L_p2
L_k1_Z2_end:
L_p2:
s_load_dwordx2 s[4:5], s[0:1], 16
s_load_dwordx4 s[8:11], s[0:1], 64
s_load_dwordx2 s[16:17], s[0:1], 104
v_lshrrev_b32 v1, 6, v0
s_and_b32 s3, s2, 7
s_lshr_b32 s41, s2, 3
v_readfirstlane_b32 s40, v1
s_waitcnt lgkmcnt(0)
s_mov_b32 s6, s8
s_mov_b32 s7, s9
s_mov_b32 s8, s10
s_mov_b32 s9, s11
s_cmp_lg_u32 s40, 0
s_cbranch_scc1 L_nw_66
s_lshl_b32 s49, s3, 13
s_add_u32 s49, s49, 6848
v_lshrrev_b32 v14, 3, v0
v_lshlrev_b32 v14, 7, v14
v_and_b32 v15, 7, v0
v_lshl_add_u32 v14, v15, 2, v14
v_add_u32 v15, s49, v14
s_branch L_chk_68
L_spin_67:
s_sleep 8
global_load_dword v13, v15, s[100:101] sc1
s_waitcnt vmcnt(0)
L_chk_68:
v_cmp_ne_u32 vcc, s59, v13
s_cbranch_vccnz L_spin_67
v_mov_b32 v13, 0
L_nw_66:
s_bitcmp1_b32 s2, 0
s_cbranch_scc1 L_k2_attn
s_cmp_lt_u32 s41, 24
s_cbranch_scc1 L_k2_attn
s_branch L_k2_sp
L_k2_end:
s_endpgm
L_p2f:
s_and_b32 s3, s2, 7
s_lshr_b32 s44, s2, 3
s_mul_i32 s49, s44, 43
s_lshr_b32 s49, s49, 7
s_mul_i32 s50, s49, 3
s_sub_u32 s50, s44, s50
s_lshl_b32 s50, s50, 1
s_and_b32 s43, s2, 1
s_add_u32 s50, s50, s43
s_sub_u32 s43, s44, 24
s_cmp_ge_u32 s44, 24
s_cselect_b32 s49, s43, s49
s_cselect_b32 s44, 6, s50
s_and_b32 s43, s2, 6
s_and_b32 s50, s49, 1
s_add_u32 s43, s43, s50
s_lshr_b32 s49, s49, 1
s_lshl_b32 s49, s49, 3
s_add_u32 s43, s43, s49
s_sub_u32 s32, 15, s44
s_xor_b32 s33, s44, 1
s_add_u32 s33, s33, 4
s_cmp_eq_u32 s44, 6
s_cselect_b32 s32, 3, s32
s_cselect_b32 s33, 2, s33
s_lshr_b32 s41, s40, 2
s_and_b32 s42, s40, 3
s_and_b32 s49, s3, 6
s_lshl_b32 s49, s49, 20
s_add_u32 s60, s6, s49
s_addc_u32 s61, s7, 0
s_mov_b32 s62, 2097152
s_mov_b32 s63, 0x20000
s_mov_b32 s20, s8
s_mov_b32 s21, s9
s_mov_b32 s22, 4194304
s_mov_b32 s23, 0x20000
s_mov_b32 s24, s16
s_mov_b32 s25, s17
s_mov_b32 s26, 2097152
s_mov_b32 s27, 0x20000
s_add_u32 s28, s16, 2097152
s_addc_u32 s29, s17, 0
s_mov_b32 s30, 33554432
s_mov_b32 s31, 0x20000
s_add_u32 s36, s16, 46137344
s_addc_u32 s37, s17, 0
s_mov_b32 s38, 20447232
s_mov_b32 s39, 0x20000
s_lshl_b32 s55, s42, 12
s_lshl_b32 s54, s43, 19
s_add_u32 s54, s54, s55
s_lshl_b32 s57, s42, 13
s_add_u32 s57, s57, 131072
v_and_b32 v28, 63, v0
v_lshlrev_b32 v7, 4, v28
v_and_b32 v28, 15, v0
v_bfe_u32 v29, v0, 4, 2
v_lshlrev_b32 v29, 2, v29
v_sub_u32 v28, v28, v29
v_cmp_le_i32 s[8:9], 0, v28
v_cmp_le_i32 s[10:11], 1, v28
v_cmp_le_i32 s[12:13], 2, v28
v_cmp_le_i32 s[14:15], 3, v28
s_mul_i32 s49, s43, 43
s_lshr_b32 s49, s49, 7
s_lshl_b32 s49, s49, 7
s_lshl_b32 s50, s3, 13
s_add_u32 s49, s49, s50
v_and_b32 v14, 15, v0
v_lshl_add_u32 v14, v14, 2, s49
s_lshl_b32 s18, s43, 8
s_lshl_b32 s49, s42, 18
s_add_u32 s18, s18, s49
s_lshl_b32 s49, s41, 7
s_add_u32 s18, s18, s49
s_lshl_b32 s19, s40, 12
s_cmp_eq_u32 s41, 0
s_cselect_b32 s47, s32, s33
s_lshl_b32 s47, s47, 17
s_lshl_b32 s49, s42, 15
s_add_u32 s47, s47, s49
v_xor_b32 v5, 0x10000, v5
v_xor_b32 v6, 0x10000, v6
v_mov_b32 v13, 0
s_mov_b32 s56, 1040356334
s_lshl_b32 s48, s32, 1
s_add_u32 s48, s48, 2
s_lshl_b32 s45, s33, 1
s_add_u32 s45, s45, 2
s_sub_u32 s53, s45, s41
s_sub_u32 s46, s45, 2
s_cmp_eq_u32 s41, 0
s_cselect_b32 s46, 0x1000, s46
s_waitcnt vmcnt(25)
s_barrier
TR 32,5,0
TR 34,5,512
TR 36,5,4096
TR 38,5,4608
TR 40,5,8192
TR 42,5,8704
TR 44,5,12288
TR 46,5,12800
TR 48,6,0
TR 50,6,512
TR 52,6,4096
TR 54,6,4608
TR 56,6,8192
TR 58,6,8704
TR 60,6,12288
TR 62,6,12800
s_waitcnt lgkmcnt(14)
MZ 64,32,128
s_waitcnt lgkmcnt(12)
M 64,36,136
s_mov_b32 s51, 0
s_add_u32 s51, s51, 2
s_and_b32 s51, s51, 3
s_lshl_b32 s51, s51, 20
s_add_u32 s51, s51, s18
s_add_u32 m0, s19, 65536
s_nop 0
buffer_load_dwordx4 v1, s[20:23], s51 offen offset:0  lds
buffer_load_dwordx4 v2, s[20:23], s51 offen offset:1024  lds
buffer_load_dwordx4 v3, s[20:23], s51 offen offset:2048  lds
buffer_load_dwordx4 v4, s[20:23], s51 offen offset:3072  lds
s_waitcnt lgkmcnt(10)
M 64,40,144
s_waitcnt lgkmcnt(8)
M 64,44,152
MZ 68,32,132
M 68,36,140
TR 32,5,256
M 68,40,148
TR 34,5,768
M 68,44,156
TR 36,5,4352
s_waitcnt lgkmcnt(9)
MZ 72,48,128
TR 38,5,4864
s_waitcnt lgkmcnt(8)
M 72,52,136
TR 40,5,8448
s_waitcnt lgkmcnt(7)
M 72,56,144
TR 42,5,8960
s_waitcnt lgkmcnt(6)
M 72,60,152
TR 44,5,12544
MZ 76,48,132
TR 46,5,13056
M 76,52,140
TR 48,6,256
M 76,56,148
TR 50,6,768
M 76,60,156
TR 52,6,4352
s_waitcnt lgkmcnt(9)
MZ 80,32,128
TR 54,6,4864
s_waitcnt lgkmcnt(8)
M 80,36,136
TR 56,6,8448
s_mov_b32 s6, 0
s_add_u32 s6, s6, 3
s_and_b32 s6, s6, 3
s_lshl_b32 s6, s6, 12
s_add_u32 s6, s6, s47
s_add_u32 s7, s6, 16384
buffer_load_dwordx4 v[224:227], v7, s[24:27], s6 offen offset:0 sc1
buffer_load_dwordx4 v[228:231], v7, s[24:27], s7 offen offset:0 sc1
s_waitcnt lgkmcnt(7)
M 80,40,144
TR 58,6,8960
s_waitcnt lgkmcnt(6)
M 80,44,152
TR 60,6,12544
MZ 84,32,132
TR 62,6,13056
M 84,36,140
TR 32,5,16384
M 84,40,148
TR 34,5,16896
M 84,44,156
TR 36,5,20480
s_waitcnt lgkmcnt(9)
MZ 88,48,128
TR 38,5,20992
s_waitcnt lgkmcnt(8)
M 88,52,136
TR 40,5,24576
s_waitcnt lgkmcnt(7)
M 88,56,144
TR 42,5,25088
s_waitcnt lgkmcnt(6)
M 88,60,152
TR 44,5,28672
MZ 92,48,132
TR 46,5,29184
M 92,52,140
TR 48,6,16384
M 92,56,148
TR 50,6,16896
M 92,60,156
TR 52,6,20480
s_waitcnt lgkmcnt(9)
MZ 96,32,128
TR 54,6,20992
s_waitcnt lgkmcnt(8)
M 96,36,136
TR 56,6,24576
buffer_load_dwordx4 v[232:235], v7, s[24:27], s6 offen offset:1024 sc1
buffer_load_dwordx4 v[236:239], v7, s[24:27], s7 offen offset:1024 sc1
s_waitcnt lgkmcnt(7)
M 96,40,144
TR 58,6,25088
s_waitcnt lgkmcnt(6)
M 96,44,152
TR 60,6,28672
MZ 100,32,132
TR 62,6,29184
M 100,36,140
TR 32,5,16640
M 100,40,148
TR 34,5,17152
M 100,44,156
TR 36,5,20736
s_waitcnt lgkmcnt(9)
MZ 104,48,128
TR 38,5,21248
s_waitcnt lgkmcnt(8)
M 104,52,136
TR 40,5,24832
s_waitcnt lgkmcnt(7)
M 104,56,144
TR 42,5,25344
s_waitcnt lgkmcnt(6)
M 104,60,152
TR 44,5,28928
MZ 108,48,132
TR 46,5,29440
M 108,52,140
TR 48,6,16640
M 108,56,148
TR 50,6,17152
M 108,60,156
TR 52,6,20736
s_waitcnt lgkmcnt(9)
MZ 112,32,128
TR 54,6,21248
s_waitcnt lgkmcnt(8)
M 112,36,136
TR 56,6,24832
s_waitcnt lgkmcnt(7)
M 112,40,144
TR 58,6,25344
s_waitcnt lgkmcnt(6)
M 112,44,152
TR 60,6,28928
MZ 116,32,132
TR 62,6,29440
M 116,36,140
s_waitcnt vmcnt(8)
s_barrier
s_cmp_eq_u32 s32, 1
s_cselect_b32 s49, 1, s40
s_cmp_lg_u32 s49, 0
s_cbranch_scc1 L_w0_69
v_lshlrev_b32 v10, 13, v0
v_add_u32 v10, s58, v10
v_mov_b32 v11, s59
s_mov_b64 exec, 0xff
global_store_dword v10, v11, s[100:101] sc1
s_mov_b64 exec, -1
L_w0_69:
TR 32,5,32768
M 116,40,148
TR 34,5,33280
M 116,44,156
TR 36,5,36864
s_waitcnt lgkmcnt(9)
MZ 120,48,128
TR 38,5,37376
s_waitcnt lgkmcnt(8)
M 120,52,136
TR 40,5,40960
s_waitcnt lgkmcnt(7)
M 120,56,144
TR 42,5,41472
s_waitcnt lgkmcnt(6)
M 120,60,152
TR 44,5,45056
MZ 124,48,132
TR 46,5,45568
M 124,52,140
TR 48,6,32768
s_mov_b32 s51, 0
s_add_u32 s51, s51, 3
s_and_b32 s51, s51, 3
s_lshl_b32 s51, s51, 20
s_add_u32 s51, s51, s18
s_add_u32 m0, s19, 98304
s_nop 0
buffer_load_dwordx4 v1, s[20:23], s51 offen offset:0  lds
buffer_load_dwordx4 v2, s[20:23], s51 offen offset:1024  lds
buffer_load_dwordx4 v3, s[20:23], s51 offen offset:2048  lds
buffer_load_dwordx4 v4, s[20:23], s51 offen offset:3072  lds
M 124,56,148
TR 50,6,33280
M 124,60,156
TR 52,6,36864
s_waitcnt lgkmcnt(9)
M 64,32,160
TR 54,6,37376
s_waitcnt lgkmcnt(8)
M 64,36,168
TR 56,6,40960
s_waitcnt lgkmcnt(7)
M 64,40,176
TR 58,6,41472
s_waitcnt lgkmcnt(6)
M 64,44,184
TR 60,6,45056
M 68,32,164
TR 62,6,45568
M 68,36,172
TR 32,5,33024
M 68,40,180
TR 34,5,33536
M 68,44,188
TR 36,5,37120
s_waitcnt lgkmcnt(9)
M 72,48,160
TR 38,5,37632
s_waitcnt lgkmcnt(8)
M 72,52,168
TR 40,5,41216
s_waitcnt lgkmcnt(7)
M 72,56,176
TR 42,5,41728
s_waitcnt lgkmcnt(6)
M 72,60,184
TR 44,5,45312
M 76,48,164
TR 46,5,45824
M 76,52,172
TR 48,6,33024
buffer_load_dwordx4 v[240:243], v7, s[24:27], s6 offen offset:2048 sc1
buffer_load_dwordx4 v[244:247], v7, s[24:27], s7 offen offset:2048 sc1
M 76,56,180
TR 50,6,33536
M 76,60,188
TR 52,6,37120
s_waitcnt lgkmcnt(9)
M 80,32,160
TR 54,6,37632
s_waitcnt lgkmcnt(8)
M 80,36,168
TR 56,6,41216
s_waitcnt lgkmcnt(7)
M 80,40,176
TR 58,6,41728
s_waitcnt lgkmcnt(6)
M 80,44,184
TR 60,6,45312
M 84,32,164
TR 62,6,45824
M 84,36,172
TR 32,5,49152
M 84,40,180
TR 34,5,49664
M 84,44,188
TR 36,5,53248
s_waitcnt lgkmcnt(9)
M 88,48,160
TR 38,5,53760
s_waitcnt lgkmcnt(8)
M 88,52,168
TR 40,5,57344
s_waitcnt lgkmcnt(7)
M 88,56,176
TR 42,5,57856
s_waitcnt lgkmcnt(6)
M 88,60,184
TR 44,5,61440
M 92,48,164
TR 46,5,61952
M 92,52,172
TR 48,6,49152
s_cmp_eq_u32 s32, 1
s_cselect_b32 s49, 1, s40
s_cmp_lg_u32 s49, 0
s_cbranch_scc1 L_w0_70
global_load_dword v13, v14, s[100:101] sc1
L_w0_70:
M 92,56,180
TR 50,6,49664
M 92,60,188
TR 52,6,53248
s_waitcnt lgkmcnt(9)
M 96,32,160
TR 54,6,53760
s_waitcnt lgkmcnt(8)
M 96,36,168
TR 56,6,57344
s_waitcnt lgkmcnt(7)
M 96,40,176
TR 58,6,57856
s_waitcnt lgkmcnt(6)
M 96,44,184
TR 60,6,61440
M 100,32,164
TR 62,6,61952
M 100,36,172
TR 32,5,49408
M 100,40,180
TR 34,5,49920
M 100,44,188
TR 36,5,53504
s_waitcnt lgkmcnt(9)
M 104,48,160
TR 38,5,54016
s_waitcnt lgkmcnt(8)
M 104,52,168
TR 40,5,57600
buffer_load_dwordx4 v[248:251], v7, s[24:27], s6 offen offset:3072 sc1
buffer_load_dwordx4 v[252:255], v7, s[24:27], s7 offen offset:3072 sc1
s_waitcnt lgkmcnt(7)
M 104,56,176
TR 42,5,58112
s_waitcnt lgkmcnt(6)
M 104,60,184
TR 44,5,61696
M 108,48,164
TR 46,5,62208
M 108,52,172
TR 48,6,49408
M 108,56,180
TR 50,6,49920
M 108,60,188
TR 52,6,53504
s_waitcnt lgkmcnt(9)
M 112,32,160
TR 54,6,54016
s_waitcnt lgkmcnt(8)
M 112,36,168
TR 56,6,57600
s_waitcnt lgkmcnt(7)
M 112,40,176
TR 58,6,58112
s_waitcnt lgkmcnt(6)
M 112,44,184
TR 60,6,61696
M 116,32,164
TR 62,6,62208
M 116,36,172
s_waitcnt vmcnt(12)
s_cmp_eq_u32 s32, 1
s_cselect_b32 s49, 1, s40
s_cmp_lg_u32 s49, 0
s_cbranch_scc1 L_w0_71
s_branch L_chk_73
L_spin_72:
s_sleep 8
global_load_dword v13, v14, s[100:101] sc1
s_waitcnt vmcnt(0)
L_chk_73:
v_cmp_ne_u32 vcc, s59, v13
s_cbranch_vccnz L_spin_72
L_w0_71:
s_barrier
v_xor_b32 v5, 0x10000, v5
v_xor_b32 v6, 0x10000, v6
s_lshl_b32 s49, s41, 24
s_add_u32 s50, s54, s49
s_add_u32 m0, s19, 0
s_nop 0
buffer_load_dwordx4 v7, s[28:31], s50 offen offset:0 sc1 lds
buffer_load_dwordx4 v7, s[28:31], s50 offen offset:1024 sc1 lds
buffer_load_dwordx4 v7, s[28:31], s50 offen offset:2048 sc1 lds
buffer_load_dwordx4 v7, s[28:31], s50 offen offset:3072 sc1 lds
TR 32,5,0
M 116,40,180
TR 34,5,512
M 116,44,188
TR 36,5,4096
s_waitcnt lgkmcnt(9)
M 120,48,160
TR 38,5,4608
s_waitcnt lgkmcnt(8)
M 120,52,168
TR 40,5,8192
s_waitcnt lgkmcnt(7)
M 120,56,176
TR 42,5,8704
s_waitcnt lgkmcnt(6)
M 120,60,184
TR 44,5,12288
M 124,48,164
TR 46,5,12800
M 124,52,172
TR 48,6,0
M 124,56,180
TR 50,6,512
M 124,60,188
TR 52,6,4096
s_waitcnt lgkmcnt(9)
M 64,32,192
TR 54,6,4608
s_waitcnt lgkmcnt(8)
M 64,36,200
TR 56,6,8192
s_waitcnt lgkmcnt(7)
M 64,40,208
TR 58,6,8704
s_waitcnt lgkmcnt(6)
M 64,44,216
TR 60,6,12288
M 68,32,196
TR 62,6,12800
M 68,36,204
TR 32,5,256
M 68,40,212
TR 34,5,768
M 68,44,220
TR 36,5,4352
s_waitcnt lgkmcnt(9)
M 72,48,192
TR 38,5,4864
s_waitcnt lgkmcnt(8)
M 72,52,200
TR 40,5,8448
s_waitcnt lgkmcnt(7)
M 72,56,208
TR 42,5,8960
s_waitcnt lgkmcnt(6)
M 72,60,216
TR 44,5,12544
M 76,48,196
TR 46,5,13056
M 76,52,204
TR 48,6,256
M 76,56,212
TR 50,6,768
M 76,60,220
TR 52,6,4352
s_waitcnt lgkmcnt(9)
M 80,32,192
TR 54,6,4864
s_waitcnt lgkmcnt(8)
M 80,36,200
TR 56,6,8448
s_waitcnt lgkmcnt(7)
M 80,40,208
TR 58,6,8960
s_waitcnt lgkmcnt(6)
M 80,44,216
TR 60,6,12544
M 84,32,196
TR 62,6,13056
M 84,36,204
TR 32,5,16384
M 84,40,212
TR 34,5,16896
M 84,44,220
TR 36,5,20480
s_waitcnt lgkmcnt(9)
M 88,48,192
TR 38,5,20992
s_waitcnt lgkmcnt(8)
M 88,52,200
TR 40,5,24576
s_waitcnt lgkmcnt(7)
M 88,56,208
TR 42,5,25088
s_waitcnt lgkmcnt(6)
M 88,60,216
TR 44,5,28672
M 92,48,196
TR 46,5,29184
M 92,52,204
TR 48,6,16384
M 92,56,212
TR 50,6,16896
M 92,60,220
TR 52,6,20480
s_waitcnt lgkmcnt(9)
M 96,32,192
TR 54,6,20992
s_waitcnt lgkmcnt(8)
M 96,36,200
TR 56,6,24576
s_waitcnt lgkmcnt(7)
M 96,40,208
TR 58,6,25088
s_waitcnt lgkmcnt(6)
M 96,44,216
TR 60,6,28672
M 100,32,196
TR 62,6,29184
M 100,36,204
TR 32,5,16640
M 100,40,212
TR 34,5,17152
M 100,44,220
TR 36,5,20736
s_waitcnt lgkmcnt(9)
M 104,48,192
TR 38,5,21248
s_waitcnt lgkmcnt(8)
M 104,52,200
TR 40,5,24832
s_waitcnt lgkmcnt(7)
M 104,56,208
TR 42,5,25344
s_waitcnt lgkmcnt(6)
M 104,60,216
TR 44,5,28928
M 108,48,196
TR 46,5,29440
M 108,52,204
TR 48,6,16640
M 108,56,212
TR 50,6,17152
M 108,60,220
TR 52,6,20736
s_waitcnt lgkmcnt(9)
M 112,32,192
TR 54,6,21248
s_waitcnt lgkmcnt(8)
M 112,36,200
TR 56,6,24832
s_waitcnt lgkmcnt(7)
M 112,40,208
TR 58,6,25344
s_waitcnt lgkmcnt(6)
M 112,44,216
TR 60,6,28928
M 116,32,196
TR 62,6,29440
M 116,36,204
s_waitcnt vmcnt(0)
s_barrier
s_lshl_b32 s49, s41, 24
s_add_u32 s50, s54, s49
s_add_u32 s50, s50, 16384
s_add_u32 m0, s19, 32768
s_nop 0
buffer_load_dwordx4 v7, s[28:31], s50 offen offset:0 sc1 lds
buffer_load_dwordx4 v7, s[28:31], s50 offen offset:1024 sc1 lds
buffer_load_dwordx4 v7, s[28:31], s50 offen offset:2048 sc1 lds
buffer_load_dwordx4 v7, s[28:31], s50 offen offset:3072 sc1 lds
TR 32,5,32768
M 116,40,212
TR 34,5,33280
M 116,44,220
TR 36,5,36864
s_waitcnt lgkmcnt(9)
M 120,48,192
TR 38,5,37376
s_waitcnt lgkmcnt(8)
M 120,52,200
TR 40,5,40960
s_waitcnt lgkmcnt(7)
M 120,56,208
TR 42,5,41472
s_waitcnt lgkmcnt(6)
M 120,60,216
TR 44,5,45056
M 124,48,196
TR 46,5,45568
M 124,52,204
TR 48,6,32768
M 124,56,212
TR 50,6,33280
M 124,60,220
TR 52,6,36864
s_waitcnt lgkmcnt(9)
M 64,32,224
TR 54,6,37376
s_waitcnt lgkmcnt(8)
M 64,36,232
TR 56,6,40960
s_waitcnt lgkmcnt(7)
M 64,40,240
TR 58,6,41472
s_waitcnt lgkmcnt(6)
M 64,44,248
TR 60,6,45056
M 68,32,228
TR 62,6,45568
M 68,36,236
TR 32,5,33024
M 68,40,244
TR 34,5,33536
M 68,44,252
TR 36,5,37120
s_waitcnt lgkmcnt(9)
M 72,48,224
TR 38,5,37632
s_waitcnt lgkmcnt(8)
M 72,52,232
TR 40,5,41216
s_waitcnt lgkmcnt(7)
M 72,56,240
TR 42,5,41728
s_waitcnt lgkmcnt(6)
M 72,60,248
TR 44,5,45312
M 76,48,228
TR 46,5,45824
M 76,52,236
TR 48,6,33024
M 76,56,244
TR 50,6,33536
M 76,60,252
TR 52,6,37120
s_waitcnt lgkmcnt(9)
M 80,32,224
TR 54,6,37632
s_waitcnt lgkmcnt(8)
M 80,36,232
TR 56,6,41216
s_waitcnt lgkmcnt(7)
M 80,40,240
TR 58,6,41728
s_waitcnt lgkmcnt(6)
M 80,44,248
TR 60,6,45312
M 84,32,228
TR 62,6,45824
M 84,36,236
TR 32,5,49152
M 84,40,244
TR 34,5,49664
M 84,44,252
TR 36,5,53248
s_waitcnt lgkmcnt(9)
M 88,48,224
TR 38,5,53760
s_waitcnt lgkmcnt(8)
M 88,52,232
TR 40,5,57344
s_waitcnt lgkmcnt(7)
M 88,56,240
TR 42,5,57856
s_waitcnt lgkmcnt(6)
M 88,60,248
TR 44,5,61440
M 92,48,228
TR 46,5,61952
M 92,52,236
TR 48,6,49152
M 92,56,244
TR 50,6,49664
M 92,60,252
TR 52,6,53248
s_waitcnt lgkmcnt(9)
M 96,32,224
TR 54,6,53760
s_waitcnt lgkmcnt(8)
M 96,36,232
TR 56,6,57344
s_waitcnt lgkmcnt(7)
M 96,40,240
TR 58,6,57856
s_waitcnt lgkmcnt(6)
M 96,44,248
TR 60,6,61440
M 100,32,228
TR 62,6,61952
M 100,36,236
TR 32,5,49408
M 100,40,244
TR 34,5,49920
M 100,44,252
TR 36,5,53504
s_waitcnt lgkmcnt(9)
M 104,48,224
TR 38,5,54016
v_mul_f32 v64, s56, v64
v_mul_f32 v65, s56, v65
s_waitcnt lgkmcnt(8)
M 104,52,232
TR 40,5,57600
v_mul_f32 v66, s56, v66
v_mul_f32 v67, s56, v67
s_waitcnt lgkmcnt(7)
M 104,56,240
TR 42,5,58112
v_mul_f32 v72, s56, v72
v_mul_f32 v73, s56, v73
s_waitcnt lgkmcnt(6)
M 104,60,248
TR 44,5,61696
v_mul_f32 v74, s56, v74
v_mul_f32 v75, s56, v75
M 108,48,228
TR 46,5,62208
PK 64,64,65
PK 65,66,67
M 108,52,236
TR 48,6,49408
PK 66,72,73
PK 67,74,75
M 108,56,244
TR 50,6,49920
v_mul_f32 v80, s56, v80
v_mul_f32 v81, s56, v81
M 108,60,252
TR 52,6,53504
v_mul_f32 v82, s56, v82
v_mul_f32 v83, s56, v83
s_waitcnt lgkmcnt(9)
M 112,32,224
TR 54,6,54016
v_mul_f32 v88, s56, v88
v_mul_f32 v89, s56, v89
s_waitcnt lgkmcnt(8)
M 112,36,232
TR 56,6,57600
v_mul_f32 v90, s56, v90
v_mul_f32 v91, s56, v91
s_waitcnt lgkmcnt(7)
M 112,40,240
TR 58,6,58112
PK 80,80,81
PK 81,82,83
s_waitcnt lgkmcnt(6)
M 112,44,248
TR 60,6,61696
PK 82,88,89
PK 83,90,91
M 116,32,228
TR 62,6,62208
v_mul_f32 v68, s56, v68
v_mul_f32 v69, s56, v69
M 116,36,236
v_mul_f32 v70, s56, v70
v_mul_f32 v71, s56, v71
M 116,40,244
v_mul_f32 v76, s56, v76
v_mul_f32 v77, s56, v77
M 116,44,252
v_mul_f32 v78, s56, v78
v_mul_f32 v79, s56, v79
s_waitcnt lgkmcnt(6)
M 120,48,224
PK 68,68,69
PK 69,70,71
s_waitcnt lgkmcnt(4)
M 120,52,232
PK 70,76,77
PK 71,78,79
s_waitcnt lgkmcnt(2)
M 120,56,240
v_mul_f32 v84, s56, v84
v_mul_f32 v85, s56, v85
s_waitcnt lgkmcnt(0)
M 120,60,248
v_mul_f32 v86, s56, v86
v_mul_f32 v87, s56, v87
M 124,48,228
v_mul_f32 v92, s56, v92
v_mul_f32 v93, s56, v93
M 124,52,236
v_mul_f32 v94, s56, v94
v_mul_f32 v95, s56, v95
M 124,56,244
PK 84,84,85
PK 85,86,87
M 124,60,252
PK 86,92,93
PK 87,94,95
s_branch L_k2_qend
L_k2_attn:
s_lshr_b32 s44, s2, 3
s_mul_i32 s49, s44, 43
s_lshr_b32 s49, s49, 7
s_mul_i32 s50, s49, 3
s_sub_u32 s50, s44, s50
s_lshl_b32 s50, s50, 1
s_and_b32 s43, s2, 1
s_add_u32 s50, s50, s43
s_sub_u32 s43, s44, 24
s_cmp_ge_u32 s44, 24
s_cselect_b32 s49, s43, s49
s_cselect_b32 s44, 6, s50
s_and_b32 s43, s2, 6
s_and_b32 s50, s49, 1
s_add_u32 s43, s43, s50
s_lshr_b32 s49, s49, 1
s_lshl_b32 s49, s49, 3
s_add_u32 s43, s43, s49
s_sub_u32 s32, 15, s44
s_xor_b32 s33, s44, 1
s_add_u32 s33, s33, 4
s_cmp_eq_u32 s44, 6
s_cselect_b32 s32, 3, s32
s_cselect_b32 s33, 2, s33
s_lshr_b32 s41, s40, 2
s_and_b32 s42, s40, 3
s_and_b32 s49, s3, 6
s_lshl_b32 s49, s49, 20
s_add_u32 s60, s6, s49
s_addc_u32 s61, s7, 0
s_mov_b32 s62, 2097152
s_mov_b32 s63, 0x20000
s_mov_b32 s20, s4
s_mov_b32 s21, s5
s_mov_b32 s22, 4194304
s_mov_b32 s23, 0x20000
s_mov_b32 s24, s16
s_mov_b32 s25, s17
s_mov_b32 s26, 2097152
s_mov_b32 s27, 0x20000
s_add_u32 s28, s16, 2097152
s_addc_u32 s29, s17, 0
s_mov_b32 s30, 33554432
s_mov_b32 s31, 0x20000
s_add_u32 s36, s16, 46137344
s_addc_u32 s37, s17, 0
s_mov_b32 s38, 20447232
s_mov_b32 s39, 0x20000
s_lshl_b32 s55, s42, 12
s_lshl_b32 s54, s43, 19
s_add_u32 s54, s54, s55
s_lshl_b32 s57, s42, 13
s_add_u32 s57, s57, 131072
v_and_b32 v28, 63, v0
v_lshlrev_b32 v7, 4, v28
v_and_b32 v28, 15, v0
v_bfe_u32 v29, v0, 4, 2
v_lshlrev_b32 v29, 2, v29
v_sub_u32 v28, v28, v29
v_cmp_le_i32 s[8:9], 0, v28
v_cmp_le_i32 s[10:11], 1, v28
v_cmp_le_i32 s[12:13], 2, v28
v_cmp_le_i32 s[14:15], 3, v28
s_mul_i32 s49, s43, 43
s_lshr_b32 s49, s49, 7
s_lshl_b32 s49, s49, 7
s_lshl_b32 s50, s3, 13
s_add_u32 s49, s49, s50
v_and_b32 v14, 15, v0
v_lshl_add_u32 v14, v14, 2, s49
s_barrier
L_k2_round:
v_bfe_u32 v28, v0, 5, 1
v_bfe_u32 v29, v0, 2, 2
v_lshl_add_u32 v28, v28, 2, v29
v_mul_u32_u24 v28, 8192, v28
v_bfe_u32 v29, v0, 4, 1
v_lshl_add_u32 v28, v29, 6, v28
v_and_b32 v29, 3, v0
v_xor_b32 v30, 2, v29
v_lshlrev_b32 v29, 4, v29
v_lshlrev_b32 v30, 4, v30
v_add_u32 v31, 0, v28
v_add_u32 v1, v31, v29
v_add_u32 v31, 64512, v28
v_add_u32 v2, v31, v30
v_add_u32 v31, 129024, v28
v_add_u32 v3, v31, v29
v_add_u32 v31, 193536, v28
v_add_u32 v4, v31, v30
s_lshl_b32 s18, s43, 8
s_lshl_b32 s49, s42, 18
s_add_u32 s18, s18, s49
s_lshl_b32 s49, s41, 7
s_add_u32 s18, s18, s49
s_lshl_b32 s19, s40, 12
s_cmp_eq_u32 s41, 0
s_cselect_b32 s47, s32, s33
s_lshl_b32 s47, s47, 17
s_lshl_b32 s49, s42, 15
s_add_u32 s47, s47, s49
s_mov_b32 s51, 0
s_add_u32 s51, s51, 0
s_and_b32 s51, s51, 3
s_lshl_b32 s51, s51, 20
s_add_u32 s51, s51, s18
s_add_u32 m0, s19, 0
s_nop 0
buffer_load_dwordx4 v1, s[20:23], s51 offen offset:0  lds
buffer_load_dwordx4 v2, s[20:23], s51 offen offset:1024  lds
buffer_load_dwordx4 v3, s[20:23], s51 offen offset:2048  lds
buffer_load_dwordx4 v4, s[20:23], s51 offen offset:3072  lds
s_mov_b32 s6, 0
s_add_u32 s6, s6, 0
s_and_b32 s6, s6, 3
s_lshl_b32 s6, s6, 12
s_add_u32 s6, s6, s47
s_add_u32 s7, s6, 16384
buffer_load_dwordx4 v[128:131], v7, s[24:27], s6 offen offset:0 sc1
buffer_load_dwordx4 v[132:135], v7, s[24:27], s7 offen offset:0 sc1
buffer_load_dwordx4 v[136:139], v7, s[24:27], s6 offen offset:1024 sc1
buffer_load_dwordx4 v[140:143], v7, s[24:27], s7 offen offset:1024 sc1
s_barrier
buffer_load_dwordx4 v[144:147], v7, s[24:27], s6 offen offset:2048 sc1
buffer_load_dwordx4 v[148:151], v7, s[24:27], s7 offen offset:2048 sc1
buffer_load_dwordx4 v[152:155], v7, s[24:27], s6 offen offset:3072 sc1
buffer_load_dwordx4 v[156:159], v7, s[24:27], s7 offen offset:3072 sc1
v_bfe_u32 v28, v0, 4, 2
v_lshlrev_b32 v29, 10, v28
v_bfe_u32 v30, v0, 2, 2
v_lshl_add_u32 v29, v30, 6, v29
v_and_b32 v30, 3, v0
v_lshl_add_u32 v29, v30, 3, v29
v_and_b32 v28, 1, v28
v_lshl_add_u32 v5, v28, 5, v29
v_xor_b32 v6, 32, v5
s_mov_b32 s56, 1040356334
s_lshl_b32 s48, s32, 1
s_add_u32 s48, s48, 2
s_lshl_b32 s45, s33, 1
s_add_u32 s45, s45, 2
s_sub_u32 s53, s45, s41
s_sub_u32 s46, s45, 2
s_cmp_eq_u32 s41, 0
s_cselect_b32 s46, 0x1000, s46
s_waitcnt vmcnt(8)
s_barrier
s_cmp_eq_u32 s32, 1
s_cselect_b32 s49, 1, s40
s_cmp_lg_u32 s49, 0
s_cbranch_scc1 L_w0_74
v_lshlrev_b32 v10, 13, v0
v_add_u32 v10, s58, v10
v_mov_b32 v11, s59
s_mov_b64 exec, 0xff
global_store_dword v10, v11, s[100:101] sc1
s_mov_b64 exec, -1
L_w0_74:
TR 32,5,0
TR 34,5,512
TR 36,5,4096
TR 38,5,4608
TR 40,5,8192
TR 42,5,8704
TR 44,5,12288
TR 46,5,12800
TR 48,6,0
TR 50,6,512
TR 52,6,4096
TR 54,6,4608
TR 56,6,8192
TR 58,6,8704
TR 60,6,12288
TR 62,6,12800
s_waitcnt vmcnt(6)
s_waitcnt lgkmcnt(14)
MZ 64,32,128
s_waitcnt vmcnt(4)
s_waitcnt lgkmcnt(12)
M 64,36,136
s_mov_b32 s51, 0
s_add_u32 s51, s51, 1
s_and_b32 s51, s51, 3
s_lshl_b32 s51, s51, 20
s_add_u32 s51, s51, s18
s_add_u32 m0, s19, 32768
s_nop 0
buffer_load_dwordx4 v1, s[20:23], s51 offen offset:0  lds
buffer_load_dwordx4 v2, s[20:23], s51 offen offset:1024  lds
buffer_load_dwordx4 v3, s[20:23], s51 offen offset:2048  lds
buffer_load_dwordx4 v4, s[20:23], s51 offen offset:3072  lds
s_waitcnt vmcnt(6)
s_waitcnt lgkmcnt(10)
M 64,40,144
s_waitcnt vmcnt(4)
s_waitcnt lgkmcnt(8)
M 64,44,152
MZ 68,32,132
M 68,36,140
TR 32,5,256
M 68,40,148
TR 34,5,768
M 68,44,156
TR 36,5,4352
s_waitcnt lgkmcnt(9)
MZ 72,48,128
TR 38,5,4864
s_waitcnt lgkmcnt(8)
M 72,52,136
TR 40,5,8448
s_mov_b32 s6, 0
s_add_u32 s6, s6, 1
s_and_b32 s6, s6, 3
s_lshl_b32 s6, s6, 12
s_add_u32 s6, s6, s47
s_add_u32 s7, s6, 16384
buffer_load_dwordx4 v[160:163], v7, s[24:27], s6 offen offset:0 sc1
buffer_load_dwordx4 v[164:167], v7, s[24:27], s7 offen offset:0 sc1
s_waitcnt lgkmcnt(7)
M 72,56,144
TR 42,5,8960
s_waitcnt lgkmcnt(6)
M 72,60,152
TR 44,5,12544
MZ 76,48,132
TR 46,5,13056
M 76,52,140
TR 48,6,256
M 76,56,148
TR 50,6,768
M 76,60,156
TR 52,6,4352
s_waitcnt lgkmcnt(9)
MZ 80,32,128
TR 54,6,4864
s_waitcnt lgkmcnt(8)
M 80,36,136
TR 56,6,8448
buffer_load_dwordx4 v[168:171], v7, s[24:27], s6 offen offset:1024 sc1
buffer_load_dwordx4 v[172:175], v7, s[24:27], s7 offen offset:1024 sc1
s_waitcnt lgkmcnt(7)
M 80,40,144
TR 58,6,8960
s_waitcnt lgkmcnt(6)
M 80,44,152
TR 60,6,12544
MZ 84,32,132
TR 62,6,13056
M 84,36,140
TR 32,5,16384
M 84,40,148
TR 34,5,16896
M 84,44,156
TR 36,5,20480
s_waitcnt lgkmcnt(9)
MZ 88,48,128
TR 38,5,20992
s_waitcnt lgkmcnt(8)
M 88,52,136
TR 40,5,24576
buffer_load_dwordx4 v[176:179], v7, s[24:27], s6 offen offset:2048 sc1
buffer_load_dwordx4 v[180:183], v7, s[24:27], s7 offen offset:2048 sc1
s_waitcnt lgkmcnt(7)
M 88,56,144
TR 42,5,25088
s_waitcnt lgkmcnt(6)
M 88,60,152
TR 44,5,28672
MZ 92,48,132
TR 46,5,29184
M 92,52,140
TR 48,6,16384
M 92,56,148
TR 50,6,16896
M 92,60,156
TR 52,6,20480
s_waitcnt lgkmcnt(9)
MZ 96,32,128
TR 54,6,20992
s_waitcnt lgkmcnt(8)
M 96,36,136
TR 56,6,24576
buffer_load_dwordx4 v[184:187], v7, s[24:27], s6 offen offset:3072 sc1
buffer_load_dwordx4 v[188:191], v7, s[24:27], s7 offen offset:3072 sc1
s_waitcnt lgkmcnt(7)
M 96,40,144
TR 58,6,25088
s_waitcnt lgkmcnt(6)
M 96,44,152
TR 60,6,28672
MZ 100,32,132
TR 62,6,29184
M 100,36,140
TR 32,5,16640
M 100,40,148
TR 34,5,17152
M 100,44,156
TR 36,5,20736
s_waitcnt lgkmcnt(9)
MZ 104,48,128
TR 38,5,21248
s_waitcnt lgkmcnt(8)
M 104,52,136
TR 40,5,24832
s_cmp_eq_u32 s32, 1
s_cselect_b32 s49, 1, s40
s_cmp_lg_u32 s49, 0
s_cbranch_scc1 L_w0_75
global_load_dword v13, v14, s[100:101] sc1
L_w0_75:
s_waitcnt lgkmcnt(7)
M 104,56,144
TR 42,5,25344
s_waitcnt lgkmcnt(6)
M 104,60,152
TR 44,5,28928
MZ 108,48,132
TR 46,5,29440
M 108,52,140
TR 48,6,16640
s_mov_b32 s51, 0
s_add_u32 s51, s51, 2
s_and_b32 s51, s51, 3
s_lshl_b32 s51, s51, 20
s_add_u32 s51, s51, s18
s_add_u32 m0, s19, 65536
s_nop 0
buffer_load_dwordx4 v1, s[20:23], s51 offen offset:0  lds
buffer_load_dwordx4 v2, s[20:23], s51 offen offset:1024  lds
buffer_load_dwordx4 v3, s[20:23], s51 offen offset:2048  lds
buffer_load_dwordx4 v4, s[20:23], s51 offen offset:3072  lds
M 108,56,148
TR 50,6,17152
M 108,60,156
TR 52,6,20736
s_waitcnt lgkmcnt(9)
MZ 112,32,128
TR 54,6,21248
s_waitcnt lgkmcnt(8)
M 112,36,136
TR 56,6,24832
s_waitcnt lgkmcnt(7)
M 112,40,144
TR 58,6,25344
s_waitcnt lgkmcnt(6)
M 112,44,152
TR 60,6,28928
MZ 116,32,132
TR 62,6,29440
M 116,36,140
s_waitcnt vmcnt(12)
s_barrier
TR 32,5,32768
M 116,40,148
TR 34,5,33280
M 116,44,156
TR 36,5,36864
s_waitcnt lgkmcnt(9)
MZ 120,48,128
TR 38,5,37376
s_waitcnt lgkmcnt(8)
M 120,52,136
TR 40,5,40960
s_mov_b32 s6, 0
s_add_u32 s6, s6, 2
s_and_b32 s6, s6, 3
s_lshl_b32 s6, s6, 12
s_add_u32 s6, s6, s47
s_add_u32 s7, s6, 16384
buffer_load_dwordx4 v[192:195], v7, s[24:27], s6 offen offset:0 sc1
buffer_load_dwordx4 v[196:199], v7, s[24:27], s7 offen offset:0 sc1
s_waitcnt lgkmcnt(7)
M 120,56,144
TR 42,5,41472
s_waitcnt lgkmcnt(6)
M 120,60,152
TR 44,5,45056
MZ 124,48,132
TR 46,5,45568
M 124,52,140
TR 48,6,32768
M 124,56,148
TR 50,6,33280
M 124,60,156
TR 52,6,36864
s_waitcnt vmcnt(12)
s_waitcnt lgkmcnt(9)
M 64,32,160
TR 54,6,37376
s_waitcnt vmcnt(10)
s_waitcnt lgkmcnt(8)
M 64,36,168
TR 56,6,40960
s_waitcnt vmcnt(8)
s_waitcnt lgkmcnt(7)
M 64,40,176
TR 58,6,41472
s_waitcnt vmcnt(6)
s_waitcnt lgkmcnt(6)
M 64,44,184
TR 60,6,45056
M 68,32,164
TR 62,6,45568
M 68,36,172
TR 32,5,33024
buffer_load_dwordx4 v[200:203], v7, s[24:27], s6 offen offset:1024 sc1
buffer_load_dwordx4 v[204:207], v7, s[24:27], s7 offen offset:1024 sc1
M 68,40,180
TR 34,5,33536
M 68,44,188
TR 36,5,37120
s_waitcnt lgkmcnt(9)
M 72,48,160
TR 38,5,37632
s_waitcnt lgkmcnt(8)
M 72,52,168
TR 40,5,41216
s_waitcnt lgkmcnt(7)
M 72,56,176
TR 42,5,41728
s_waitcnt lgkmcnt(6)
M 72,60,184
TR 44,5,45312
M 76,48,164
TR 46,5,45824
M 76,52,172
TR 48,6,33024
M 76,56,180
TR 50,6,33536
M 76,60,188
TR 52,6,37120
s_waitcnt lgkmcnt(9)
M 80,32,160
TR 54,6,37632
s_waitcnt lgkmcnt(8)
M 80,36,168
TR 56,6,41216
buffer_load_dwordx4 v[208:211], v7, s[24:27], s6 offen offset:2048 sc1
buffer_load_dwordx4 v[212:215], v7, s[24:27], s7 offen offset:2048 sc1
s_waitcnt lgkmcnt(7)
M 80,40,176
TR 58,6,41728
s_waitcnt lgkmcnt(6)
M 80,44,184
TR 60,6,45312
M 84,32,164
TR 62,6,45824
M 84,36,172
TR 32,5,49152
M 84,40,180
TR 34,5,49664
M 84,44,188
TR 36,5,53248
s_waitcnt lgkmcnt(9)
M 88,48,160
TR 38,5,53760
s_waitcnt lgkmcnt(8)
M 88,52,168
TR 40,5,57344
s_waitcnt lgkmcnt(7)
M 88,56,176
TR 42,5,57856
s_waitcnt lgkmcnt(6)
M 88,60,184
TR 44,5,61440
M 92,48,164
TR 46,5,61952
M 92,52,172
TR 48,6,49152
buffer_load_dwordx4 v[216:219], v7, s[24:27], s6 offen offset:3072 sc1
buffer_load_dwordx4 v[220:223], v7, s[24:27], s7 offen offset:3072 sc1
M 92,56,180
TR 50,6,49664
M 92,60,188
TR 52,6,53248
s_waitcnt lgkmcnt(9)
M 96,32,160
TR 54,6,53760
s_waitcnt lgkmcnt(8)
M 96,36,168
TR 56,6,57344
s_waitcnt lgkmcnt(7)
M 96,40,176
TR 58,6,57856
s_waitcnt lgkmcnt(6)
M 96,44,184
TR 60,6,61440
M 100,32,164
TR 62,6,61952
M 100,36,172
TR 32,5,49408
s_mov_b32 s51, 0
s_add_u32 s51, s51, 3
s_and_b32 s51, s51, 3
s_lshl_b32 s51, s51, 20
s_add_u32 s51, s51, s18
s_add_u32 m0, s19, 98304
s_nop 0
buffer_load_dwordx4 v1, s[20:23], s51 offen offset:0  lds
buffer_load_dwordx4 v2, s[20:23], s51 offen offset:1024  lds
buffer_load_dwordx4 v3, s[20:23], s51 offen offset:2048  lds
buffer_load_dwordx4 v4, s[20:23], s51 offen offset:3072  lds
M 100,40,180
TR 34,5,49920
M 100,44,188
TR 36,5,53504
s_waitcnt lgkmcnt(9)
M 104,48,160
TR 38,5,54016
s_waitcnt lgkmcnt(8)
M 104,52,168
TR 40,5,57600
s_waitcnt lgkmcnt(7)
M 104,56,176
TR 42,5,58112
s_waitcnt lgkmcnt(6)
M 104,60,184
TR 44,5,61696
M 108,48,164
TR 46,5,62208
M 108,52,172
TR 48,6,49408
M 108,56,180
TR 50,6,49920
M 108,60,188
TR 52,6,53504
s_waitcnt lgkmcnt(9)
M 112,32,160
TR 54,6,54016
s_waitcnt lgkmcnt(8)
M 112,36,168
TR 56,6,57600
s_mov_b32 s6, 0
s_add_u32 s6, s6, 3
s_and_b32 s6, s6, 3
s_lshl_b32 s6, s6, 12
s_add_u32 s6, s6, s47
s_add_u32 s7, s6, 16384
buffer_load_dwordx4 v[224:227], v7, s[24:27], s6 offen offset:0 sc1
buffer_load_dwordx4 v[228:231], v7, s[24:27], s7 offen offset:0 sc1
s_waitcnt lgkmcnt(7)
M 112,40,176
TR 58,6,58112
s_waitcnt lgkmcnt(6)
M 112,44,184
TR 60,6,61696
M 116,32,164
TR 62,6,62208
M 116,36,172
s_waitcnt vmcnt(14)
s_cmp_eq_u32 s32, 1
s_cselect_b32 s49, 1, s40
s_cmp_lg_u32 s49, 0
s_cbranch_scc1 L_w0_76
s_branch L_chk_78
L_spin_77:
s_sleep 8
global_load_dword v13, v14, s[100:101] sc1
s_waitcnt vmcnt(0)
L_chk_78:
v_cmp_ne_u32 vcc, s59, v13
s_cbranch_vccnz L_spin_77
L_w0_76:
s_barrier
v_xor_b32 v5, 0x10000, v5
v_xor_b32 v6, 0x10000, v6
s_lshl_b32 s49, s41, 24
s_add_u32 s50, s54, s49
s_add_u32 m0, s19, 0
s_nop 0
buffer_load_dwordx4 v7, s[28:31], s50 offen offset:0 sc1 lds
buffer_load_dwordx4 v7, s[28:31], s50 offen offset:1024 sc1 lds
buffer_load_dwordx4 v7, s[28:31], s50 offen offset:2048 sc1 lds
buffer_load_dwordx4 v7, s[28:31], s50 offen offset:3072 sc1 lds
TR 32,5,0
M 116,40,180
TR 34,5,512
M 116,44,188
TR 36,5,4096
s_waitcnt lgkmcnt(9)
M 120,48,160
TR 38,5,4608
s_waitcnt lgkmcnt(8)
M 120,52,168
TR 40,5,8192
s_waitcnt lgkmcnt(7)
M 120,56,176
TR 42,5,8704
s_waitcnt lgkmcnt(6)
M 120,60,184
TR 44,5,12288
M 124,48,164
TR 46,5,12800
M 124,52,172
TR 48,6,0
buffer_load_dwordx4 v[232:235], v7, s[24:27], s6 offen offset:1024 sc1
buffer_load_dwordx4 v[236:239], v7, s[24:27], s7 offen offset:1024 sc1
M 124,56,180
TR 50,6,512
M 124,60,188
TR 52,6,4096
s_waitcnt vmcnt(18)
s_waitcnt lgkmcnt(9)
M 64,32,192
TR 54,6,4608
s_waitcnt vmcnt(16)
s_waitcnt lgkmcnt(8)
M 64,36,200
TR 56,6,8192
s_waitcnt vmcnt(14)
s_waitcnt lgkmcnt(7)
M 64,40,208
TR 58,6,8704
s_waitcnt vmcnt(12)
s_waitcnt lgkmcnt(6)
M 64,44,216
TR 60,6,12288
M 68,32,196
TR 62,6,12800
M 68,36,204
TR 32,5,256
M 68,40,212
TR 34,5,768
M 68,44,220
TR 36,5,4352
s_waitcnt lgkmcnt(9)
M 72,48,192
TR 38,5,4864
s_waitcnt lgkmcnt(8)
M 72,52,200
TR 40,5,8448
buffer_load_dwordx4 v[240:243], v7, s[24:27], s6 offen offset:2048 sc1
buffer_load_dwordx4 v[244:247], v7, s[24:27], s7 offen offset:2048 sc1
s_waitcnt lgkmcnt(7)
M 72,56,208
TR 42,5,8960
s_waitcnt lgkmcnt(6)
M 72,60,216
TR 44,5,12544
M 76,48,196
TR 46,5,13056
M 76,52,204
TR 48,6,256
M 76,56,212
TR 50,6,768
M 76,60,220
TR 52,6,4352
s_waitcnt lgkmcnt(9)
M 80,32,192
TR 54,6,4864
s_waitcnt lgkmcnt(8)
M 80,36,200
TR 56,6,8448
s_waitcnt lgkmcnt(7)
M 80,40,208
TR 58,6,8960
s_waitcnt lgkmcnt(6)
M 80,44,216
TR 60,6,12544
M 84,32,196
TR 62,6,13056
M 84,36,204
TR 32,5,16384
buffer_load_dwordx4 v[248:251], v7, s[24:27], s6 offen offset:3072 sc1
buffer_load_dwordx4 v[252:255], v7, s[24:27], s7 offen offset:3072 sc1
M 84,40,212
TR 34,5,16896
M 84,44,220
TR 36,5,20480
s_waitcnt lgkmcnt(9)
M 88,48,192
TR 38,5,20992
s_waitcnt lgkmcnt(8)
M 88,52,200
TR 40,5,24576
s_waitcnt lgkmcnt(7)
M 88,56,208
TR 42,5,25088
s_waitcnt lgkmcnt(6)
M 88,60,216
TR 44,5,28672
M 92,48,196
TR 46,5,29184
M 92,52,204
TR 48,6,16384
M 92,56,212
TR 50,6,16896
M 92,60,220
TR 52,6,20480
s_waitcnt lgkmcnt(9)
M 96,32,192
TR 54,6,20992
s_waitcnt lgkmcnt(8)
M 96,36,200
TR 56,6,24576
s_waitcnt lgkmcnt(7)
M 96,40,208
TR 58,6,25088
s_waitcnt lgkmcnt(6)
M 96,44,216
TR 60,6,28672
M 100,32,196
TR 62,6,29184
M 100,36,204
TR 32,5,16640
M 100,40,212
TR 34,5,17152
M 100,44,220
TR 36,5,20736
s_waitcnt lgkmcnt(9)
M 104,48,192
TR 38,5,21248
s_waitcnt lgkmcnt(8)
M 104,52,200
TR 40,5,24832
s_waitcnt lgkmcnt(7)
M 104,56,208
TR 42,5,25344
s_waitcnt lgkmcnt(6)
M 104,60,216
TR 44,5,28928
M 108,48,196
TR 46,5,29440
M 108,52,204
TR 48,6,16640
M 108,56,212
TR 50,6,17152
M 108,60,220
TR 52,6,20736
s_waitcnt lgkmcnt(9)
M 112,32,192
TR 54,6,21248
s_waitcnt lgkmcnt(8)
M 112,36,200
TR 56,6,24832
s_waitcnt lgkmcnt(7)
M 112,40,208
TR 58,6,25344
s_waitcnt lgkmcnt(6)
M 112,44,216
TR 60,6,28928
M 116,32,196
TR 62,6,29440
M 116,36,204
s_waitcnt vmcnt(6)
s_barrier
s_lshl_b32 s49, s41, 24
s_add_u32 s50, s54, s49
s_add_u32 s50, s50, 16384
s_add_u32 m0, s19, 32768
s_nop 0
buffer_load_dwordx4 v7, s[28:31], s50 offen offset:0 sc1 lds
buffer_load_dwordx4 v7, s[28:31], s50 offen offset:1024 sc1 lds
buffer_load_dwordx4 v7, s[28:31], s50 offen offset:2048 sc1 lds
buffer_load_dwordx4 v7, s[28:31], s50 offen offset:3072 sc1 lds
TR 32,5,32768
M 116,40,212
TR 34,5,33280
M 116,44,220
TR 36,5,36864
s_waitcnt lgkmcnt(9)
M 120,48,192
TR 38,5,37376
s_waitcnt lgkmcnt(8)
M 120,52,200
TR 40,5,40960
s_waitcnt lgkmcnt(7)
M 120,56,208
TR 42,5,41472
s_waitcnt lgkmcnt(6)
M 120,60,216
TR 44,5,45056
M 124,48,196
TR 46,5,45568
M 124,52,204
TR 48,6,32768
M 124,56,212
TR 50,6,33280
M 124,60,220
TR 52,6,36864
s_waitcnt lgkmcnt(9)
M 64,32,224
TR 54,6,37376
s_waitcnt vmcnt(8)
s_waitcnt lgkmcnt(8)
M 64,36,232
TR 56,6,40960
s_waitcnt vmcnt(6)
s_waitcnt lgkmcnt(7)
M 64,40,240
TR 58,6,41472
s_waitcnt vmcnt(4)
s_waitcnt lgkmcnt(6)
M 64,44,248
TR 60,6,45056
M 68,32,228
TR 62,6,45568
M 68,36,236
TR 32,5,33024
M 68,40,244
TR 34,5,33536
M 68,44,252
TR 36,5,37120
s_waitcnt lgkmcnt(9)
M 72,48,224
TR 38,5,37632
s_waitcnt lgkmcnt(8)
M 72,52,232
TR 40,5,41216
s_waitcnt lgkmcnt(7)
M 72,56,240
TR 42,5,41728
s_waitcnt lgkmcnt(6)
M 72,60,248
TR 44,5,45312
M 76,48,228
TR 46,5,45824
M 76,52,236
TR 48,6,33024
M 76,56,244
TR 50,6,33536
M 76,60,252
TR 52,6,37120
s_waitcnt lgkmcnt(9)
M 80,32,224
TR 54,6,37632
s_waitcnt lgkmcnt(8)
M 80,36,232
TR 56,6,41216
s_waitcnt lgkmcnt(7)
M 80,40,240
TR 58,6,41728
s_waitcnt lgkmcnt(6)
M 80,44,248
TR 60,6,45312
M 84,32,228
TR 62,6,45824
M 84,36,236
TR 32,5,49152
M 84,40,244
TR 34,5,49664
M 84,44,252
TR 36,5,53248
s_waitcnt lgkmcnt(9)
M 88,48,224
TR 38,5,53760
s_waitcnt lgkmcnt(8)
M 88,52,232
TR 40,5,57344
s_waitcnt lgkmcnt(7)
M 88,56,240
TR 42,5,57856
s_waitcnt lgkmcnt(6)
M 88,60,248
TR 44,5,61440
M 92,48,228
TR 46,5,61952
M 92,52,236
TR 48,6,49152
M 92,56,244
TR 50,6,49664
M 92,60,252
TR 52,6,53248
s_waitcnt lgkmcnt(9)
M 96,32,224
TR 54,6,53760
s_waitcnt lgkmcnt(8)
M 96,36,232
TR 56,6,57344
s_waitcnt lgkmcnt(7)
M 96,40,240
TR 58,6,57856
s_waitcnt lgkmcnt(6)
M 96,44,248
TR 60,6,61440
M 100,32,228
TR 62,6,61952
M 100,36,236
TR 32,5,49408
M 100,40,244
TR 34,5,49920
M 100,44,252
TR 36,5,53504
s_waitcnt lgkmcnt(9)
M 104,48,224
TR 38,5,54016
v_mul_f32 v64, s56, v64
v_mul_f32 v65, s56, v65
s_waitcnt lgkmcnt(8)
M 104,52,232
TR 40,5,57600
v_mul_f32 v66, s56, v66
v_mul_f32 v67, s56, v67
s_waitcnt lgkmcnt(7)
M 104,56,240
TR 42,5,58112
v_mul_f32 v72, s56, v72
v_mul_f32 v73, s56, v73
s_waitcnt lgkmcnt(6)
M 104,60,248
TR 44,5,61696
v_mul_f32 v74, s56, v74
v_mul_f32 v75, s56, v75
M 108,48,228
TR 46,5,62208
PK 64,64,65
PK 65,66,67
M 108,52,236
TR 48,6,49408
PK 66,72,73
PK 67,74,75
M 108,56,244
TR 50,6,49920
v_mul_f32 v80, s56, v80
v_mul_f32 v81, s56, v81
M 108,60,252
TR 52,6,53504
v_mul_f32 v82, s56, v82
v_mul_f32 v83, s56, v83
s_waitcnt lgkmcnt(9)
M 112,32,224
TR 54,6,54016
v_mul_f32 v88, s56, v88
v_mul_f32 v89, s56, v89
s_waitcnt lgkmcnt(8)
M 112,36,232
TR 56,6,57600
v_mul_f32 v90, s56, v90
v_mul_f32 v91, s56, v91
s_waitcnt lgkmcnt(7)
M 112,40,240
TR 58,6,58112
PK 80,80,81
PK 81,82,83
s_waitcnt lgkmcnt(6)
M 112,44,248
TR 60,6,61696
PK 82,88,89
PK 83,90,91
M 116,32,228
TR 62,6,62208
v_mul_f32 v68, s56, v68
v_mul_f32 v69, s56, v69
M 116,36,236
v_mul_f32 v70, s56, v70
v_mul_f32 v71, s56, v71
M 116,40,244
v_mul_f32 v76, s56, v76
v_mul_f32 v77, s56, v77
M 116,44,252
v_mul_f32 v78, s56, v78
v_mul_f32 v79, s56, v79
s_waitcnt lgkmcnt(6)
M 120,48,224
PK 68,68,69
PK 69,70,71
s_waitcnt lgkmcnt(4)
M 120,52,232
PK 70,76,77
PK 71,78,79
s_waitcnt lgkmcnt(2)
M 120,56,240
v_mul_f32 v84, s56, v84
v_mul_f32 v85, s56, v85
s_waitcnt lgkmcnt(0)
M 120,60,248
v_mul_f32 v86, s56, v86
v_mul_f32 v87, s56, v87
M 124,48,228
v_mul_f32 v92, s56, v92
v_mul_f32 v93, s56, v93
M 124,52,236
v_mul_f32 v94, s56, v94
v_mul_f32 v95, s56, v95
M 124,56,244
PK 84,84,85
PK 85,86,87
M 124,60,252
PK 86,92,93
PK 87,94,95
L_k2_qend:
s_mov_b32 s47, 0
s_and_b32 s19, s47, 3
s_lshl_b32 s19, s19, 15
s_xor_b32 s50, s19, 0x10000
s_add_u32 s50, s50, s55
s_add_u32 s49, s47, 2
s_lshl_b32 s51, s49, 14
s_add_u32 s51, s51, s54
s_cmp_lt_u32 s49, s48
s_cselect_b32 s51, s51, s54
s_cmp_lt_u32 s47, s45
s_cselect_b32 s49, s41, 0
s_lshl_b32 s7, s49, 14
s_add_u32 m0, s50, s7
s_lshl_b32 s49, s49, 24
s_add_u32 s7, s51, s49
s_add_u32 s51, s51, 16777216
s_mov_b32 s52, s47
v_add_u32 v1, s19, v7
DR 192,1,0
DR 224,1,1024
DR 196,1,2048
DR 228,1,3072
DR 200,1,4096
DR 232,1,5120
DR 204,1,6144
DR 236,1,7168
DR 208,1,8192
DR 240,1,9216
DR 212,1,10240
DR 244,1,11264
DR 216,1,12288
DR 248,1,13312
DR 220,1,14336
DR 252,1,15360
v_mul_f32 v96, s56, v96
v_mul_f32 v97, s56, v97
v_mul_f32 v98, s56, v98
v_mul_f32 v99, s56, v99
v_mul_f32 v104, s56, v104
v_mul_f32 v105, s56, v105
v_mul_f32 v106, s56, v106
v_mul_f32 v107, s56, v107
PK 96,96,97
PK 97,98,99
PK 98,104,105
PK 99,106,107
v_mul_f32 v112, s56, v112
v_mul_f32 v113, s56, v113
v_mul_f32 v114, s56, v114
v_mul_f32 v115, s56, v115
v_mul_f32 v120, s56, v120
v_mul_f32 v121, s56, v121
v_mul_f32 v122, s56, v122
v_mul_f32 v123, s56, v123
PK 112,112,113
PK 113,114,115
PK 114,120,121
PK 115,122,123
v_mul_f32 v100, s56, v100
v_mul_f32 v101, s56, v101
v_mul_f32 v102, s56, v102
v_mul_f32 v103, s56, v103
v_mul_f32 v108, s56, v108
v_mul_f32 v109, s56, v109
v_mul_f32 v110, s56, v110
v_mul_f32 v111, s56, v111
PK 100,100,101
PK 101,102,103
PK 102,108,109
PK 103,110,111
v_mul_f32 v116, s56, v116
v_mul_f32 v117, s56, v117
v_mul_f32 v118, s56, v118
v_mul_f32 v119, s56, v119
v_mul_f32 v124, s56, v124
v_mul_f32 v125, s56, v125
v_mul_f32 v126, s56, v126
v_mul_f32 v127, s56, v127
PK 116,116,117
PK 117,118,119
PK 118,124,125
PK 119,126,127
v_mov_b32 v3, 4048155338
s_mov_b32 s56, 1434451968
s_mov_b32 s6, 696254464
v_mov_b32 v16, 0
v_mov_b32 v17, 0
v_mov_b32 v18, 0
v_mov_b32 v19, 0
v_mov_b32 v20, 0
v_mov_b32 v21, 0
v_mov_b32 v22, 0
v_mov_b32 v23, 0
v_add_u32 v9, s57, v7
s_load_dwordx2 s[96:97], s[0:1], 40
s_load_dwordx2 s[34:35], s[0:1], 80
s_and_b32 s5, s2, 0xf8
s_add_u32 s5, s5, s40
s_and_b32 s49, s2, 1
s_mul_i32 s49, s49, 192
s_add_u32 s5, s5, s49
s_lshr_b32 s4, s3, 1
s_mul_i32 s4, s4, 448
s_add_u32 s4, s4, s5
s_cmp_eq_u32 s32, 1
s_cselect_b32 s49, 0x10000, 0
v_lshl_add_u32 v15, v7, 3, s49
v_mov_b32 v13, 0x10000000
v_cmp_gt_u32 vcc, 4736, v15
s_mul_i32 s49, s5, 4736
v_add_u32 v10, s49, v15
v_cndmask_b32 v10, v13, v10, vcc
v_cmp_gt_u32 vcc, 2432, v15
s_mul_i32 s49, s4, 2432
v_add_u32 v11, s49, v15
v_cndmask_b32 v11, v13, v11, vcc
v_cmp_gt_u32 vcc, 512, v15
s_mul_i32 s49, s4, 512
v_add_u32 v12, s49, v15
v_cndmask_b32 v12, v13, v12, vcc
s_waitcnt vmcnt(0) lgkmcnt(0)
s_cmp_eq_u32 s41, 0
s_cbranch_scc1 L_qa_79
s_barrier
L_qa_79:
MC 72,192,64,16
M 72,224,80
s_add_u32 s49, s52, 2
M 72,196,96
M 72,228,112
s_cmp_ge_u32 s49, s48
s_cselect_b32 s4, 0, 4
MC 76,192,68,20
M 76,224,84
s_sub_u32 s49, s52, s46
M 76,196,100
DR 192,1,16384
M 76,228,116
s_min_u32 s4, s4, s49
MC 88,200,64,16
DR 224,1,24576
M 88,232,80
s_cmp_lt_u32 s52, s53
s_cselect_b32 s47, 1, 2
M 88,204,96
DR 196,1,17408
M 88,236,112
s_add_u32 s47, s47, s52
MC 92,200,68,20
DR 228,1,25600
M 92,232,84
M 92,204,100
DR 200,1,18432
M 92,236,116
MC 104,208,64,16
DR 232,1,26624
M 104,240,80
M 104,212,96
DR 204,1,19456
M 104,244,112
MC 108,208,68,20
DR 236,1,27648
M 108,240,84
M 108,212,100
DR 208,1,20480
M 108,244,116
MC 120,216,64,16
DR 240,1,28672
M 120,248,80
M 120,220,96
DR 212,1,21504
M 120,252,112
s_cmp_eq_u32 s41, 0
s_cbranch_scc0 L_nost_80
DW 9,64,0
DW 9,80,1024
DW 9,96,2048
DW 9,112,3072
DW 9,68,4096
DW 9,84,5120
DW 9,100,6144
DW 9,116,7168
L_nost_80:
s_setprio 2
s_barrier
MC 124,216,68,20
DR 244,1,29696
buffer_load_dwordx4 v7, s[28:31], s7 offen offset:0 sc1 lds
M 124,248,84
DR 216,1,22528
buffer_load_dwordx4 v7, s[28:31], s7 offen offset:1024 sc1 lds
M 124,220,100
DR 248,1,30720
buffer_load_dwordx4 v7, s[28:31], s7 offen offset:2048 sc1 lds
M 124,252,116
DR 220,1,23552
buffer_load_dwordx4 v7, s[28:31], s7 offen offset:3072 sc1 lds
s_mov_b32 s98, 4194304
s_mov_b32 s99, 0x20000
buffer_load_dword v13, v10, s[60:63], 0 offen
buffer_load_dword v13, v11, s[96:99], 0 offen
s_mov_b32 s96, s34
s_mov_b32 s97, s35
s_mov_b32 s98, 917504
s_mov_b32 s99, 0x20000
buffer_load_dword v13, v12, s[96:99], 0 offen
s_and_b32 s19, s47, 3
s_lshl_b32 s19, s19, 15
s_xor_b32 s50, s19, 0x10000
s_add_u32 s50, s50, s55
s_add_u32 s49, s47, 2
s_lshl_b32 s51, s49, 14
s_add_u32 s51, s51, s54
s_cmp_lt_u32 s49, s48
s_cselect_b32 s51, s51, s54
s_cmp_lt_u32 s47, s45
s_cselect_b32 s49, s41, 0
s_lshl_b32 s7, s49, 14
s_add_u32 m0, s50, s7
s_lshl_b32 s49, s49, 24
s_add_u32 s7, s51, s49
s_add_u32 s51, s51, 16777216
DR 252,1,31744
s_setprio 0
s_cmp_lt_u32 s4, 4
s_cbranch_scc1 L_k2_sgen
v_exp_f32 v40, v72
v_exp_f32 v41, v73
v_exp_f32 v42, v74
v_exp_f32 v43, v75
v_exp_f32 v44, v76
v_exp_f32 v45, v77
v_exp_f32 v46, v78
v_exp_f32 v47, v79
v_add_f32 v8, v40, v41
v_add_f32 v9, v44, v45
PK 24,40,41
PK 32,44,45
v_add_f32 v8, v8, v42
v_add_f32 v9, v9, v46
PK 25,42,43
PK 33,46,47
v_add_f32 v8, v8, v43
v_add_f32 v9, v9, v47
v_exp_f32 v40, v88
v_exp_f32 v41, v89
v_exp_f32 v42, v90
v_exp_f32 v43, v91
v_add_f32 v8, v8, v40
v_add_f32 v8, v8, v41
PK 26,40,41
v_add_f32 v8, v8, v42
v_add_f32 v8, v8, v43
PK 27,42,43
v_exp_f32 v44, v92
v_exp_f32 v45, v93
v_exp_f32 v46, v94
v_exp_f32 v47, v95
v_add_f32 v9, v9, v44
v_add_f32 v9, v9, v45
PK 34,44,45
v_add_f32 v9, v9, v46
v_add_f32 v9, v9, v47
PK 35,46,47
v_exp_f32 v40, v104
v_exp_f32 v41, v105
v_exp_f32 v42, v106
v_exp_f32 v43, v107
v_add_f32 v8, v8, v40
v_add_f32 v8, v8, v41
PK 28,40,41
v_add_f32 v8, v8, v42
v_add_f32 v8, v8, v43
PK 29,42,43
v_exp_f32 v44, v108
v_exp_f32 v45, v109
v_exp_f32 v46, v110
v_exp_f32 v47, v111
v_add_f32 v9, v9, v44
v_add_f32 v9, v9, v45
PK 36,44,45
v_add_f32 v9, v9, v46
v_add_f32 v9, v9, v47
PK 37,46,47
v_exp_f32 v40, v120
v_exp_f32 v41, v121
v_exp_f32 v42, v122
v_exp_f32 v43, v123
v_add_f32 v8, v8, v40
v_add_f32 v8, v8, v41
PK 30,40,41
v_add_f32 v8, v8, v42
v_add_f32 v8, v8, v43
PK 31,42,43
v_exp_f32 v44, v124
v_exp_f32 v45, v125
v_exp_f32 v46, v126
v_exp_f32 v47, v127
v_add_f32 v9, v9, v44
v_add_f32 v9, v9, v45
PK 38,44,45
v_add_f32 v9, v9, v46
v_add_f32 v9, v9, v47
PK 39,46,47
v_max_f32 v6, v8, v9
v_min_f32 v40, v8, v9
v_cmp_lt_f32 vcc, s56, v6
s_cbranch_vccnz L_k2_sgen
v_cmp_gt_f32 vcc, s6, v40
s_cbranch_vccnz L_k2_sgen
v_mov_b32 v4, v8
v_mov_b32 v5, v9
s_mov_b32 s52, s47
v_add_u32 v1, s19, v7
s_waitcnt lgkmcnt(0)
s_branch L_k2_mzsh
L_k2_ssh:
v_exp_f32 v40, v72
v_exp_f32 v41, v73
v_exp_f32 v42, v74
v_exp_f32 v43, v75
v_exp_f32 v44, v76
v_exp_f32 v45, v77
v_exp_f32 v46, v78
v_exp_f32 v47, v79
v_add_f32 v8, v40, v41
v_add_f32 v9, v44, v45
PK 24,40,41
PK 32,44,45
v_add_f32 v8, v8, v42
v_add_f32 v9, v9, v46
PK 25,42,43
PK 33,46,47
v_add_f32 v8, v8, v43
v_add_f32 v9, v9, v47
v_exp_f32 v40, v88
v_exp_f32 v41, v89
v_exp_f32 v42, v90
v_exp_f32 v43, v91
v_add_f32 v8, v8, v40
v_add_f32 v8, v8, v41
PK 26,40,41
v_add_f32 v8, v8, v42
v_add_f32 v8, v8, v43
PK 27,42,43
v_exp_f32 v44, v92
v_exp_f32 v45, v93
v_exp_f32 v46, v94
v_exp_f32 v47, v95
v_add_f32 v9, v9, v44
v_add_f32 v9, v9, v45
PK 34,44,45
v_add_f32 v9, v9, v46
v_add_f32 v9, v9, v47
PK 35,46,47
v_exp_f32 v40, v104
v_exp_f32 v41, v105
v_exp_f32 v42, v106
v_exp_f32 v43, v107
v_add_f32 v8, v8, v40
v_add_f32 v8, v8, v41
PK 28,40,41
v_add_f32 v8, v8, v42
v_add_f32 v8, v8, v43
PK 29,42,43
v_exp_f32 v44, v108
v_exp_f32 v45, v109
v_exp_f32 v46, v110
v_exp_f32 v47, v111
v_add_f32 v9, v9, v44
v_add_f32 v9, v9, v45
PK 36,44,45
v_add_f32 v9, v9, v46
v_add_f32 v9, v9, v47
PK 37,46,47
v_exp_f32 v40, v120
v_exp_f32 v41, v121
v_exp_f32 v42, v122
v_exp_f32 v43, v123
v_add_f32 v8, v8, v40
v_add_f32 v8, v8, v41
PK 30,40,41
v_add_f32 v8, v8, v42
v_add_f32 v8, v8, v43
PK 31,42,43
v_exp_f32 v44, v124
v_exp_f32 v45, v125
v_exp_f32 v46, v126
v_exp_f32 v47, v127
v_add_f32 v9, v9, v44
v_add_f32 v9, v9, v45
PK 38,44,45
v_add_f32 v9, v9, v46
v_add_f32 v9, v9, v47
PK 39,46,47
v_max_f32 v6, v8, v9
v_cmp_lt_f32 vcc, s56, v6
s_cbranch_vccnz L_k2_sgen
v_add_f32 v4, v4, v8
v_add_f32 v5, v5, v9
s_mov_b32 s52, s47
v_add_u32 v1, s19, v7
s_cmp_lt_u32 s52, s45
s_waitcnt lgkmcnt(0)
s_cbranch_scc0 L_k2_msp
L_k2_msh:
s_sub_u32 s49, s52, s46
s_cmp_lt_u32 s49, 4
s_cbranch_scc1 L_k2_mdisp
L_k2_msh2:
s_barrier
M 128,192,24
M 128,224,28
buffer_load_dwordx4 v7, s[28:31], s7 offen offset:0 sc1 lds
M 132,192,32
M 132,224,36
s_add_u32 s49, s52, 2
M 136,196,24
DR 192,1,0
M 136,228,28
s_cmp_ge_u32 s49, s48
s_cselect_b32 s4, 0, 4
M 140,196,32
DR 224,1,1024
M 140,228,36
s_sub_u32 s49, s52, s46
M 144,200,24
DR 196,1,2048
M 144,232,28
buffer_load_dwordx4 v7, s[28:31], s7 offen offset:1024 sc1 lds
M 148,200,32
DR 228,1,3072
M 148,232,36
s_min_u32 s4, s4, s49
M 152,204,24
DR 200,1,4096
M 152,236,28
s_cmp_lt_u32 s52, s53
s_cselect_b32 s47, 1, 2
M 156,204,32
DR 232,1,5120
M 156,236,36
s_add_u32 s47, s47, s52
M 160,208,24
DR 204,1,6144
M 160,240,28
buffer_load_dwordx4 v7, s[28:31], s7 offen offset:2048 sc1 lds
M 164,208,32
DR 236,1,7168
M 164,240,36
M 168,212,24
DR 208,1,8192
M 168,244,28
M 172,212,32
DR 240,1,9216
M 172,244,36
M 176,216,24
DR 212,1,10240
M 176,248,28
buffer_load_dwordx4 v7, s[28:31], s7 offen offset:3072 sc1 lds
M 180,216,32
DR 244,1,11264
M 180,248,36
M 184,220,24
DR 216,1,12288
M 184,252,28
M 188,220,32
DR 248,1,13312
M 188,252,36
s_waitcnt lgkmcnt(4)
MC 72,192,64,16
DR 220,1,14336
s_and_b32 s19, s47, 3
M 72,224,80
s_lshl_b32 s19, s19, 15
M 72,196,96
DR 252,1,15360
s_xor_b32 s50, s19, 0x10000
M 72,228,112
s_add_u32 s50, s50, s55
MC 76,192,68,20
s_add_u32 s49, s47, 2
M 76,224,84
s_lshl_b32 s51, s49, 14
M 76,196,100
DR 192,1,16384
s_add_u32 s51, s51, s54
M 76,228,116
s_cmp_lt_u32 s49, s48
s_cselect_b32 s51, s51, s54
MC 88,200,64,16
DR 224,1,24576
s_cmp_lt_u32 s47, s45
s_cselect_b32 s49, s41, 0
M 88,232,80
s_lshl_b32 s7, s49, 14
M 88,204,96
DR 196,1,17408
s_add_u32 m0, s50, s7
M 88,236,112
s_lshl_b32 s49, s49, 24
s_waitcnt lgkmcnt(3)
MC 92,200,68,20
DR 228,1,25600
s_add_u32 s7, s51, s49
M 92,232,84
s_add_u32 s51, s51, 16777216
M 92,204,100
DR 200,1,18432
M 92,236,116
MC 104,208,64,16
DR 232,1,26624
M 104,240,80
M 104,212,96
DR 204,1,19456
M 104,244,112
MC 108,208,68,20
DR 236,1,27648
M 108,240,84
M 108,212,100
DR 208,1,20480
M 108,244,116
MC 120,216,64,16
DR 240,1,28672
M 120,248,80
M 120,220,96
DR 212,1,21504
M 120,252,112
s_waitcnt vmcnt(4)
s_setprio 2
s_barrier
MC 124,216,68,20
DR 244,1,29696
M 124,248,84
DR 216,1,22528
M 124,220,100
DR 248,1,30720
M 124,252,116
DR 220,1,23552
DR 252,1,31744
s_setprio 0
s_cmp_lt_u32 s4, 4
s_cbranch_scc1 L_k2_sgen
s_branch L_k2_ssh
L_k2_ssp:
v_exp_f32 v40, v72
v_exp_f32 v41, v73
v_exp_f32 v42, v74
v_exp_f32 v43, v75
v_exp_f32 v44, v76
v_exp_f32 v45, v77
v_exp_f32 v46, v78
v_exp_f32 v47, v79
v_add_f32 v8, v40, v41
v_add_f32 v9, v44, v45
PK 24,40,41
PK 32,44,45
v_add_f32 v8, v8, v42
v_add_f32 v9, v9, v46
PK 25,42,43
PK 33,46,47
v_add_f32 v8, v8, v43
v_add_f32 v9, v9, v47
v_exp_f32 v40, v88
v_exp_f32 v41, v89
v_exp_f32 v42, v90
v_exp_f32 v43, v91
v_add_f32 v8, v8, v40
v_add_f32 v8, v8, v41
PK 26,40,41
v_add_f32 v8, v8, v42
v_add_f32 v8, v8, v43
PK 27,42,43
v_exp_f32 v44, v92
v_exp_f32 v45, v93
v_exp_f32 v46, v94
v_exp_f32 v47, v95
v_add_f32 v9, v9, v44
v_add_f32 v9, v9, v45
PK 34,44,45
v_add_f32 v9, v9, v46
v_add_f32 v9, v9, v47
PK 35,46,47
v_exp_f32 v40, v104
v_exp_f32 v41, v105
v_exp_f32 v42, v106
v_exp_f32 v43, v107
v_add_f32 v8, v8, v40
v_add_f32 v8, v8, v41
PK 28,40,41
v_add_f32 v8, v8, v42
v_add_f32 v8, v8, v43
PK 29,42,43
v_exp_f32 v44, v108
v_exp_f32 v45, v109
v_exp_f32 v46, v110
v_exp_f32 v47, v111
v_add_f32 v9, v9, v44
v_add_f32 v9, v9, v45
PK 36,44,45
v_add_f32 v9, v9, v46
v_add_f32 v9, v9, v47
PK 37,46,47
v_exp_f32 v40, v120
v_exp_f32 v41, v121
v_exp_f32 v42, v122
v_exp_f32 v43, v123
v_add_f32 v8, v8, v40
v_add_f32 v8, v8, v41
PK 30,40,41
v_add_f32 v8, v8, v42
v_add_f32 v8, v8, v43
PK 31,42,43
v_exp_f32 v44, v124
v_exp_f32 v45, v125
v_exp_f32 v46, v126
v_exp_f32 v47, v127
v_add_f32 v9, v9, v44
v_add_f32 v9, v9, v45
PK 38,44,45
v_add_f32 v9, v9, v46
v_add_f32 v9, v9, v47
PK 39,46,47
v_max_f32 v6, v8, v9
v_cmp_lt_f32 vcc, s56, v6
s_cbranch_vccnz L_k2_sgen
v_add_f32 v4, v4, v8
v_add_f32 v5, v5, v9
s_mov_b32 s52, s47
v_add_u32 v1, s19, v7
s_waitcnt vmcnt(0) lgkmcnt(0)
L_k2_msp:
s_sub_u32 s49, s52, s46
s_cmp_lt_u32 s49, 4
s_cbranch_scc1 L_k2_mdisp
s_add_u32 s49, s52, 2
s_cmp_ge_u32 s49, s48
s_cbranch_scc1 L_k2_mdisp
L_k2_msp2:
s_barrier
M 128,192,24
M 128,224,28
buffer_load_dwordx4 v7, s[28:31], s7 offen offset:0 sc1 lds
M 132,192,32
M 132,224,36
s_add_u32 s49, s52, 2
M 136,196,24
DR 192,1,0
M 136,228,28
s_cmp_ge_u32 s49, s48
s_cselect_b32 s4, 0, 4
M 140,196,32
DR 224,1,1024
M 140,228,36
buffer_load_dwordx4 v7, s[28:31], s7 offen offset:1024 sc1 lds
M 144,200,24
DR 196,1,2048
M 144,232,28
s_sub_u32 s49, s52, s46
M 148,200,32
DR 228,1,3072
M 148,232,36
s_min_u32 s4, s4, s49
M 152,204,24
DR 200,1,4096
M 152,236,28
buffer_load_dwordx4 v7, s[28:31], s7 offen offset:2048 sc1 lds
M 156,204,32
DR 232,1,5120
M 156,236,36
s_cmp_lt_u32 s52, s53
s_cselect_b32 s47, 1, 2
M 160,208,24
DR 204,1,6144
M 160,240,28
s_add_u32 s47, s47, s52
M 164,208,32
DR 236,1,7168
M 164,240,36
buffer_load_dwordx4 v7, s[28:31], s7 offen offset:3072 sc1 lds
M 168,212,24
DR 208,1,8192
M 168,244,28
M 172,212,32
DR 240,1,9216
M 172,244,36
M 176,216,24
DR 212,1,10240
M 176,248,28
s_add_u32 m0, s50, 16384
s_nop 0
buffer_load_dwordx4 v7, s[28:31], s51 offen offset:0 sc1 lds
M 180,216,32
DR 244,1,11264
M 180,248,36
M 184,220,24
DR 216,1,12288
M 184,252,28
M 188,220,32
DR 248,1,13312
M 188,252,36
buffer_load_dwordx4 v7, s[28:31], s51 offen offset:1024 sc1 lds
s_waitcnt lgkmcnt(4)
MC 72,192,64,16
DR 220,1,14336
M 72,224,80
M 72,196,96
DR 252,1,15360
M 72,228,112
MC 76,192,68,20
M 76,224,84
buffer_load_dwordx4 v7, s[28:31], s51 offen offset:2048 sc1 lds
M 76,196,100
DR 192,1,16384
M 76,228,116
MC 88,200,64,16
DR 224,1,24576
M 88,232,80
M 88,204,96
DR 196,1,17408
M 88,236,112
buffer_load_dwordx4 v7, s[28:31], s51 offen offset:3072 sc1 lds
s_waitcnt lgkmcnt(3)
MC 92,200,68,20
DR 228,1,25600
s_and_b32 s19, s47, 3
M 92,232,84
s_lshl_b32 s19, s19, 15
M 92,204,100
DR 200,1,18432
s_xor_b32 s50, s19, 0x10000
M 92,236,116
s_add_u32 s50, s50, s55
MC 104,208,64,16
DR 232,1,26624
s_add_u32 s49, s47, 2
M 104,240,80
s_lshl_b32 s51, s49, 14
M 104,212,96
DR 204,1,19456
s_add_u32 s51, s51, s54
M 104,244,112
s_cmp_lt_u32 s49, s48
s_cselect_b32 s51, s51, s54
MC 108,208,68,20
DR 236,1,27648
s_cmp_lt_u32 s47, s45
s_cselect_b32 s49, s41, 0
M 108,240,84
s_lshl_b32 s7, s49, 14
M 108,212,100
DR 208,1,20480
s_add_u32 m0, s50, s7
M 108,244,116
s_lshl_b32 s49, s49, 24
MC 120,216,64,16
DR 240,1,28672
s_add_u32 s7, s51, s49
M 120,248,80
s_add_u32 s51, s51, 16777216
M 120,220,96
DR 212,1,21504
M 120,252,112
s_waitcnt vmcnt(8)
s_setprio 2
s_barrier
MC 124,216,68,20
DR 244,1,29696
M 124,248,84
DR 216,1,22528
M 124,220,100
DR 248,1,30720
M 124,252,116
DR 220,1,23552
DR 252,1,31744
s_setprio 0
s_cmp_lt_u32 s4, 4
s_cbranch_scc1 L_k2_sgen
s_branch L_k2_ssp
L_k2_mzsh:
s_barrier
MZ 128,192,24
M 128,224,28
buffer_load_dwordx4 v7, s[28:31], s7 offen offset:0 sc1 lds
MZ 132,192,32
M 132,224,36
s_add_u32 s49, s52, 2
MZ 136,196,24
DR 192,1,0
M 136,228,28
s_cmp_ge_u32 s49, s48
s_cselect_b32 s4, 0, 4
MZ 140,196,32
DR 224,1,1024
M 140,228,36
s_sub_u32 s49, s52, s46
MZ 144,200,24
DR 196,1,2048
M 144,232,28
buffer_load_dwordx4 v7, s[28:31], s7 offen offset:1024 sc1 lds
MZ 148,200,32
DR 228,1,3072
M 148,232,36
s_min_u32 s4, s4, s49
MZ 152,204,24
DR 200,1,4096
M 152,236,28
s_cmp_lt_u32 s52, s53
s_cselect_b32 s47, 1, 2
MZ 156,204,32
DR 232,1,5120
M 156,236,36
s_add_u32 s47, s47, s52
MZ 160,208,24
DR 204,1,6144
M 160,240,28
buffer_load_dwordx4 v7, s[28:31], s7 offen offset:2048 sc1 lds
MZ 164,208,32
DR 236,1,7168
M 164,240,36
MZ 168,212,24
DR 208,1,8192
M 168,244,28
MZ 172,212,32
DR 240,1,9216
M 172,244,36
MZ 176,216,24
DR 212,1,10240
M 176,248,28
buffer_load_dwordx4 v7, s[28:31], s7 offen offset:3072 sc1 lds
MZ 180,216,32
DR 244,1,11264
M 180,248,36
MZ 184,220,24
DR 216,1,12288
M 184,252,28
MZ 188,220,32
DR 248,1,13312
M 188,252,36
s_waitcnt lgkmcnt(4)
MC 72,192,64,16
DR 220,1,14336
s_and_b32 s19, s47, 3
M 72,224,80
s_lshl_b32 s19, s19, 15
M 72,196,96
DR 252,1,15360
s_xor_b32 s50, s19, 0x10000
M 72,228,112
s_add_u32 s50, s50, s55
MC 76,192,68,20
s_add_u32 s49, s47, 2
M 76,224,84
s_lshl_b32 s51, s49, 14
M 76,196,100
DR 192,1,16384
s_add_u32 s51, s51, s54
M 76,228,116
s_cmp_lt_u32 s49, s48
s_cselect_b32 s51, s51, s54
MC 88,200,64,16
DR 224,1,24576
s_cmp_lt_u32 s47, s45
s_cselect_b32 s49, s41, 0
M 88,232,80
s_lshl_b32 s7, s49, 14
M 88,204,96
DR 196,1,17408
s_add_u32 m0, s50, s7
M 88,236,112
s_lshl_b32 s49, s49, 24
s_waitcnt lgkmcnt(3)
MC 92,200,68,20
DR 228,1,25600
s_add_u32 s7, s51, s49
M 92,232,84
s_add_u32 s51, s51, 16777216
M 92,204,100
DR 200,1,18432
M 92,236,116
MC 104,208,64,16
DR 232,1,26624
M 104,240,80
M 104,212,96
DR 204,1,19456
M 104,244,112
MC 108,208,68,20
DR 236,1,27648
M 108,240,84
M 108,212,100
DR 208,1,20480
M 108,244,116
MC 120,216,64,16
DR 240,1,28672
M 120,248,80
M 120,220,96
DR 212,1,21504
M 120,252,112
s_waitcnt vmcnt(4)
s_setprio 2
s_barrier
MC 124,216,68,20
DR 244,1,29696
M 124,248,84
DR 216,1,22528
M 124,220,100
DR 248,1,30720
M 124,252,116
DR 220,1,23552
DR 252,1,31744
s_setprio 0
s_cmp_lt_u32 s4, 4
s_cbranch_scc1 L_k2_sgen
s_branch L_k2_ssh
L_k2_mzsp:
s_barrier
MZ 128,192,24
M 128,224,28
buffer_load_dwordx4 v7, s[28:31], s7 offen offset:0 sc1 lds
MZ 132,192,32
M 132,224,36
s_add_u32 s49, s52, 2
MZ 136,196,24
DR 192,1,0
M 136,228,28
s_cmp_ge_u32 s49, s48
s_cselect_b32 s4, 0, 4
MZ 140,196,32
DR 224,1,1024
M 140,228,36
buffer_load_dwordx4 v7, s[28:31], s7 offen offset:1024 sc1 lds
MZ 144,200,24
DR 196,1,2048
M 144,232,28
s_sub_u32 s49, s52, s46
MZ 148,200,32
DR 228,1,3072
M 148,232,36
s_min_u32 s4, s4, s49
MZ 152,204,24
DR 200,1,4096
M 152,236,28
buffer_load_dwordx4 v7, s[28:31], s7 offen offset:2048 sc1 lds
MZ 156,204,32
DR 232,1,5120
M 156,236,36
s_cmp_lt_u32 s52, s53
s_cselect_b32 s47, 1, 2
MZ 160,208,24
DR 204,1,6144
M 160,240,28
s_add_u32 s47, s47, s52
MZ 164,208,32
DR 236,1,7168
M 164,240,36
buffer_load_dwordx4 v7, s[28:31], s7 offen offset:3072 sc1 lds
MZ 168,212,24
DR 208,1,8192
M 168,244,28
MZ 172,212,32
DR 240,1,9216
M 172,244,36
MZ 176,216,24
DR 212,1,10240
M 176,248,28
s_add_u32 m0, s50, 16384
s_nop 0
buffer_load_dwordx4 v7, s[28:31], s51 offen offset:0 sc1 lds
MZ 180,216,32
DR 244,1,11264
M 180,248,36
MZ 184,220,24
DR 216,1,12288
M 184,252,28
MZ 188,220,32
DR 248,1,13312
M 188,252,36
buffer_load_dwordx4 v7, s[28:31], s51 offen offset:1024 sc1 lds
s_waitcnt lgkmcnt(4)
MC 72,192,64,16
DR 220,1,14336
M 72,224,80
M 72,196,96
DR 252,1,15360
M 72,228,112
MC 76,192,68,20
M 76,224,84
buffer_load_dwordx4 v7, s[28:31], s51 offen offset:2048 sc1 lds
M 76,196,100
DR 192,1,16384
M 76,228,116
MC 88,200,64,16
DR 224,1,24576
M 88,232,80
M 88,204,96
DR 196,1,17408
M 88,236,112
buffer_load_dwordx4 v7, s[28:31], s51 offen offset:3072 sc1 lds
s_waitcnt lgkmcnt(3)
MC 92,200,68,20
DR 228,1,25600
s_and_b32 s19, s47, 3
M 92,232,84
s_lshl_b32 s19, s19, 15
M 92,204,100
DR 200,1,18432
s_xor_b32 s50, s19, 0x10000
M 92,236,116
s_add_u32 s50, s50, s55
MC 104,208,64,16
DR 232,1,26624
s_add_u32 s49, s47, 2
M 104,240,80
s_lshl_b32 s51, s49, 14
M 104,212,96
DR 204,1,19456
s_add_u32 s51, s51, s54
M 104,244,112
s_cmp_lt_u32 s49, s48
s_cselect_b32 s51, s51, s54
MC 108,208,68,20
DR 236,1,27648
s_cmp_lt_u32 s47, s45
s_cselect_b32 s49, s41, 0
M 108,240,84
s_lshl_b32 s7, s49, 14
M 108,212,100
DR 208,1,20480
s_add_u32 m0, s50, s7
M 108,244,116
s_lshl_b32 s49, s49, 24
MC 120,216,64,16
DR 240,1,28672
s_add_u32 s7, s51, s49
M 120,248,80
s_add_u32 s51, s51, 16777216
M 120,220,96
DR 212,1,21504
M 120,252,112
s_waitcnt vmcnt(8)
s_setprio 2
s_barrier
MC 124,216,68,20
DR 244,1,29696
M 124,248,84
DR 216,1,22528
M 124,220,100
DR 248,1,30720
M 124,252,116
DR 220,1,23552
DR 252,1,31744
s_setprio 0
s_cmp_lt_u32 s4, 4
s_cbranch_scc1 L_k2_sgen
s_branch L_k2_ssp
L_k2_mdisp:
s_and_b32 s49, s52, 1
s_lshl_b32 s4, s49, 1
s_add_u32 s4, s4, 1
s_sub_u32 s4, s4, s42
s_max_i32 s4, s4, 0
s_min_i32 s4, s4, 2
s_sub_u32 s49, s52, s46
s_add_u32 s5, s52, 2
s_cmp_ge_u32 s5, s48
s_cselect_b32 s5, 0, s49
s_cmp_lt_u32 s5, 2
s_cselect_b32 s4, s4, 0
s_lshr_b32 s18, s49, 1
s_lshl_b32 s5, s18, 1
s_add_u32 s5, s5, 1
s_sub_u32 s5, s5, s42
s_max_i32 s5, s5, 0
s_min_i32 s5, s5, 2
s_or_b32 s49, s49, 2
s_cmp_eq_u32 s49, 3
s_cselect_b32 s5, s5, 0
s_or_b32 s49, s4, s5
s_cbranch_scc1 L_k2_mx
s_cmp_lt_u32 s52, s45
s_cbranch_scc1 L_k2_msh2
s_branch L_k2_msp2
L_k2_mx:
s_barrier
s_cmp_gt_u32 s5, 1
s_cbranch_scc1 L_sk_81
M 128,192,24
M 132,192,32
M 136,196,24
M 140,196,32
M 144,200,24
M 148,200,32
M 152,204,24
M 156,204,32
M 160,208,24
M 164,208,32
M 168,212,24
M 172,212,32
M 176,216,24
M 180,216,32
M 184,220,24
M 188,220,32
L_sk_81:
s_cmp_gt_u32 s4, 1
s_cbranch_scc1 L_sk_82
DR 192,1,0
DR 196,1,1024
DR 200,1,2048
DR 204,1,3072
DR 208,1,4096
DR 212,1,5120
DR 216,1,6144
DR 220,1,7168
L_sk_82:
buffer_load_dwordx4 v7, s[28:31], s7 offen offset:0 sc1 lds
buffer_load_dwordx4 v7, s[28:31], s7 offen offset:1024 sc1 lds
buffer_load_dwordx4 v7, s[28:31], s7 offen offset:2048 sc1 lds
buffer_load_dwordx4 v7, s[28:31], s7 offen offset:3072 sc1 lds
s_cmp_gt_u32 s5, 0
s_cbranch_scc1 L_sk_83
M 128,224,28
M 132,224,36
M 136,228,28
M 140,228,36
M 144,232,28
M 148,232,36
M 152,236,28
M 156,236,36
M 160,240,28
M 164,240,36
M 168,244,28
M 172,244,36
M 176,248,28
M 180,248,36
M 184,252,28
M 188,252,36
L_sk_83:
s_cmp_gt_u32 s4, 0
s_cbranch_scc1 L_sk_84
DR 224,1,8192
DR 228,1,9216
DR 232,1,10240
DR 236,1,11264
DR 240,1,12288
DR 244,1,13312
DR 248,1,14336
DR 252,1,15360
L_sk_84:
s_cmp_lt_u32 s52, s45
s_cbranch_scc1 L_sh_85
s_add_u32 m0, s50, 16384
s_nop 0
buffer_load_dwordx4 v7, s[28:31], s51 offen offset:0 sc1 lds
buffer_load_dwordx4 v7, s[28:31], s51 offen offset:1024 sc1 lds
buffer_load_dwordx4 v7, s[28:31], s51 offen offset:2048 sc1 lds
buffer_load_dwordx4 v7, s[28:31], s51 offen offset:3072 sc1 lds
s_waitcnt vmcnt(8)
s_branch L_j_86
L_sh_85:
s_waitcnt vmcnt(4)
L_j_86:
s_cmp_lt_u32 s52, s53
s_cselect_b32 s47, 1, 2
s_add_u32 s47, s47, s52
s_and_b32 s19, s47, 3
s_lshl_b32 s19, s19, 15
s_xor_b32 s50, s19, 0x10000
s_add_u32 s50, s50, s55
s_add_u32 s49, s47, 2
s_lshl_b32 s51, s49, 14
s_add_u32 s51, s51, s54
s_cmp_lt_u32 s49, s48
s_cselect_b32 s51, s51, s54
s_cmp_lt_u32 s47, s45
s_cselect_b32 s49, s41, 0
s_lshl_b32 s7, s49, 14
s_add_u32 m0, s50, s7
s_lshl_b32 s49, s49, 24
s_add_u32 s7, s51, s49
s_add_u32 s51, s51, 16777216
s_waitcnt lgkmcnt(0)
s_cmp_gt_u32 s4, 1
s_cbranch_scc1 L_sk_87
MC 72,192,64,16
M 72,196,80
M 72,200,96
M 72,204,112
MC 76,192,68,20
M 76,196,84
M 76,200,100
M 76,204,116
MC 88,208,64,16
M 88,212,80
M 88,216,96
M 88,220,112
MC 92,208,68,20
M 92,212,84
M 92,216,100
M 92,220,116
DR 192,1,16384
DR 196,1,17408
DR 200,1,18432
DR 204,1,19456
DR 208,1,20480
DR 212,1,21504
DR 216,1,22528
DR 220,1,23552
L_sk_87:
s_cmp_gt_u32 s4, 0
s_cbranch_scc1 L_sk_88
MC 104,224,64,16
M 104,228,80
M 104,232,96
M 104,236,112
MC 108,224,68,20
M 108,228,84
M 108,232,100
M 108,236,116
MC 120,240,64,16
M 120,244,80
M 120,248,96
M 120,252,112
MC 124,240,68,20
M 124,244,84
M 124,248,100
M 124,252,116
DR 224,1,24576
DR 228,1,25600
DR 232,1,26624
DR 236,1,27648
DR 240,1,28672
DR 244,1,29696
DR 248,1,30720
DR 252,1,31744
L_sk_88:
s_barrier
s_nop 4
s_branch L_k2_sgen
L_k2_sgen:
s_sub_u32 s49, s52, s46
s_cmp_eq_u32 s49, 3
s_cselect_b32 s5, 2, 0
s_cmp_eq_u32 s52, 0
s_cselect_b32 s5, 1, s5
s_cselect_b32 s18, s6, 0
s_cmp_eq_u32 s5, 2
s_cselect_b32 s18, s6, s18
s_add_u32 s49, s52, 2
s_cmp_ge_u32 s49, s48
s_cbranch_scc1 L_domask_92
s_sub_u32 s49, s52, s46
s_cmp_lt_u32 s49, 2
s_cbranch_scc0 L_nomask_89
L_domask_92:
s_and_b32 s49, s52, 1
s_lshl_b32 s49, s49, 1
s_sub_u32 s49, s42, s49
s_cmp_ge_i32 s49, 2
s_cbranch_scc1 L_nomask_89
s_cmp_eq_i32 s49, 1
s_cbranch_scc1 L_m1_90
s_cmp_lt_i32 s49, 0
s_cbranch_scc1 L_mf_91
v_cndmask_b32 v72, v3, v72, s[8:9]
v_cndmask_b32 v73, v3, v73, s[10:11]
v_cndmask_b32 v74, v3, v74, s[12:13]
v_cndmask_b32 v75, v3, v75, s[14:15]
v_mov_b32 v88, v3
v_mov_b32 v89, v3
v_mov_b32 v90, v3
v_mov_b32 v91, v3
v_cndmask_b32 v92, v3, v92, s[8:9]
v_cndmask_b32 v93, v3, v93, s[10:11]
v_cndmask_b32 v94, v3, v94, s[12:13]
v_cndmask_b32 v95, v3, v95, s[14:15]
v_mov_b32 v104, v3
v_mov_b32 v105, v3
v_mov_b32 v106, v3
v_mov_b32 v107, v3
v_mov_b32 v108, v3
v_mov_b32 v109, v3
v_mov_b32 v110, v3
v_mov_b32 v111, v3
v_mov_b32 v120, v3
v_mov_b32 v121, v3
v_mov_b32 v122, v3
v_mov_b32 v123, v3
v_mov_b32 v124, v3
v_mov_b32 v125, v3
v_mov_b32 v126, v3
v_mov_b32 v127, v3
s_branch L_nomask_89
L_m1_90:
v_cndmask_b32 v104, v3, v104, s[8:9]
v_cndmask_b32 v105, v3, v105, s[10:11]
v_cndmask_b32 v106, v3, v106, s[12:13]
v_cndmask_b32 v107, v3, v107, s[14:15]
v_mov_b32 v120, v3
v_mov_b32 v121, v3
v_mov_b32 v122, v3
v_mov_b32 v123, v3
v_cndmask_b32 v124, v3, v124, s[8:9]
v_cndmask_b32 v125, v3, v125, s[10:11]
v_cndmask_b32 v126, v3, v126, s[12:13]
v_cndmask_b32 v127, v3, v127, s[14:15]
s_branch L_nomask_89
L_mf_91:
v_mov_b32 v72, v3
v_mov_b32 v73, v3
v_mov_b32 v74, v3
v_mov_b32 v75, v3
v_mov_b32 v76, v3
v_mov_b32 v77, v3
v_mov_b32 v78, v3
v_mov_b32 v79, v3
v_mov_b32 v88, v3
v_mov_b32 v89, v3
v_mov_b32 v90, v3
v_mov_b32 v91, v3
v_mov_b32 v92, v3
v_mov_b32 v93, v3
v_mov_b32 v94, v3
v_mov_b32 v95, v3
v_mov_b32 v104, v3
v_mov_b32 v105, v3
v_mov_b32 v106, v3
v_mov_b32 v107, v3
v_mov_b32 v108, v3
v_mov_b32 v109, v3
v_mov_b32 v110, v3
v_mov_b32 v111, v3
v_mov_b32 v120, v3
v_mov_b32 v121, v3
v_mov_b32 v122, v3
v_mov_b32 v123, v3
v_mov_b32 v124, v3
v_mov_b32 v125, v3
v_mov_b32 v126, v3
v_mov_b32 v127, v3
L_nomask_89:
s_cmp_eq_u32 s5, 2
s_cbranch_scc0 L_ny_93
s_lshl_b32 s49, s33, 3
s_lshl_b32 s35, s42, 1
s_add_u32 s49, s49, s35
s_mul_i32 s49, s49, 159744
s_lshl_b32 s35, s43, 12
s_add_u32 s34, s49, s35
s_add_u32 s35, s34, 159744
v_mul_f32 v128, v128, v56
v_mul_f32 v129, v129, v56
v_mul_f32 v130, v130, v56
v_mul_f32 v131, v131, v56
v_mul_f32 v136, v136, v56
v_mul_f32 v137, v137, v56
v_mul_f32 v138, v138, v56
v_mul_f32 v139, v139, v56
PK 128,128,129
PK 129,130,131
PK 130,136,137
PK 131,138,139
buffer_store_dwordx4 v[128:131], v7, s[36:39], s34 offen offset:0 sc1
v_exp_f32 v40, v72
v_exp_f32 v41, v73
v_exp_f32 v42, v74
v_exp_f32 v43, v75
v_exp_f32 v44, v76
v_exp_f32 v45, v77
v_exp_f32 v46, v78
v_exp_f32 v47, v79
v_add_f32 v8, v40, v41
v_mul_f32 v132, v132, v57
v_mul_f32 v133, v133, v57
v_mul_f32 v134, v134, v57
v_mul_f32 v135, v135, v57
v_mul_f32 v140, v140, v57
v_mul_f32 v141, v141, v57
v_mul_f32 v142, v142, v57
v_mul_f32 v143, v143, v57
PK 132,132,133
PK 133,134,135
PK 134,140,141
PK 135,142,143
buffer_store_dwordx4 v[132:135], v7, s[36:39], s35 offen offset:0 sc1
v_add_f32 v9, v44, v45
PK 24,40,41
PK 32,44,45
v_add_f32 v8, v8, v42
v_add_f32 v9, v9, v46
PK 25,42,43
PK 33,46,47
v_add_f32 v8, v8, v43
v_add_f32 v9, v9, v47
v_mul_f32 v144, v144, v56
v_mul_f32 v145, v145, v56
v_mul_f32 v146, v146, v56
v_mul_f32 v147, v147, v56
v_mul_f32 v152, v152, v56
v_mul_f32 v153, v153, v56
v_mul_f32 v154, v154, v56
v_mul_f32 v155, v155, v56
PK 144,144,145
PK 145,146,147
PK 146,152,153
PK 147,154,155
buffer_store_dwordx4 v[144:147], v7, s[36:39], s34 offen offset:1024 sc1
v_exp_f32 v40, v88
v_exp_f32 v41, v89
v_exp_f32 v42, v90
v_exp_f32 v43, v91
v_add_f32 v8, v8, v40
v_add_f32 v8, v8, v41
PK 26,40,41
v_add_f32 v8, v8, v42
v_add_f32 v8, v8, v43
PK 27,42,43
v_mul_f32 v148, v148, v57
v_mul_f32 v149, v149, v57
v_mul_f32 v150, v150, v57
v_mul_f32 v151, v151, v57
v_mul_f32 v156, v156, v57
v_mul_f32 v157, v157, v57
v_mul_f32 v158, v158, v57
v_mul_f32 v159, v159, v57
PK 148,148,149
PK 149,150,151
PK 150,156,157
PK 151,158,159
buffer_store_dwordx4 v[148:151], v7, s[36:39], s35 offen offset:1024 sc1
v_exp_f32 v44, v92
v_exp_f32 v45, v93
v_exp_f32 v46, v94
v_exp_f32 v47, v95
v_add_f32 v9, v9, v44
v_add_f32 v9, v9, v45
PK 34,44,45
v_add_f32 v9, v9, v46
v_add_f32 v9, v9, v47
PK 35,46,47
v_mul_f32 v160, v160, v56
v_mul_f32 v161, v161, v56
v_mul_f32 v162, v162, v56
v_mul_f32 v163, v163, v56
v_mul_f32 v168, v168, v56
v_mul_f32 v169, v169, v56
v_mul_f32 v170, v170, v56
v_mul_f32 v171, v171, v56
PK 160,160,161
PK 161,162,163
PK 162,168,169
PK 163,170,171
buffer_store_dwordx4 v[160:163], v7, s[36:39], s34 offen offset:2048 sc1
v_exp_f32 v40, v104
v_exp_f32 v41, v105
v_exp_f32 v42, v106
v_exp_f32 v43, v107
v_add_f32 v8, v8, v40
v_add_f32 v8, v8, v41
PK 28,40,41
v_add_f32 v8, v8, v42
v_add_f32 v8, v8, v43
PK 29,42,43
v_mul_f32 v164, v164, v57
v_mul_f32 v165, v165, v57
v_mul_f32 v166, v166, v57
v_mul_f32 v167, v167, v57
v_mul_f32 v172, v172, v57
v_mul_f32 v173, v173, v57
v_mul_f32 v174, v174, v57
v_mul_f32 v175, v175, v57
PK 164,164,165
PK 165,166,167
PK 166,172,173
PK 167,174,175
buffer_store_dwordx4 v[164:167], v7, s[36:39], s35 offen offset:2048 sc1
v_exp_f32 v44, v108
v_exp_f32 v45, v109
v_exp_f32 v46, v110
v_exp_f32 v47, v111
v_add_f32 v9, v9, v44
v_add_f32 v9, v9, v45
PK 36,44,45
v_add_f32 v9, v9, v46
v_add_f32 v9, v9, v47
PK 37,46,47
v_mul_f32 v176, v176, v56
v_mul_f32 v177, v177, v56
v_mul_f32 v178, v178, v56
v_mul_f32 v179, v179, v56
v_mul_f32 v184, v184, v56
v_mul_f32 v185, v185, v56
v_mul_f32 v186, v186, v56
v_mul_f32 v187, v187, v56
PK 176,176,177
PK 177,178,179
PK 178,184,185
PK 179,186,187
buffer_store_dwordx4 v[176:179], v7, s[36:39], s34 offen offset:3072 sc1
v_exp_f32 v40, v120
v_exp_f32 v41, v121
v_exp_f32 v42, v122
v_exp_f32 v43, v123
v_add_f32 v8, v8, v40
v_add_f32 v8, v8, v41
PK 30,40,41
v_add_f32 v8, v8, v42
v_add_f32 v8, v8, v43
PK 31,42,43
v_mul_f32 v180, v180, v57
v_mul_f32 v181, v181, v57
v_mul_f32 v182, v182, v57
v_mul_f32 v183, v183, v57
v_mul_f32 v188, v188, v57
v_mul_f32 v189, v189, v57
v_mul_f32 v190, v190, v57
v_mul_f32 v191, v191, v57
PK 180,180,181
PK 181,182,183
PK 182,188,189
PK 183,190,191
buffer_store_dwordx4 v[180:183], v7, s[36:39], s35 offen offset:3072 sc1
v_exp_f32 v44, v124
v_exp_f32 v45, v125
v_exp_f32 v46, v126
v_exp_f32 v47, v127
v_add_f32 v9, v9, v44
v_add_f32 v9, v9, v45
PK 38,44,45
v_add_f32 v9, v9, v46
v_add_f32 v9, v9, v47
PK 39,46,47
s_branch L_jy_94
L_ny_93:
v_exp_f32 v40, v72
v_exp_f32 v41, v73
v_exp_f32 v42, v74
v_exp_f32 v43, v75
v_exp_f32 v44, v76
v_exp_f32 v45, v77
v_exp_f32 v46, v78
v_exp_f32 v47, v79
v_add_f32 v8, v40, v41
v_add_f32 v9, v44, v45
PK 24,40,41
PK 32,44,45
v_add_f32 v8, v8, v42
v_add_f32 v9, v9, v46
PK 25,42,43
PK 33,46,47
v_add_f32 v8, v8, v43
v_add_f32 v9, v9, v47
v_exp_f32 v40, v88
v_exp_f32 v41, v89
v_exp_f32 v42, v90
v_exp_f32 v43, v91
v_add_f32 v8, v8, v40
v_add_f32 v8, v8, v41
PK 26,40,41
v_add_f32 v8, v8, v42
v_add_f32 v8, v8, v43
PK 27,42,43
v_exp_f32 v44, v92
v_exp_f32 v45, v93
v_exp_f32 v46, v94
v_exp_f32 v47, v95
v_add_f32 v9, v9, v44
v_add_f32 v9, v9, v45
PK 34,44,45
v_add_f32 v9, v9, v46
v_add_f32 v9, v9, v47
PK 35,46,47
v_exp_f32 v40, v104
v_exp_f32 v41, v105
v_exp_f32 v42, v106
v_exp_f32 v43, v107
v_add_f32 v8, v8, v40
v_add_f32 v8, v8, v41
PK 28,40,41
v_add_f32 v8, v8, v42
v_add_f32 v8, v8, v43
PK 29,42,43
v_exp_f32 v44, v108
v_exp_f32 v45, v109
v_exp_f32 v46, v110
v_exp_f32 v47, v111
v_add_f32 v9, v9, v44
v_add_f32 v9, v9, v45
PK 36,44,45
v_add_f32 v9, v9, v46
v_add_f32 v9, v9, v47
PK 37,46,47
v_exp_f32 v40, v120
v_exp_f32 v41, v121
v_exp_f32 v42, v122
v_exp_f32 v43, v123
v_add_f32 v8, v8, v40
v_add_f32 v8, v8, v41
PK 30,40,41
v_add_f32 v8, v8, v42
v_add_f32 v8, v8, v43
PK 31,42,43
v_exp_f32 v44, v124
v_exp_f32 v45, v125
v_exp_f32 v46, v126
v_exp_f32 v47, v127
v_add_f32 v9, v9, v44
v_add_f32 v9, v9, v45
PK 38,44,45
v_add_f32 v9, v9, v46
v_add_f32 v9, v9, v47
PK 39,46,47
L_jy_94:
v_max_f32 v6, v8, v9
v_min_f32 v40, v8, v9
v_cmp_lt_f32 vcc, s56, v6
s_cbranch_vccnz L_k2_slow
v_cmp_gt_f32 vcc, s18, v40
s_cbranch_vccnz L_k2_slow
L_k2_back:
s_cmp_eq_u32 s5, 0
s_cbranch_scc1 L_nf_95
v_mov_b32 v4, 0
v_mov_b32 v5, 0
L_nf_95:
v_add_f32 v4, v4, v8
v_add_f32 v5, v5, v9
s_add_u32 s49, s52, 2
s_cmp_ge_u32 s49, s48
s_cbranch_scc1 L_k2_xlast
s_sub_u32 s49, s52, s46
s_cmp_eq_u32 s49, 1
s_cbranch_scc0 L_nyl_96
v_add_u32 v10, s57, v7
DR 64,10,0
DR 80,10,1024
DR 96,10,2048
DR 112,10,3072
DR 68,10,4096
DR 84,10,5120
DR 100,10,6144
DR 116,10,7168
v_mov_b32 v42, v4
v_mov_b32 v43, v5
s_nop 1
v_permlane32_swap_b32 v42, v4
v_permlane32_swap_b32 v43, v5
s_nop 1
v_add_f32 v4, v4, v42
v_add_f32 v5, v5, v43
v_mov_b32 v42, v4
v_mov_b32 v43, v5
s_nop 1
v_permlane16_swap_b32 v42, v4
v_permlane16_swap_b32 v43, v5
s_nop 1
v_add_f32 v4, v4, v42
v_add_f32 v5, v5, v43
v_rcp_f32 v56, v4
v_rcp_f32 v57, v5
v_mov_b32 v16, 0
v_mov_b32 v17, 0
v_mov_b32 v18, 0
v_mov_b32 v19, 0
v_mov_b32 v20, 0
v_mov_b32 v21, 0
v_mov_b32 v22, 0
v_mov_b32 v23, 0
L_nyl_96:
s_mov_b32 s52, s47
v_add_u32 v1, s19, v7
s_cmp_lt_u32 s52, s45
s_cselect_b32 s49, 0, 4
s_add_u32 s5, s5, s49
s_and_b32 s49, s5, 3
s_cbranch_scc1 L_w8_97
s_waitcnt vmcnt(0)
L_w8_97:
s_waitcnt vmcnt(8) lgkmcnt(0)
s_cmp_eq_u32 s5, 0
s_cbranch_scc1 L_k2_msh
s_cmp_eq_u32 s5, 4
s_cbranch_scc1 L_k2_msp
s_cmp_eq_u32 s5, 1
s_cbranch_scc1 L_k2_mzsh
s_branch L_k2_mzsp
L_k2_xlast:
s_and_b32 s49, s48, 3
s_lshl_b32 s49, s49, 15
s_lshl_b32 s50, s42, 13
s_add_u32 s50, s50, s49
v_add_u32 v11, s50, v7
v_add_u32 v10, s57, v7
s_xor_b32 s49, s49, 0x10000
s_lshl_b32 s50, s42, 10
s_add_u32 s49, s49, s50
v_add_u32 v6, s49, v7
s_cmp_eq_u32 s41, 0
s_cbranch_scc0 L_k2_xlastB
v_mov_b32 v52, v16
v_mov_b32 v53, v20
v_mov_b32 v54, v4
v_mov_b32 v55, v5
DW 6,52,0
s_waitcnt vmcnt(0) lgkmcnt(0)
s_barrier
M 128,192,24
M 132,192,32
M 128,224,28
M 132,224,36
M 136,196,24
M 140,196,32
M 136,228,28
M 140,228,36
M 144,200,24
M 148,200,32
M 144,232,28
M 148,232,36
M 152,204,24
DW 10,128,0
M 156,204,32
DW 10,132,1024
M 152,236,28
M 156,236,36
M 160,208,24
DW 10,136,2048
M 164,208,32
DW 10,140,3072
M 160,240,28
M 164,240,36
M 168,212,24
DW 10,144,4096
M 172,212,32
DW 10,148,5120
M 168,244,28
M 172,244,36
M 176,216,24
DW 10,152,6144
M 180,216,32
DW 10,156,7168
M 176,248,28
M 180,248,36
M 184,220,24
DW 11,160,0
M 188,220,32
DW 11,164,1024
M 184,252,28
M 188,252,36
DW 11,168,2048
DW 11,172,3072
s_nop 3
DW 11,176,4096
DW 11,180,5120
DW 11,184,6144
DW 11,188,7168
s_waitcnt lgkmcnt(0)
s_barrier
s_branch L_k2_rend
L_k2_xlastB:
DR 52,6,0
s_lshl_b32 s49, s32, 3
s_lshl_b32 s35, s42, 1
s_add_u32 s49, s49, s35
s_mul_i32 s49, s49, 159744
s_lshl_b32 s35, s43, 12
s_add_u32 s34, s49, s35
s_add_u32 s35, s34, 159744
s_waitcnt lgkmcnt(0)
v_min_f32 v40, v52, v16
v_min_f32 v41, v53, v20
v_sub_f32 v56, v40, v52
v_sub_f32 v57, v41, v53
v_sub_f32 v58, v40, v16
v_sub_f32 v59, v41, v20
v_exp_f32 v56, v56
v_exp_f32 v57, v57
v_exp_f32 v58, v58
v_exp_f32 v59, v59
s_nop 0
v_mul_f32 v4, v4, v58
v_mul_f32 v5, v5, v59
v_fmac_f32 v4, v54, v56
v_fmac_f32 v5, v55, v57
v_mov_b32 v42, v4
v_mov_b32 v43, v5
s_nop 1
v_permlane32_swap_b32 v42, v4
v_permlane32_swap_b32 v43, v5
s_nop 1
v_add_f32 v4, v4, v42
v_add_f32 v5, v5, v43
v_mov_b32 v42, v4
v_mov_b32 v43, v5
s_nop 1
v_permlane16_swap_b32 v42, v4
v_permlane16_swap_b32 v43, v5
s_nop 1
v_add_f32 v4, v4, v42
v_add_f32 v5, v5, v43
v_rcp_f32 v4, v4
v_rcp_f32 v5, v5
s_nop 0
v_mul_f32 v56, v56, v4
v_mul_f32 v57, v57, v5
v_mul_f32 v58, v58, v4
v_mul_f32 v59, v59, v5
s_cmp_eq_u32 s5, 0
s_cbranch_scc0 L_finz_98
M 128,192,24
M 132,192,32
M 128,224,28
M 132,224,36
M 136,196,24
M 140,196,32
M 136,228,28
M 140,228,36
M 144,200,24
M 148,200,32
M 144,232,28
M 148,232,36
M 152,204,24
M 156,204,32
M 152,236,28
M 156,236,36
s_waitcnt vmcnt(0)
s_barrier
DR 192,10,0
DR 224,10,1024
DR 196,10,2048
DR 228,10,3072
DR 200,10,4096
DR 232,10,5120
M 160,208,24
DR 204,10,6144
M 164,208,32
DR 236,10,7168
M 160,240,28
M 164,240,36
M 168,212,24
DR 208,11,0
M 172,212,32
DR 240,11,1024
M 168,244,28
M 172,244,36
M 176,216,24
DR 212,11,2048
DR 244,11,3072
v_mul_f32 v128, v128, v58
v_mul_f32 v129, v129, v58
v_mul_f32 v130, v130, v58
v_mul_f32 v131, v131, v58
s_waitcnt lgkmcnt(11)
M 180,216,32
v_fmac_f32 v128, v192, v56
v_fmac_f32 v129, v193, v56
v_fmac_f32 v130, v194, v56
v_fmac_f32 v131, v195, v56
v_mul_f32 v136, v136, v58
v_mul_f32 v137, v137, v58
M 176,248,28
v_mul_f32 v138, v138, v58
v_mul_f32 v139, v139, v58
s_waitcnt lgkmcnt(9)
v_fmac_f32 v136, v196, v56
v_fmac_f32 v137, v197, v56
v_fmac_f32 v138, v198, v56
M 180,248,36
v_fmac_f32 v139, v199, v56
PK 128,128,129
PK 129,130,131
PK 130,136,137
PK 131,138,139
buffer_store_dwordx4 v[128:131], v7, s[36:39], s34 offen offset:0 sc1
M 184,220,24
DR 216,11,4096
DR 248,11,5120
v_mul_f32 v132, v132, v59
v_mul_f32 v133, v133, v59
v_mul_f32 v134, v134, v59
v_mul_f32 v135, v135, v59
M 188,220,32
v_fmac_f32 v132, v224, v57
v_fmac_f32 v133, v225, v57
v_fmac_f32 v134, v226, v57
v_fmac_f32 v135, v227, v57
v_mul_f32 v140, v140, v59
v_mul_f32 v141, v141, v59
M 184,252,28
v_mul_f32 v142, v142, v59
v_mul_f32 v143, v143, v59
s_waitcnt lgkmcnt(10)
v_fmac_f32 v140, v228, v57
v_fmac_f32 v141, v229, v57
v_fmac_f32 v142, v230, v57
M 188,252,36
v_fmac_f32 v143, v231, v57
PK 132,132,133
PK 133,134,135
PK 134,140,141
PK 135,142,143
buffer_store_dwordx4 v[132:135], v7, s[36:39], s35 offen offset:0 sc1
DR 220,11,6144
DR 252,11,7168
v_mul_f32 v144, v144, v58
v_mul_f32 v145, v145, v58
v_mul_f32 v146, v146, v58
v_mul_f32 v147, v147, v58
s_waitcnt lgkmcnt(11)
v_fmac_f32 v144, v200, v56
v_fmac_f32 v145, v201, v56
v_fmac_f32 v146, v202, v56
v_fmac_f32 v147, v203, v56
v_mul_f32 v152, v152, v58
v_mul_f32 v153, v153, v58
v_mul_f32 v154, v154, v58
v_mul_f32 v155, v155, v58
s_waitcnt lgkmcnt(9)
v_fmac_f32 v152, v204, v56
v_fmac_f32 v153, v205, v56
v_fmac_f32 v154, v206, v56
v_fmac_f32 v155, v207, v56
PK 144,144,145
PK 145,146,147
PK 146,152,153
PK 147,154,155
buffer_store_dwordx4 v[144:147], v7, s[36:39], s34 offen offset:1024 sc1
v_mul_f32 v148, v148, v59
v_mul_f32 v149, v149, v59
v_mul_f32 v150, v150, v59
v_mul_f32 v151, v151, v59
v_fmac_f32 v148, v232, v57
v_fmac_f32 v149, v233, v57
v_fmac_f32 v150, v234, v57
v_fmac_f32 v151, v235, v57
v_mul_f32 v156, v156, v59
v_mul_f32 v157, v157, v59
v_mul_f32 v158, v158, v59
v_mul_f32 v159, v159, v59
s_waitcnt lgkmcnt(8)
v_fmac_f32 v156, v236, v57
v_fmac_f32 v157, v237, v57
v_fmac_f32 v158, v238, v57
v_fmac_f32 v159, v239, v57
PK 148,148,149
PK 149,150,151
PK 150,156,157
PK 151,158,159
buffer_store_dwordx4 v[148:151], v7, s[36:39], s35 offen offset:1024 sc1
v_mul_f32 v160, v160, v58
v_mul_f32 v161, v161, v58
v_mul_f32 v162, v162, v58
v_mul_f32 v163, v163, v58
s_waitcnt lgkmcnt(7)
v_fmac_f32 v160, v208, v56
v_fmac_f32 v161, v209, v56
v_fmac_f32 v162, v210, v56
v_fmac_f32 v163, v211, v56
v_mul_f32 v168, v168, v58
v_mul_f32 v169, v169, v58
v_mul_f32 v170, v170, v58
v_mul_f32 v171, v171, v58
s_waitcnt lgkmcnt(5)
v_fmac_f32 v168, v212, v56
v_fmac_f32 v169, v213, v56
v_fmac_f32 v170, v214, v56
v_fmac_f32 v171, v215, v56
PK 160,160,161
PK 161,162,163
PK 162,168,169
PK 163,170,171
buffer_store_dwordx4 v[160:163], v7, s[36:39], s34 offen offset:2048 sc1
v_mul_f32 v164, v164, v59
v_mul_f32 v165, v165, v59
v_mul_f32 v166, v166, v59
v_mul_f32 v167, v167, v59
v_fmac_f32 v164, v240, v57
v_fmac_f32 v165, v241, v57
v_fmac_f32 v166, v242, v57
v_fmac_f32 v167, v243, v57
v_mul_f32 v172, v172, v59
v_mul_f32 v173, v173, v59
v_mul_f32 v174, v174, v59
v_mul_f32 v175, v175, v59
s_waitcnt lgkmcnt(4)
v_fmac_f32 v172, v244, v57
v_fmac_f32 v173, v245, v57
v_fmac_f32 v174, v246, v57
v_fmac_f32 v175, v247, v57
PK 164,164,165
PK 165,166,167
PK 166,172,173
PK 167,174,175
buffer_store_dwordx4 v[164:167], v7, s[36:39], s35 offen offset:2048 sc1
v_mul_f32 v176, v176, v58
v_mul_f32 v177, v177, v58
v_mul_f32 v178, v178, v58
v_mul_f32 v179, v179, v58
s_waitcnt lgkmcnt(3)
v_fmac_f32 v176, v216, v56
v_fmac_f32 v177, v217, v56
v_fmac_f32 v178, v218, v56
v_fmac_f32 v179, v219, v56
v_mul_f32 v184, v184, v58
v_mul_f32 v185, v185, v58
v_mul_f32 v186, v186, v58
v_mul_f32 v187, v187, v58
s_waitcnt lgkmcnt(1)
v_fmac_f32 v184, v220, v56
v_fmac_f32 v185, v221, v56
v_fmac_f32 v186, v222, v56
v_fmac_f32 v187, v223, v56
PK 176,176,177
PK 177,178,179
PK 178,184,185
PK 179,186,187
buffer_store_dwordx4 v[176:179], v7, s[36:39], s34 offen offset:3072 sc1
v_mul_f32 v180, v180, v59
v_mul_f32 v181, v181, v59
v_mul_f32 v182, v182, v59
v_mul_f32 v183, v183, v59
v_fmac_f32 v180, v248, v57
v_fmac_f32 v181, v249, v57
v_fmac_f32 v182, v250, v57
v_fmac_f32 v183, v251, v57
v_mul_f32 v188, v188, v59
v_mul_f32 v189, v189, v59
v_mul_f32 v190, v190, v59
v_mul_f32 v191, v191, v59
s_waitcnt lgkmcnt(0)
v_fmac_f32 v188, v252, v57
v_fmac_f32 v189, v253, v57
v_fmac_f32 v190, v254, v57
v_fmac_f32 v191, v255, v57
PK 180,180,181
PK 181,182,183
PK 182,188,189
PK 183,190,191
buffer_store_dwordx4 v[180:183], v7, s[36:39], s35 offen offset:3072 sc1
s_branch L_k2_rend
L_finz_98:
MZ 128,192,24
MZ 132,192,32
M 128,224,28
M 132,224,36
MZ 136,196,24
MZ 140,196,32
M 136,228,28
M 140,228,36
MZ 144,200,24
MZ 148,200,32
M 144,232,28
M 148,232,36
MZ 152,204,24
MZ 156,204,32
M 152,236,28
M 156,236,36
s_waitcnt vmcnt(0)
s_barrier
DR 192,10,0
DR 224,10,1024
DR 196,10,2048
DR 228,10,3072
DR 200,10,4096
DR 232,10,5120
MZ 160,208,24
DR 204,10,6144
MZ 164,208,32
DR 236,10,7168
M 160,240,28
M 164,240,36
MZ 168,212,24
DR 208,11,0
MZ 172,212,32
DR 240,11,1024
M 168,244,28
M 172,244,36
MZ 176,216,24
DR 212,11,2048
DR 244,11,3072
v_mul_f32 v128, v128, v58
v_mul_f32 v129, v129, v58
v_mul_f32 v130, v130, v58
v_mul_f32 v131, v131, v58
s_waitcnt lgkmcnt(11)
MZ 180,216,32
v_fmac_f32 v128, v192, v56
v_fmac_f32 v129, v193, v56
v_fmac_f32 v130, v194, v56
v_fmac_f32 v131, v195, v56
v_mul_f32 v136, v136, v58
v_mul_f32 v137, v137, v58
M 176,248,28
v_mul_f32 v138, v138, v58
v_mul_f32 v139, v139, v58
s_waitcnt lgkmcnt(9)
v_fmac_f32 v136, v196, v56
v_fmac_f32 v137, v197, v56
v_fmac_f32 v138, v198, v56
M 180,248,36
v_fmac_f32 v139, v199, v56
PK 128,128,129
PK 129,130,131
PK 130,136,137
PK 131,138,139
buffer_store_dwordx4 v[128:131], v7, s[36:39], s34 offen offset:0 sc1
MZ 184,220,24
DR 216,11,4096
DR 248,11,5120
v_mul_f32 v132, v132, v59
v_mul_f32 v133, v133, v59
v_mul_f32 v134, v134, v59
v_mul_f32 v135, v135, v59
MZ 188,220,32
v_fmac_f32 v132, v224, v57
v_fmac_f32 v133, v225, v57
v_fmac_f32 v134, v226, v57
v_fmac_f32 v135, v227, v57
v_mul_f32 v140, v140, v59
v_mul_f32 v141, v141, v59
M 184,252,28
v_mul_f32 v142, v142, v59
v_mul_f32 v143, v143, v59
s_waitcnt lgkmcnt(10)
v_fmac_f32 v140, v228, v57
v_fmac_f32 v141, v229, v57
v_fmac_f32 v142, v230, v57
M 188,252,36
v_fmac_f32 v143, v231, v57
PK 132,132,133
PK 133,134,135
PK 134,140,141
PK 135,142,143
buffer_store_dwordx4 v[132:135], v7, s[36:39], s35 offen offset:0 sc1
DR 220,11,6144
DR 252,11,7168
v_mul_f32 v144, v144, v58
v_mul_f32 v145, v145, v58
v_mul_f32 v146, v146, v58
v_mul_f32 v147, v147, v58
s_waitcnt lgkmcnt(11)
v_fmac_f32 v144, v200, v56
v_fmac_f32 v145, v201, v56
v_fmac_f32 v146, v202, v56
v_fmac_f32 v147, v203, v56
v_mul_f32 v152, v152, v58
v_mul_f32 v153, v153, v58
v_mul_f32 v154, v154, v58
v_mul_f32 v155, v155, v58
s_waitcnt lgkmcnt(9)
v_fmac_f32 v152, v204, v56
v_fmac_f32 v153, v205, v56
v_fmac_f32 v154, v206, v56
v_fmac_f32 v155, v207, v56
PK 144,144,145
PK 145,146,147
PK 146,152,153
PK 147,154,155
buffer_store_dwordx4 v[144:147], v7, s[36:39], s34 offen offset:1024 sc1
v_mul_f32 v148, v148, v59
v_mul_f32 v149, v149, v59
v_mul_f32 v150, v150, v59
v_mul_f32 v151, v151, v59
v_fmac_f32 v148, v232, v57
v_fmac_f32 v149, v233, v57
v_fmac_f32 v150, v234, v57
v_fmac_f32 v151, v235, v57
v_mul_f32 v156, v156, v59
v_mul_f32 v157, v157, v59
v_mul_f32 v158, v158, v59
v_mul_f32 v159, v159, v59
s_waitcnt lgkmcnt(8)
v_fmac_f32 v156, v236, v57
v_fmac_f32 v157, v237, v57
v_fmac_f32 v158, v238, v57
v_fmac_f32 v159, v239, v57
PK 148,148,149
PK 149,150,151
PK 150,156,157
PK 151,158,159
buffer_store_dwordx4 v[148:151], v7, s[36:39], s35 offen offset:1024 sc1
v_mul_f32 v160, v160, v58
v_mul_f32 v161, v161, v58
v_mul_f32 v162, v162, v58
v_mul_f32 v163, v163, v58
s_waitcnt lgkmcnt(7)
v_fmac_f32 v160, v208, v56
v_fmac_f32 v161, v209, v56
v_fmac_f32 v162, v210, v56
v_fmac_f32 v163, v211, v56
v_mul_f32 v168, v168, v58
v_mul_f32 v169, v169, v58
v_mul_f32 v170, v170, v58
v_mul_f32 v171, v171, v58
s_waitcnt lgkmcnt(5)
v_fmac_f32 v168, v212, v56
v_fmac_f32 v169, v213, v56
v_fmac_f32 v170, v214, v56
v_fmac_f32 v171, v215, v56
PK 160,160,161
PK 161,162,163
PK 162,168,169
PK 163,170,171
buffer_store_dwordx4 v[160:163], v7, s[36:39], s34 offen offset:2048 sc1
v_mul_f32 v164, v164, v59
v_mul_f32 v165, v165, v59
v_mul_f32 v166, v166, v59
v_mul_f32 v167, v167, v59
v_fmac_f32 v164, v240, v57
v_fmac_f32 v165, v241, v57
v_fmac_f32 v166, v242, v57
v_fmac_f32 v167, v243, v57
v_mul_f32 v172, v172, v59
v_mul_f32 v173, v173, v59
v_mul_f32 v174, v174, v59
v_mul_f32 v175, v175, v59
s_waitcnt lgkmcnt(4)
v_fmac_f32 v172, v244, v57
v_fmac_f32 v173, v245, v57
v_fmac_f32 v174, v246, v57
v_fmac_f32 v175, v247, v57
PK 164,164,165
PK 165,166,167
PK 166,172,173
PK 167,174,175
buffer_store_dwordx4 v[164:167], v7, s[36:39], s35 offen offset:2048 sc1
v_mul_f32 v176, v176, v58
v_mul_f32 v177, v177, v58
v_mul_f32 v178, v178, v58
v_mul_f32 v179, v179, v58
s_waitcnt lgkmcnt(3)
v_fmac_f32 v176, v216, v56
v_fmac_f32 v177, v217, v56
v_fmac_f32 v178, v218, v56
v_fmac_f32 v179, v219, v56
v_mul_f32 v184, v184, v58
v_mul_f32 v185, v185, v58
v_mul_f32 v186, v186, v58
v_mul_f32 v187, v187, v58
s_waitcnt lgkmcnt(1)
v_fmac_f32 v184, v220, v56
v_fmac_f32 v185, v221, v56
v_fmac_f32 v186, v222, v56
v_fmac_f32 v187, v223, v56
PK 176,176,177
PK 177,178,179
PK 178,184,185
PK 179,186,187
buffer_store_dwordx4 v[176:179], v7, s[36:39], s34 offen offset:3072 sc1
v_mul_f32 v180, v180, v59
v_mul_f32 v181, v181, v59
v_mul_f32 v182, v182, v59
v_mul_f32 v183, v183, v59
v_fmac_f32 v180, v248, v57
v_fmac_f32 v181, v249, v57
v_fmac_f32 v182, v250, v57
v_fmac_f32 v183, v251, v57
v_mul_f32 v188, v188, v59
v_mul_f32 v189, v189, v59
v_mul_f32 v190, v190, v59
v_mul_f32 v191, v191, v59
s_waitcnt lgkmcnt(0)
v_fmac_f32 v188, v252, v57
v_fmac_f32 v189, v253, v57
v_fmac_f32 v190, v254, v57
v_fmac_f32 v191, v255, v57
PK 180,180,181
PK 181,182,183
PK 182,188,189
PK 183,190,191
buffer_store_dwordx4 v[180:183], v7, s[36:39], s35 offen offset:3072 sc1
L_k2_rend:
s_cmp_eq_u32 s32, 3
s_cbranch_scc0 L_k2_aend
s_mov_b32 s32, 1
s_mov_b32 s33, 0
s_waitcnt vmcnt(0) lgkmcnt(0)
s_barrier
s_branch L_k2_round
L_k2_aend:
s_cmp_eq_u32 s44, 6
s_cbranch_scc0 L_nocode_99
s_getpc_b64 s[96:97]
L_pc_100:
s_add_u32 s96, s96, L_p3-L_pc_100
s_addc_u32 s97, s97, 0
v_lshlrev_b32 v26, 7, v0
v_min_u32 v26, L_all_end-L_p3-4, v26
v_mov_b32 v27, s97
v_add_co_u32 v26, vcc, s96, v26
s_nop 1
v_addc_co_u32 v27, vcc, 0, v27, vcc
global_load_dword v14, v[26:27], off
L_nocode_99:
s_lshl_b32 s58, s44, 2
s_bfe_u32 s49, s43, 0x20001
s_add_u32 s58, s58, s49
s_add_u32 s58, s58, 21
s_lshl_b32 s58, s58, 7
s_lshr_b32 s49, s43, 3
s_lshl_b32 s49, s49, 3
s_add_u32 s58, s58, s49
s_and_b32 s49, s43, 1
s_lshl_b32 s49, s49, 2
s_add_u32 s58, s58, s49
s_branch L_p3
L_k2_slow:
s_cmp_eq_u32 s5, 0
s_cbranch_scc0 L_slow1_101
v_max3_f32 v48, v72, v73, v74
v_max3_f32 v48, v48, v75, v88
v_max3_f32 v48, v48, v89, v90
v_max3_f32 v48, v48, v91, v104
v_max3_f32 v48, v48, v105, v106
v_max3_f32 v48, v48, v107, v120
v_max3_f32 v48, v48, v121, v122
v_max_f32 v48, v48, v123
v_max3_f32 v49, v76, v77, v78
v_max3_f32 v49, v49, v79, v92
v_max3_f32 v49, v49, v93, v94
v_max3_f32 v49, v49, v95, v108
v_max3_f32 v49, v49, v109, v110
v_max3_f32 v49, v49, v111, v124
v_max3_f32 v49, v49, v125, v126
v_max_f32 v49, v49, v127
v_mov_b32 v50, v48
v_mov_b32 v51, v49
s_nop 1
v_permlane32_swap_b32 v50, v48
v_permlane32_swap_b32 v51, v49
s_nop 1
v_max_f32 v48, v48, v50
v_max_f32 v49, v49, v51
v_mov_b32 v50, v48
v_mov_b32 v51, v49
s_nop 1
v_permlane16_swap_b32 v50, v48
v_permlane16_swap_b32 v51, v49
s_nop 1
v_max_f32 v48, v48, v50
v_max_f32 v49, v49, v51
v_max_f32 v48, 0, v48
v_max_f32 v49, 0, v49
v_sub_f32 v72, v72, v48
v_sub_f32 v73, v73, v48
v_sub_f32 v74, v74, v48
v_sub_f32 v75, v75, v48
v_sub_f32 v76, v76, v49
v_sub_f32 v77, v77, v49
v_sub_f32 v78, v78, v49
v_sub_f32 v79, v79, v49
v_sub_f32 v88, v88, v48
v_sub_f32 v89, v89, v48
v_sub_f32 v90, v90, v48
v_sub_f32 v91, v91, v48
v_sub_f32 v92, v92, v49
v_sub_f32 v93, v93, v49
v_sub_f32 v94, v94, v49
v_sub_f32 v95, v95, v49
v_sub_f32 v104, v104, v48
v_sub_f32 v105, v105, v48
v_sub_f32 v106, v106, v48
v_sub_f32 v107, v107, v48
v_sub_f32 v108, v108, v49
v_sub_f32 v109, v109, v49
v_sub_f32 v110, v110, v49
v_sub_f32 v111, v111, v49
v_sub_f32 v120, v120, v48
v_sub_f32 v121, v121, v48
v_sub_f32 v122, v122, v48
v_sub_f32 v123, v123, v48
v_sub_f32 v124, v124, v49
v_sub_f32 v125, v125, v49
v_sub_f32 v126, v126, v49
v_sub_f32 v127, v127, v49
v_sub_f32 v16, v16, v48
v_sub_f32 v17, v17, v48
v_sub_f32 v18, v18, v48
v_sub_f32 v19, v19, v48
v_sub_f32 v20, v20, v49
v_sub_f32 v21, v21, v49
v_sub_f32 v22, v22, v49
v_sub_f32 v23, v23, v49
v_exp_f32 v48, -v48
v_exp_f32 v49, -v49
s_nop 0
v_mul_f32 v128, v128, v48
v_mul_f32 v129, v129, v48
v_mul_f32 v130, v130, v48
v_mul_f32 v131, v131, v48
v_mul_f32 v132, v132, v49
v_mul_f32 v133, v133, v49
v_mul_f32 v134, v134, v49
v_mul_f32 v135, v135, v49
v_mul_f32 v136, v136, v48
v_mul_f32 v137, v137, v48
v_mul_f32 v138, v138, v48
v_mul_f32 v139, v139, v48
v_mul_f32 v140, v140, v49
v_mul_f32 v141, v141, v49
v_mul_f32 v142, v142, v49
v_mul_f32 v143, v143, v49
v_mul_f32 v144, v144, v48
v_mul_f32 v145, v145, v48
v_mul_f32 v146, v146, v48
v_mul_f32 v147, v147, v48
v_mul_f32 v148, v148, v49
v_mul_f32 v149, v149, v49
v_mul_f32 v150, v150, v49
v_mul_f32 v151, v151, v49
v_mul_f32 v152, v152, v48
v_mul_f32 v153, v153, v48
v_mul_f32 v154, v154, v48
v_mul_f32 v155, v155, v48
v_mul_f32 v156, v156, v49
v_mul_f32 v157, v157, v49
v_mul_f32 v158, v158, v49
v_mul_f32 v159, v159, v49
v_mul_f32 v160, v160, v48
v_mul_f32 v161, v161, v48
v_mul_f32 v162, v162, v48
v_mul_f32 v163, v163, v48
v_mul_f32 v164, v164, v49
v_mul_f32 v165, v165, v49
v_mul_f32 v166, v166, v49
v_mul_f32 v167, v167, v49
v_mul_f32 v168, v168, v48
v_mul_f32 v169, v169, v48
v_mul_f32 v170, v170, v48
v_mul_f32 v171, v171, v48
v_mul_f32 v172, v172, v49
v_mul_f32 v173, v173, v49
v_mul_f32 v174, v174, v49
v_mul_f32 v175, v175, v49
v_mul_f32 v176, v176, v48
v_mul_f32 v177, v177, v48
v_mul_f32 v178, v178, v48
v_mul_f32 v179, v179, v48
v_mul_f32 v180, v180, v49
v_mul_f32 v181, v181, v49
v_mul_f32 v182, v182, v49
v_mul_f32 v183, v183, v49
v_mul_f32 v184, v184, v48
v_mul_f32 v185, v185, v48
v_mul_f32 v186, v186, v48
v_mul_f32 v187, v187, v48
v_mul_f32 v188, v188, v49
v_mul_f32 v189, v189, v49
v_mul_f32 v190, v190, v49
v_mul_f32 v191, v191, v49
v_mul_f32 v4, v4, v48
v_mul_f32 v5, v5, v49
s_branch L_slow2_102
L_slow1_101:
v_max3_f32 v48, v72, v73, v74
v_max3_f32 v48, v48, v75, v88
v_max3_f32 v48, v48, v89, v90
v_max3_f32 v48, v48, v91, v104
v_max3_f32 v48, v48, v105, v106
v_max3_f32 v48, v48, v107, v120
v_max3_f32 v48, v48, v121, v122
v_max_f32 v48, v48, v123
v_max3_f32 v49, v76, v77, v78
v_max3_f32 v49, v49, v79, v92
v_max3_f32 v49, v49, v93, v94
v_max3_f32 v49, v49, v95, v108
v_max3_f32 v49, v49, v109, v110
v_max3_f32 v49, v49, v111, v124
v_max3_f32 v49, v49, v125, v126
v_max_f32 v49, v49, v127
v_mov_b32 v50, v48
v_mov_b32 v51, v49
s_nop 1
v_permlane32_swap_b32 v50, v48
v_permlane32_swap_b32 v51, v49
s_nop 1
v_max_f32 v48, v48, v50
v_max_f32 v49, v49, v51
v_mov_b32 v50, v48
v_mov_b32 v51, v49
s_nop 1
v_permlane16_swap_b32 v50, v48
v_permlane16_swap_b32 v51, v49
s_nop 1
v_max_f32 v48, v48, v50
v_max_f32 v49, v49, v51
v_sub_f32 v72, v72, v48
v_sub_f32 v73, v73, v48
v_sub_f32 v74, v74, v48
v_sub_f32 v75, v75, v48
v_sub_f32 v76, v76, v49
v_sub_f32 v77, v77, v49
v_sub_f32 v78, v78, v49
v_sub_f32 v79, v79, v49
v_sub_f32 v88, v88, v48
v_sub_f32 v89, v89, v48
v_sub_f32 v90, v90, v48
v_sub_f32 v91, v91, v48
v_sub_f32 v92, v92, v49
v_sub_f32 v93, v93, v49
v_sub_f32 v94, v94, v49
v_sub_f32 v95, v95, v49
v_sub_f32 v104, v104, v48
v_sub_f32 v105, v105, v48
v_sub_f32 v106, v106, v48
v_sub_f32 v107, v107, v48
v_sub_f32 v108, v108, v49
v_sub_f32 v109, v109, v49
v_sub_f32 v110, v110, v49
v_sub_f32 v111, v111, v49
v_sub_f32 v120, v120, v48
v_sub_f32 v121, v121, v48
v_sub_f32 v122, v122, v48
v_sub_f32 v123, v123, v48
v_sub_f32 v124, v124, v49
v_sub_f32 v125, v125, v49
v_sub_f32 v126, v126, v49
v_sub_f32 v127, v127, v49
v_sub_f32 v16, v16, v48
v_sub_f32 v17, v17, v48
v_sub_f32 v18, v18, v48
v_sub_f32 v19, v19, v48
v_sub_f32 v20, v20, v49
v_sub_f32 v21, v21, v49
v_sub_f32 v22, v22, v49
v_sub_f32 v23, v23, v49
L_slow2_102:
v_exp_f32 v40, v72
v_exp_f32 v41, v73
v_exp_f32 v42, v74
v_exp_f32 v43, v75
v_exp_f32 v44, v76
v_exp_f32 v45, v77
v_exp_f32 v46, v78
v_exp_f32 v47, v79
v_add_f32 v8, v40, v41
v_add_f32 v9, v44, v45
PK 24,40,41
PK 32,44,45
v_add_f32 v8, v8, v42
v_add_f32 v9, v9, v46
PK 25,42,43
PK 33,46,47
v_add_f32 v8, v8, v43
v_add_f32 v9, v9, v47
v_exp_f32 v40, v88
v_exp_f32 v41, v89
v_exp_f32 v42, v90
v_exp_f32 v43, v91
v_add_f32 v8, v8, v40
v_add_f32 v8, v8, v41
PK 26,40,41
v_add_f32 v8, v8, v42
v_add_f32 v8, v8, v43
PK 27,42,43
v_exp_f32 v44, v92
v_exp_f32 v45, v93
v_exp_f32 v46, v94
v_exp_f32 v47, v95
v_add_f32 v9, v9, v44
v_add_f32 v9, v9, v45
PK 34,44,45
v_add_f32 v9, v9, v46
v_add_f32 v9, v9, v47
PK 35,46,47
v_exp_f32 v40, v104
v_exp_f32 v41, v105
v_exp_f32 v42, v106
v_exp_f32 v43, v107
v_add_f32 v8, v8, v40
v_add_f32 v8, v8, v41
PK 28,40,41
v_add_f32 v8, v8, v42
v_add_f32 v8, v8, v43
PK 29,42,43
v_exp_f32 v44, v108
v_exp_f32 v45, v109
v_exp_f32 v46, v110
v_exp_f32 v47, v111
v_add_f32 v9, v9, v44
v_add_f32 v9, v9, v45
PK 36,44,45
v_add_f32 v9, v9, v46
v_add_f32 v9, v9, v47
PK 37,46,47
v_exp_f32 v40, v120
v_exp_f32 v41, v121
v_exp_f32 v42, v122
v_exp_f32 v43, v123
v_add_f32 v8, v8, v40
v_add_f32 v8, v8, v41
PK 30,40,41
v_add_f32 v8, v8, v42
v_add_f32 v8, v8, v43
PK 31,42,43
v_exp_f32 v44, v124
v_exp_f32 v45, v125
v_exp_f32 v46, v126
v_exp_f32 v47, v127
v_add_f32 v9, v9, v44
v_add_f32 v9, v9, v45
PK 38,44,45
v_add_f32 v9, v9, v46
v_add_f32 v9, v9, v47
PK 39,46,47
s_branch L_k2_back
L_k2_sp:
s_lshl_b32 s57, s3, 13
s_and_b32 s44, s41, 3
s_bfe_u32 s49, s41, 0x10002
s_add_u32 s3, s3, s49
s_and_b32 s42, s40, 3
s_lshr_b32 s41, s40, 2
s_mov_b32 s20, s6
s_mov_b32 s21, s7
s_mov_b32 s22, 8388608
s_mov_b32 s23, 0x20000
s_add_u32 s24, s16, 39845888
s_addc_u32 s25, s17, 0
s_mov_b32 s26, 3670016
s_mov_b32 s27, 0x20000
v_and_b32 v28, 63, v0
v_lshlrev_b32 v7, 4, v28
v_bfe_u32 v28, v0, 3, 3
v_and_b32 v29, 7, v0
v_lshrrev_b32 v30, 1, v28
v_xor_b32 v29, v29, v30
s_lshl_b32 s49, s3, 8
s_lshl_b32 s50, s40, 5
s_add_u32 s49, s49, s50
v_add_u32 v28, s49, v28
v_lshlrev_b32 v28, 12, v28
v_xor_b32 v30, 4, v29
v_lshl_add_u32 v29, v29, 4, v28
v_lshl_add_u32 v30, v30, 4, v28
v_add_u32 v80, 0, v29
v_add_u32 v81, 31744, v30
v_add_u32 v82, 63488, v29
v_add_u32 v83, 95232, v30
s_lshl_b32 s48, s40, 1
s_min_u32 s48, s48, 12
s_mul_i32 s49, s44, 14
s_add_u32 s49, s49, s48
s_lshl_b32 s43, s49, 10
s_mov_b32 s45, 0
s_lshl_b32 s46, s40, 12
s_lshl_b32 s47, s48, 10
s_add_u32 s47, s47, 98304
s_waitcnt vmcnt(0)
s_barrier
s_cmp_lg_u32 s40, 0
s_cbranch_scc1 L_nw_103
v_lshlrev_b32 v10, 13, v0
v_add_u32 v10, s58, v10
v_mov_b32 v11, s59
s_mov_b64 exec, 0xff
global_store_dword v10, v11, s[100:101] sc1
s_mov_b64 exec, -1
v_min_u32 v14, 55, v0
v_and_b32 v15, 7, v14
v_lshrrev_b32 v14, 3, v14
v_lshlrev_b32 v14, 7, v14
v_lshl_add_u32 v14, v15, 2, v14
s_add_u32 s49, s57, 1824
v_add_u32 v14, s49, v14
global_load_dword v12, v14, s[100:101] sc1
L_nw_103:
s_barrier
s_add_u32 m0, s46, 0
s_nop 0
buffer_load_dwordx4 v80, s[20:23], s45 offen offset:0  lds
buffer_load_dwordx4 v81, s[20:23], s45 offen offset:1024  lds
s_add_u32 m0, s46, 0
s_nop 0
buffer_load_dwordx4 v82, s[20:23], s45 offen offset:2048  lds
buffer_load_dwordx4 v83, s[20:23], s45 offen offset:3072  lds
s_add_u32 s45, s45, 128
s_cmp_lg_u32 s40, 0
s_cbranch_scc1 L_nw_104
s_waitcnt vmcnt(4)
s_branch L_chk_106
L_spin_105:
s_sleep 10
global_load_dword v12, v14, s[100:101] sc1
s_waitcnt vmcnt(0)
L_chk_106:
v_cmp_ne_u32 vcc, s59, v12
s_cbranch_vccnz L_spin_105
v_min_u32 v14, 39, v0
v_and_b32 v15, 3, v14
v_lshrrev_b32 v14, 2, v14
v_lshlrev_b32 v14, 7, v14
v_lshl_add_u32 v14, v15, 3, v14
s_add_u32 s49, s57, 1408
v_add_u32 v14, s49, v14
L_nw_104:
s_barrier
s_add_u32 m0, s47, 0
s_nop 0
buffer_load_dwordx4 v7, s[24:27], s43 offen offset:0 sc1 lds
buffer_load_dwordx4 v7, s[24:27], s43 offen offset:1024 sc1 lds
s_add_u32 s43, s43, 57344
s_mov_b32 s12, s8
s_mov_b32 s13, s9
s_mov_b32 s14, 4096
s_mov_b32 s15, 0x20000
v_and_b32 v11, 15, v0
v_lshlrev_b32 v11, 1, v11
s_lshl_b32 s49, s3, 9
s_lshl_b32 s50, s42, 7
s_add_u32 s49, s49, s50
buffer_load_ushort v16, v11, s[12:15], s49 offen offset:0
buffer_load_ushort v17, v11, s[12:15], s49 offen offset:32
buffer_load_ushort v18, v11, s[12:15], s49 offen offset:64
buffer_load_ushort v19, v11, s[12:15], s49 offen offset:96
s_barrier
s_add_u32 m0, s47, 14336
s_nop 0
buffer_load_dwordx4 v7, s[24:27], s43 offen offset:0 sc1 lds
buffer_load_dwordx4 v7, s[24:27], s43 offen offset:1024 sc1 lds
s_add_u32 s43, s43, 57344
s_add_u32 s28, s16, 35651584
s_addc_u32 s29, s17, 0
s_mov_b32 s30, 3670016
s_mov_b32 s31, 0x20000
s_add_u32 s36, s16, 46137344
s_addc_u32 s37, s17, 0
s_mov_b32 s38, 20447232
s_mov_b32 s39, 0x20000
s_mul_i32 s49, s41, 7168
s_add_u32 s49, s49, 98304
v_add_u32 v4, s49, v7
v_and_b32 v28, 15, v0
v_bfe_u32 v29, v0, 4, 2
v_lshrrev_b32 v30, 1, v28
v_xor_b32 v29, v29, v30
v_lshlrev_b32 v29, 4, v29
v_lshl_add_u32 v29, v28, 7, v29
s_lshl_b32 s49, s42, 13
v_add_u32 v1, s49, v29
v_xor_b32 v2, 64, v1
v_add_u32 v5, 0x10000, v1
v_add_u32 v6, 0x10000, v2
s_waitcnt vmcnt(2)
s_barrier
DR 116,4,0
DR 84,1,0
DR 88,1,2048
DR 92,1,4096
DR 96,1,6144
DR 120,4,1024
DR 124,4,2048
DR 128,4,3072
v_lshlrev_b32 v24, 16, v16
v_lshlrev_b32 v25, 16, v16
v_lshlrev_b32 v26, 16, v16
v_lshlrev_b32 v27, 16, v16
v_lshlrev_b32 v28, 16, v17
v_lshlrev_b32 v29, 16, v17
v_lshlrev_b32 v30, 16, v17
v_lshlrev_b32 v31, 16, v17
v_lshlrev_b32 v32, 16, v18
v_lshlrev_b32 v33, 16, v18
v_lshlrev_b32 v34, 16, v18
v_lshlrev_b32 v35, 16, v18
v_lshlrev_b32 v36, 16, v19
v_lshlrev_b32 v37, 16, v19
v_lshlrev_b32 v38, 16, v19
v_lshlrev_b32 v39, 16, v19
s_mov_b32 s52, 0
s_waitcnt lgkmcnt(3)
MC 144,116,84,24
DR 132,4,4096
MC 148,116,88,28
s_add_u32 m0, s46, 32768
s_nop 0
buffer_load_dwordx4 v80, s[20:23], s45 offen offset:0  lds
MC 152,116,92,32
MC 156,116,96,36
buffer_load_dwordx4 v81, s[20:23], s45 offen offset:1024  lds
s_waitcnt lgkmcnt(3)
MC 160,120,84,24
DR 136,4,5120
MC 164,120,88,28
s_add_u32 m0, s46, 32768
s_nop 0
buffer_load_dwordx4 v82, s[20:23], s45 offen offset:2048  lds
MC 168,120,92,32
MC 172,120,96,36
buffer_load_dwordx4 v83, s[20:23], s45 offen offset:3072  lds
s_add_u32 s45, s45, 128
s_waitcnt lgkmcnt(3)
MC 176,124,84,24
DR 140,4,6144
MC 180,124,88,28
s_add_u32 m0, s47, 28672
s_nop 0
buffer_load_dwordx4 v7, s[24:27], s43 offen offset:0 sc1 lds
MC 184,124,92,32
MC 188,124,96,36
buffer_load_dwordx4 v7, s[24:27], s43 offen offset:1024 sc1 lds
s_add_u32 s43, s43, 57344
s_waitcnt lgkmcnt(3)
MC 192,128,84,24
s_waitcnt vmcnt(6)
s_barrier
DR 116,4,14336
MC 196,128,88,28
DR 100,2,0
MC 200,128,92,32
DR 104,2,2048
MC 204,128,96,36
s_add_u32 m0, s47, 43008
s_nop 0
buffer_load_dwordx4 v7, s[24:27], s43 offen offset:0 sc1 lds
s_waitcnt lgkmcnt(5)
MC 208,132,84,24
DR 108,2,4096
MC 212,132,88,28
DR 112,2,6144
MC 216,132,92,32
DR 120,4,15360
MC 220,132,96,36
buffer_load_dwordx4 v7, s[24:27], s43 offen offset:1024 sc1 lds
s_add_u32 s43, s43, 57344
s_waitcnt lgkmcnt(7)
MC 224,136,84,24
DR 124,4,16384
MC 228,136,88,28
MC 232,136,92,32
MC 236,136,96,36
s_add_u32 m0, s46, 65536
s_nop 0
buffer_load_dwordx4 v80, s[20:23], s45 offen offset:0  lds
s_waitcnt lgkmcnt(7)
MC 240,140,84,24
DR 128,4,17408
MC 244,140,88,28
MC 248,140,92,32
MC 252,140,96,36
buffer_load_dwordx4 v81, s[20:23], s45 offen offset:1024  lds
s_waitcnt lgkmcnt(3)
M 144,116,100
DR 132,4,18432
M 148,116,104
M 152,116,108
M 156,116,112
s_waitcnt lgkmcnt(3)
M 160,120,100
DR 136,4,19456
M 164,120,104
M 168,120,108
M 172,120,112
s_waitcnt lgkmcnt(3)
M 176,124,100
DR 140,4,20480
M 180,124,104
M 184,124,108
M 188,124,112
s_waitcnt lgkmcnt(3)
M 192,128,100
s_waitcnt vmcnt(4)
s_barrier
DR 116,4,28672
M 196,128,104
DR 84,1,32768
M 200,128,108
DR 88,1,34816
M 204,128,112
s_add_u32 m0, s47, 0
s_nop 0
buffer_load_dwordx4 v7, s[24:27], s43 offen offset:0 sc1 lds
s_waitcnt lgkmcnt(5)
M 208,132,100
DR 92,1,36864
M 212,132,104
DR 96,1,38912
M 216,132,108
DR 120,4,29696
M 220,132,112
buffer_load_dwordx4 v7, s[24:27], s43 offen offset:1024 sc1 lds
s_add_u32 s43, s43, 57344
s_waitcnt lgkmcnt(7)
M 224,136,100
DR 124,4,30720
M 228,136,104
M 232,136,108
M 236,136,112
s_add_u32 m0, s46, 65536
s_nop 0
buffer_load_dwordx4 v82, s[20:23], s45 offen offset:2048  lds
s_waitcnt lgkmcnt(7)
M 240,140,100
DR 128,4,31744
M 244,140,104
M 248,140,108
M 252,140,112
buffer_load_dwordx4 v83, s[20:23], s45 offen offset:3072  lds
s_add_u32 s45, s45, 128
s_waitcnt lgkmcnt(3)
M 144,116,84
DR 132,4,32768
M 148,116,88
M 152,116,92
M 156,116,96
s_waitcnt lgkmcnt(3)
M 160,120,84
DR 136,4,33792
M 164,120,88
M 168,120,92
M 172,120,96
s_waitcnt lgkmcnt(3)
M 176,124,84
DR 140,4,34816
M 180,124,88
M 184,124,92
M 188,124,96
s_waitcnt lgkmcnt(3)
M 192,128,84
s_waitcnt vmcnt(6)
s_barrier
DR 116,4,43008
M 196,128,88
DR 100,2,32768
M 200,128,92
DR 104,2,34816
M 204,128,96
s_add_u32 m0, s47, 14336
s_nop 0
buffer_load_dwordx4 v7, s[24:27], s43 offen offset:0 sc1 lds
s_waitcnt lgkmcnt(5)
M 208,132,84
DR 108,2,36864
M 212,132,88
DR 112,2,38912
M 216,132,92
DR 120,4,44032
M 220,132,96
buffer_load_dwordx4 v7, s[24:27], s43 offen offset:1024 sc1 lds
s_add_u32 s43, s43, 57344
s_waitcnt lgkmcnt(7)
M 224,136,84
DR 124,4,45056
M 228,136,88
M 232,136,92
M 236,136,96
s_add_u32 m0, s46, 0
s_nop 0
buffer_load_dwordx4 v80, s[20:23], s45 offen offset:0  lds
s_waitcnt lgkmcnt(7)
M 240,140,84
DR 128,4,46080
M 244,140,88
M 248,140,92
M 252,140,96
buffer_load_dwordx4 v81, s[20:23], s45 offen offset:1024  lds
s_waitcnt lgkmcnt(3)
M 144,116,100
DR 132,4,47104
M 148,116,104
M 152,116,108
M 156,116,112
s_waitcnt lgkmcnt(3)
M 160,120,100
DR 136,4,48128
M 164,120,104
M 168,120,108
M 172,120,112
s_waitcnt lgkmcnt(3)
M 176,124,100
DR 140,4,49152
M 180,124,104
M 184,124,108
M 188,124,112
s_waitcnt lgkmcnt(3)
M 192,128,100
s_waitcnt vmcnt(4)
s_barrier
DR 116,4,0
M 196,128,104
DR 84,5,0
M 200,128,108
DR 88,5,2048
M 204,128,112
s_add_u32 m0, s47, 28672
s_nop 0
buffer_load_dwordx4 v7, s[24:27], s43 offen offset:0 sc1 lds
s_waitcnt lgkmcnt(5)
M 208,132,100
DR 92,5,4096
M 212,132,104
DR 96,5,6144
M 216,132,108
DR 120,4,1024
M 220,132,112
buffer_load_dwordx4 v7, s[24:27], s43 offen offset:1024 sc1 lds
s_add_u32 s43, s43, 57344
s_waitcnt lgkmcnt(7)
M 224,136,100
DR 124,4,2048
M 228,136,104
M 232,136,108
M 236,136,112
s_add_u32 m0, s46, 0
s_nop 0
buffer_load_dwordx4 v82, s[20:23], s45 offen offset:2048  lds
s_waitcnt lgkmcnt(7)
M 240,140,100
DR 128,4,3072
M 244,140,104
M 248,140,108
M 252,140,112
buffer_load_dwordx4 v83, s[20:23], s45 offen offset:3072  lds
s_add_u32 s45, s45, 128
L_k2_sploop:
s_waitcnt lgkmcnt(3)
M 144,116,84
DR 132,4,4096
M 148,116,88
M 152,116,92
M 156,116,96
s_waitcnt lgkmcnt(3)
M 160,120,84
DR 136,4,5120
M 164,120,88
M 168,120,92
M 172,120,96
s_waitcnt lgkmcnt(3)
M 176,124,84
DR 140,4,6144
M 180,124,88
M 184,124,92
M 188,124,96
s_waitcnt lgkmcnt(3)
M 192,128,84
s_waitcnt vmcnt(6)
s_barrier
DR 116,4,14336
M 196,128,88
DR 100,6,0
M 200,128,92
DR 104,6,2048
M 204,128,96
s_add_u32 m0, s47, 43008
s_nop 0
buffer_load_dwordx4 v7, s[24:27], s43 offen offset:0 sc1 lds
s_waitcnt lgkmcnt(5)
M 208,132,84
DR 108,6,4096
M 212,132,88
DR 112,6,6144
M 216,132,92
DR 120,4,15360
M 220,132,96
buffer_load_dwordx4 v7, s[24:27], s43 offen offset:1024 sc1 lds
s_add_u32 s43, s43, 57344
s_waitcnt lgkmcnt(7)
M 224,136,84
DR 124,4,16384
M 228,136,88
M 232,136,92
M 236,136,96
s_add_u32 m0, s46, 32768
s_nop 0
buffer_load_dwordx4 v80, s[20:23], s45 offen offset:0  lds
s_waitcnt lgkmcnt(7)
M 240,140,84
DR 128,4,17408
M 244,140,88
M 248,140,92
M 252,140,96
buffer_load_dwordx4 v81, s[20:23], s45 offen offset:1024  lds
s_waitcnt lgkmcnt(3)
M 144,116,100
DR 132,4,18432
M 148,116,104
M 152,116,108
M 156,116,112
s_waitcnt lgkmcnt(3)
M 160,120,100
DR 136,4,19456
M 164,120,104
M 168,120,108
M 172,120,112
s_waitcnt lgkmcnt(3)
M 176,124,100
DR 140,4,20480
M 180,124,104
M 184,124,108
M 188,124,112
s_waitcnt lgkmcnt(3)
M 192,128,100
s_waitcnt vmcnt(4)
s_barrier
DR 116,4,28672
M 196,128,104
DR 84,1,0
M 200,128,108
DR 88,1,2048
M 204,128,112
s_add_u32 m0, s47, 0
s_nop 0
buffer_load_dwordx4 v7, s[24:27], s43 offen offset:0 sc1 lds
s_waitcnt lgkmcnt(5)
M 208,132,100
DR 92,1,4096
M 212,132,104
DR 96,1,6144
M 216,132,108
DR 120,4,29696
M 220,132,112
buffer_load_dwordx4 v7, s[24:27], s43 offen offset:1024 sc1 lds
s_add_u32 s43, s43, 57344
s_waitcnt lgkmcnt(7)
M 224,136,100
DR 124,4,30720
M 228,136,104
M 232,136,108
M 236,136,112
s_add_u32 m0, s46, 32768
s_nop 0
buffer_load_dwordx4 v82, s[20:23], s45 offen offset:2048  lds
s_waitcnt lgkmcnt(7)
M 240,140,100
DR 128,4,31744
M 244,140,104
M 248,140,108
M 252,140,112
buffer_load_dwordx4 v83, s[20:23], s45 offen offset:3072  lds
s_add_u32 s45, s45, 128
s_waitcnt lgkmcnt(3)
M 144,116,84
DR 132,4,32768
M 148,116,88
M 152,116,92
M 156,116,96
s_waitcnt lgkmcnt(3)
M 160,120,84
DR 136,4,33792
M 164,120,88
M 168,120,92
M 172,120,96
s_waitcnt lgkmcnt(3)
M 176,124,84
DR 140,4,34816
M 180,124,88
M 184,124,92
M 188,124,96
s_waitcnt lgkmcnt(3)
M 192,128,84
s_waitcnt vmcnt(6)
s_barrier
DR 116,4,43008
M 196,128,88
DR 100,2,0
M 200,128,92
DR 104,2,2048
M 204,128,96
s_add_u32 m0, s47, 14336
s_nop 0
buffer_load_dwordx4 v7, s[24:27], s43 offen offset:0 sc1 lds
s_waitcnt lgkmcnt(5)
M 208,132,84
DR 108,2,4096
M 212,132,88
DR 112,2,6144
M 216,132,92
DR 120,4,44032
M 220,132,96
buffer_load_dwordx4 v7, s[24:27], s43 offen offset:1024 sc1 lds
s_add_u32 s43, s43, 57344
s_waitcnt lgkmcnt(7)
M 224,136,84
DR 124,4,45056
M 228,136,88
M 232,136,92
M 236,136,96
s_add_u32 m0, s46, 65536
s_nop 0
buffer_load_dwordx4 v80, s[20:23], s45 offen offset:0  lds
s_waitcnt lgkmcnt(7)
M 240,140,84
DR 128,4,46080
M 244,140,88
M 248,140,92
M 252,140,96
buffer_load_dwordx4 v81, s[20:23], s45 offen offset:1024  lds
s_waitcnt lgkmcnt(3)
M 144,116,100
DR 132,4,47104
M 148,116,104
M 152,116,108
M 156,116,112
s_waitcnt lgkmcnt(3)
M 160,120,100
DR 136,4,48128
M 164,120,104
M 168,120,108
M 172,120,112
s_waitcnt lgkmcnt(3)
M 176,124,100
DR 140,4,49152
M 180,124,104
M 184,124,108
M 188,124,112
s_waitcnt lgkmcnt(3)
M 192,128,100
s_waitcnt vmcnt(4)
s_barrier
DR 116,4,0
M 196,128,104
DR 84,1,32768
M 200,128,108
DR 88,1,34816
M 204,128,112
s_add_u32 m0, s47, 28672
s_nop 0
buffer_load_dwordx4 v7, s[24:27], s43 offen offset:0 sc1 lds
s_waitcnt lgkmcnt(5)
M 208,132,100
DR 92,1,36864
M 212,132,104
DR 96,1,38912
M 216,132,108
DR 120,4,1024
M 220,132,112
buffer_load_dwordx4 v7, s[24:27], s43 offen offset:1024 sc1 lds
s_add_u32 s43, s43, 57344
s_waitcnt lgkmcnt(7)
M 224,136,100
DR 124,4,2048
M 228,136,104
M 232,136,108
M 236,136,112
s_add_u32 m0, s46, 65536
s_nop 0
buffer_load_dwordx4 v82, s[20:23], s45 offen offset:2048  lds
s_waitcnt lgkmcnt(7)
M 240,140,100
DR 128,4,3072
M 244,140,104
M 248,140,108
M 252,140,112
buffer_load_dwordx4 v83, s[20:23], s45 offen offset:3072  lds
s_add_u32 s45, s45, 128
s_waitcnt lgkmcnt(3)
M 144,116,84
DR 132,4,4096
M 148,116,88
M 152,116,92
M 156,116,96
s_waitcnt lgkmcnt(3)
M 160,120,84
DR 136,4,5120
M 164,120,88
M 168,120,92
M 172,120,96
s_waitcnt lgkmcnt(3)
M 176,124,84
DR 140,4,6144
M 180,124,88
M 184,124,92
M 188,124,96
s_waitcnt lgkmcnt(3)
M 192,128,84
s_waitcnt vmcnt(6)
s_barrier
DR 116,4,14336
M 196,128,88
DR 100,2,32768
M 200,128,92
DR 104,2,34816
M 204,128,96
s_add_u32 m0, s47, 43008
s_nop 0
buffer_load_dwordx4 v7, s[24:27], s43 offen offset:0 sc1 lds
s_waitcnt lgkmcnt(5)
M 208,132,84
DR 108,2,36864
M 212,132,88
DR 112,2,38912
M 216,132,92
DR 120,4,15360
M 220,132,96
buffer_load_dwordx4 v7, s[24:27], s43 offen offset:1024 sc1 lds
s_add_u32 s43, s43, 57344
s_waitcnt lgkmcnt(7)
M 224,136,84
DR 124,4,16384
M 228,136,88
M 232,136,92
M 236,136,96
s_add_u32 m0, s46, 0
s_nop 0
buffer_load_dwordx4 v80, s[20:23], s45 offen offset:0  lds
s_waitcnt lgkmcnt(7)
M 240,140,84
DR 128,4,17408
M 244,140,88
M 248,140,92
M 252,140,96
buffer_load_dwordx4 v81, s[20:23], s45 offen offset:1024  lds
s_waitcnt lgkmcnt(3)
M 144,116,100
DR 132,4,18432
M 148,116,104
M 152,116,108
M 156,116,112
s_waitcnt lgkmcnt(3)
M 160,120,100
DR 136,4,19456
M 164,120,104
M 168,120,108
M 172,120,112
s_waitcnt lgkmcnt(3)
M 176,124,100
DR 140,4,20480
M 180,124,104
M 184,124,108
M 188,124,112
s_waitcnt lgkmcnt(3)
M 192,128,100
s_waitcnt vmcnt(4)
s_barrier
DR 116,4,28672
M 196,128,104
DR 84,5,0
M 200,128,108
DR 88,5,2048
M 204,128,112
s_add_u32 m0, s47, 0
s_nop 0
buffer_load_dwordx4 v7, s[24:27], s43 offen offset:0 sc1 lds
s_waitcnt lgkmcnt(5)
M 208,132,100
DR 92,5,4096
M 212,132,104
DR 96,5,6144
M 216,132,108
DR 120,4,29696
M 220,132,112
buffer_load_dwordx4 v7, s[24:27], s43 offen offset:1024 sc1 lds
s_add_u32 s43, s43, 57344
s_waitcnt lgkmcnt(7)
M 224,136,100
DR 124,4,30720
M 228,136,104
M 232,136,108
M 236,136,112
s_add_u32 m0, s46, 0
s_nop 0
buffer_load_dwordx4 v82, s[20:23], s45 offen offset:2048  lds
s_waitcnt lgkmcnt(7)
M 240,140,100
DR 128,4,31744
M 244,140,104
M 248,140,108
M 252,140,112
buffer_load_dwordx4 v83, s[20:23], s45 offen offset:3072  lds
s_add_u32 s45, s45, 128
s_waitcnt lgkmcnt(3)
M 144,116,84
DR 132,4,32768
M 148,116,88
M 152,116,92
M 156,116,96
s_waitcnt lgkmcnt(3)
M 160,120,84
DR 136,4,33792
M 164,120,88
M 168,120,92
M 172,120,96
s_waitcnt lgkmcnt(3)
M 176,124,84
DR 140,4,34816
M 180,124,88
M 184,124,92
M 188,124,96
s_waitcnt lgkmcnt(3)
M 192,128,84
s_waitcnt vmcnt(6)
s_barrier
DR 116,4,43008
M 196,128,88
DR 100,6,0
M 200,128,92
DR 104,6,2048
M 204,128,96
s_add_u32 m0, s47, 14336
s_nop 0
buffer_load_dwordx4 v7, s[24:27], s43 offen offset:0 sc1 lds
s_waitcnt lgkmcnt(5)
M 208,132,84
DR 108,6,4096
M 212,132,88
DR 112,6,6144
M 216,132,92
DR 120,4,44032
M 220,132,96
buffer_load_dwordx4 v7, s[24:27], s43 offen offset:1024 sc1 lds
s_add_u32 s43, s43, 57344
s_waitcnt lgkmcnt(7)
M 224,136,84
DR 124,4,45056
M 228,136,88
M 232,136,92
M 236,136,96
s_add_u32 m0, s46, 32768
s_nop 0
buffer_load_dwordx4 v80, s[20:23], s45 offen offset:0  lds
s_waitcnt lgkmcnt(7)
M 240,140,84
DR 128,4,46080
M 244,140,88
M 248,140,92
M 252,140,96
buffer_load_dwordx4 v81, s[20:23], s45 offen offset:1024  lds
s_waitcnt lgkmcnt(3)
M 144,116,100
DR 132,4,47104
M 148,116,104
M 152,116,108
M 156,116,112
s_waitcnt lgkmcnt(3)
M 160,120,100
DR 136,4,48128
M 164,120,104
M 168,120,108
M 172,120,112
s_waitcnt lgkmcnt(3)
M 176,124,100
DR 140,4,49152
M 180,124,104
M 184,124,108
M 188,124,112
s_waitcnt lgkmcnt(3)
M 192,128,100
s_waitcnt vmcnt(4)
s_barrier
DR 116,4,0
M 196,128,104
DR 84,1,0
M 200,128,108
DR 88,1,2048
M 204,128,112
s_add_u32 m0, s47, 28672
s_nop 0
buffer_load_dwordx4 v7, s[24:27], s43 offen offset:0 sc1 lds
s_waitcnt lgkmcnt(5)
M 208,132,100
DR 92,1,4096
M 212,132,104
DR 96,1,6144
M 216,132,108
DR 120,4,1024
M 220,132,112
buffer_load_dwordx4 v7, s[24:27], s43 offen offset:1024 sc1 lds
s_add_u32 s43, s43, 57344
s_waitcnt lgkmcnt(7)
M 224,136,100
DR 124,4,2048
M 228,136,104
M 232,136,108
M 236,136,112
s_add_u32 m0, s46, 32768
s_nop 0
buffer_load_dwordx4 v82, s[20:23], s45 offen offset:2048  lds
s_waitcnt lgkmcnt(7)
M 240,140,100
DR 128,4,3072
M 244,140,104
M 248,140,108
M 252,140,112
buffer_load_dwordx4 v83, s[20:23], s45 offen offset:3072  lds
s_add_u32 s45, s45, 128
s_waitcnt lgkmcnt(3)
M 144,116,84
DR 132,4,4096
M 148,116,88
M 152,116,92
M 156,116,96
s_waitcnt lgkmcnt(3)
M 160,120,84
DR 136,4,5120
M 164,120,88
M 168,120,92
M 172,120,96
s_waitcnt lgkmcnt(3)
M 176,124,84
DR 140,4,6144
M 180,124,88
M 184,124,92
M 188,124,96
s_waitcnt lgkmcnt(3)
M 192,128,84
s_waitcnt vmcnt(6)
s_barrier
DR 116,4,14336
M 196,128,88
DR 100,2,0
M 200,128,92
DR 104,2,2048
M 204,128,96
s_add_u32 m0, s47, 43008
s_nop 0
buffer_load_dwordx4 v7, s[24:27], s43 offen offset:0 sc1 lds
s_waitcnt lgkmcnt(5)
M 208,132,84
DR 108,2,4096
M 212,132,88
DR 112,2,6144
M 216,132,92
DR 120,4,15360
M 220,132,96
buffer_load_dwordx4 v7, s[24:27], s43 offen offset:1024 sc1 lds
s_add_u32 s43, s43, 57344
s_waitcnt lgkmcnt(7)
M 224,136,84
DR 124,4,16384
M 228,136,88
M 232,136,92
M 236,136,96
s_add_u32 m0, s46, 65536
s_nop 0
buffer_load_dwordx4 v80, s[20:23], s45 offen offset:0  lds
s_waitcnt lgkmcnt(7)
M 240,140,84
DR 128,4,17408
M 244,140,88
M 248,140,92
M 252,140,96
buffer_load_dwordx4 v81, s[20:23], s45 offen offset:1024  lds
s_waitcnt lgkmcnt(3)
M 144,116,100
DR 132,4,18432
M 148,116,104
M 152,116,108
M 156,116,112
s_waitcnt lgkmcnt(3)
M 160,120,100
DR 136,4,19456
M 164,120,104
M 168,120,108
M 172,120,112
s_waitcnt lgkmcnt(3)
M 176,124,100
DR 140,4,20480
M 180,124,104
M 184,124,108
M 188,124,112
s_waitcnt lgkmcnt(3)
M 192,128,100
s_waitcnt vmcnt(4)
s_barrier
DR 116,4,28672
M 196,128,104
DR 84,1,32768
M 200,128,108
DR 88,1,34816
M 204,128,112
s_add_u32 m0, s47, 0
s_nop 0
buffer_load_dwordx4 v7, s[24:27], s43 offen offset:0 sc1 lds
s_waitcnt lgkmcnt(5)
M 208,132,100
DR 92,1,36864
M 212,132,104
DR 96,1,38912
M 216,132,108
DR 120,4,29696
M 220,132,112
buffer_load_dwordx4 v7, s[24:27], s43 offen offset:1024 sc1 lds
s_add_u32 s43, s43, 57344
s_waitcnt lgkmcnt(7)
M 224,136,100
DR 124,4,30720
M 228,136,104
M 232,136,108
M 236,136,112
s_add_u32 m0, s46, 65536
s_nop 0
buffer_load_dwordx4 v82, s[20:23], s45 offen offset:2048  lds
s_waitcnt lgkmcnt(7)
M 240,140,100
DR 128,4,31744
M 244,140,104
M 248,140,108
M 252,140,112
buffer_load_dwordx4 v83, s[20:23], s45 offen offset:3072  lds
s_add_u32 s45, s45, 128
s_waitcnt lgkmcnt(3)
M 144,116,84
DR 132,4,32768
M 148,116,88
M 152,116,92
M 156,116,96
s_waitcnt lgkmcnt(3)
M 160,120,84
DR 136,4,33792
M 164,120,88
M 168,120,92
M 172,120,96
s_waitcnt lgkmcnt(3)
M 176,124,84
DR 140,4,34816
M 180,124,88
M 184,124,92
M 188,124,96
s_waitcnt lgkmcnt(3)
M 192,128,84
s_waitcnt vmcnt(6)
s_barrier
DR 116,4,43008
M 196,128,88
DR 100,2,32768
M 200,128,92
DR 104,2,34816
M 204,128,96
s_add_u32 m0, s47, 14336
s_nop 0
buffer_load_dwordx4 v7, s[24:27], s43 offen offset:0 sc1 lds
s_waitcnt lgkmcnt(5)
M 208,132,84
DR 108,2,36864
M 212,132,88
DR 112,2,38912
M 216,132,92
DR 120,4,44032
M 220,132,96
buffer_load_dwordx4 v7, s[24:27], s43 offen offset:1024 sc1 lds
s_add_u32 s43, s43, 57344
s_waitcnt lgkmcnt(7)
M 224,136,84
DR 124,4,45056
M 228,136,88
M 232,136,92
M 236,136,96
s_add_u32 m0, s46, 0
s_nop 0
buffer_load_dwordx4 v80, s[20:23], s45 offen offset:0  lds
s_waitcnt lgkmcnt(7)
M 240,140,84
DR 128,4,46080
M 244,140,88
M 248,140,92
M 252,140,96
buffer_load_dwordx4 v81, s[20:23], s45 offen offset:1024  lds
s_waitcnt lgkmcnt(3)
M 144,116,100
DR 132,4,47104
M 148,116,104
M 152,116,108
M 156,116,112
s_waitcnt lgkmcnt(3)
M 160,120,100
DR 136,4,48128
M 164,120,104
M 168,120,108
M 172,120,112
s_waitcnt lgkmcnt(3)
M 176,124,100
DR 140,4,49152
M 180,124,104
M 184,124,108
M 188,124,112
s_waitcnt lgkmcnt(3)
M 192,128,100
s_waitcnt vmcnt(4)
s_barrier
DR 116,4,0
M 196,128,104
DR 84,5,0
M 200,128,108
DR 88,5,2048
M 204,128,112
s_add_u32 m0, s47, 28672
s_nop 0
buffer_load_dwordx4 v7, s[24:27], s43 offen offset:0 sc1 lds
s_waitcnt lgkmcnt(5)
M 208,132,100
DR 92,5,4096
M 212,132,104
DR 96,5,6144
M 216,132,108
DR 120,4,1024
M 220,132,112
buffer_load_dwordx4 v7, s[24:27], s43 offen offset:1024 sc1 lds
s_add_u32 s43, s43, 57344
s_waitcnt lgkmcnt(7)
M 224,136,100
DR 124,4,2048
M 228,136,104
M 232,136,108
M 236,136,112
s_add_u32 m0, s46, 0
s_nop 0
buffer_load_dwordx4 v82, s[20:23], s45 offen offset:2048  lds
s_waitcnt lgkmcnt(7)
M 240,140,100
DR 128,4,3072
M 244,140,104
M 248,140,108
M 252,140,112
buffer_load_dwordx4 v83, s[20:23], s45 offen offset:3072  lds
s_add_u32 s45, s45, 128
s_add_u32 s52, s52, 1
s_cmp_lt_u32 s52, 4
s_cbranch_scc1 L_k2_sploop
s_lshl_b32 s49, s3, 4
s_lshl_b32 s50, s42, 2
s_add_u32 s49, s49, s50
s_mul_i32 s54, s49, 28672
s_mul_i32 s55, s49, 159744
s_add_u32 s55, s55, 131072
v_add_u32 v16, 0, v7
v_add_u32 v20, 0, v7
v_add_u32 v17, 28672, v7
v_add_u32 v21, 159744, v7
v_add_u32 v18, 57344, v7
v_add_u32 v22, 319488, v7
v_add_u32 v19, 86016, v7
v_add_u32 v23, 479232, v7
s_mul_i32 s56, s44, 14
s_mul_i32 s48, s41, 7
s_add_u32 s56, s56, s48
s_lshr_b32 s56, s56, 1
s_lshl_b32 s56, s56, 10
s_add_u32 s54, s54, s56
s_add_u32 s55, s55, s56
s_waitcnt lgkmcnt(3)
M 144,116,84
DR 132,4,4096
M 148,116,88
s_cmp_lg_u32 s40, 0
s_cbranch_scc1 L_w0_107
global_load_dwordx2 v[12:13], v14, s[100:101] sc1
L_w0_107:
M 152,116,92
M 156,116,96
s_waitcnt lgkmcnt(3)
M 160,120,84
DR 136,4,5120
M 164,120,88
M 168,120,92
M 172,120,96
s_waitcnt lgkmcnt(3)
M 176,124,84
DR 140,4,6144
M 180,124,88
M 184,124,92
M 188,124,96
s_waitcnt lgkmcnt(3)
M 192,128,84
s_waitcnt vmcnt(6)
s_barrier
DR 116,4,14336
M 196,128,88
DR 100,6,0
M 200,128,92
DR 104,6,2048
M 204,128,96
s_add_u32 m0, s47, 43008
s_nop 0
buffer_load_dwordx4 v7, s[24:27], s43 offen offset:0 sc1 lds
s_waitcnt lgkmcnt(5)
M 208,132,84
DR 108,6,4096
M 212,132,88
DR 112,6,6144
M 216,132,92
DR 120,4,15360
M 220,132,96
buffer_load_dwordx4 v7, s[24:27], s43 offen offset:1024 sc1 lds
s_add_u32 s43, s43, 57344
s_waitcnt lgkmcnt(7)
M 224,136,84
DR 124,4,16384
M 228,136,88
M 232,136,92
M 236,136,96
s_add_u32 m0, s46, 32768
s_nop 0
buffer_load_dwordx4 v80, s[20:23], s45 offen offset:0  lds
s_waitcnt lgkmcnt(7)
M 240,140,84
DR 128,4,17408
M 244,140,88
M 248,140,92
M 252,140,96
buffer_load_dwordx4 v81, s[20:23], s45 offen offset:1024  lds
s_waitcnt lgkmcnt(3)
M 144,116,100
DR 132,4,18432
M 148,116,104
M 152,116,108
M 156,116,112
s_waitcnt lgkmcnt(3)
M 160,120,100
DR 136,4,19456
M 164,120,104
M 168,120,108
M 172,120,112
s_waitcnt lgkmcnt(3)
M 176,124,100
DR 140,4,20480
M 180,124,104
M 184,124,108
M 188,124,112
s_waitcnt lgkmcnt(3)
M 192,128,100
s_waitcnt vmcnt(4)
s_barrier
DR 116,4,28672
M 196,128,104
DR 84,1,0
M 200,128,108
DR 88,1,2048
M 204,128,112
s_add_u32 m0, s47, 0
s_nop 0
buffer_load_dwordx4 v7, s[24:27], s43 offen offset:0 sc1 lds
s_waitcnt lgkmcnt(5)
M 208,132,100
DR 92,1,4096
M 212,132,104
DR 96,1,6144
M 216,132,108
DR 120,4,29696
M 220,132,112
buffer_load_dwordx4 v7, s[24:27], s43 offen offset:1024 sc1 lds
s_add_u32 s43, s43, 57344
s_waitcnt lgkmcnt(7)
M 224,136,100
DR 124,4,30720
M 228,136,104
M 232,136,108
M 236,136,112
s_add_u32 m0, s46, 32768
s_nop 0
buffer_load_dwordx4 v82, s[20:23], s45 offen offset:2048  lds
s_waitcnt lgkmcnt(7)
M 240,140,100
DR 128,4,31744
M 244,140,104
M 248,140,108
M 252,140,112
buffer_load_dwordx4 v83, s[20:23], s45 offen offset:3072  lds
s_add_u32 s45, s45, 128
s_waitcnt lgkmcnt(3)
M 144,116,84
DR 132,4,32768
M 148,116,88
M 152,116,92
M 156,116,96
s_waitcnt lgkmcnt(3)
M 160,120,84
DR 136,4,33792
M 164,120,88
M 168,120,92
M 172,120,96
s_waitcnt lgkmcnt(3)
M 176,124,84
DR 140,4,34816
M 180,124,88
M 184,124,92
M 188,124,96
s_waitcnt lgkmcnt(3)
M 192,128,84
s_waitcnt vmcnt(6)
s_barrier
DR 116,4,43008
M 196,128,88
DR 100,2,0
M 200,128,92
DR 104,2,2048
M 204,128,96
s_add_u32 m0, s47, 14336
s_nop 0
buffer_load_dwordx4 v7, s[24:27], s43 offen offset:0 sc1 lds
s_waitcnt lgkmcnt(5)
M 208,132,84
DR 108,2,4096
M 212,132,88
DR 112,2,6144
M 216,132,92
DR 120,4,44032
M 220,132,96
buffer_load_dwordx4 v7, s[24:27], s43 offen offset:1024 sc1 lds
s_add_u32 s43, s43, 57344
s_waitcnt lgkmcnt(7)
M 224,136,84
DR 124,4,45056
M 228,136,88
M 232,136,92
M 236,136,96
s_add_u32 m0, s46, 65536
s_nop 0
buffer_load_dwordx4 v80, s[20:23], s45 offen offset:0  lds
s_waitcnt lgkmcnt(7)
M 240,140,84
DR 128,4,46080
M 244,140,88
M 248,140,92
M 252,140,96
buffer_load_dwordx4 v81, s[20:23], s45 offen offset:1024  lds
s_waitcnt lgkmcnt(3)
M 144,116,100
DR 132,4,47104
M 148,116,104
s_cmp_lg_u32 s40, 0
s_cbranch_scc1 L_w0_108
s_branch L_chk_110
L_spin_109:
s_sleep 10
global_load_dwordx2 v[12:13], v14, s[100:101] sc1
s_waitcnt vmcnt(0)
L_chk_110:
v_cmp_ne_u32 vcc, s59, v12
s_cbranch_vccnz L_spin_109
v_cmp_ne_u32 vcc, s59, v13
s_cbranch_vccnz L_spin_109
L_w0_108:
M 152,116,108
M 156,116,112
s_waitcnt lgkmcnt(3)
M 160,120,100
DR 136,4,48128
M 164,120,104
M 168,120,108
M 172,120,112
s_waitcnt lgkmcnt(3)
M 176,124,100
DR 140,4,49152
M 180,124,104
M 184,124,108
M 188,124,112
s_waitcnt lgkmcnt(3)
M 192,128,100
s_waitcnt vmcnt(4)
s_barrier
DR 116,4,0
M 196,128,104
DR 84,1,32768
M 200,128,108
DR 88,1,34816
M 204,128,112
s_add_u32 m0, s47, 28672
s_nop 0
buffer_load_dwordx4 v7, s[24:27], s43 offen offset:0 sc1 lds
s_waitcnt lgkmcnt(5)
M 208,132,100
DR 92,1,36864
M 212,132,104
DR 96,1,38912
M 216,132,108
DR 120,4,1024
M 220,132,112
buffer_load_dwordx4 v7, s[24:27], s43 offen offset:1024 sc1 lds
s_add_u32 s43, s43, 57344
s_waitcnt lgkmcnt(7)
M 224,136,100
DR 124,4,2048
M 228,136,104
M 232,136,108
M 236,136,112
s_add_u32 m0, s46, 65536
s_nop 0
buffer_load_dwordx4 v82, s[20:23], s45 offen offset:2048  lds
s_waitcnt lgkmcnt(7)
M 240,140,100
DR 128,4,3072
M 244,140,104
M 248,140,108
M 252,140,112
buffer_load_dwordx4 v83, s[20:23], s45 offen offset:3072  lds
s_add_u32 s45, s45, 128
s_waitcnt lgkmcnt(3)
M 144,116,84
DR 132,4,4096
M 148,116,88
buffer_load_dwordx4 v[24:27], v16, s[28:31], s54 offen offset:0 sc1
buffer_load_dwordx4 v[28:31], v17, s[28:31], s54 offen offset:0 sc1
buffer_load_dwordx4 v[32:35], v18, s[28:31], s54 offen offset:0 sc1
buffer_load_dwordx4 v[36:39], v19, s[28:31], s54 offen offset:0 sc1
M 152,116,92
M 156,116,96
s_waitcnt lgkmcnt(3)
M 160,120,84
DR 136,4,5120
M 164,120,88
M 168,120,92
M 172,120,96
s_waitcnt lgkmcnt(3)
M 176,124,84
DR 140,4,6144
M 180,124,88
M 184,124,92
M 188,124,96
s_waitcnt lgkmcnt(3)
M 192,128,84
s_waitcnt vmcnt(10)
s_barrier
DR 116,4,14336
M 196,128,88
DR 100,2,32768
M 200,128,92
DR 104,2,34816
M 204,128,96
s_add_u32 m0, s47, 43008
s_nop 0
buffer_load_dwordx4 v7, s[24:27], s43 offen offset:0 sc1 lds
s_waitcnt lgkmcnt(5)
M 208,132,84
DR 108,2,36864
M 212,132,88
DR 112,2,38912
M 216,132,92
DR 120,4,15360
M 220,132,96
buffer_load_dwordx4 v7, s[24:27], s43 offen offset:1024 sc1 lds
s_add_u32 s43, s43, 57344
s_waitcnt lgkmcnt(7)
M 224,136,84
DR 124,4,16384
M 228,136,88
M 232,136,92
M 236,136,96
s_add_u32 m0, s46, 0
s_nop 0
buffer_load_dwordx4 v80, s[20:23], s45 offen offset:0  lds
s_waitcnt lgkmcnt(7)
M 240,140,84
DR 128,4,17408
M 244,140,88
M 248,140,92
M 252,140,96
buffer_load_dwordx4 v81, s[20:23], s45 offen offset:1024  lds
s_waitcnt lgkmcnt(3)
M 144,116,100
DR 132,4,18432
M 148,116,104
M 152,116,108
M 156,116,112
s_waitcnt lgkmcnt(3)
M 160,120,100
DR 136,4,19456
M 164,120,104
M 168,120,108
M 172,120,112
s_waitcnt lgkmcnt(3)
M 176,124,100
DR 140,4,20480
M 180,124,104
M 184,124,108
M 188,124,112
s_waitcnt lgkmcnt(3)
M 192,128,100
s_waitcnt vmcnt(8)
s_barrier
DR 116,4,28672
M 196,128,104
DR 84,5,0
M 200,128,108
DR 88,5,2048
M 204,128,112
s_add_u32 m0, s47, 0
s_nop 0
buffer_load_dwordx4 v7, s[24:27], s43 offen offset:0 sc1 lds
s_waitcnt lgkmcnt(5)
M 208,132,100
DR 92,5,4096
M 212,132,104
DR 96,5,6144
M 216,132,108
DR 120,4,29696
M 220,132,112
buffer_load_dwordx4 v7, s[24:27], s43 offen offset:1024 sc1 lds
s_add_u32 s43, s43, 57344
s_waitcnt lgkmcnt(7)
M 224,136,100
DR 124,4,30720
M 228,136,104
M 232,136,108
M 236,136,112
s_add_u32 m0, s46, 0
s_nop 0
buffer_load_dwordx4 v82, s[20:23], s45 offen offset:2048  lds
s_waitcnt lgkmcnt(7)
M 240,140,100
DR 128,4,31744
M 244,140,104
M 248,140,108
M 252,140,112
buffer_load_dwordx4 v83, s[20:23], s45 offen offset:3072  lds
s_add_u32 s45, s45, 128
s_waitcnt lgkmcnt(3)
M 144,116,84
DR 132,4,32768
M 148,116,88
buffer_load_dwordx4 v[40:43], v16, s[28:31], s54 offen offset:1024 sc1
buffer_load_dwordx4 v[44:47], v17, s[28:31], s54 offen offset:1024 sc1
buffer_load_dwordx4 v[48:51], v18, s[28:31], s54 offen offset:1024 sc1
buffer_load_dwordx4 v[52:55], v19, s[28:31], s54 offen offset:1024 sc1
M 152,116,92
M 156,116,96
s_waitcnt lgkmcnt(3)
M 160,120,84
DR 136,4,33792
M 164,120,88
M 168,120,92
M 172,120,96
s_waitcnt lgkmcnt(3)
M 176,124,84
DR 140,4,34816
M 180,124,88
M 184,124,92
M 188,124,96
s_waitcnt lgkmcnt(3)
M 192,128,84
s_waitcnt vmcnt(10)
s_barrier
DR 116,4,43008
M 196,128,88
DR 100,6,0
M 200,128,92
DR 104,6,2048
M 204,128,96
s_add_u32 m0, s47, 14336
s_nop 0
buffer_load_dwordx4 v7, s[24:27], s43 offen offset:0 sc1 lds
s_waitcnt lgkmcnt(5)
M 208,132,84
DR 108,6,4096
M 212,132,88
DR 112,6,6144
M 216,132,92
DR 120,4,44032
M 220,132,96
buffer_load_dwordx4 v7, s[24:27], s43 offen offset:1024 sc1 lds
s_add_u32 s43, s43, 57344
s_waitcnt lgkmcnt(7)
M 224,136,84
DR 124,4,45056
M 228,136,88
M 232,136,92
M 236,136,96
s_add_u32 m0, s46, 32768
s_nop 0
buffer_load_dwordx4 v80, s[20:23], s45 offen offset:0  lds
s_waitcnt lgkmcnt(7)
M 240,140,84
DR 128,4,46080
M 244,140,88
M 248,140,92
M 252,140,96
buffer_load_dwordx4 v81, s[20:23], s45 offen offset:1024  lds
s_waitcnt lgkmcnt(3)
M 144,116,100
DR 132,4,47104
M 148,116,104
M 152,116,108
M 156,116,112
s_waitcnt lgkmcnt(3)
M 160,120,100
DR 136,4,48128
M 164,120,104
M 168,120,108
M 172,120,112
s_waitcnt lgkmcnt(3)
M 176,124,100
DR 140,4,49152
M 180,124,104
M 184,124,108
M 188,124,112
s_waitcnt lgkmcnt(3)
M 192,128,100
s_waitcnt vmcnt(8)
s_barrier
DR 116,4,0
M 196,128,104
DR 84,1,0
M 200,128,108
DR 88,1,2048
M 204,128,112
s_add_u32 m0, s47, 28672
s_nop 0
buffer_load_dwordx4 v7, s[24:27], s43 offen offset:0 sc1 lds
s_waitcnt lgkmcnt(5)
M 208,132,100
DR 92,1,4096
M 212,132,104
DR 96,1,6144
M 216,132,108
DR 120,4,1024
M 220,132,112
buffer_load_dwordx4 v7, s[24:27], s43 offen offset:1024 sc1 lds
s_add_u32 s43, s43, 57344
s_waitcnt lgkmcnt(7)
M 224,136,100
DR 124,4,2048
M 228,136,104
M 232,136,108
M 236,136,112
s_add_u32 m0, s46, 32768
s_nop 0
buffer_load_dwordx4 v82, s[20:23], s45 offen offset:2048  lds
s_waitcnt lgkmcnt(7)
M 240,140,100
DR 128,4,3072
M 244,140,104
M 248,140,108
M 252,140,112
buffer_load_dwordx4 v83, s[20:23], s45 offen offset:3072  lds
s_add_u32 s45, s45, 128
s_waitcnt lgkmcnt(3)
M 144,116,84
DR 132,4,4096
M 148,116,88
buffer_load_dwordx4 v[56:59], v16, s[28:31], s54 offen offset:2048 sc1
buffer_load_dwordx4 v[60:63], v17, s[28:31], s54 offen offset:2048 sc1
buffer_load_dwordx4 v[64:67], v18, s[28:31], s54 offen offset:2048 sc1
buffer_load_dwordx4 v[68:71], v19, s[28:31], s54 offen offset:2048 sc1
M 152,116,92
M 156,116,96
s_waitcnt lgkmcnt(3)
M 160,120,84
DR 136,4,5120
M 164,120,88
M 168,120,92
M 172,120,96
s_waitcnt lgkmcnt(3)
M 176,124,84
DR 140,4,6144
M 180,124,88
M 184,124,92
M 188,124,96
s_waitcnt lgkmcnt(3)
M 192,128,84
s_waitcnt vmcnt(10)
s_barrier
DR 116,4,14336
M 196,128,88
DR 100,2,0
M 200,128,92
DR 104,2,2048
M 204,128,96
s_add_u32 m0, s47, 43008
s_nop 0
buffer_load_dwordx4 v7, s[24:27], s43 offen offset:0 sc1 lds
s_waitcnt lgkmcnt(5)
M 208,132,84
DR 108,2,4096
M 212,132,88
DR 112,2,6144
M 216,132,92
DR 120,4,15360
M 220,132,96
buffer_load_dwordx4 v7, s[24:27], s43 offen offset:1024 sc1 lds
s_add_u32 s43, s43, 57344
s_waitcnt lgkmcnt(7)
M 224,136,84
DR 124,4,16384
M 228,136,88
M 232,136,92
M 236,136,96
s_waitcnt lgkmcnt(7)
M 240,140,84
DR 128,4,17408
M 244,140,88
M 248,140,92
M 252,140,96
s_waitcnt lgkmcnt(3)
M 144,116,100
DR 132,4,18432
M 148,116,104
M 152,116,108
M 156,116,112
s_waitcnt lgkmcnt(3)
M 160,120,100
DR 136,4,19456
M 164,120,104
M 168,120,108
M 172,120,112
s_waitcnt lgkmcnt(3)
M 176,124,100
DR 140,4,20480
M 180,124,104
M 184,124,108
M 188,124,112
s_waitcnt lgkmcnt(3)
M 192,128,100
s_waitcnt vmcnt(6)
s_barrier
DR 116,4,28672
M 196,128,104
DR 84,1,32768
M 200,128,108
DR 88,1,34816
M 204,128,112
s_waitcnt lgkmcnt(5)
M 208,132,100
DR 92,1,36864
M 212,132,104
DR 96,1,38912
M 216,132,108
DR 120,4,29696
M 220,132,112
s_waitcnt lgkmcnt(7)
M 224,136,100
DR 124,4,30720
M 228,136,104
M 232,136,108
M 236,136,112
s_waitcnt lgkmcnt(7)
M 240,140,100
DR 128,4,31744
M 244,140,104
M 248,140,108
M 252,140,112
s_waitcnt lgkmcnt(3)
M 144,116,84
DR 132,4,32768
M 148,116,88
M 152,116,92
M 156,116,96
s_waitcnt lgkmcnt(3)
M 160,120,84
DR 136,4,33792
M 164,120,88
M 168,120,92
M 172,120,96
s_waitcnt lgkmcnt(3)
M 176,124,84
DR 140,4,34816
M 180,124,88
M 184,124,92
M 188,124,96
s_waitcnt lgkmcnt(3)
M 192,128,84
s_waitcnt vmcnt(0)
s_barrier
DR 116,4,43008
M 196,128,88
DR 100,2,32768
M 200,128,92
DR 104,2,34816
M 204,128,96
s_waitcnt lgkmcnt(5)
M 208,132,84
DR 108,2,36864
M 212,132,88
DR 112,2,38912
M 216,132,92
DR 120,4,44032
M 220,132,96
s_waitcnt lgkmcnt(7)
M 224,136,84
DR 124,4,45056
M 228,136,88
M 232,136,92
M 236,136,96
s_waitcnt lgkmcnt(7)
M 240,140,84
DR 128,4,46080
M 244,140,88
M 248,140,92
M 252,140,96
s_waitcnt lgkmcnt(3)
M 144,116,100
DR 132,4,47104
M 148,116,104
buffer_load_dwordx4 v[72:75], v16, s[28:31], s54 offen offset:3072 sc1
buffer_load_dwordx4 v[76:79], v17, s[28:31], s54 offen offset:3072 sc1
buffer_load_dwordx4 v[80:83], v18, s[28:31], s54 offen offset:3072 sc1
buffer_load_dwordx4 v[84:87], v19, s[28:31], s54 offen offset:3072 sc1
M 152,116,108
M 156,116,112
s_waitcnt lgkmcnt(3)
M 160,120,100
DR 136,4,48128
M 164,120,104
M 168,120,108
M 172,120,112
s_waitcnt lgkmcnt(3)
M 176,124,100
DR 140,4,49152
M 180,124,104
M 184,124,108
M 188,124,112
s_waitcnt lgkmcnt(3)
M 192,128,100
M 196,128,104
M 200,128,108
M 204,128,112
s_waitcnt lgkmcnt(2)
M 208,132,100
M 212,132,104
M 216,132,108
M 220,132,112
s_waitcnt lgkmcnt(1)
M 224,136,100
M 228,136,104
M 232,136,108
M 236,136,112
s_waitcnt lgkmcnt(0)
M 240,140,100
M 244,140,104
M 248,140,108
M 252,140,112
s_nop 4
s_mov_b32 s53, 0xffff0000
s_lshl_b32 s49, s42, 11
s_add_u32 s49, s49, 155648
v_lshrrev_b32 v12, 1, v7
v_add_u32 v12, s49, v12
s_cmp_eq_u32 s41, 1
s_cbranch_scc1 L_spodd_111
v_lshlrev_b32 v1, 16, v24
v_and_b32 v2, s53, v24
v_lshlrev_b32 v3, 16, v25
v_and_b32 v4, s53, v25
v_mul_f32 v144, v144, v1
v_mul_f32 v145, v145, v2
v_mul_f32 v146, v146, v3
v_mul_f32 v147, v147, v4
PK 24,144,145
PK 25,146,147
v_lshlrev_b32 v8, 16, v26
v_and_b32 v9, s53, v26
v_lshlrev_b32 v10, 16, v27
v_and_b32 v11, s53, v27
v_mul_f32 v160, v160, v8
v_mul_f32 v161, v161, v9
v_mul_f32 v162, v162, v10
v_mul_f32 v163, v163, v11
PK 26,160,161
PK 27,162,163
buffer_store_dwordx4 v[24:27], v20, s[36:39], s55 offen offset:0 sc1
v_lshlrev_b32 v1, 16, v28
v_and_b32 v2, s53, v28
v_lshlrev_b32 v3, 16, v29
v_and_b32 v4, s53, v29
v_mul_f32 v148, v148, v1
v_mul_f32 v149, v149, v2
v_mul_f32 v150, v150, v3
v_mul_f32 v151, v151, v4
PK 28,148,149
PK 29,150,151
v_lshlrev_b32 v8, 16, v30
v_and_b32 v9, s53, v30
v_lshlrev_b32 v10, 16, v31
v_and_b32 v11, s53, v31
v_mul_f32 v164, v164, v8
v_mul_f32 v165, v165, v9
v_mul_f32 v166, v166, v10
v_mul_f32 v167, v167, v11
PK 30,164,165
PK 31,166,167
buffer_store_dwordx4 v[28:31], v21, s[36:39], s55 offen offset:0 sc1
v_lshlrev_b32 v1, 16, v32
v_and_b32 v2, s53, v32
v_lshlrev_b32 v3, 16, v33
v_and_b32 v4, s53, v33
v_mul_f32 v152, v152, v1
v_mul_f32 v153, v153, v2
v_mul_f32 v154, v154, v3
v_mul_f32 v155, v155, v4
PK 32,152,153
PK 33,154,155
v_lshlrev_b32 v8, 16, v34
v_and_b32 v9, s53, v34
v_lshlrev_b32 v10, 16, v35
v_and_b32 v11, s53, v35
v_mul_f32 v168, v168, v8
v_mul_f32 v169, v169, v9
v_mul_f32 v170, v170, v10
v_mul_f32 v171, v171, v11
PK 34,168,169
PK 35,170,171
buffer_store_dwordx4 v[32:35], v22, s[36:39], s55 offen offset:0 sc1
v_lshlrev_b32 v1, 16, v36
v_and_b32 v2, s53, v36
v_lshlrev_b32 v3, 16, v37
v_and_b32 v4, s53, v37
v_mul_f32 v156, v156, v1
v_mul_f32 v157, v157, v2
v_mul_f32 v158, v158, v3
v_mul_f32 v159, v159, v4
PK 36,156,157
PK 37,158,159
v_lshlrev_b32 v8, 16, v38
v_and_b32 v9, s53, v38
v_lshlrev_b32 v10, 16, v39
v_and_b32 v11, s53, v39
v_mul_f32 v172, v172, v8
v_mul_f32 v173, v173, v9
v_mul_f32 v174, v174, v10
v_mul_f32 v175, v175, v11
PK 38,172,173
PK 39,174,175
buffer_store_dwordx4 v[36:39], v23, s[36:39], s55 offen offset:0 sc1
v_lshlrev_b32 v1, 16, v40
v_and_b32 v2, s53, v40
v_lshlrev_b32 v3, 16, v41
v_and_b32 v4, s53, v41
v_mul_f32 v176, v176, v1
v_mul_f32 v177, v177, v2
v_mul_f32 v178, v178, v3
v_mul_f32 v179, v179, v4
PK 40,176,177
PK 41,178,179
v_lshlrev_b32 v8, 16, v42
v_and_b32 v9, s53, v42
v_lshlrev_b32 v10, 16, v43
v_and_b32 v11, s53, v43
v_mul_f32 v192, v192, v8
v_mul_f32 v193, v193, v9
v_mul_f32 v194, v194, v10
v_mul_f32 v195, v195, v11
PK 42,192,193
PK 43,194,195
buffer_store_dwordx4 v[40:43], v20, s[36:39], s55 offen offset:1024 sc1
v_lshlrev_b32 v1, 16, v44
v_and_b32 v2, s53, v44
v_lshlrev_b32 v3, 16, v45
v_and_b32 v4, s53, v45
v_mul_f32 v180, v180, v1
v_mul_f32 v181, v181, v2
v_mul_f32 v182, v182, v3
v_mul_f32 v183, v183, v4
PK 44,180,181
PK 45,182,183
v_lshlrev_b32 v8, 16, v46
v_and_b32 v9, s53, v46
v_lshlrev_b32 v10, 16, v47
v_and_b32 v11, s53, v47
v_mul_f32 v196, v196, v8
v_mul_f32 v197, v197, v9
v_mul_f32 v198, v198, v10
v_mul_f32 v199, v199, v11
PK 46,196,197
PK 47,198,199
buffer_store_dwordx4 v[44:47], v21, s[36:39], s55 offen offset:1024 sc1
v_lshlrev_b32 v1, 16, v48
v_and_b32 v2, s53, v48
v_lshlrev_b32 v3, 16, v49
v_and_b32 v4, s53, v49
v_mul_f32 v184, v184, v1
v_mul_f32 v185, v185, v2
v_mul_f32 v186, v186, v3
v_mul_f32 v187, v187, v4
PK 48,184,185
PK 49,186,187
v_lshlrev_b32 v8, 16, v50
v_and_b32 v9, s53, v50
v_lshlrev_b32 v10, 16, v51
v_and_b32 v11, s53, v51
v_mul_f32 v200, v200, v8
v_mul_f32 v201, v201, v9
v_mul_f32 v202, v202, v10
v_mul_f32 v203, v203, v11
PK 50,200,201
PK 51,202,203
buffer_store_dwordx4 v[48:51], v22, s[36:39], s55 offen offset:1024 sc1
v_lshlrev_b32 v1, 16, v52
v_and_b32 v2, s53, v52
v_lshlrev_b32 v3, 16, v53
v_and_b32 v4, s53, v53
v_mul_f32 v188, v188, v1
v_mul_f32 v189, v189, v2
v_mul_f32 v190, v190, v3
v_mul_f32 v191, v191, v4
PK 52,188,189
PK 53,190,191
v_lshlrev_b32 v8, 16, v54
v_and_b32 v9, s53, v54
v_lshlrev_b32 v10, 16, v55
v_and_b32 v11, s53, v55
v_mul_f32 v204, v204, v8
v_mul_f32 v205, v205, v9
v_mul_f32 v206, v206, v10
v_mul_f32 v207, v207, v11
PK 54,204,205
PK 55,206,207
buffer_store_dwordx4 v[52:55], v23, s[36:39], s55 offen offset:1024 sc1
v_lshlrev_b32 v1, 16, v56
v_and_b32 v2, s53, v56
v_lshlrev_b32 v3, 16, v57
v_and_b32 v4, s53, v57
v_mul_f32 v208, v208, v1
v_mul_f32 v209, v209, v2
v_mul_f32 v210, v210, v3
v_mul_f32 v211, v211, v4
PK 56,208,209
PK 57,210,211
v_lshlrev_b32 v8, 16, v58
v_and_b32 v9, s53, v58
v_lshlrev_b32 v10, 16, v59
v_and_b32 v11, s53, v59
v_mul_f32 v224, v224, v8
v_mul_f32 v225, v225, v9
v_mul_f32 v226, v226, v10
v_mul_f32 v227, v227, v11
PK 58,224,225
PK 59,226,227
buffer_store_dwordx4 v[56:59], v20, s[36:39], s55 offen offset:2048 sc1
v_lshlrev_b32 v1, 16, v60
v_and_b32 v2, s53, v60
v_lshlrev_b32 v3, 16, v61
v_and_b32 v4, s53, v61
v_mul_f32 v212, v212, v1
v_mul_f32 v213, v213, v2
v_mul_f32 v214, v214, v3
v_mul_f32 v215, v215, v4
PK 60,212,213
PK 61,214,215
v_lshlrev_b32 v8, 16, v62
v_and_b32 v9, s53, v62
v_lshlrev_b32 v10, 16, v63
v_and_b32 v11, s53, v63
v_mul_f32 v228, v228, v8
v_mul_f32 v229, v229, v9
v_mul_f32 v230, v230, v10
v_mul_f32 v231, v231, v11
PK 62,228,229
PK 63,230,231
buffer_store_dwordx4 v[60:63], v21, s[36:39], s55 offen offset:2048 sc1
v_lshlrev_b32 v1, 16, v64
v_and_b32 v2, s53, v64
v_lshlrev_b32 v3, 16, v65
v_and_b32 v4, s53, v65
v_mul_f32 v216, v216, v1
v_mul_f32 v217, v217, v2
v_mul_f32 v218, v218, v3
v_mul_f32 v219, v219, v4
PK 64,216,217
PK 65,218,219
v_lshlrev_b32 v8, 16, v66
v_and_b32 v9, s53, v66
v_lshlrev_b32 v10, 16, v67
v_and_b32 v11, s53, v67
v_mul_f32 v232, v232, v8
v_mul_f32 v233, v233, v9
v_mul_f32 v234, v234, v10
v_mul_f32 v235, v235, v11
PK 66,232,233
PK 67,234,235
buffer_store_dwordx4 v[64:67], v22, s[36:39], s55 offen offset:2048 sc1
v_lshlrev_b32 v1, 16, v68
v_and_b32 v2, s53, v68
v_lshlrev_b32 v3, 16, v69
v_and_b32 v4, s53, v69
v_mul_f32 v220, v220, v1
v_mul_f32 v221, v221, v2
v_mul_f32 v222, v222, v3
v_mul_f32 v223, v223, v4
PK 68,220,221
PK 69,222,223
v_lshlrev_b32 v8, 16, v70
v_and_b32 v9, s53, v70
v_lshlrev_b32 v10, 16, v71
v_and_b32 v11, s53, v71
v_mul_f32 v236, v236, v8
v_mul_f32 v237, v237, v9
v_mul_f32 v238, v238, v10
v_mul_f32 v239, v239, v11
PK 70,236,237
PK 71,238,239
buffer_store_dwordx4 v[68:71], v23, s[36:39], s55 offen offset:2048 sc1
s_waitcnt vmcnt(12)
s_waitcnt lgkmcnt(0)
s_barrier
ds_read_b64 v[74:75], v12 offset:0
ds_read_b64 v[78:79], v12 offset:512
ds_read_b64 v[82:83], v12 offset:1024
ds_read_b64 v[86:87], v12 offset:1536
v_lshlrev_b32 v1, 16, v72
v_and_b32 v2, s53, v72
v_lshlrev_b32 v3, 16, v73
v_and_b32 v4, s53, v73
v_mul_f32 v240, v240, v1
v_mul_f32 v241, v241, v2
v_mul_f32 v242, v242, v3
v_mul_f32 v243, v243, v4
PK 72,240,241
PK 73,242,243
s_waitcnt lgkmcnt(3)
buffer_store_dwordx4 v[72:75], v20, s[36:39], s55 offen offset:3072 sc1
v_lshlrev_b32 v1, 16, v76
v_and_b32 v2, s53, v76
v_lshlrev_b32 v3, 16, v77
v_and_b32 v4, s53, v77
v_mul_f32 v244, v244, v1
v_mul_f32 v245, v245, v2
v_mul_f32 v246, v246, v3
v_mul_f32 v247, v247, v4
PK 76,244,245
PK 77,246,247
s_waitcnt lgkmcnt(2)
buffer_store_dwordx4 v[76:79], v21, s[36:39], s55 offen offset:3072 sc1
v_lshlrev_b32 v1, 16, v80
v_and_b32 v2, s53, v80
v_lshlrev_b32 v3, 16, v81
v_and_b32 v4, s53, v81
v_mul_f32 v248, v248, v1
v_mul_f32 v249, v249, v2
v_mul_f32 v250, v250, v3
v_mul_f32 v251, v251, v4
PK 80,248,249
PK 81,250,251
s_waitcnt lgkmcnt(1)
buffer_store_dwordx4 v[80:83], v22, s[36:39], s55 offen offset:3072 sc1
v_lshlrev_b32 v1, 16, v84
v_and_b32 v2, s53, v84
v_lshlrev_b32 v3, 16, v85
v_and_b32 v4, s53, v85
v_mul_f32 v252, v252, v1
v_mul_f32 v253, v253, v2
v_mul_f32 v254, v254, v3
v_mul_f32 v255, v255, v4
PK 84,252,253
PK 85,254,255
s_waitcnt lgkmcnt(0)
buffer_store_dwordx4 v[84:87], v23, s[36:39], s55 offen offset:3072 sc1
s_branch L_spend_112
L_spodd_111:
v_lshlrev_b32 v8, 16, v26
v_and_b32 v9, s53, v26
v_lshlrev_b32 v10, 16, v27
v_and_b32 v11, s53, v27
v_mul_f32 v144, v144, v8
v_mul_f32 v145, v145, v9
v_mul_f32 v146, v146, v10
v_mul_f32 v147, v147, v11
PK 26,144,145
PK 27,146,147
ds_write_b64 v12, v[26:27] offset:0
v_lshlrev_b32 v8, 16, v30
v_and_b32 v9, s53, v30
v_lshlrev_b32 v10, 16, v31
v_and_b32 v11, s53, v31
v_mul_f32 v148, v148, v8
v_mul_f32 v149, v149, v9
v_mul_f32 v150, v150, v10
v_mul_f32 v151, v151, v11
PK 30,148,149
PK 31,150,151
ds_write_b64 v12, v[30:31] offset:512
v_lshlrev_b32 v8, 16, v34
v_and_b32 v9, s53, v34
v_lshlrev_b32 v10, 16, v35
v_and_b32 v11, s53, v35
v_mul_f32 v152, v152, v8
v_mul_f32 v153, v153, v9
v_mul_f32 v154, v154, v10
v_mul_f32 v155, v155, v11
PK 34,152,153
PK 35,154,155
ds_write_b64 v12, v[34:35] offset:1024
v_lshlrev_b32 v8, 16, v38
v_and_b32 v9, s53, v38
v_lshlrev_b32 v10, 16, v39
v_and_b32 v11, s53, v39
v_mul_f32 v156, v156, v8
v_mul_f32 v157, v157, v9
v_mul_f32 v158, v158, v10
v_mul_f32 v159, v159, v11
PK 38,156,157
PK 39,158,159
ds_write_b64 v12, v[38:39] offset:1536
v_lshlrev_b32 v1, 16, v40
v_and_b32 v2, s53, v40
v_lshlrev_b32 v3, 16, v41
v_and_b32 v4, s53, v41
v_mul_f32 v160, v160, v1
v_mul_f32 v161, v161, v2
v_mul_f32 v162, v162, v3
v_mul_f32 v163, v163, v4
PK 40,160,161
PK 41,162,163
v_lshlrev_b32 v8, 16, v42
v_and_b32 v9, s53, v42
v_lshlrev_b32 v10, 16, v43
v_and_b32 v11, s53, v43
v_mul_f32 v176, v176, v8
v_mul_f32 v177, v177, v9
v_mul_f32 v178, v178, v10
v_mul_f32 v179, v179, v11
PK 42,176,177
PK 43,178,179
buffer_store_dwordx4 v[40:43], v20, s[36:39], s55 offen offset:1024 sc1
v_lshlrev_b32 v1, 16, v44
v_and_b32 v2, s53, v44
v_lshlrev_b32 v3, 16, v45
v_and_b32 v4, s53, v45
v_mul_f32 v164, v164, v1
v_mul_f32 v165, v165, v2
v_mul_f32 v166, v166, v3
v_mul_f32 v167, v167, v4
PK 44,164,165
PK 45,166,167
v_lshlrev_b32 v8, 16, v46
v_and_b32 v9, s53, v46
v_lshlrev_b32 v10, 16, v47
v_and_b32 v11, s53, v47
v_mul_f32 v180, v180, v8
v_mul_f32 v181, v181, v9
v_mul_f32 v182, v182, v10
v_mul_f32 v183, v183, v11
PK 46,180,181
PK 47,182,183
buffer_store_dwordx4 v[44:47], v21, s[36:39], s55 offen offset:1024 sc1
v_lshlrev_b32 v1, 16, v48
v_and_b32 v2, s53, v48
v_lshlrev_b32 v3, 16, v49
v_and_b32 v4, s53, v49
v_mul_f32 v168, v168, v1
v_mul_f32 v169, v169, v2
v_mul_f32 v170, v170, v3
v_mul_f32 v171, v171, v4
PK 48,168,169
PK 49,170,171
v_lshlrev_b32 v8, 16, v50
v_and_b32 v9, s53, v50
v_lshlrev_b32 v10, 16, v51
v_and_b32 v11, s53, v51
v_mul_f32 v184, v184, v8
v_mul_f32 v185, v185, v9
v_mul_f32 v186, v186, v10
v_mul_f32 v187, v187, v11
PK 50,184,185
PK 51,186,187
buffer_store_dwordx4 v[48:51], v22, s[36:39], s55 offen offset:1024 sc1
v_lshlrev_b32 v1, 16, v52
v_and_b32 v2, s53, v52
v_lshlrev_b32 v3, 16, v53
v_and_b32 v4, s53, v53
v_mul_f32 v172, v172, v1
v_mul_f32 v173, v173, v2
v_mul_f32 v174, v174, v3
v_mul_f32 v175, v175, v4
PK 52,172,173
PK 53,174,175
v_lshlrev_b32 v8, 16, v54
v_and_b32 v9, s53, v54
v_lshlrev_b32 v10, 16, v55
v_and_b32 v11, s53, v55
v_mul_f32 v188, v188, v8
v_mul_f32 v189, v189, v9
v_mul_f32 v190, v190, v10
v_mul_f32 v191, v191, v11
PK 54,188,189
PK 55,190,191
buffer_store_dwordx4 v[52:55], v23, s[36:39], s55 offen offset:1024 sc1
v_lshlrev_b32 v1, 16, v56
v_and_b32 v2, s53, v56
v_lshlrev_b32 v3, 16, v57
v_and_b32 v4, s53, v57
v_mul_f32 v192, v192, v1
v_mul_f32 v193, v193, v2
v_mul_f32 v194, v194, v3
v_mul_f32 v195, v195, v4
PK 56,192,193
PK 57,194,195
v_lshlrev_b32 v8, 16, v58
v_and_b32 v9, s53, v58
v_lshlrev_b32 v10, 16, v59
v_and_b32 v11, s53, v59
v_mul_f32 v208, v208, v8
v_mul_f32 v209, v209, v9
v_mul_f32 v210, v210, v10
v_mul_f32 v211, v211, v11
PK 58,208,209
PK 59,210,211
buffer_store_dwordx4 v[56:59], v20, s[36:39], s55 offen offset:2048 sc1
v_lshlrev_b32 v1, 16, v60
v_and_b32 v2, s53, v60
v_lshlrev_b32 v3, 16, v61
v_and_b32 v4, s53, v61
v_mul_f32 v196, v196, v1
v_mul_f32 v197, v197, v2
v_mul_f32 v198, v198, v3
v_mul_f32 v199, v199, v4
PK 60,196,197
PK 61,198,199
v_lshlrev_b32 v8, 16, v62
v_and_b32 v9, s53, v62
v_lshlrev_b32 v10, 16, v63
v_and_b32 v11, s53, v63
v_mul_f32 v212, v212, v8
v_mul_f32 v213, v213, v9
v_mul_f32 v214, v214, v10
v_mul_f32 v215, v215, v11
PK 62,212,213
PK 63,214,215
buffer_store_dwordx4 v[60:63], v21, s[36:39], s55 offen offset:2048 sc1
v_lshlrev_b32 v1, 16, v64
v_and_b32 v2, s53, v64
v_lshlrev_b32 v3, 16, v65
v_and_b32 v4, s53, v65
v_mul_f32 v200, v200, v1
v_mul_f32 v201, v201, v2
v_mul_f32 v202, v202, v3
v_mul_f32 v203, v203, v4
PK 64,200,201
PK 65,202,203
v_lshlrev_b32 v8, 16, v66
v_and_b32 v9, s53, v66
v_lshlrev_b32 v10, 16, v67
v_and_b32 v11, s53, v67
v_mul_f32 v216, v216, v8
v_mul_f32 v217, v217, v9
v_mul_f32 v218, v218, v10
v_mul_f32 v219, v219, v11
PK 66,216,217
PK 67,218,219
buffer_store_dwordx4 v[64:67], v22, s[36:39], s55 offen offset:2048 sc1
v_lshlrev_b32 v1, 16, v68
v_and_b32 v2, s53, v68
v_lshlrev_b32 v3, 16, v69
v_and_b32 v4, s53, v69
v_mul_f32 v204, v204, v1
v_mul_f32 v205, v205, v2
v_mul_f32 v206, v206, v3
v_mul_f32 v207, v207, v4
PK 68,204,205
PK 69,206,207
v_lshlrev_b32 v8, 16, v70
v_and_b32 v9, s53, v70
v_lshlrev_b32 v10, 16, v71
v_and_b32 v11, s53, v71
v_mul_f32 v220, v220, v8
v_mul_f32 v221, v221, v9
v_mul_f32 v222, v222, v10
v_mul_f32 v223, v223, v11
PK 70,220,221
PK 71,222,223
buffer_store_dwordx4 v[68:71], v23, s[36:39], s55 offen offset:2048 sc1
s_waitcnt vmcnt(8)
s_waitcnt lgkmcnt(0)
s_barrier
v_lshlrev_b32 v1, 16, v72
v_and_b32 v2, s53, v72
v_lshlrev_b32 v3, 16, v73
v_and_b32 v4, s53, v73
v_mul_f32 v224, v224, v1
v_mul_f32 v225, v225, v2
v_mul_f32 v226, v226, v3
v_mul_f32 v227, v227, v4
PK 72,224,225
PK 73,226,227
v_lshlrev_b32 v8, 16, v74
v_and_b32 v9, s53, v74
v_lshlrev_b32 v10, 16, v75
v_and_b32 v11, s53, v75
v_mul_f32 v240, v240, v8
v_mul_f32 v241, v241, v9
v_mul_f32 v242, v242, v10
v_mul_f32 v243, v243, v11
PK 74,240,241
PK 75,242,243
buffer_store_dwordx4 v[72:75], v20, s[36:39], s55 offen offset:3072 sc1
v_lshlrev_b32 v1, 16, v76
v_and_b32 v2, s53, v76
v_lshlrev_b32 v3, 16, v77
v_and_b32 v4, s53, v77
v_mul_f32 v228, v228, v1
v_mul_f32 v229, v229, v2
v_mul_f32 v230, v230, v3
v_mul_f32 v231, v231, v4
PK 76,228,229
PK 77,230,231
v_lshlrev_b32 v8, 16, v78
v_and_b32 v9, s53, v78
v_lshlrev_b32 v10, 16, v79
v_and_b32 v11, s53, v79
v_mul_f32 v244, v244, v8
v_mul_f32 v245, v245, v9
v_mul_f32 v246, v246, v10
v_mul_f32 v247, v247, v11
PK 78,244,245
PK 79,246,247
buffer_store_dwordx4 v[76:79], v21, s[36:39], s55 offen offset:3072 sc1
v_lshlrev_b32 v1, 16, v80
v_and_b32 v2, s53, v80
v_lshlrev_b32 v3, 16, v81
v_and_b32 v4, s53, v81
v_mul_f32 v232, v232, v1
v_mul_f32 v233, v233, v2
v_mul_f32 v234, v234, v3
v_mul_f32 v235, v235, v4
PK 80,232,233
PK 81,234,235
v_lshlrev_b32 v8, 16, v82
v_and_b32 v9, s53, v82
v_lshlrev_b32 v10, 16, v83
v_and_b32 v11, s53, v83
v_mul_f32 v248, v248, v8
v_mul_f32 v249, v249, v9
v_mul_f32 v250, v250, v10
v_mul_f32 v251, v251, v11
PK 82,248,249
PK 83,250,251
buffer_store_dwordx4 v[80:83], v22, s[36:39], s55 offen offset:3072 sc1
v_lshlrev_b32 v1, 16, v84
v_and_b32 v2, s53, v84
v_lshlrev_b32 v3, 16, v85
v_and_b32 v4, s53, v85
v_mul_f32 v236, v236, v1
v_mul_f32 v237, v237, v2
v_mul_f32 v238, v238, v3
v_mul_f32 v239, v239, v4
PK 84,236,237
PK 85,238,239
v_lshlrev_b32 v8, 16, v86
v_and_b32 v9, s53, v86
v_lshlrev_b32 v10, 16, v87
v_and_b32 v11, s53, v87
v_mul_f32 v252, v252, v8
v_mul_f32 v253, v253, v9
v_mul_f32 v254, v254, v10
v_mul_f32 v255, v255, v11
PK 86,252,253
PK 87,254,255
buffer_store_dwordx4 v[84:87], v23, s[36:39], s55 offen offset:3072 sc1
L_spend_112:
s_add_u32 s58, s44, 49
s_lshl_b32 s58, s58, 7
s_lshl_b32 s49, s3, 2
s_add_u32 s58, s58, s49
s_branch L_p3
L_k2_spend:
L_p3:
s_load_dwordx2 s[6:7], s[0:1], 40
s_load_dwordx4 s[8:11], s[0:1], 80
s_load_dwordx2 s[4:5], s[0:1], 0
s_load_dwordx2 s[16:17], s[0:1], 104
v_lshrrev_b32 v1, 6, v0
s_bfe_u32 s43, s2, 0x20001
s_and_b32 s42, s2, 1
v_readfirstlane_b32 s40, v1
s_lshl_b32 s42, s42, 3
s_lshr_b32 s49, s2, 5
s_add_u32 s42, s42, s49
s_bfe_u32 s41, s2, 0x20003
v_bfe_u32 v28, v0, 5, 1
v_bfe_u32 v29, v0, 2, 2
v_lshl_add_u32 v28, v28, 4, v29
v_bfe_u32 v29, v0, 6, 2
v_lshl_add_u32 v28, v29, 2, v28
v_lshlrev_b32 v28, 10, v28
v_bfe_u32 v30, v0, 4, 1
v_lshl_add_u32 v28, v30, 6, v28
v_lshrrev_b32 v30, 8, v0
v_lshl_add_u32 v28, v30, 7, v28
v_and_b32 v29, 1, v29
v_lshlrev_b32 v29, 1, v29
v_and_b32 v30, 3, v0
v_xor_b32 v29, v29, v30
v_lshl_add_u32 v1, v29, 4, v28
v_and_b32 v28, 63, v0
v_lshlrev_b32 v7, 4, v28
s_lshl_b32 s46, s40, 10
s_lshl_b32 s49, s42, 3
s_add_u32 s49, s49, s40
s_mul_i32 s47, s49, 159744
s_lshl_b32 s49, s43, 13
s_add_u32 s44, s47, s49
s_mul_i32 s49, s43, 7168
s_add_u32 s45, s47, s49
s_add_u32 s45, s45, 131072
s_lshl_b32 s49, s41, 8
s_lshl_b32 s52, s43, 18
s_add_u32 s52, s52, s49
s_mul_i32 s53, s43, 229376
s_add_u32 s53, s53, s49
s_waitcnt lgkmcnt(0)
s_mov_b32 s20, s6
s_mov_b32 s21, s7
s_mov_b32 s22, 4194304
s_mov_b32 s23, 0x20000
s_mov_b32 s24, s8
s_mov_b32 s25, s9
s_mov_b32 s26, 917504
s_mov_b32 s27, 0x20000
s_add_u32 s28, s16, 46137344
s_addc_u32 s29, s17, 0
s_mov_b32 s30, 20447232
s_mov_b32 s31, 0x20000
s_sub_u32 s49, 15, s42
s_sub_u32 s50, s42, 4
s_xor_b32 s50, s50, 1
s_cmp_ge_u32 s42, 10
s_cselect_b32 s49, s49, s50
s_cmp_lt_u32 s42, 4
s_cselect_b32 s49, 6, s49
s_lshl_b32 s49, s49, 2
s_add_u32 s49, s49, s43
s_add_u32 s49, s49, 21
s_lshl_b32 s49, s49, 7
s_and_b32 s50, s2, 7
s_lshl_b32 s50, s50, 13
s_add_u32 s49, s49, s50
v_and_b32 v17, 7, v0
v_lshl_add_u32 v17, v17, 2, s49
s_add_u32 s49, s43, 49
s_lshl_b32 s49, s49, 7
s_add_u32 s49, s49, s50
s_lshr_b32 s50, s42, 1
s_lshl_b32 s50, s50, 2
s_add_u32 s49, s49, s50
v_mov_b32 v18, s49
s_waitcnt vmcnt(0)
s_barrier
s_cmp_lg_u32 s40, 0
s_cbranch_scc1 L_w0_113
v_lshlrev_b32 v20, 13, v0
v_add_u32 v20, s58, v20
v_mov_b32 v21, s59
s_mov_b64 exec, 0xff
global_store_dword v20, v21, s[100:101] sc1
s_mov_b64 exec, -1
global_load_dword v26, v17, s[100:101] sc1
L_w0_113:
s_barrier
s_add_u32 m0, s46, 65536
s_add_u32 s49, s52, 0
buffer_load_dwordx4 v1, s[20:23], s49 offen lds
s_add_u32 m0, s46, 73728
s_add_u32 s49, s52, 32768
buffer_load_dwordx4 v1, s[20:23], s49 offen lds
s_add_u32 m0, s46, 81920
s_add_u32 s49, s52, 65536
buffer_load_dwordx4 v1, s[20:23], s49 offen lds
s_add_u32 m0, s46, 90112
s_add_u32 s49, s52, 98304
buffer_load_dwordx4 v1, s[20:23], s49 offen lds
s_add_u32 m0, s46, 98304
s_add_u32 s49, s52, 131072
buffer_load_dwordx4 v1, s[20:23], s49 offen lds
s_add_u32 m0, s46, 106496
s_add_u32 s49, s52, 163840
buffer_load_dwordx4 v1, s[20:23], s49 offen lds
s_add_u32 m0, s46, 114688
s_add_u32 s49, s52, 196608
buffer_load_dwordx4 v1, s[20:23], s49 offen lds
s_add_u32 m0, s46, 122880
s_add_u32 s49, s52, 229376
buffer_load_dwordx4 v1, s[20:23], s49 offen lds
s_add_u32 m0, s46, 131072
s_add_u32 s49, s52, 1048576
buffer_load_dwordx4 v1, s[20:23], s49 offen lds
s_add_u32 m0, s46, 139264
s_add_u32 s49, s52, 1081344
buffer_load_dwordx4 v1, s[20:23], s49 offen lds
s_add_u32 m0, s46, 147456
s_add_u32 s49, s52, 1114112
buffer_load_dwordx4 v1, s[20:23], s49 offen lds
s_add_u32 m0, s46, 155648
s_add_u32 s49, s52, 1146880
buffer_load_dwordx4 v1, s[20:23], s49 offen lds
s_cmp_lg_u32 s40, 0
s_cbranch_scc1 L_w0_114
s_waitcnt vmcnt(12)
s_branch L_chk_116
L_spin_115:
s_sleep 4
global_load_dword v26, v17, s[100:101] sc1
s_waitcnt vmcnt(0)
L_chk_116:
v_cmp_ne_u32 vcc, s59, v26
s_cbranch_vccnz L_spin_115
L_w0_114:
v_mov_b32 v26, 0
s_barrier
s_add_u32 m0, s46, 0
s_add_u32 s49, s44, 0
buffer_load_dwordx4 v7, s[28:31], s49 offen sc1 lds
s_add_u32 m0, s46, 8192
s_add_u32 s49, s44, 1024
buffer_load_dwordx4 v7, s[28:31], s49 offen sc1 lds
s_add_u32 m0, s46, 16384
s_add_u32 s49, s44, 2048
buffer_load_dwordx4 v7, s[28:31], s49 offen sc1 lds
s_add_u32 m0, s46, 24576
s_add_u32 s49, s44, 3072
buffer_load_dwordx4 v7, s[28:31], s49 offen sc1 lds
s_add_u32 s32, s16, 67108864
s_addc_u32 s33, s17, 0
s_mov_b32 s34, 8421376
s_mov_b32 s35, 0x20000
s_mov_b32 s12, s4
s_mov_b32 s13, s5
s_mov_b32 s14, 2097152
s_mov_b32 s15, 0x20000
s_mov_b32 s36, s10
s_mov_b32 s37, s11
s_mov_b32 s38, 2097152
s_mov_b32 s39, 0x20000
s_lshl_b32 s49, s42, 2
s_add_u32 s49, s49, s41
s_lshl_b32 s56, s49, 9
s_add_u32 s56, s56, 8388608
s_lshl_b32 s57, s43, 7
s_add_u32 s57, s57, s56
s_lshl_b32 s49, s49, 15
s_lshl_b32 s50, s40, 12
s_add_u32 s49, s49, s50
s_lshl_b32 s50, s43, 21
s_add_u32 s54, s49, s50
s_lshl_b32 s50, s43, 10
s_add_u32 s55, s49, s50
v_lshlrev_b32 v22, 20, v7
v_lshlrev_b32 v23, 3, v7
v_bfe_u32 v24, v0, 2, 4
v_lshl_add_u32 v23, v24, 24, v23
v_and_b32 v19, 15, v0
v_lshlrev_b32 v19, 10, v19
v_bfe_u32 v24, v0, 4, 1
v_lshl_add_u32 v19, v24, 5, v19
v_bfe_u32 v24, v0, 5, 1
v_lshl_add_u32 v19, v24, 4, v19
s_lshl_b32 s48, s42, 17
s_lshr_b32 s49, s40, 2
s_lshl_b32 s49, s49, 16
s_add_u32 s48, s48, s49
s_lshl_b32 s49, s43, 14
s_add_u32 s48, s48, s49
s_lshl_b32 s49, s41, 8
s_add_u32 s48, s48, s49
s_and_b32 s49, s40, 3
s_lshl_b32 s49, s49, 6
s_add_u32 s48, s48, s49
v_bfe_u32 v28, v0, 4, 2
v_lshlrev_b32 v29, 10, v28
v_bfe_u32 v30, v0, 2, 2
v_lshl_add_u32 v29, v30, 6, v29
v_and_b32 v30, 3, v0
v_lshl_add_u32 v29, v30, 3, v29
v_and_b32 v28, 1, v28
v_lshl_add_u32 v8, v28, 5, v29
v_xor_b32 v9, 32, v8
s_bfe_u32 s49, s40, 0x10001
s_lshl_b32 s49, s49, 12
s_and_b32 s50, s40, 1
s_lshl_b32 s50, s50, 8
s_add_u32 s49, s49, s50
v_add_u32 v8, s49, v8
v_add_u32 v9, s49, v9
s_lshr_b32 s49, s40, 2
s_lshl_b32 s49, s49, 12
v_add_u32 v10, s49, v7
v_add_u32 v11, 65536, v8
v_add_u32 v12, 65536, v9
v_add_u32 v13, 65536, v10
v_add_u32 v14, 131072, v8
v_add_u32 v15, 131072, v9
v_add_u32 v16, 131072, v10
s_waitcnt vmcnt(2)
s_barrier
TR 96,11,0
TR 98,11,512
DR 64,10,0
DR 68,10,1024
DR 72,10,2048
DR 76,10,3072
TR 100,12,0
TR 102,12,512
s_waitcnt lgkmcnt(0)
MZ 32,96,64
TR 104,11,8192
TR 106,11,8704
s_add_u32 m0, s46, 32768
s_add_u32 s49, s44, 4096
buffer_load_dwordx4 v7, s[28:31], s49 offen sc1 lds
MZ 36,96,68
DR 80,10,8192
DR 84,10,9216
s_add_u32 m0, s46, 40960
s_add_u32 s49, s44, 5120
buffer_load_dwordx4 v7, s[28:31], s49 offen sc1 lds
MZ 40,96,72
DR 88,10,10240
DR 92,10,11264
s_add_u32 m0, s46, 49152
s_add_u32 s49, s44, 6144
buffer_load_dwordx4 v7, s[28:31], s49 offen sc1 lds
MZ 44,96,76
TR 108,12,8192
TR 110,12,8704
s_add_u32 m0, s46, 57344
s_add_u32 s49, s44, 7168
buffer_load_dwordx4 v7, s[28:31], s49 offen sc1 lds
MZ 48,100,64
MZ 52,100,68
MZ 56,100,72
MZ 60,100,76
s_waitcnt lgkmcnt(0)
M 32,104,80
s_waitcnt vmcnt(4)
s_barrier
TR 96,11,16384
M 36,104,84
TR 98,11,16896
DR 64,10,16384
M 40,104,88
DR 68,10,17408
DR 72,10,18432
M 44,104,92
DR 76,10,19456
TR 100,12,16384
M 48,108,80
TR 102,12,16896
M 52,108,84
s_add_u32 m0, s46, 0
s_add_u32 s49, s44, 32768
buffer_load_dwordx4 v7, s[28:31], s49 offen sc1 lds
M 56,108,88
M 60,108,92
s_add_u32 m0, s46, 65536
s_add_u32 s49, s52, 1179648
buffer_load_dwordx4 v1, s[20:23], s49 offen lds
s_waitcnt lgkmcnt(0)
M 32,96,64
TR 104,11,24576
TR 106,11,25088
M 36,96,68
DR 80,10,24576
DR 84,10,25600
M 40,96,72
DR 88,10,26624
DR 92,10,27648
M 44,96,76
TR 108,12,24576
TR 110,12,25088
M 48,100,64
M 52,100,68
s_add_u32 m0, s46, 8192
s_add_u32 s49, s44, 33792
buffer_load_dwordx4 v7, s[28:31], s49 offen sc1 lds
M 56,100,72
M 60,100,76
s_add_u32 m0, s46, 73728
s_add_u32 s49, s52, 1212416
buffer_load_dwordx4 v1, s[20:23], s49 offen lds
s_waitcnt lgkmcnt(0)
M 32,104,80
s_waitcnt vmcnt(6)
s_barrier
TR 96,11,32768
M 36,104,84
TR 98,11,33280
DR 64,10,32768
M 40,104,88
DR 68,10,33792
DR 72,10,34816
M 44,104,92
DR 76,10,35840
TR 100,12,32768
M 48,108,80
TR 102,12,33280
M 52,108,84
s_add_u32 m0, s46, 16384
s_add_u32 s49, s44, 34816
buffer_load_dwordx4 v7, s[28:31], s49 offen sc1 lds
M 56,108,88
M 60,108,92
s_add_u32 m0, s46, 81920
s_add_u32 s49, s52, 1245184
buffer_load_dwordx4 v1, s[20:23], s49 offen lds
s_waitcnt lgkmcnt(0)
M 32,96,64
TR 104,11,40960
TR 106,11,41472
M 36,96,68
DR 80,10,40960
DR 84,10,41984
M 40,96,72
DR 88,10,43008
DR 92,10,44032
M 44,96,76
TR 108,12,40960
TR 110,12,41472
M 48,100,64
M 52,100,68
s_add_u32 m0, s46, 24576
s_add_u32 s49, s44, 35840
buffer_load_dwordx4 v7, s[28:31], s49 offen sc1 lds
M 56,100,72
M 60,100,76
s_add_u32 m0, s46, 90112
s_add_u32 s49, s52, 1277952
buffer_load_dwordx4 v1, s[20:23], s49 offen lds
s_waitcnt lgkmcnt(0)
M 32,104,80
s_waitcnt vmcnt(8)
s_barrier
TR 96,11,49152
M 36,104,84
TR 98,11,49664
DR 64,10,49152
M 40,104,88
DR 68,10,50176
DR 72,10,51200
M 44,104,92
DR 76,10,52224
TR 100,12,49152
M 48,108,80
TR 102,12,49664
M 52,108,84
s_add_u32 m0, s46, 32768
s_add_u32 s49, s44, 36864
buffer_load_dwordx4 v7, s[28:31], s49 offen sc1 lds
M 56,108,88
M 60,108,92
s_add_u32 m0, s46, 98304
s_add_u32 s49, s52, 2097152
buffer_load_dwordx4 v1, s[20:23], s49 offen lds
s_waitcnt lgkmcnt(0)
M 32,96,64
TR 104,11,57344
TR 106,11,57856
M 36,96,68
DR 80,10,57344
DR 84,10,58368
M 40,96,72
DR 88,10,59392
DR 92,10,60416
M 44,96,76
TR 108,12,57344
TR 110,12,57856
M 48,100,64
M 52,100,68
s_add_u32 m0, s46, 40960
s_add_u32 s49, s44, 37888
buffer_load_dwordx4 v7, s[28:31], s49 offen sc1 lds
M 56,100,72
M 60,100,76
s_add_u32 m0, s46, 106496
s_add_u32 s49, s52, 2129920
buffer_load_dwordx4 v1, s[20:23], s49 offen lds
s_waitcnt lgkmcnt(0)
M 32,104,80
s_waitcnt vmcnt(9)
s_barrier
TR 96,14,0
M 36,104,84
TR 98,14,512
DR 64,10,0
M 40,104,88
DR 68,10,1024
DR 72,10,2048
M 44,104,92
DR 76,10,3072
TR 100,15,0
M 48,108,80
TR 102,15,512
M 52,108,84
s_add_u32 m0, s46, 49152
s_add_u32 s49, s44, 38912
buffer_load_dwordx4 v7, s[28:31], s49 offen sc1 lds
M 56,108,88
M 60,108,92
s_add_u32 m0, s46, 114688
s_add_u32 s49, s52, 2162688
buffer_load_dwordx4 v1, s[20:23], s49 offen lds
s_waitcnt lgkmcnt(0)
M 32,96,64
TR 104,14,8192
TR 106,14,8704
M 36,96,68
DR 80,10,8192
DR 84,10,9216
M 40,96,72
DR 88,10,10240
DR 92,10,11264
M 44,96,76
TR 108,15,8192
TR 110,15,8704
M 48,100,64
M 52,100,68
s_add_u32 m0, s46, 57344
s_add_u32 s49, s44, 39936
buffer_load_dwordx4 v7, s[28:31], s49 offen sc1 lds
M 56,100,72
M 60,100,76
s_add_u32 m0, s46, 122880
s_add_u32 s49, s52, 2195456
buffer_load_dwordx4 v1, s[20:23], s49 offen lds
s_waitcnt lgkmcnt(0)
M 32,104,80
s_waitcnt vmcnt(9)
s_barrier
TR 96,14,16384
M 36,104,84
TR 98,14,16896
DR 64,10,16384
M 40,104,88
DR 68,10,17408
DR 72,10,18432
M 44,104,92
DR 76,10,19456
TR 100,15,16384
M 48,108,80
TR 102,15,16896
M 52,108,84
s_add_u32 m0, s46, 0
s_add_u32 s49, s44, 65536
buffer_load_dwordx4 v7, s[28:31], s49 offen sc1 lds
M 56,108,88
M 60,108,92
s_add_u32 m0, s46, 131072
s_add_u32 s49, s52, 2228224
buffer_load_dwordx4 v1, s[20:23], s49 offen lds
s_waitcnt lgkmcnt(0)
M 32,96,64
TR 104,14,24576
TR 106,14,25088
M 36,96,68
DR 80,10,24576
DR 84,10,25600
M 40,96,72
DR 88,10,26624
DR 92,10,27648
M 44,96,76
TR 108,15,24576
TR 110,15,25088
M 48,100,64
M 52,100,68
s_add_u32 m0, s46, 8192
s_add_u32 s49, s44, 66560
buffer_load_dwordx4 v7, s[28:31], s49 offen sc1 lds
M 56,100,72
M 60,100,76
s_add_u32 m0, s46, 139264
s_add_u32 s49, s52, 2260992
buffer_load_dwordx4 v1, s[20:23], s49 offen lds
s_waitcnt lgkmcnt(0)
M 32,104,80
s_waitcnt vmcnt(9)
s_barrier
TR 96,11,0
M 36,104,84
TR 98,11,512
DR 64,10,32768
M 40,104,88
DR 68,10,33792
DR 72,10,34816
M 44,104,92
DR 76,10,35840
TR 100,12,0
M 48,108,80
TR 102,12,512
M 52,108,84
s_add_u32 m0, s46, 16384
s_add_u32 s49, s44, 67584
buffer_load_dwordx4 v7, s[28:31], s49 offen sc1 lds
M 56,108,88
M 60,108,92
s_add_u32 m0, s46, 147456
s_add_u32 s49, s52, 2293760
buffer_load_dwordx4 v1, s[20:23], s49 offen lds
s_waitcnt lgkmcnt(0)
M 32,96,64
TR 104,11,8192
TR 106,11,8704
M 36,96,68
DR 80,10,40960
DR 84,10,41984
M 40,96,72
DR 88,10,43008
DR 92,10,44032
M 44,96,76
TR 108,12,8192
TR 110,12,8704
M 48,100,64
M 52,100,68
s_add_u32 m0, s46, 24576
s_add_u32 s49, s44, 68608
buffer_load_dwordx4 v7, s[28:31], s49 offen sc1 lds
M 56,100,72
M 60,100,76
s_add_u32 m0, s46, 155648
s_add_u32 s49, s52, 2326528
buffer_load_dwordx4 v1, s[20:23], s49 offen lds
s_waitcnt lgkmcnt(0)
M 32,104,80
s_waitcnt vmcnt(9)
s_barrier
TR 96,11,16384
M 36,104,84
TR 98,11,16896
DR 64,10,49152
M 40,104,88
DR 68,10,50176
DR 72,10,51200
M 44,104,92
DR 76,10,52224
TR 100,12,16384
M 48,108,80
TR 102,12,16896
M 52,108,84
s_add_u32 m0, s46, 32768
s_add_u32 s49, s44, 69632
buffer_load_dwordx4 v7, s[28:31], s49 offen sc1 lds
M 56,108,88
M 60,108,92
s_add_u32 m0, s46, 65536
s_add_u32 s49, s52, 3145728
buffer_load_dwordx4 v1, s[20:23], s49 offen lds
s_waitcnt lgkmcnt(0)
M 32,96,64
TR 104,11,24576
TR 106,11,25088
M 36,96,68
DR 80,10,57344
DR 84,10,58368
M 40,96,72
DR 88,10,59392
DR 92,10,60416
M 44,96,76
TR 108,12,24576
TR 110,12,25088
M 48,100,64
M 52,100,68
s_add_u32 m0, s46, 40960
s_add_u32 s49, s44, 70656
buffer_load_dwordx4 v7, s[28:31], s49 offen sc1 lds
M 56,100,72
M 60,100,76
s_add_u32 m0, s46, 73728
s_add_u32 s49, s52, 3178496
buffer_load_dwordx4 v1, s[20:23], s49 offen lds
s_waitcnt lgkmcnt(0)
M 32,104,80
s_waitcnt vmcnt(9)
s_barrier
TR 96,11,32768
M 36,104,84
TR 98,11,33280
DR 64,10,0
M 40,104,88
DR 68,10,1024
DR 72,10,2048
M 44,104,92
DR 76,10,3072
TR 100,12,32768
M 48,108,80
TR 102,12,33280
M 52,108,84
s_add_u32 m0, s46, 49152
s_add_u32 s49, s44, 71680
buffer_load_dwordx4 v7, s[28:31], s49 offen sc1 lds
M 56,108,88
M 60,108,92
s_add_u32 m0, s46, 81920
s_add_u32 s49, s52, 3211264
buffer_load_dwordx4 v1, s[20:23], s49 offen lds
s_waitcnt lgkmcnt(0)
M 32,96,64
TR 104,11,40960
TR 106,11,41472
M 36,96,68
DR 80,10,8192
DR 84,10,9216
M 40,96,72
DR 88,10,10240
DR 92,10,11264
M 44,96,76
TR 108,12,40960
TR 110,12,41472
M 48,100,64
M 52,100,68
s_add_u32 m0, s46, 57344
s_add_u32 s49, s44, 72704
buffer_load_dwordx4 v7, s[28:31], s49 offen sc1 lds
M 56,100,72
M 60,100,76
s_add_u32 m0, s46, 90112
s_add_u32 s49, s52, 3244032
buffer_load_dwordx4 v1, s[20:23], s49 offen lds
s_waitcnt lgkmcnt(0)
M 32,104,80
s_waitcnt vmcnt(9)
s_barrier
TR 96,11,49152
M 36,104,84
TR 98,11,49664
DR 64,10,16384
M 40,104,88
DR 68,10,17408
DR 72,10,18432
M 44,104,92
DR 76,10,19456
TR 100,12,49152
M 48,108,80
TR 102,12,49664
M 52,108,84
s_add_u32 m0, s46, 0
s_add_u32 s49, s44, 98304
buffer_load_dwordx4 v7, s[28:31], s49 offen sc1 lds
M 56,108,88
M 60,108,92
s_add_u32 m0, s46, 98304
s_add_u32 s49, s52, 3276800
buffer_load_dwordx4 v1, s[20:23], s49 offen lds
s_waitcnt lgkmcnt(0)
M 32,96,64
TR 104,11,57344
TR 106,11,57856
M 36,96,68
DR 80,10,24576
DR 84,10,25600
M 40,96,72
DR 88,10,26624
DR 92,10,27648
M 44,96,76
TR 108,12,57344
TR 110,12,57856
M 48,100,64
M 52,100,68
s_add_u32 m0, s46, 8192
s_add_u32 s49, s44, 99328
buffer_load_dwordx4 v7, s[28:31], s49 offen sc1 lds
M 56,100,72
M 60,100,76
s_add_u32 m0, s46, 106496
s_add_u32 s49, s52, 3309568
buffer_load_dwordx4 v1, s[20:23], s49 offen lds
s_waitcnt lgkmcnt(0)
M 32,104,80
s_waitcnt vmcnt(9)
s_barrier
s_cmp_lg_u32 s40, 0
s_cbranch_scc1 L_w0_117
global_load_dword v26, v18, s[100:101] sc1
L_w0_117:
TR 96,14,0
M 36,104,84
TR 98,14,512
DR 64,10,32768
M 40,104,88
DR 68,10,33792
DR 72,10,34816
M 44,104,92
DR 76,10,35840
TR 100,15,0
M 48,108,80
TR 102,15,512
M 52,108,84
s_add_u32 m0, s46, 16384
s_add_u32 s49, s44, 100352
buffer_load_dwordx4 v7, s[28:31], s49 offen sc1 lds
M 56,108,88
M 60,108,92
s_add_u32 m0, s46, 114688
s_add_u32 s49, s52, 3342336
buffer_load_dwordx4 v1, s[20:23], s49 offen lds
s_waitcnt lgkmcnt(0)
M 32,96,64
TR 104,14,8192
TR 106,14,8704
M 36,96,68
DR 80,10,40960
DR 84,10,41984
M 40,96,72
DR 88,10,43008
DR 92,10,44032
M 44,96,76
TR 108,15,8192
TR 110,15,8704
M 48,100,64
M 52,100,68
s_add_u32 m0, s46, 24576
s_add_u32 s49, s44, 101376
buffer_load_dwordx4 v7, s[28:31], s49 offen sc1 lds
M 56,100,72
M 60,100,76
s_add_u32 m0, s46, 122880
s_add_u32 s49, s52, 3375104
buffer_load_dwordx4 v1, s[20:23], s49 offen lds
s_waitcnt lgkmcnt(0)
M 32,104,80
s_waitcnt vmcnt(9)
s_barrier
TR 96,14,16384
M 36,104,84
TR 98,14,16896
DR 64,10,49152
M 40,104,88
DR 68,10,50176
DR 72,10,51200
M 44,104,92
DR 76,10,52224
TR 100,15,16384
M 48,108,80
TR 102,15,16896
M 52,108,84
s_add_u32 m0, s46, 32768
s_add_u32 s49, s44, 102400
buffer_load_dwordx4 v7, s[28:31], s49 offen sc1 lds
M 56,108,88
M 60,108,92
s_add_u32 m0, s46, 131072
s_add_u32 s49, s53, 0
buffer_load_dwordx4 v1, s[24:27], s49 offen lds
s_waitcnt lgkmcnt(0)
M 32,96,64
TR 104,14,24576
TR 106,14,25088
M 36,96,68
DR 80,10,57344
DR 84,10,58368
M 40,96,72
DR 88,10,59392
DR 92,10,60416
M 44,96,76
TR 108,15,24576
TR 110,15,25088
M 48,100,64
M 52,100,68
s_add_u32 m0, s46, 40960
s_add_u32 s49, s44, 103424
buffer_load_dwordx4 v7, s[28:31], s49 offen sc1 lds
M 56,100,72
M 60,100,76
s_add_u32 m0, s46, 139264
s_add_u32 s49, s53, 32768
buffer_load_dwordx4 v1, s[24:27], s49 offen lds
s_waitcnt lgkmcnt(0)
M 32,104,80
s_waitcnt vmcnt(9)
s_barrier
TR 96,11,0
M 36,104,84
TR 98,11,512
DR 64,10,0
M 40,104,88
DR 68,10,1024
DR 72,10,2048
M 44,104,92
DR 76,10,3072
TR 100,12,0
M 48,108,80
TR 102,12,512
M 52,108,84
s_add_u32 m0, s46, 49152
s_add_u32 s49, s44, 104448
buffer_load_dwordx4 v7, s[28:31], s49 offen sc1 lds
M 56,108,88
M 60,108,92
s_add_u32 m0, s46, 147456
s_add_u32 s49, s53, 65536
buffer_load_dwordx4 v1, s[24:27], s49 offen lds
s_waitcnt lgkmcnt(0)
M 32,96,64
TR 104,11,8192
TR 106,11,8704
M 36,96,68
DR 80,10,8192
DR 84,10,9216
M 40,96,72
DR 88,10,10240
DR 92,10,11264
M 44,96,76
TR 108,12,8192
TR 110,12,8704
M 48,100,64
M 52,100,68
s_add_u32 m0, s46, 57344
s_add_u32 s49, s44, 105472
buffer_load_dwordx4 v7, s[28:31], s49 offen sc1 lds
M 56,100,72
M 60,100,76
s_add_u32 m0, s46, 155648
s_add_u32 s49, s53, 98304
buffer_load_dwordx4 v1, s[24:27], s49 offen lds
s_waitcnt lgkmcnt(0)
M 32,104,80
s_waitcnt vmcnt(9)
s_cmp_lg_u32 s40, 0
s_cbranch_scc1 L_w0_118
s_branch L_chk_120
L_spin_119:
s_sleep 4
global_load_dword v26, v18, s[100:101] sc1
s_waitcnt vmcnt(0)
L_chk_120:
v_cmp_ne_u32 vcc, s59, v26
s_cbranch_vccnz L_spin_119
L_w0_118:
s_barrier
TR 96,11,16384
M 36,104,84
TR 98,11,16896
DR 64,10,16384
M 40,104,88
DR 68,10,17408
DR 72,10,18432
M 44,104,92
DR 76,10,19456
TR 100,12,16384
M 48,108,80
TR 102,12,16896
M 52,108,84
s_add_u32 m0, s46, 0
s_add_u32 s49, s45, 0
buffer_load_dwordx4 v7, s[28:31], s49 offen sc1 lds
M 56,108,88
M 60,108,92
s_add_u32 m0, s46, 65536
s_add_u32 s49, s53, 131072
buffer_load_dwordx4 v1, s[24:27], s49 offen lds
s_waitcnt lgkmcnt(0)
M 32,96,64
TR 104,11,24576
TR 106,11,25088
M 36,96,68
DR 80,10,24576
DR 84,10,25600
M 40,96,72
DR 88,10,26624
DR 92,10,27648
M 44,96,76
TR 108,12,24576
TR 110,12,25088
M 48,100,64
M 52,100,68
s_add_u32 m0, s46, 8192
s_add_u32 s49, s45, 1024
buffer_load_dwordx4 v7, s[28:31], s49 offen sc1 lds
M 56,100,72
M 60,100,76
s_add_u32 m0, s46, 73728
s_add_u32 s49, s53, 163840
buffer_load_dwordx4 v1, s[24:27], s49 offen lds
s_waitcnt lgkmcnt(0)
M 32,104,80
s_waitcnt vmcnt(9)
s_barrier
TR 96,11,32768
M 36,104,84
TR 98,11,33280
DR 64,10,32768
M 40,104,88
DR 68,10,33792
DR 72,10,34816
M 44,104,92
DR 76,10,35840
TR 100,12,32768
M 48,108,80
TR 102,12,33280
M 52,108,84
s_add_u32 m0, s46, 16384
s_add_u32 s49, s45, 2048
buffer_load_dwordx4 v7, s[28:31], s49 offen sc1 lds
M 56,108,88
M 60,108,92
s_add_u32 m0, s46, 81920
s_add_u32 s49, s53, 196608
buffer_load_dwordx4 v1, s[24:27], s49 offen lds
s_waitcnt lgkmcnt(0)
M 32,96,64
TR 104,11,40960
TR 106,11,41472
M 36,96,68
DR 80,10,40960
DR 84,10,41984
M 40,96,72
DR 88,10,43008
DR 92,10,44032
M 44,96,76
TR 108,12,40960
TR 110,12,41472
M 48,100,64
M 52,100,68
s_add_u32 m0, s46, 24576
s_add_u32 s49, s45, 3072
buffer_load_dwordx4 v7, s[28:31], s49 offen sc1 lds
M 56,100,72
M 60,100,76
s_waitcnt lgkmcnt(0)
M 32,104,80
s_waitcnt vmcnt(8)
s_barrier
TR 96,11,49152
M 36,104,84
TR 98,11,49664
DR 64,10,49152
M 40,104,88
DR 68,10,50176
DR 72,10,51200
M 44,104,92
DR 76,10,52224
TR 100,12,49152
M 48,108,80
TR 102,12,49664
M 52,108,84
s_add_u32 m0, s46, 32768
s_add_u32 s49, s45, 4096
buffer_load_dwordx4 v7, s[28:31], s49 offen sc1 lds
M 56,108,88
M 60,108,92
s_add_u32 m0, s46, 40960
s_add_u32 s49, s45, 5120
buffer_load_dwordx4 v7, s[28:31], s49 offen sc1 lds
s_waitcnt lgkmcnt(0)
M 32,96,64
TR 104,11,57344
TR 106,11,57856
M 36,96,68
DR 80,10,57344
DR 84,10,58368
M 40,96,72
DR 88,10,59392
DR 92,10,60416
M 44,96,76
TR 108,12,57344
TR 110,12,57856
M 48,100,64
M 52,100,68
M 56,100,72
M 60,100,76
s_waitcnt lgkmcnt(0)
M 32,104,80
s_waitcnt vmcnt(6)
s_barrier
TR 96,14,0
M 36,104,84
TR 98,14,512
DR 64,10,0
M 40,104,88
DR 68,10,1024
DR 72,10,2048
M 44,104,92
DR 76,10,3072
TR 100,15,0
M 48,108,80
TR 102,15,512
M 52,108,84
s_add_u32 m0, s46, 49152
s_add_u32 s49, s45, 6144
buffer_load_dwordx4 v7, s[28:31], s49 offen sc1 lds
M 56,108,88
M 60,108,92
s_waitcnt lgkmcnt(0)
M 32,96,64
TR 104,14,8192
TR 106,14,8704
M 36,96,68
DR 80,10,8192
DR 84,10,9216
M 40,96,72
DR 88,10,10240
DR 92,10,11264
M 44,96,76
TR 108,15,8192
TR 110,15,8704
M 48,100,64
M 52,100,68
M 56,100,72
M 60,100,76
buffer_load_dwordx4 v[112:115], v19, s[12:15], s48 offen
s_waitcnt lgkmcnt(0)
M 32,104,80
s_waitcnt vmcnt(4)
s_barrier
TR 96,14,16384
M 36,104,84
TR 98,14,16896
DR 64,10,16384
M 40,104,88
DR 68,10,17408
DR 72,10,18432
M 44,104,92
DR 76,10,19456
TR 100,15,16384
M 48,108,80
TR 102,15,16896
M 52,108,84
M 56,108,88
M 60,108,92
s_waitcnt lgkmcnt(0)
M 32,96,64
TR 104,14,24576
TR 106,14,25088
M 36,96,68
DR 80,10,24576
DR 84,10,25600
M 40,96,72
DR 88,10,26624
DR 92,10,27648
M 44,96,76
TR 108,15,24576
TR 110,15,25088
M 48,100,64
M 52,100,68
M 56,100,72
M 60,100,76
s_waitcnt lgkmcnt(0)
M 32,104,80
s_waitcnt vmcnt(2)
s_barrier
TR 96,11,0
M 36,104,84
TR 98,11,512
DR 64,10,32768
M 40,104,88
DR 68,10,33792
DR 72,10,34816
M 44,104,92
DR 76,10,35840
TR 100,12,0
M 48,108,80
TR 102,12,512
M 52,108,84
M 56,108,88
M 60,108,92
s_waitcnt lgkmcnt(0)
M 32,96,64
TR 104,11,8192
TR 106,11,8704
M 36,96,68
DR 80,10,40960
DR 84,10,41984
M 40,96,72
DR 88,10,43008
DR 92,10,44032
M 44,96,76
TR 108,12,8192
TR 110,12,8704
M 48,100,64
M 52,100,68
M 56,100,72
M 60,100,76
s_waitcnt lgkmcnt(0)
M 32,104,80
s_waitcnt vmcnt(1)
s_barrier
TR 96,11,16384
M 36,104,84
TR 98,11,16896
DR 64,10,49152
M 40,104,88
DR 68,10,50176
DR 72,10,51200
M 44,104,92
DR 76,10,52224
TR 100,12,16384
M 48,108,80
TR 102,12,16896
M 52,108,84
M 56,108,88
M 60,108,92
s_waitcnt lgkmcnt(0)
M 32,96,64
M 36,96,68
M 40,96,72
M 44,96,76
M 48,100,64
M 52,100,68
M 56,100,72
M 60,100,76
s_nop 4
PK 64,32,33
PK 65,34,35
PK 66,48,49
PK 67,50,51
s_cmp_eq_u32 s43, 0
s_cbranch_scc1 L_own_121
buffer_store_dwordx4 v[64:67], v7, s[32:35], s54 offen offset:0 sc1
L_own_121:
PK 68,36,37
PK 69,38,39
PK 70,52,53
PK 71,54,55
s_cmp_eq_u32 s43, 1
s_cbranch_scc1 L_own_122
buffer_store_dwordx4 v[68:71], v7, s[32:35], s54 offen offset:1024 sc1
L_own_122:
PK 72,40,41
PK 73,42,43
PK 74,56,57
PK 75,58,59
s_cmp_eq_u32 s43, 2
s_cbranch_scc1 L_own_123
buffer_store_dwordx4 v[72:75], v7, s[32:35], s54 offen offset:2048 sc1
L_own_123:
PK 76,44,45
PK 77,46,47
PK 78,60,61
PK 79,62,63
s_cmp_eq_u32 s43, 3
s_cbranch_scc1 L_own_124
buffer_store_dwordx4 v[76:79], v7, s[32:35], s54 offen offset:3072 sc1
L_own_124:
s_cmp_lg_u32 s43, 1
s_cbranch_scc1 L_mv_125
v_mov_b32 v32, v36
v_mov_b32 v33, v37
v_mov_b32 v34, v38
v_mov_b32 v35, v39
v_mov_b32 v48, v52
v_mov_b32 v49, v53
v_mov_b32 v50, v54
v_mov_b32 v51, v55
L_mv_125:
s_cmp_lg_u32 s43, 2
s_cbranch_scc1 L_mv_126
v_mov_b32 v32, v40
v_mov_b32 v33, v41
v_mov_b32 v34, v42
v_mov_b32 v35, v43
v_mov_b32 v48, v56
v_mov_b32 v49, v57
v_mov_b32 v50, v58
v_mov_b32 v51, v59
L_mv_126:
s_cmp_lg_u32 s43, 3
s_cbranch_scc1 L_mv_127
v_mov_b32 v32, v44
v_mov_b32 v33, v45
v_mov_b32 v34, v46
v_mov_b32 v35, v47
v_mov_b32 v48, v60
v_mov_b32 v49, v61
v_mov_b32 v50, v62
v_mov_b32 v51, v63
L_mv_127:
v_mov_b32 v21, s59
s_waitcnt vmcnt(0)
s_barrier
s_cmp_lg_u32 s40, 0
s_cbranch_scc1 L_done_129
buffer_store_dword v21, v22, s[32:35], s57 offen sc1
L_spin_128:
buffer_load_dword v24, v23, s[32:35], s56 offen sc1
s_waitcnt vmcnt(0)
v_cmp_eq_u32 vcc, v21, v24
s_nop 1
s_and_b32 s49, vcc_lo, 15
s_cmp_eq_u32 s49, 15
s_cbranch_scc1 L_done_129
s_sleep 2
s_branch L_spin_128
L_done_129:
s_barrier
s_add_u32 s49, s43, 1
s_and_b32 s49, s49, 3
s_lshl_b32 s49, s49, 21
s_add_u32 s49, s49, s55
buffer_load_dwordx4 v[64:67], v7, s[32:35], s49 offen sc1
s_add_u32 s49, s43, 2
s_and_b32 s49, s49, 3
s_lshl_b32 s49, s49, 21
s_add_u32 s49, s49, s55
buffer_load_dwordx4 v[68:71], v7, s[32:35], s49 offen sc1
s_add_u32 s49, s43, 3
s_and_b32 s49, s49, 3
s_lshl_b32 s49, s49, 21
s_add_u32 s49, s49, s55
buffer_load_dwordx4 v[72:75], v7, s[32:35], s49 offen sc1
s_mov_b32 s50, 0xffff0000
s_waitcnt vmcnt(2)
v_lshlrev_b32 v24, 16, v64
v_and_b32 v25, s50, v64
v_add_f32 v32, v32, v24
v_add_f32 v33, v33, v25
v_lshlrev_b32 v24, 16, v65
v_and_b32 v25, s50, v65
v_add_f32 v34, v34, v24
v_add_f32 v35, v35, v25
v_lshlrev_b32 v24, 16, v66
v_and_b32 v25, s50, v66
v_add_f32 v48, v48, v24
v_add_f32 v49, v49, v25
v_lshlrev_b32 v24, 16, v67
v_and_b32 v25, s50, v67
v_add_f32 v50, v50, v24
v_add_f32 v51, v51, v25
s_waitcnt vmcnt(1)
v_lshlrev_b32 v24, 16, v68
v_and_b32 v25, s50, v68
v_add_f32 v32, v32, v24
v_add_f32 v33, v33, v25
v_lshlrev_b32 v24, 16, v69
v_and_b32 v25, s50, v69
v_add_f32 v34, v34, v24
v_add_f32 v35, v35, v25
v_lshlrev_b32 v24, 16, v70
v_and_b32 v25, s50, v70
v_add_f32 v48, v48, v24
v_add_f32 v49, v49, v25
v_lshlrev_b32 v24, 16, v71
v_and_b32 v25, s50, v71
v_add_f32 v50, v50, v24
v_add_f32 v51, v51, v25
s_waitcnt vmcnt(0)
v_lshlrev_b32 v24, 16, v72
v_and_b32 v25, s50, v72
v_add_f32 v32, v32, v24
v_add_f32 v33, v33, v25
v_lshlrev_b32 v24, 16, v73
v_and_b32 v25, s50, v73
v_add_f32 v34, v34, v24
v_add_f32 v35, v35, v25
v_lshlrev_b32 v24, 16, v74
v_and_b32 v25, s50, v74
v_add_f32 v48, v48, v24
v_add_f32 v49, v49, v25
v_lshlrev_b32 v24, 16, v75
v_and_b32 v25, s50, v75
v_add_f32 v50, v50, v24
v_add_f32 v51, v51, v25
s_nop 1
v_permlane16_swap_b32 v32, v48
v_permlane16_swap_b32 v33, v49
v_permlane16_swap_b32 v34, v50
v_permlane16_swap_b32 v35, v51
s_nop 1
v_lshlrev_b32 v24, 16, v112
v_and_b32 v25, s50, v112
v_add_f32 v32, v32, v24
v_add_f32 v33, v33, v25
v_lshlrev_b32 v24, 16, v113
v_and_b32 v25, s50, v113
v_add_f32 v34, v34, v24
v_add_f32 v35, v35, v25
v_lshlrev_b32 v24, 16, v114
v_and_b32 v25, s50, v114
v_add_f32 v48, v48, v24
v_add_f32 v49, v49, v25
v_lshlrev_b32 v24, 16, v115
v_and_b32 v25, s50, v115
v_add_f32 v50, v50, v24
v_add_f32 v51, v51, v25
PK 28,32,33
PK 29,34,35
PK 30,48,49
PK 31,50,51
buffer_store_dwordx4 v[28:31], v19, s[36:39], s48 offen
L_k3_end:
s_endpgm
L_all_end:
.section .rodata,"a"
.p2align 6
.amdhsa_kernel parallel_sum__compressed_kv_cla__mixer_gmlp__prompt_kernel
  .amdhsa_next_free_vgpr 256
  .amdhsa_next_free_sgpr 102
  .amdhsa_accum_offset 256
  .amdhsa_group_segment_fixed_size 0
  .amdhsa_kernarg_size 112
  .amdhsa_user_sgpr_count 2
  .amdhsa_user_sgpr_kernarg_segment_ptr 1
  .amdhsa_system_sgpr_workgroup_id_x 1
.end_amdhsa_kernel
```
